```python
import torch

def _softmax(x, axis=-1):
    return torch.softmax(x, dim=axis)

def _gelu(x):
    return torch.nn.functional.gelu(x, approximate='tanh')

def _silu(x):
    return torch.nn.functional.silu(x)

def _sigmoid(x):
    return torch.sigmoid(x)

def _layernorm(x, axis=-1, eps=1e-05):
    m = x.mean(dim=axis, keepdim=True)
    v = x.var(dim=axis, keepdim=True, unbiased=False)
    return (x - m) / torch.sqrt(v + eps)

def _scatter_add(tgt, idx, src, axis=0):
    return tgt.clone().index_add_(axis, idx, src)

def _segment_sum(src, seg, n):
    out = torch.zeros((n,) + src.shape[1:], dtype=src.dtype)
    return out.index_add_(0, seg, src)

def _pad(x, pw):
    flat = tuple((v for pair in reversed(pw) for v in pair))
    return torch.nn.functional.pad(x, flat)
kernel_name = 'concat_heads__memory_aug_recurrent_mem_tr__sliding_block__prompt'

def setup_inputs():

    _w = lambda a: (lambda t: t.to(torch.bfloat16) if t.is_floating_point() else t)(torch.as_tensor(a))

    def _A_setup():
        B, S, Dm = (1, 2048, 1024)
        H, Dh = (32, 128)
        M, seg = (8, 32)
        seg = min(seg, S)
        S = S // seg * seg
        return {'x': _w((lambda *s: torch.randn(*s, dtype=torch.bfloat16) * 0.05)(B, S, Dm)), 'mem0': _w((lambda *s: torch.randn(*s, dtype=torch.bfloat16) * 1.6)(B, M, Dm)), 'Wq': _w((lambda *s: torch.randn(*s, dtype=torch.bfloat16) * 0.8)(Dm, H, Dh) * Dm ** (-0.5)), 'Wk': _w((lambda *s: torch.randn(*s, dtype=torch.bfloat16) * 0.8)(Dm, H, Dh) * Dm ** (-0.5)), 'Wv': _w((lambda *s: torch.randn(*s, dtype=torch.bfloat16) * 1.6)(Dm, H, Dh) * Dm ** (-0.5)), 'Wo': _w((lambda *s: torch.randn(*s, dtype=torch.bfloat16) * 1.6)(H, Dh, Dm) * (H * Dh) ** (-0.5)), 'seg_len': seg}
    _A_in = _A_setup()

    def _B_setup():
        B, S, D = (1, 2048, 1024)
        return {'x': _w((lambda *s: torch.randn(*s, dtype=torch.bfloat16) * 0.2)(B, S, D)), 'wqkv': _w((lambda *s: torch.randn(*s, dtype=torch.bfloat16) * 0.2)(D, 3 * D)), 'wo': _w((lambda *s: torch.randn(*s, dtype=torch.bfloat16) * 0.05)(D, D))}
    _B_in = _B_setup()
    return {'A_x': _A_in['x'], 'A_mem0': _A_in['mem0'], 'A_Wq': _A_in['Wq'], 'A_Wk': _A_in['Wk'], 'A_Wv': _A_in['Wv'], 'A_Wo': _A_in['Wo'], 'A_seg_len': _A_in['seg_len'], 'B_x': _B_in['x'], 'B_wqkv': _B_in['wqkv'], 'B_wo': _B_in['wo']}

def reference(A_x, A_mem0, A_Wq, A_Wk, A_Wv, A_Wo, A_seg_len, B_x, B_wqkv, B_wo):

    def _A_ref(x, mem0, Wq, Wk, Wv, Wo, seg_len):
        B, S, Dm = x.shape
        H, Dh = (Wq.shape[1], Wq.shape[2])
        M = mem0.shape[1]
        scale = Dh ** (-0.5)
        n_seg = S // seg_len
        L = M + seg_len
        idx = torch.arange(L)
        mask = (idx[:, None] < M) | (idx[:, None] >= idx[None, :])
        mem = mem0
        outs = []
        for s in range(n_seg):
            xs = x[:, s * seg_len:(s + 1) * seg_len, :].clone()
            h = torch.concatenate([mem, xs], axis=1)
            q = torch.einsum('btd,dhe->bhte', h, Wq)
            k = torch.einsum('btd,dhe->bhte', h, Wk)
            v = torch.einsum('btd,dhe->bhte', h, Wv)
            scores = torch.einsum('bhqe,bhke->bhqk', q, k) * scale
            scores = torch.where(mask[None, None], scores, -1000000000.0)
            p = _softmax(scores, axis=-1)
            o = torch.einsum('bhqk,bhke->bhqe', p, v)
            o = torch.einsum('bhte,hed->btd', o, Wo)
            mem = o[:, :M, :].clone()
            outs.append(o[:, M:, :])
        return torch.concatenate(outs, axis=1)

    def _B_ref(x, wqkv, wo):
        B, S, D = x.shape
        H = 32
        Dh = D // H
        W = 256
        qkv = (lambda x, *d: x.permute(*d))((x @ wqkv).reshape(B, S, 3, H, Dh), 2, 0, 3, 1, 4)
        q, k, v = (qkv[0], qkv[1], qkv[2])
        scores = torch.einsum('bhqd,bhkd->bhqk', q, k) * Dh ** (-0.5)
        idx = torch.arange(S)
        mask = (idx[:, None] - idx[None, :] >= 0) & (idx[:, None] - idx[None, :] < W)
        scores = torch.where(mask[None, None], scores, -1000000000.0)
        p = _softmax(scores, axis=-1)
        o = torch.einsum('bhqk,bhkd->bhqd', p, v)
        return (lambda x, *d: x.permute(*d))(o, 0, 2, 1, 3).reshape(B, S, D) @ wo
    a = _A_ref(A_x, A_mem0, A_Wq, A_Wk, A_Wv, A_Wo, A_seg_len)
    b = _B_ref(B_x, B_wqkv, B_wo)
    return torch.concatenate([a, b], axis=-1)
```

```asm
; @launch grid=(256,1,1) block=(256,1,1) lds=163840
.amdgcn_target "amdgcn-amd-amdhsa--gfx950"
.text
.globl concat_heads__memory_aug_recurrent_mem_tr__sliding_block__prompt_kernel
.p2align 8
.type concat_heads__memory_aug_recurrent_mem_tr__sliding_block__prompt_kernel,@function
concat_heads__memory_aug_recurrent_mem_tr__sliding_block__prompt_kernel:
s_cmp_ge_u32 s2, 256
s_cbranch_scc1 L_end
s_load_dwordx16 s[64:79], s[0:1], 0
s_load_dwordx8 s[80:87], s[0:1], 64
s_load_dwordx2 s[88:89], s[0:1], 96
s_getreg_b32 s3, hwreg(HW_REG_XCC_ID)
s_and_b32 s3, s3, 7
v_lshrrev_b32 v5, 6, v0
v_and_b32 v1, 63, v0
v_readfirstlane_b32 s20, v5
v_lshlrev_b32 v2, 4, v1
v_lshrrev_b32 v3, 4, v1
v_and_b32 v4, 15, v1
v_mov_b32 v8, -1
v_mov_b32 v9, -1
v_mov_b32 v10, -1
v_mov_b32 v11, -1
s_mov_b32 s28, 400000
s_waitcnt lgkmcnt(0)
s_mov_b32 s4, s88
s_mov_b32 s5, s89
s_mov_b32 s6, 268435456
s_mov_b32 s7, 0x20000
s_mov_b32 s8, s86
s_mov_b32 s9, s87
s_mov_b32 s10, 256
s_mov_b32 s11, 0x20000
s_mov_b32 s12, s68
s_mov_b32 s13, s69
s_mov_b32 s14, 8388608
s_mov_b32 s15, 0x20000
s_mov_b32 s16, s64
s_mov_b32 s17, s65
s_mov_b32 s18, 4194304
s_mov_b32 s19, 0x20000
s_lshr_b32 s24, s2, 3
s_lshl_b32 s25, 1, s24
s_lshl_b32 s21, s3, 5
s_add_u32 s21, s21, s24
s_mov_b32 s22, 0
s_cmp_lg_u32 s20, 3
s_cbranch_scc1 L_reg_done
s_mul_i32 s24, s2, 5120
s_add_u32 s26, s24, 4096
buffer_store_dwordx4 v[8:11], v2, s[4:7], s24 offen offset:0 sc1
buffer_store_dwordx4 v[8:11], v2, s[4:7], s24 offen offset:1024 sc1
buffer_store_dwordx4 v[8:11], v2, s[4:7], s24 offen offset:2048 sc1
buffer_store_dwordx4 v[8:11], v2, s[4:7], s24 offen offset:3072 sc1
buffer_store_dwordx4 v[8:11], v2, s[4:7], s26 offen offset:0 sc1
s_lshl_b32 s24, s2, 10
s_add_u32 s24, s24, 7864320
buffer_store_dwordx4 v[8:11], v2, s[4:7], s24 offen sc1
s_and_b32 s24, s2, 15
s_lshl_b32 s24, s24, 10
s_add_u32 s24, s24, 4194304
s_cmp_lt_u32 s2, 16
s_cselect_b32 s24, s24, 2147483648
buffer_store_dwordx4 v[8:11], v2, s[4:7], s24 offen sc1
s_lshl_b32 s25, 1, s3
v_mov_b32 v12, s25
v_mov_b32 v5, s2
s_waitcnt vmcnt(0)
s_mov_b64 exec, 1
buffer_store_byte v12, v5, s[8:11], 0 offen sc1
s_mov_b64 exec, -1
L_reg_done:
s_branch L_dispatch
L_respec:
s_barrier
s_mov_b32 s30, 0
s_mov_b32 s23, 0
s_mov_b32 s48, 0
s_mov_b32 s49, 0
s_mov_b32 s50, 0
s_mov_b32 s51, 0
s_mov_b32 s52, 0
s_mov_b32 s53, 0
s_mov_b32 s54, 0
s_mov_b32 s55, 0
s_lshl_b32 s27, 0x01010101, s3
L_rs_loop:
v_readlane_b32 s31, v6, s30
s_nop 0
s_and_b32 s24, s31, 16843009
s_bcnt1_i32_b32 s24, s24
s_add_u32 s48, s48, s24
s_and_b32 s24, s31, 33686018
s_bcnt1_i32_b32 s24, s24
s_add_u32 s49, s49, s24
s_and_b32 s24, s31, 67372036
s_bcnt1_i32_b32 s24, s24
s_add_u32 s50, s50, s24
s_and_b32 s24, s31, 134744072
s_bcnt1_i32_b32 s24, s24
s_add_u32 s51, s51, s24
s_and_b32 s24, s31, 269488144
s_bcnt1_i32_b32 s24, s24
s_add_u32 s52, s52, s24
s_and_b32 s24, s31, 538976288
s_bcnt1_i32_b32 s24, s24
s_add_u32 s53, s53, s24
s_and_b32 s24, s31, 1077952576
s_bcnt1_i32_b32 s24, s24
s_add_u32 s54, s54, s24
s_and_b32 s24, s31, 2155905152
s_bcnt1_i32_b32 s24, s24
s_add_u32 s55, s55, s24
s_and_b32 s24, s31, s27
s_lshr_b32 s25, s2, 2
s_cmp_gt_u32 s30, s25
s_cselect_b32 s24, 0, s24
s_and_b32 s26, s2, 3
s_lshl_b32 s26, s26, 3
s_lshl_b32 s26, 1, s26
s_sub_u32 s26, s26, 1
s_cmp_eq_u32 s30, s25
s_cselect_b32 s26, s26, -1
s_and_b32 s24, s24, s26
s_bcnt1_i32_b32 s24, s24
s_add_u32 s23, s23, s24
s_add_u32 s30, s30, 1
s_cmp_lt_u32 s30, 64
s_cbranch_scc1 L_rs_loop
s_mov_b32 s24, 0
s_xor_b32 s25, s48, 32
s_or_b32 s24, s24, s25
s_xor_b32 s25, s49, 32
s_or_b32 s24, s24, s25
s_xor_b32 s25, s50, 32
s_or_b32 s24, s24, s25
s_xor_b32 s25, s51, 32
s_or_b32 s24, s24, s25
s_xor_b32 s25, s52, 32
s_or_b32 s24, s24, s25
s_xor_b32 s25, s53, 32
s_or_b32 s24, s24, s25
s_xor_b32 s25, s54, 32
s_or_b32 s24, s24, s25
s_xor_b32 s25, s55, 32
s_or_b32 s24, s24, s25
s_lshl_b32 s21, s3, 5
s_add_u32 s21, s21, s23
s_cmp_eq_u32 s24, 0
s_cselect_b32 s21, s21, s2
s_cselect_b32 s22, 1, 2
L_dispatch:
v_mov_b32 v8, -1
v_mov_b32 v9, -1
v_mov_b32 v10, -1
v_mov_b32 v11, -1
s_cmp_ge_u32 s21, 128
s_cbranch_scc1 L_grole
s_lshr_b32 s32, s21, 5
s_and_b32 s33, s21, 31
s_lshr_b32 s35, s21, 2
s_and_b32 s36, s21, 3
v_lshrrev_b32 v5, 2, v1
v_and_b32 v6, 3, v1
v_lshlrev_b32 v6, 4, v6
v_lshl_add_u32 v14, v5, 13, v6
v_lshl_add_u32 v15, v5, 11, v6
s_lshl_b32 s41, s20, 15
v_lshrrev_b32 v5, 1, v3
v_lshlrev_b32 v5, 4, v5
v_and_b32 v6, 1, v3
v_lshl_add_u32 v5, v6, 2, v5
v_bfe_u32 v6, v1, 2, 1
v_add_u32 v5, v5, v6
v_bfe_u32 v6, v1, 3, 1
v_lshl_add_u32 v5, v6, 3, v5
v_lshlrev_b32 v5, 6, v5
v_and_b32 v6, 3, v1
v_lshl_add_u32 v5, v6, 3, v5
v_add_u32 v16, s41, v5
s_lshl_b32 s24, s33, 2
s_add_u32 s24, s24, s20
s_lshr_b32 s25, s24, 5
s_mov_b32 s12, s68
s_mov_b32 s13, s69
s_mov_b32 s14, 8388608
s_cmp_eq_u32 s25, 1
s_cselect_b32 s12, s70, s12
s_cselect_b32 s13, s71, s13
s_cmp_eq_u32 s25, 2
s_cselect_b32 s12, s72, s12
s_cselect_b32 s13, s73, s13
s_cmp_eq_u32 s25, 3
s_cselect_b32 s12, s74, s12
s_cselect_b32 s13, s75, s13
s_cselect_b32 s26, 11, 13
s_cselect_b32 s27, 21, 11
s_lshl_b32 s42, s32, s27
s_bfe_u32 s27, s24, 0x10004
s_lshl_b32 s27, s27, 10
s_add_u32 s42, s42, s27
s_and_b32 s27, s24, 15
s_lshl_b32 s27, s27, 6
v_add_u32 v5, s27, v1
v_lshlrev_b32 v5, s26, v5
buffer_load_dword v253, v5, s[12:15], s42 offen offset:384
buffer_load_dword v254, v5, s[12:15], s42 offen offset:448
s_and_b32 s24, s21, 2
s_cmp_lg_u32 s24, 0
s_cbranch_scc1 L_rlBa
s_mov_b32 s12, s68
s_mov_b32 s13, s69
s_mov_b32 s14, 8388608
s_lshl_b32 s42, s20, 21
s_lshl_b32 s24, s21, 6
s_add_u32 s42, s42, s24
s_add_u32 m0, s41, 0
s_nop 0
buffer_load_dwordx4 v14, s[12:15], s42 offen lds
s_add_u32 s42, s42, 131072
s_add_u32 m0, s41, 1024
s_nop 0
buffer_load_dwordx4 v14, s[12:15], s42 offen lds
s_add_u32 s42, s42, 131072
s_add_u32 m0, s41, 2048
s_nop 0
buffer_load_dwordx4 v14, s[12:15], s42 offen lds
s_add_u32 s42, s42, 131072
s_add_u32 m0, s41, 3072
s_nop 0
buffer_load_dwordx4 v14, s[12:15], s42 offen lds
s_add_u32 s42, s42, 131072
s_add_u32 m0, s41, 4096
s_nop 0
buffer_load_dwordx4 v14, s[12:15], s42 offen lds
s_add_u32 s42, s42, 131072
s_add_u32 m0, s41, 5120
s_nop 0
buffer_load_dwordx4 v14, s[12:15], s42 offen lds
s_add_u32 s42, s42, 131072
s_add_u32 m0, s41, 6144
s_nop 0
buffer_load_dwordx4 v14, s[12:15], s42 offen lds
s_add_u32 s42, s42, 131072
s_add_u32 m0, s41, 7168
s_nop 0
buffer_load_dwordx4 v14, s[12:15], s42 offen lds
s_add_u32 s42, s42, 131072
s_add_u32 m0, s41, 8192
s_nop 0
buffer_load_dwordx4 v14, s[12:15], s42 offen lds
s_add_u32 s42, s42, 131072
s_add_u32 m0, s41, 9216
s_nop 0
buffer_load_dwordx4 v14, s[12:15], s42 offen lds
s_add_u32 s42, s42, 131072
s_add_u32 m0, s41, 10240
s_nop 0
buffer_load_dwordx4 v14, s[12:15], s42 offen lds
s_add_u32 s42, s42, 131072
s_add_u32 m0, s41, 11264
s_nop 0
buffer_load_dwordx4 v14, s[12:15], s42 offen lds
s_add_u32 s42, s42, 131072
s_add_u32 m0, s41, 12288
s_nop 0
buffer_load_dwordx4 v14, s[12:15], s42 offen lds
s_add_u32 s42, s42, 131072
s_add_u32 m0, s41, 13312
s_nop 0
buffer_load_dwordx4 v14, s[12:15], s42 offen lds
s_add_u32 s42, s42, 131072
s_add_u32 m0, s41, 14336
s_nop 0
buffer_load_dwordx4 v14, s[12:15], s42 offen lds
s_add_u32 s42, s42, 131072
s_add_u32 m0, s41, 15360
s_nop 0
buffer_load_dwordx4 v14, s[12:15], s42 offen lds
s_add_u32 s42, s42, 131072
s_mov_b32 s12, s70
s_mov_b32 s13, s71
s_mov_b32 s14, 8388608
s_lshl_b32 s42, s20, 21
s_lshl_b32 s24, s21, 6
s_add_u32 s42, s42, s24
s_add_u32 m0, s41, 16384
s_nop 0
buffer_load_dwordx4 v14, s[12:15], s42 offen lds
s_add_u32 s42, s42, 131072
s_add_u32 m0, s41, 17408
s_nop 0
buffer_load_dwordx4 v14, s[12:15], s42 offen lds
s_add_u32 s42, s42, 131072
s_add_u32 m0, s41, 18432
s_nop 0
buffer_load_dwordx4 v14, s[12:15], s42 offen lds
s_add_u32 s42, s42, 131072
s_add_u32 m0, s41, 19456
s_nop 0
buffer_load_dwordx4 v14, s[12:15], s42 offen lds
s_add_u32 s42, s42, 131072
s_add_u32 m0, s41, 20480
s_nop 0
buffer_load_dwordx4 v14, s[12:15], s42 offen lds
s_add_u32 s42, s42, 131072
s_add_u32 m0, s41, 21504
s_nop 0
buffer_load_dwordx4 v14, s[12:15], s42 offen lds
s_add_u32 s42, s42, 131072
s_add_u32 m0, s41, 22528
s_nop 0
buffer_load_dwordx4 v14, s[12:15], s42 offen lds
s_add_u32 s42, s42, 131072
s_add_u32 m0, s41, 23552
s_nop 0
buffer_load_dwordx4 v14, s[12:15], s42 offen lds
s_add_u32 s42, s42, 131072
s_add_u32 m0, s41, 24576
s_nop 0
buffer_load_dwordx4 v14, s[12:15], s42 offen lds
s_add_u32 s42, s42, 131072
s_add_u32 m0, s41, 25600
s_nop 0
buffer_load_dwordx4 v14, s[12:15], s42 offen lds
s_add_u32 s42, s42, 131072
s_add_u32 m0, s41, 26624
s_nop 0
buffer_load_dwordx4 v14, s[12:15], s42 offen lds
s_add_u32 s42, s42, 131072
s_add_u32 m0, s41, 27648
s_nop 0
buffer_load_dwordx4 v14, s[12:15], s42 offen lds
s_add_u32 s42, s42, 131072
s_add_u32 m0, s41, 28672
s_nop 0
buffer_load_dwordx4 v14, s[12:15], s42 offen lds
s_add_u32 s42, s42, 131072
s_add_u32 m0, s41, 29696
s_nop 0
buffer_load_dwordx4 v14, s[12:15], s42 offen lds
s_add_u32 s42, s42, 131072
s_add_u32 m0, s41, 30720
s_nop 0
buffer_load_dwordx4 v14, s[12:15], s42 offen lds
s_add_u32 s42, s42, 131072
s_add_u32 m0, s41, 31744
s_nop 0
buffer_load_dwordx4 v14, s[12:15], s42 offen lds
s_add_u32 s42, s42, 131072
s_branch L_rlDa
L_rlBa:
s_mov_b32 s12, s72
s_mov_b32 s13, s73
s_mov_b32 s14, 8388608
s_lshl_b32 s42, s20, 21
s_lshl_b32 s24, s21, 6
s_add_u32 s42, s42, s24
s_xor_b32 s42, s42, 128
s_add_u32 m0, s41, 0
s_nop 0
buffer_load_dwordx4 v14, s[12:15], s42 offen lds
s_add_u32 s42, s42, 131072
s_add_u32 m0, s41, 1024
s_nop 0
buffer_load_dwordx4 v14, s[12:15], s42 offen lds
s_add_u32 s42, s42, 131072
s_add_u32 m0, s41, 2048
s_nop 0
buffer_load_dwordx4 v14, s[12:15], s42 offen lds
s_add_u32 s42, s42, 131072
s_add_u32 m0, s41, 3072
s_nop 0
buffer_load_dwordx4 v14, s[12:15], s42 offen lds
s_add_u32 s42, s42, 131072
s_add_u32 m0, s41, 4096
s_nop 0
buffer_load_dwordx4 v14, s[12:15], s42 offen lds
s_add_u32 s42, s42, 131072
s_add_u32 m0, s41, 5120
s_nop 0
buffer_load_dwordx4 v14, s[12:15], s42 offen lds
s_add_u32 s42, s42, 131072
s_add_u32 m0, s41, 6144
s_nop 0
buffer_load_dwordx4 v14, s[12:15], s42 offen lds
s_add_u32 s42, s42, 131072
s_add_u32 m0, s41, 7168
s_nop 0
buffer_load_dwordx4 v14, s[12:15], s42 offen lds
s_add_u32 s42, s42, 131072
s_add_u32 m0, s41, 8192
s_nop 0
buffer_load_dwordx4 v14, s[12:15], s42 offen lds
s_add_u32 s42, s42, 131072
s_add_u32 m0, s41, 9216
s_nop 0
buffer_load_dwordx4 v14, s[12:15], s42 offen lds
s_add_u32 s42, s42, 131072
s_add_u32 m0, s41, 10240
s_nop 0
buffer_load_dwordx4 v14, s[12:15], s42 offen lds
s_add_u32 s42, s42, 131072
s_add_u32 m0, s41, 11264
s_nop 0
buffer_load_dwordx4 v14, s[12:15], s42 offen lds
s_add_u32 s42, s42, 131072
s_add_u32 m0, s41, 12288
s_nop 0
buffer_load_dwordx4 v14, s[12:15], s42 offen lds
s_add_u32 s42, s42, 131072
s_add_u32 m0, s41, 13312
s_nop 0
buffer_load_dwordx4 v14, s[12:15], s42 offen lds
s_add_u32 s42, s42, 131072
s_add_u32 m0, s41, 14336
s_nop 0
buffer_load_dwordx4 v14, s[12:15], s42 offen lds
s_add_u32 s42, s42, 131072
s_add_u32 m0, s41, 15360
s_nop 0
buffer_load_dwordx4 v14, s[12:15], s42 offen lds
s_add_u32 s42, s42, 131072
s_mov_b32 s12, s74
s_mov_b32 s13, s75
s_mov_b32 s14, 8388608
s_lshl_b32 s42, s32, 21
s_lshl_b32 s24, s20, 19
s_add_u32 s42, s42, s24
s_lshl_b32 s24, s33, 6
s_add_u32 s42, s42, s24
s_xor_b32 s42, s42, 128
s_add_u32 m0, s41, 16384
s_nop 0
buffer_load_dwordx4 v15, s[12:15], s42 offen lds
s_add_u32 s42, s42, 32768
s_add_u32 m0, s41, 17408
s_nop 0
buffer_load_dwordx4 v15, s[12:15], s42 offen lds
s_add_u32 s42, s42, 32768
s_add_u32 m0, s41, 18432
s_nop 0
buffer_load_dwordx4 v15, s[12:15], s42 offen lds
s_add_u32 s42, s42, 32768
s_add_u32 m0, s41, 19456
s_nop 0
buffer_load_dwordx4 v15, s[12:15], s42 offen lds
s_add_u32 s42, s42, 32768
s_add_u32 m0, s41, 20480
s_nop 0
buffer_load_dwordx4 v15, s[12:15], s42 offen lds
s_add_u32 s42, s42, 32768
s_add_u32 m0, s41, 21504
s_nop 0
buffer_load_dwordx4 v15, s[12:15], s42 offen lds
s_add_u32 s42, s42, 32768
s_add_u32 m0, s41, 22528
s_nop 0
buffer_load_dwordx4 v15, s[12:15], s42 offen lds
s_add_u32 s42, s42, 32768
s_add_u32 m0, s41, 23552
s_nop 0
buffer_load_dwordx4 v15, s[12:15], s42 offen lds
s_add_u32 s42, s42, 32768
s_add_u32 m0, s41, 24576
s_nop 0
buffer_load_dwordx4 v15, s[12:15], s42 offen lds
s_add_u32 s42, s42, 32768
s_add_u32 m0, s41, 25600
s_nop 0
buffer_load_dwordx4 v15, s[12:15], s42 offen lds
s_add_u32 s42, s42, 32768
s_add_u32 m0, s41, 26624
s_nop 0
buffer_load_dwordx4 v15, s[12:15], s42 offen lds
s_add_u32 s42, s42, 32768
s_add_u32 m0, s41, 27648
s_nop 0
buffer_load_dwordx4 v15, s[12:15], s42 offen lds
s_add_u32 s42, s42, 32768
s_add_u32 m0, s41, 28672
s_nop 0
buffer_load_dwordx4 v15, s[12:15], s42 offen lds
s_add_u32 s42, s42, 32768
s_add_u32 m0, s41, 29696
s_nop 0
buffer_load_dwordx4 v15, s[12:15], s42 offen lds
s_add_u32 s42, s42, 32768
s_add_u32 m0, s41, 30720
s_nop 0
buffer_load_dwordx4 v15, s[12:15], s42 offen lds
s_add_u32 s42, s42, 32768
s_add_u32 m0, s41, 31744
s_nop 0
buffer_load_dwordx4 v15, s[12:15], s42 offen lds
s_add_u32 s42, s42, 32768
L_rlDa:
v_mov_b32 v56, 2147483648
s_xor_b32 s24, s21, 32
s_lshr_b32 s26, s24, 3
s_lshl_b32 s26, s26, 14
s_and_b32 s24, s24, 7
s_lshl_b32 s24, s24, 10
s_add_u32 s24, s24, s26
s_add_u32 s24, s24, 4194304
v_add_u32 v17, s24, v2
s_xor_b32 s24, s21, 64
s_lshr_b32 s26, s24, 3
s_lshl_b32 s26, s26, 14
s_and_b32 s24, s24, 7
s_lshl_b32 s24, s24, 10
s_add_u32 s24, s24, s26
s_add_u32 s24, s24, 4194304
v_add_u32 v18, s24, v2
s_xor_b32 s24, s21, 96
s_lshr_b32 s26, s24, 3
s_lshl_b32 s26, s26, 14
s_and_b32 s24, s24, 7
s_lshl_b32 s24, s24, 10
s_add_u32 s24, s24, s26
s_add_u32 s24, s24, 4194304
v_add_u32 v19, s24, v2
s_lshr_b32 s26, s21, 3
s_lshl_b32 s26, s26, 14
s_and_b32 s25, s21, 7
s_lshl_b32 s25, s25, 10
s_add_u32 s25, s25, s26
s_add_u32 s25, s25, 4194304
v_add_u32 v20, s25, v2
s_xor_b32 s34, s21, 2
s_lshl_b32 s24, s34, 9
s_add_u32 s25, s24, 0
v_lshlrev_b32 v5, 3, v1
v_add_u32 v21, s25, v5
v_and_b32 v5, 31, v1
v_lshlrev_b32 v5, 4, v5
v_lshrrev_b32 v6, 5, v1
v_lshl_add_u32 v5, v6, 16, v5
s_add_u32 s25, s24, 0
v_add_u32 v41, s25, v5
v_lshl_add_u32 v5, v3, 3, v4
v_lshlrev_b32 v5, 4, v5
s_add_u32 s25, s24, 65536
v_add_u32 v5, s25, v5
v_cmp_gt_u32 vcc, 8, v4
s_nop 1
v_cndmask_b32 v34, v56, v5, vcc
s_lshl_b32 s24, s32, 14
s_lshl_b32 s25, s20, 12
s_add_u32 s24, s24, s25
s_add_u32 s24, s24, 0
v_add_u32 v22, s24, v2
v_add_u32 v23, 65536, v22
s_mul_i32 s24, s21, 1280
s_add_u32 s24, s24, 131072
v_add_u32 v5, s24, v2
v_cndmask_b32 v24, v56, v5, vcc
v_mov_b32 v42, v5
v_cmp_gt_u32 vcc, 16, v1
v_add_u32 v6, 1024, v5
s_nop 0
v_cndmask_b32 v43, v56, v6, vcc
v_lshl_add_u32 v5, v3, 3, v4
v_lshlrev_b32 v5, 4, v5
s_add_u32 s25, s24, 768
v_add_u32 v5, s25, v5
v_and_b32 v6, 0x28, v1
v_cmp_eq_u32 vcc, 0x20, v6
s_nop 1
v_cndmask_b32 v25, v56, v5, vcc
v_lshrrev_b32 v5, 3, v1
v_lshrrev_b32 v6, 2, v5
v_lshlrev_b32 v6, 7, v6
v_and_b32 v5, 3, v5
v_lshl_add_u32 v6, v5, 2, v6
v_and_b32 v5, 7, v1
v_lshl_add_u32 v6, v5, 4, v6
v_add_u32 v6, 1024, v6
s_xor_b32 s24, s21, 0
s_mul_i32 s24, s24, 1280
s_add_u32 s24, s24, 131072
v_add_u32 v26, s24, v2
v_add_u32 v30, s24, v6
s_xor_b32 s24, s21, 1
s_mul_i32 s24, s24, 1280
s_add_u32 s24, s24, 131072
v_add_u32 v27, s24, v2
v_add_u32 v31, s24, v6
s_xor_b32 s24, s21, 2
s_mul_i32 s24, s24, 1280
s_add_u32 s24, s24, 131072
v_add_u32 v28, s24, v2
v_add_u32 v32, s24, v6
s_xor_b32 s24, s21, 3
s_mul_i32 s24, s24, 1280
s_add_u32 s24, s24, 131072
v_add_u32 v29, s24, v2
v_add_u32 v33, s24, v6
v_lshrrev_b32 v5, 5, v1
v_lshlrev_b32 v5, 8, v5
v_and_b32 v6, 7, v1
v_lshl_add_u32 v5, v6, 4, v5
v_bfe_u32 v6, v1, 3, 2
v_lshl_add_u32 v5, v6, 2, v5
v_add_u32 v30, 24064, v5
s_lshl_b32 s24, s35, 14
s_lshl_b32 s25, s36, 11
s_add_u32 s24, s24, s25
s_add_u32 s25, s24, 71303168
v_add_u32 v35, s25, v2
s_xor_b32 s24, s24, 4096
s_add_u32 s25, s24, 104857600
v_add_u32 v36, s25, v2
s_lshl_b32 s24, s35, 6
s_lshl_b32 s25, s36, 2
s_add_u32 s24, s24, s25
v_and_b32 v5, 1, v1
v_mul_u32_u24 v5, 2056, v5
v_xor_b32 v37, s24, v5
s_lshr_b32 s26, s21, 3
s_lshl_b32 s26, s26, 14
s_and_b32 s24, s21, 7
s_lshl_b32 s24, s24, 10
s_add_u32 s24, s24, s26
s_add_u32 s24, s24, 4456448
v_lshl_add_u32 v5, v3, 3, v4
v_lshlrev_b32 v5, 4, v5
s_sub_u32 s25, s24, 128
v_add_u32 v5, s25, v5
v_cmp_lt_u32 vcc, 7, v4
v_add_u32 v6, 640, v5
s_nop 0
v_cndmask_b32 v38, v6, v5, vcc
s_not_b64 s[92:93], vcc
v_lshlrev_b32 v39, 2, v1
v_add_u32 v39, 22528, v39
v_lshl_add_u32 v5, v3, 3, v4
v_lshlrev_b32 v5, 4, v5
v_add_u32 v44, 22528, v5
s_lshl_b32 s24, s35, 7
s_lshl_b32 s25, s36, 2
s_add_u32 s24, s24, s25
s_add_u32 s24, s24, 4194304
v_mov_b32 v5, s24
v_cmp_eq_u32 s[30:31], 0, v1
s_nop 1
v_cndmask_b32 v45, v56, v5, s[30:31]
v_mov_b32 v5, 0x4444
v_mov_b32 v6, 0xeeee
v_cndmask_b32 v54, v5, v6, vcc
v_and_b32 v5, 1, v3
v_mul_u32_u24 v5, 576, v5
v_lshrrev_b32 v6, 1, v3
v_lshl_add_u32 v7, v6, 4, v4
v_lshl_add_u32 v5, v7, 2, v5
s_mul_i32 s24, s20, 2304
v_add_u32 v47, s24, v5
v_add_u32 v48, 1152, v47
s_mul_i32 s24, s20, 1152
s_add_u32 s24, s24, 13312
v_add_u32 v52, s24, v5
v_and_b32 v5, 1, v3
v_lshlrev_b32 v5, 4, v5
v_lshl_add_u32 v5, v7, 5, v5
s_lshl_b32 s24, s20, 10
s_add_u32 s24, s24, 9216
v_add_u32 v50, s24, v5
v_mul_u32_u24 v5, 144, v4
v_lshl_add_u32 v49, v3, 5, v5
v_lshrrev_b32 v5, 2, v4
v_lshlrev_b32 v5, 3, v5
v_and_b32 v6, 3, v4
v_add_u32 v5, v5, v6
v_lshlrev_b32 v5, 5, v5
v_lshl_add_u32 v5, v3, 3, v5
v_add_u32 v51, 9216, v5
v_lshrrev_b32 v5, 1, v4
v_mul_u32_u24 v5, 144, v5
v_lshl_add_u32 v5, v3, 5, v5
v_and_b32 v6, 1, v4
v_lshl_add_u32 v5, v6, 4, v5
v_add_u32 v53, 13312, v5
v_mov_b32 v212, 0x3f803f80
v_mov_b32 v213, 0x3f803f80
v_mov_b32 v214, 0x3f803f80
v_mov_b32 v215, 0x3f803f80
v_mov_b32 v221, 0
v_mov_b32 v205, 0
v_mov_b32 v209, 0
v_mov_b32 v222, 0
v_mov_b32 v206, 0
v_mov_b32 v210, 0
v_mov_b32 v223, 0
v_mov_b32 v207, 0
v_mov_b32 v211, 0
s_mov_b32 s37, 65536
s_mov_b32 s62, 655360
s_mov_b32 s38, 0
s_mov_b32 s39, 0
s_mov_b32 s40, 0
s_mov_b32 s43, 0
s_and_b32 s24, s21, 2
s_cmp_lg_u32 s24, 0
s_cbranch_scc1 L_rlBb
s_waitcnt vmcnt(16)
ds_read_b64_tr_b16 a[0:1], v16 offset:0
ds_read_b64_tr_b16 a[2:3], v16 offset:128
ds_read_b64_tr_b16 a[4:5], v16 offset:2048
ds_read_b64_tr_b16 a[6:7], v16 offset:2176
ds_read_b64_tr_b16 a[8:9], v16 offset:4096
ds_read_b64_tr_b16 a[10:11], v16 offset:4224
ds_read_b64_tr_b16 a[12:13], v16 offset:6144
ds_read_b64_tr_b16 a[14:15], v16 offset:6272
ds_read_b64_tr_b16 a[16:17], v16 offset:8192
ds_read_b64_tr_b16 a[18:19], v16 offset:8320
ds_read_b64_tr_b16 a[20:21], v16 offset:10240
ds_read_b64_tr_b16 a[22:23], v16 offset:10368
ds_read_b64_tr_b16 a[24:25], v16 offset:12288
ds_read_b64_tr_b16 a[26:27], v16 offset:12416
ds_read_b64_tr_b16 a[28:29], v16 offset:14336
ds_read_b64_tr_b16 a[30:31], v16 offset:14464
ds_read_b64_tr_b16 a[32:33], v16 offset:32
ds_read_b64_tr_b16 a[34:35], v16 offset:160
ds_read_b64_tr_b16 a[36:37], v16 offset:2080
ds_read_b64_tr_b16 a[38:39], v16 offset:2208
ds_read_b64_tr_b16 a[40:41], v16 offset:4128
ds_read_b64_tr_b16 a[42:43], v16 offset:4256
ds_read_b64_tr_b16 a[44:45], v16 offset:6176
ds_read_b64_tr_b16 a[46:47], v16 offset:6304
ds_read_b64_tr_b16 a[48:49], v16 offset:8224
ds_read_b64_tr_b16 a[50:51], v16 offset:8352
ds_read_b64_tr_b16 a[52:53], v16 offset:10272
ds_read_b64_tr_b16 a[54:55], v16 offset:10400
ds_read_b64_tr_b16 a[56:57], v16 offset:12320
ds_read_b64_tr_b16 a[58:59], v16 offset:12448
ds_read_b64_tr_b16 a[60:61], v16 offset:14368
ds_read_b64_tr_b16 a[62:63], v16 offset:14496
s_waitcnt lgkmcnt(0)
s_mov_b32 s12, s72
s_mov_b32 s13, s73
s_mov_b32 s14, 8388608
s_lshl_b32 s42, s20, 21
s_lshl_b32 s24, s21, 6
s_add_u32 s42, s42, s24
s_xor_b32 s42, s42, 128
s_add_u32 m0, s41, 0
s_nop 0
buffer_load_dwordx4 v14, s[12:15], s42 offen lds
s_add_u32 s42, s42, 131072
s_add_u32 m0, s41, 1024
s_nop 0
buffer_load_dwordx4 v14, s[12:15], s42 offen lds
s_add_u32 s42, s42, 131072
s_add_u32 m0, s41, 2048
s_nop 0
buffer_load_dwordx4 v14, s[12:15], s42 offen lds
s_add_u32 s42, s42, 131072
s_add_u32 m0, s41, 3072
s_nop 0
buffer_load_dwordx4 v14, s[12:15], s42 offen lds
s_add_u32 s42, s42, 131072
s_add_u32 m0, s41, 4096
s_nop 0
buffer_load_dwordx4 v14, s[12:15], s42 offen lds
s_add_u32 s42, s42, 131072
s_add_u32 m0, s41, 5120
s_nop 0
buffer_load_dwordx4 v14, s[12:15], s42 offen lds
s_add_u32 s42, s42, 131072
s_add_u32 m0, s41, 6144
s_nop 0
buffer_load_dwordx4 v14, s[12:15], s42 offen lds
s_add_u32 s42, s42, 131072
s_add_u32 m0, s41, 7168
s_nop 0
buffer_load_dwordx4 v14, s[12:15], s42 offen lds
s_add_u32 s42, s42, 131072
s_add_u32 m0, s41, 8192
s_nop 0
buffer_load_dwordx4 v14, s[12:15], s42 offen lds
s_add_u32 s42, s42, 131072
s_add_u32 m0, s41, 9216
s_nop 0
buffer_load_dwordx4 v14, s[12:15], s42 offen lds
s_add_u32 s42, s42, 131072
s_add_u32 m0, s41, 10240
s_nop 0
buffer_load_dwordx4 v14, s[12:15], s42 offen lds
s_add_u32 s42, s42, 131072
s_add_u32 m0, s41, 11264
s_nop 0
buffer_load_dwordx4 v14, s[12:15], s42 offen lds
s_add_u32 s42, s42, 131072
s_add_u32 m0, s41, 12288
s_nop 0
buffer_load_dwordx4 v14, s[12:15], s42 offen lds
s_add_u32 s42, s42, 131072
s_add_u32 m0, s41, 13312
s_nop 0
buffer_load_dwordx4 v14, s[12:15], s42 offen lds
s_add_u32 s42, s42, 131072
s_add_u32 m0, s41, 14336
s_nop 0
buffer_load_dwordx4 v14, s[12:15], s42 offen lds
s_add_u32 s42, s42, 131072
s_add_u32 m0, s41, 15360
s_nop 0
buffer_load_dwordx4 v14, s[12:15], s42 offen lds
s_add_u32 s42, s42, 131072
s_waitcnt vmcnt(16)
ds_read_b64_tr_b16 a[64:65], v16 offset:16384
ds_read_b64_tr_b16 a[66:67], v16 offset:16512
ds_read_b64_tr_b16 a[68:69], v16 offset:18432
ds_read_b64_tr_b16 a[70:71], v16 offset:18560
ds_read_b64_tr_b16 a[72:73], v16 offset:20480
ds_read_b64_tr_b16 a[74:75], v16 offset:20608
ds_read_b64_tr_b16 a[76:77], v16 offset:22528
ds_read_b64_tr_b16 a[78:79], v16 offset:22656
ds_read_b64_tr_b16 a[80:81], v16 offset:24576
ds_read_b64_tr_b16 a[82:83], v16 offset:24704
ds_read_b64_tr_b16 a[84:85], v16 offset:26624
ds_read_b64_tr_b16 a[86:87], v16 offset:26752
ds_read_b64_tr_b16 a[88:89], v16 offset:28672
ds_read_b64_tr_b16 a[90:91], v16 offset:28800
ds_read_b64_tr_b16 a[92:93], v16 offset:30720
ds_read_b64_tr_b16 a[94:95], v16 offset:30848
ds_read_b64_tr_b16 a[96:97], v16 offset:16416
ds_read_b64_tr_b16 a[98:99], v16 offset:16544
ds_read_b64_tr_b16 a[100:101], v16 offset:18464
ds_read_b64_tr_b16 a[102:103], v16 offset:18592
ds_read_b64_tr_b16 a[104:105], v16 offset:20512
ds_read_b64_tr_b16 a[106:107], v16 offset:20640
ds_read_b64_tr_b16 a[108:109], v16 offset:22560
ds_read_b64_tr_b16 a[110:111], v16 offset:22688
ds_read_b64_tr_b16 a[112:113], v16 offset:24608
ds_read_b64_tr_b16 a[114:115], v16 offset:24736
ds_read_b64_tr_b16 a[116:117], v16 offset:26656
ds_read_b64_tr_b16 a[118:119], v16 offset:26784
ds_read_b64_tr_b16 a[120:121], v16 offset:28704
ds_read_b64_tr_b16 a[122:123], v16 offset:28832
ds_read_b64_tr_b16 a[124:125], v16 offset:30752
ds_read_b64_tr_b16 a[126:127], v16 offset:30880
s_waitcnt lgkmcnt(0)
v_lshlrev_b32 v5, 2, v1
buffer_load_dword v250, v5, s[8:11], 0 offen sc1
s_mov_b32 s12, s74
s_mov_b32 s13, s75
s_mov_b32 s14, 8388608
s_lshl_b32 s42, s32, 21
s_lshl_b32 s24, s20, 19
s_add_u32 s42, s42, s24
s_lshl_b32 s24, s33, 6
s_add_u32 s42, s42, s24
s_xor_b32 s42, s42, 128
s_add_u32 m0, s41, 16384
s_nop 0
buffer_load_dwordx4 v15, s[12:15], s42 offen lds
s_add_u32 s42, s42, 32768
s_add_u32 m0, s41, 17408
s_nop 0
buffer_load_dwordx4 v15, s[12:15], s42 offen lds
s_add_u32 s42, s42, 32768
s_add_u32 m0, s41, 18432
s_nop 0
buffer_load_dwordx4 v15, s[12:15], s42 offen lds
s_add_u32 s42, s42, 32768
s_add_u32 m0, s41, 19456
s_nop 0
buffer_load_dwordx4 v15, s[12:15], s42 offen lds
s_add_u32 s42, s42, 32768
s_add_u32 m0, s41, 20480
s_nop 0
buffer_load_dwordx4 v15, s[12:15], s42 offen lds
s_add_u32 s42, s42, 32768
s_add_u32 m0, s41, 21504
s_nop 0
buffer_load_dwordx4 v15, s[12:15], s42 offen lds
s_add_u32 s42, s42, 32768
s_add_u32 m0, s41, 22528
s_nop 0
buffer_load_dwordx4 v15, s[12:15], s42 offen lds
s_add_u32 s42, s42, 32768
s_add_u32 m0, s41, 23552
s_nop 0
buffer_load_dwordx4 v15, s[12:15], s42 offen lds
s_add_u32 s42, s42, 32768
s_add_u32 m0, s41, 24576
s_nop 0
buffer_load_dwordx4 v15, s[12:15], s42 offen lds
s_add_u32 s42, s42, 32768
s_add_u32 m0, s41, 25600
s_nop 0
buffer_load_dwordx4 v15, s[12:15], s42 offen lds
s_add_u32 s42, s42, 32768
s_add_u32 m0, s41, 26624
s_nop 0
buffer_load_dwordx4 v15, s[12:15], s42 offen lds
s_add_u32 s42, s42, 32768
s_add_u32 m0, s41, 27648
s_nop 0
buffer_load_dwordx4 v15, s[12:15], s42 offen lds
s_add_u32 s42, s42, 32768
s_add_u32 m0, s41, 28672
s_nop 0
buffer_load_dwordx4 v15, s[12:15], s42 offen lds
s_add_u32 s42, s42, 32768
s_add_u32 m0, s41, 29696
s_nop 0
buffer_load_dwordx4 v15, s[12:15], s42 offen lds
s_add_u32 s42, s42, 32768
s_add_u32 m0, s41, 30720
s_nop 0
buffer_load_dwordx4 v15, s[12:15], s42 offen lds
s_add_u32 s42, s42, 32768
s_add_u32 m0, s41, 31744
s_nop 0
buffer_load_dwordx4 v15, s[12:15], s42 offen lds
s_add_u32 s42, s42, 32768
s_waitcnt vmcnt(16)
v_and_b32 v5, 31, v1
v_lshlrev_b32 v5, 2, v5
v_add_u32 v5, 49664, v5
buffer_load_dword v251, v5, s[4:7], 0 offen sc1
v_mov_b32 v252, -1
s_mov_b32 s16, s66
s_mov_b32 s17, s67
s_mov_b32 s18, 16384
s_mov_b32 s19, 0x20000
v_lshrrev_b32 v5, 1, v4
v_lshlrev_b32 v5, 11, v5
v_lshl_add_u32 v5, v3, 4, v5
v_and_b32 v6, 1, v4
v_lshl_add_u32 v5, v6, 3, v5
s_lshl_b32 s24, s33, 6
s_xor_b32 s24, s24, 128
buffer_load_dwordx2 v[232:233], v5, s[16:19], s24 offen
s_mul_i32 s24, s20, 294912
s_add_u32 s24, s24, 65536
buffer_load_dwordx4 v[120:123], v41, s[4:7], s24 offen sc1
buffer_load_dwordx4 v[124:127], v42, s[4:7], s24 offen sc1
buffer_load_dwordx4 v[128:131], v43, s[4:7], s24 offen sc1
ds_read_b64_tr_b16 a[128:129], v16 offset:0
ds_read_b64_tr_b16 a[130:131], v16 offset:128
ds_read_b64_tr_b16 a[132:133], v16 offset:2048
ds_read_b64_tr_b16 a[134:135], v16 offset:2176
ds_read_b64_tr_b16 a[136:137], v16 offset:4096
ds_read_b64_tr_b16 a[138:139], v16 offset:4224
ds_read_b64_tr_b16 a[140:141], v16 offset:6144
ds_read_b64_tr_b16 a[142:143], v16 offset:6272
ds_read_b64_tr_b16 a[144:145], v16 offset:8192
ds_read_b64_tr_b16 a[146:147], v16 offset:8320
ds_read_b64_tr_b16 a[148:149], v16 offset:10240
ds_read_b64_tr_b16 a[150:151], v16 offset:10368
ds_read_b64_tr_b16 a[152:153], v16 offset:12288
ds_read_b64_tr_b16 a[154:155], v16 offset:12416
ds_read_b64_tr_b16 a[156:157], v16 offset:14336
ds_read_b64_tr_b16 a[158:159], v16 offset:14464
ds_read_b64_tr_b16 a[160:161], v16 offset:32
ds_read_b64_tr_b16 a[162:163], v16 offset:160
ds_read_b64_tr_b16 a[164:165], v16 offset:2080
ds_read_b64_tr_b16 a[166:167], v16 offset:2208
ds_read_b64_tr_b16 a[168:169], v16 offset:4128
ds_read_b64_tr_b16 a[170:171], v16 offset:4256
ds_read_b64_tr_b16 a[172:173], v16 offset:6176
ds_read_b64_tr_b16 a[174:175], v16 offset:6304
ds_read_b64_tr_b16 a[176:177], v16 offset:8224
ds_read_b64_tr_b16 a[178:179], v16 offset:8352
ds_read_b64_tr_b16 a[180:181], v16 offset:10272
ds_read_b64_tr_b16 a[182:183], v16 offset:10400
ds_read_b64_tr_b16 a[184:185], v16 offset:12320
ds_read_b64_tr_b16 a[186:187], v16 offset:12448
ds_read_b64_tr_b16 a[188:189], v16 offset:14368
ds_read_b64_tr_b16 a[190:191], v16 offset:14496
s_waitcnt lgkmcnt(0)
s_waitcnt vmcnt(0)
ds_read_b64_tr_b16 a[192:193], v16 offset:16384
ds_read_b64_tr_b16 a[194:195], v16 offset:16512
ds_read_b64_tr_b16 a[196:197], v16 offset:18432
ds_read_b64_tr_b16 a[198:199], v16 offset:18560
ds_read_b64_tr_b16 a[200:201], v16 offset:20480
ds_read_b64_tr_b16 a[202:203], v16 offset:20608
ds_read_b64_tr_b16 a[204:205], v16 offset:22528
ds_read_b64_tr_b16 a[206:207], v16 offset:22656
ds_read_b64_tr_b16 a[208:209], v16 offset:24576
ds_read_b64_tr_b16 a[210:211], v16 offset:24704
ds_read_b64_tr_b16 a[212:213], v16 offset:26624
ds_read_b64_tr_b16 a[214:215], v16 offset:26752
ds_read_b64_tr_b16 a[216:217], v16 offset:28672
ds_read_b64_tr_b16 a[218:219], v16 offset:28800
ds_read_b64_tr_b16 a[220:221], v16 offset:30720
ds_read_b64_tr_b16 a[222:223], v16 offset:30848
ds_read_b64_tr_b16 a[224:225], v16 offset:16416
ds_read_b64_tr_b16 a[226:227], v16 offset:16544
ds_read_b64_tr_b16 a[228:229], v16 offset:18464
ds_read_b64_tr_b16 a[230:231], v16 offset:18592
ds_read_b64_tr_b16 a[232:233], v16 offset:20512
ds_read_b64_tr_b16 a[234:235], v16 offset:20640
ds_read_b64_tr_b16 a[236:237], v16 offset:22560
ds_read_b64_tr_b16 a[238:239], v16 offset:22688
ds_read_b64_tr_b16 a[240:241], v16 offset:24608
ds_read_b64_tr_b16 a[242:243], v16 offset:24736
ds_read_b64_tr_b16 a[244:245], v16 offset:26656
ds_read_b64_tr_b16 a[246:247], v16 offset:26784
ds_read_b64_tr_b16 a[248:249], v16 offset:28704
ds_read_b64_tr_b16 a[250:251], v16 offset:28832
ds_read_b64_tr_b16 a[252:253], v16 offset:30752
ds_read_b64_tr_b16 a[254:255], v16 offset:30880
s_waitcnt lgkmcnt(0)
s_branch L_rlDb
L_rlBb:
s_waitcnt vmcnt(16)
ds_read_b64_tr_b16 a[128:129], v16 offset:0
ds_read_b64_tr_b16 a[130:131], v16 offset:128
ds_read_b64_tr_b16 a[132:133], v16 offset:2048
ds_read_b64_tr_b16 a[134:135], v16 offset:2176
ds_read_b64_tr_b16 a[136:137], v16 offset:4096
ds_read_b64_tr_b16 a[138:139], v16 offset:4224
ds_read_b64_tr_b16 a[140:141], v16 offset:6144
ds_read_b64_tr_b16 a[142:143], v16 offset:6272
ds_read_b64_tr_b16 a[144:145], v16 offset:8192
ds_read_b64_tr_b16 a[146:147], v16 offset:8320
ds_read_b64_tr_b16 a[148:149], v16 offset:10240
ds_read_b64_tr_b16 a[150:151], v16 offset:10368
ds_read_b64_tr_b16 a[152:153], v16 offset:12288
ds_read_b64_tr_b16 a[154:155], v16 offset:12416
ds_read_b64_tr_b16 a[156:157], v16 offset:14336
ds_read_b64_tr_b16 a[158:159], v16 offset:14464
ds_read_b64_tr_b16 a[160:161], v16 offset:32
ds_read_b64_tr_b16 a[162:163], v16 offset:160
ds_read_b64_tr_b16 a[164:165], v16 offset:2080
ds_read_b64_tr_b16 a[166:167], v16 offset:2208
ds_read_b64_tr_b16 a[168:169], v16 offset:4128
ds_read_b64_tr_b16 a[170:171], v16 offset:4256
ds_read_b64_tr_b16 a[172:173], v16 offset:6176
ds_read_b64_tr_b16 a[174:175], v16 offset:6304
ds_read_b64_tr_b16 a[176:177], v16 offset:8224
ds_read_b64_tr_b16 a[178:179], v16 offset:8352
ds_read_b64_tr_b16 a[180:181], v16 offset:10272
ds_read_b64_tr_b16 a[182:183], v16 offset:10400
ds_read_b64_tr_b16 a[184:185], v16 offset:12320
ds_read_b64_tr_b16 a[186:187], v16 offset:12448
ds_read_b64_tr_b16 a[188:189], v16 offset:14368
ds_read_b64_tr_b16 a[190:191], v16 offset:14496
s_waitcnt lgkmcnt(0)
s_mov_b32 s12, s68
s_mov_b32 s13, s69
s_mov_b32 s14, 8388608
s_lshl_b32 s42, s20, 21
s_lshl_b32 s24, s21, 6
s_add_u32 s42, s42, s24
s_add_u32 m0, s41, 0
s_nop 0
buffer_load_dwordx4 v14, s[12:15], s42 offen lds
s_add_u32 s42, s42, 131072
s_add_u32 m0, s41, 1024
s_nop 0
buffer_load_dwordx4 v14, s[12:15], s42 offen lds
s_add_u32 s42, s42, 131072
s_add_u32 m0, s41, 2048
s_nop 0
buffer_load_dwordx4 v14, s[12:15], s42 offen lds
s_add_u32 s42, s42, 131072
s_add_u32 m0, s41, 3072
s_nop 0
buffer_load_dwordx4 v14, s[12:15], s42 offen lds
s_add_u32 s42, s42, 131072
s_add_u32 m0, s41, 4096
s_nop 0
buffer_load_dwordx4 v14, s[12:15], s42 offen lds
s_add_u32 s42, s42, 131072
s_add_u32 m0, s41, 5120
s_nop 0
buffer_load_dwordx4 v14, s[12:15], s42 offen lds
s_add_u32 s42, s42, 131072
s_add_u32 m0, s41, 6144
s_nop 0
buffer_load_dwordx4 v14, s[12:15], s42 offen lds
s_add_u32 s42, s42, 131072
s_add_u32 m0, s41, 7168
s_nop 0
buffer_load_dwordx4 v14, s[12:15], s42 offen lds
s_add_u32 s42, s42, 131072
s_add_u32 m0, s41, 8192
s_nop 0
buffer_load_dwordx4 v14, s[12:15], s42 offen lds
s_add_u32 s42, s42, 131072
s_add_u32 m0, s41, 9216
s_nop 0
buffer_load_dwordx4 v14, s[12:15], s42 offen lds
s_add_u32 s42, s42, 131072
s_add_u32 m0, s41, 10240
s_nop 0
buffer_load_dwordx4 v14, s[12:15], s42 offen lds
s_add_u32 s42, s42, 131072
s_add_u32 m0, s41, 11264
s_nop 0
buffer_load_dwordx4 v14, s[12:15], s42 offen lds
s_add_u32 s42, s42, 131072
s_add_u32 m0, s41, 12288
s_nop 0
buffer_load_dwordx4 v14, s[12:15], s42 offen lds
s_add_u32 s42, s42, 131072
s_add_u32 m0, s41, 13312
s_nop 0
buffer_load_dwordx4 v14, s[12:15], s42 offen lds
s_add_u32 s42, s42, 131072
s_add_u32 m0, s41, 14336
s_nop 0
buffer_load_dwordx4 v14, s[12:15], s42 offen lds
s_add_u32 s42, s42, 131072
s_add_u32 m0, s41, 15360
s_nop 0
buffer_load_dwordx4 v14, s[12:15], s42 offen lds
s_add_u32 s42, s42, 131072
s_waitcnt vmcnt(16)
ds_read_b64_tr_b16 a[192:193], v16 offset:16384
ds_read_b64_tr_b16 a[194:195], v16 offset:16512
ds_read_b64_tr_b16 a[196:197], v16 offset:18432
ds_read_b64_tr_b16 a[198:199], v16 offset:18560
ds_read_b64_tr_b16 a[200:201], v16 offset:20480
ds_read_b64_tr_b16 a[202:203], v16 offset:20608
ds_read_b64_tr_b16 a[204:205], v16 offset:22528
ds_read_b64_tr_b16 a[206:207], v16 offset:22656
ds_read_b64_tr_b16 a[208:209], v16 offset:24576
ds_read_b64_tr_b16 a[210:211], v16 offset:24704
ds_read_b64_tr_b16 a[212:213], v16 offset:26624
ds_read_b64_tr_b16 a[214:215], v16 offset:26752
ds_read_b64_tr_b16 a[216:217], v16 offset:28672
ds_read_b64_tr_b16 a[218:219], v16 offset:28800
ds_read_b64_tr_b16 a[220:221], v16 offset:30720
ds_read_b64_tr_b16 a[222:223], v16 offset:30848
ds_read_b64_tr_b16 a[224:225], v16 offset:16416
ds_read_b64_tr_b16 a[226:227], v16 offset:16544
ds_read_b64_tr_b16 a[228:229], v16 offset:18464
ds_read_b64_tr_b16 a[230:231], v16 offset:18592
ds_read_b64_tr_b16 a[232:233], v16 offset:20512
ds_read_b64_tr_b16 a[234:235], v16 offset:20640
ds_read_b64_tr_b16 a[236:237], v16 offset:22560
ds_read_b64_tr_b16 a[238:239], v16 offset:22688
ds_read_b64_tr_b16 a[240:241], v16 offset:24608
ds_read_b64_tr_b16 a[242:243], v16 offset:24736
ds_read_b64_tr_b16 a[244:245], v16 offset:26656
ds_read_b64_tr_b16 a[246:247], v16 offset:26784
ds_read_b64_tr_b16 a[248:249], v16 offset:28704
ds_read_b64_tr_b16 a[250:251], v16 offset:28832
ds_read_b64_tr_b16 a[252:253], v16 offset:30752
ds_read_b64_tr_b16 a[254:255], v16 offset:30880
s_waitcnt lgkmcnt(0)
v_lshlrev_b32 v5, 2, v1
buffer_load_dword v250, v5, s[8:11], 0 offen sc1
s_mov_b32 s12, s70
s_mov_b32 s13, s71
s_mov_b32 s14, 8388608
s_lshl_b32 s42, s20, 21
s_lshl_b32 s24, s21, 6
s_add_u32 s42, s42, s24
s_add_u32 m0, s41, 16384
s_nop 0
buffer_load_dwordx4 v14, s[12:15], s42 offen lds
s_add_u32 s42, s42, 131072
s_add_u32 m0, s41, 17408
s_nop 0
buffer_load_dwordx4 v14, s[12:15], s42 offen lds
s_add_u32 s42, s42, 131072
s_add_u32 m0, s41, 18432
s_nop 0
buffer_load_dwordx4 v14, s[12:15], s42 offen lds
s_add_u32 s42, s42, 131072
s_add_u32 m0, s41, 19456
s_nop 0
buffer_load_dwordx4 v14, s[12:15], s42 offen lds
s_add_u32 s42, s42, 131072
s_add_u32 m0, s41, 20480
s_nop 0
buffer_load_dwordx4 v14, s[12:15], s42 offen lds
s_add_u32 s42, s42, 131072
s_add_u32 m0, s41, 21504
s_nop 0
buffer_load_dwordx4 v14, s[12:15], s42 offen lds
s_add_u32 s42, s42, 131072
s_add_u32 m0, s41, 22528
s_nop 0
buffer_load_dwordx4 v14, s[12:15], s42 offen lds
s_add_u32 s42, s42, 131072
s_add_u32 m0, s41, 23552
s_nop 0
buffer_load_dwordx4 v14, s[12:15], s42 offen lds
s_add_u32 s42, s42, 131072
s_add_u32 m0, s41, 24576
s_nop 0
buffer_load_dwordx4 v14, s[12:15], s42 offen lds
s_add_u32 s42, s42, 131072
s_add_u32 m0, s41, 25600
s_nop 0
buffer_load_dwordx4 v14, s[12:15], s42 offen lds
s_add_u32 s42, s42, 131072
s_add_u32 m0, s41, 26624
s_nop 0
buffer_load_dwordx4 v14, s[12:15], s42 offen lds
s_add_u32 s42, s42, 131072
s_add_u32 m0, s41, 27648
s_nop 0
buffer_load_dwordx4 v14, s[12:15], s42 offen lds
s_add_u32 s42, s42, 131072
s_add_u32 m0, s41, 28672
s_nop 0
buffer_load_dwordx4 v14, s[12:15], s42 offen lds
s_add_u32 s42, s42, 131072
s_add_u32 m0, s41, 29696
s_nop 0
buffer_load_dwordx4 v14, s[12:15], s42 offen lds
s_add_u32 s42, s42, 131072
s_add_u32 m0, s41, 30720
s_nop 0
buffer_load_dwordx4 v14, s[12:15], s42 offen lds
s_add_u32 s42, s42, 131072
s_add_u32 m0, s41, 31744
s_nop 0
buffer_load_dwordx4 v14, s[12:15], s42 offen lds
s_add_u32 s42, s42, 131072
s_waitcnt vmcnt(16)
v_and_b32 v5, 31, v1
v_lshlrev_b32 v5, 2, v5
v_add_u32 v5, 49664, v5
buffer_load_dword v251, v5, s[4:7], 0 offen sc1
v_mov_b32 v252, -1
s_mov_b32 s16, s66
s_mov_b32 s17, s67
s_mov_b32 s18, 16384
s_mov_b32 s19, 0x20000
v_lshrrev_b32 v5, 1, v4
v_lshlrev_b32 v5, 11, v5
v_lshl_add_u32 v5, v3, 4, v5
v_and_b32 v6, 1, v4
v_lshl_add_u32 v5, v6, 3, v5
s_lshl_b32 s24, s33, 6
s_xor_b32 s24, s24, 128
buffer_load_dwordx2 v[232:233], v5, s[16:19], s24 offen
s_mul_i32 s24, s20, 294912
s_add_u32 s24, s24, 65536
buffer_load_dwordx4 v[120:123], v41, s[4:7], s24 offen sc1
buffer_load_dwordx4 v[124:127], v42, s[4:7], s24 offen sc1
buffer_load_dwordx4 v[128:131], v43, s[4:7], s24 offen sc1
ds_read_b64_tr_b16 a[0:1], v16 offset:0
ds_read_b64_tr_b16 a[2:3], v16 offset:128
ds_read_b64_tr_b16 a[4:5], v16 offset:2048
ds_read_b64_tr_b16 a[6:7], v16 offset:2176
ds_read_b64_tr_b16 a[8:9], v16 offset:4096
ds_read_b64_tr_b16 a[10:11], v16 offset:4224
ds_read_b64_tr_b16 a[12:13], v16 offset:6144
ds_read_b64_tr_b16 a[14:15], v16 offset:6272
ds_read_b64_tr_b16 a[16:17], v16 offset:8192
ds_read_b64_tr_b16 a[18:19], v16 offset:8320
ds_read_b64_tr_b16 a[20:21], v16 offset:10240
ds_read_b64_tr_b16 a[22:23], v16 offset:10368
ds_read_b64_tr_b16 a[24:25], v16 offset:12288
ds_read_b64_tr_b16 a[26:27], v16 offset:12416
ds_read_b64_tr_b16 a[28:29], v16 offset:14336
ds_read_b64_tr_b16 a[30:31], v16 offset:14464
ds_read_b64_tr_b16 a[32:33], v16 offset:32
ds_read_b64_tr_b16 a[34:35], v16 offset:160
ds_read_b64_tr_b16 a[36:37], v16 offset:2080
ds_read_b64_tr_b16 a[38:39], v16 offset:2208
ds_read_b64_tr_b16 a[40:41], v16 offset:4128
ds_read_b64_tr_b16 a[42:43], v16 offset:4256
ds_read_b64_tr_b16 a[44:45], v16 offset:6176
ds_read_b64_tr_b16 a[46:47], v16 offset:6304
ds_read_b64_tr_b16 a[48:49], v16 offset:8224
ds_read_b64_tr_b16 a[50:51], v16 offset:8352
ds_read_b64_tr_b16 a[52:53], v16 offset:10272
ds_read_b64_tr_b16 a[54:55], v16 offset:10400
ds_read_b64_tr_b16 a[56:57], v16 offset:12320
ds_read_b64_tr_b16 a[58:59], v16 offset:12448
ds_read_b64_tr_b16 a[60:61], v16 offset:14368
ds_read_b64_tr_b16 a[62:63], v16 offset:14496
s_waitcnt lgkmcnt(0)
s_waitcnt vmcnt(0)
ds_read_b64_tr_b16 a[64:65], v16 offset:16384
ds_read_b64_tr_b16 a[66:67], v16 offset:16512
ds_read_b64_tr_b16 a[68:69], v16 offset:18432
ds_read_b64_tr_b16 a[70:71], v16 offset:18560
ds_read_b64_tr_b16 a[72:73], v16 offset:20480
ds_read_b64_tr_b16 a[74:75], v16 offset:20608
ds_read_b64_tr_b16 a[76:77], v16 offset:22528
ds_read_b64_tr_b16 a[78:79], v16 offset:22656
ds_read_b64_tr_b16 a[80:81], v16 offset:24576
ds_read_b64_tr_b16 a[82:83], v16 offset:24704
ds_read_b64_tr_b16 a[84:85], v16 offset:26624
ds_read_b64_tr_b16 a[86:87], v16 offset:26752
ds_read_b64_tr_b16 a[88:89], v16 offset:28672
ds_read_b64_tr_b16 a[90:91], v16 offset:28800
ds_read_b64_tr_b16 a[92:93], v16 offset:30720
ds_read_b64_tr_b16 a[94:95], v16 offset:30848
ds_read_b64_tr_b16 a[96:97], v16 offset:16416
ds_read_b64_tr_b16 a[98:99], v16 offset:16544
ds_read_b64_tr_b16 a[100:101], v16 offset:18464
ds_read_b64_tr_b16 a[102:103], v16 offset:18592
ds_read_b64_tr_b16 a[104:105], v16 offset:20512
ds_read_b64_tr_b16 a[106:107], v16 offset:20640
ds_read_b64_tr_b16 a[108:109], v16 offset:22560
ds_read_b64_tr_b16 a[110:111], v16 offset:22688
ds_read_b64_tr_b16 a[112:113], v16 offset:24608
ds_read_b64_tr_b16 a[114:115], v16 offset:24736
ds_read_b64_tr_b16 a[116:117], v16 offset:26656
ds_read_b64_tr_b16 a[118:119], v16 offset:26784
ds_read_b64_tr_b16 a[120:121], v16 offset:28704
ds_read_b64_tr_b16 a[122:123], v16 offset:28832
ds_read_b64_tr_b16 a[124:125], v16 offset:30752
ds_read_b64_tr_b16 a[126:127], v16 offset:30880
s_waitcnt lgkmcnt(0)
L_rlDb:
s_cmp_lg_u32 s22, 0
s_cbranch_scc1 L_conf_ok_r
v_lshlrev_b32 v5, 2, v1
s_waitcnt vmcnt(0) lgkmcnt(0)
v_mov_b32 v6, v250
s_branch L_conf_ev_r
L_conf_poll_r:
s_sleep 8
v_mov_b32 v251, -1
v_mov_b32 v252, -1
L_conf_go_r:
buffer_load_dword v6, v5, s[8:11], 0 offen sc1
s_sub_u32 s28, s28, 1
s_cbranch_scc1 L_end
s_waitcnt vmcnt(0) lgkmcnt(0)
L_conf_ev_r:
v_bcnt_u32_b32 v7, v6, 0
v_cmp_ne_u32 vcc, 4, v7
s_cbranch_vccnz L_conf_poll_r
v_lshrrev_b32 v7, 16, v6
v_or_b32 v7, v7, v6
v_lshrrev_b32 v5, 8, v7
v_or_b32 v7, v7, v5
v_and_b32 v7, 0xff, v7
s_nop 1
v_or_b32_dpp v7, v7, v7 quad_perm:[1,0,3,2] row_mask:0xf bank_mask:0xf
s_mov_b32 s22, 1
v_cmp_ne_u32 vcc, 0xff, v7
s_cbranch_vccnz L_respec
L_conf_ok_r:
s_barrier
v_and_b32 v5, 31, v1
v_lshlrev_b32 v5, 2, v5
v_add_u32 v5, 49664, v5
v_mov_b32 v6, v251
s_branch L_gm_ev_r
L_gm_r:
s_sleep 4
L_gm_go_r:
buffer_load_dword v6, v5, s[4:7], 0 offen sc1
s_sub_u32 s28, s28, 1
s_cbranch_scc1 L_end
s_waitcnt vmcnt(0)
L_gm_ev_r:
v_cmp_gt_i32 vcc, 0, v6
s_cbranch_vccnz L_gm_r
v_cmp_eq_u32 vcc, 1, v6
s_nop 1
s_bcnt1_i32_b32 s63, vcc_lo
s_cmp_gt_u32 s63, 16
s_cselect_b32 s63, 0x2000, 0
s_lshl_b32 s24, s20, 18
s_add_u32 s24, s24, s63
s_add_u32 s24, s24, 180355072
buffer_store_dwordx4 v[8:11], v20, s[4:7], s24 offen sc1
s_add_u32 s24, s24, 4194304
buffer_store_dwordx4 v[8:11], v20, s[4:7], s24 offen sc1
s_add_u32 s24, s24, 4194304
s_mov_b32 s31, 3670016
s_lshr_b32 s45, s31, 8
s_and_b32 s45, s45, 0x2000
s_xor_b32 s45, s45, s63
s_or_b32 s45, s45, s31
s_mov_b32 s31, 4194304
s_lshr_b32 s38, s31, 8
s_and_b32 s38, s38, 0x2000
s_xor_b32 s38, s38, s63
s_or_b32 s38, s38, s31
v_add_u32 v45, s63, v45
s_xor_b32 s24, s63, 0x2000
v_add_u32 v37, s24, v37
s_mov_b32 s44, 0x3e0293ee
s_cmp_eq_u32 s22, 2
s_cbranch_scc1 L_r_safe
s_cmp_eq_u32 s20, 1
s_cbranch_scc1 L_pre_f1
s_cmp_eq_u32 s20, 2
s_cbranch_scc1 L_loop_f2
s_cmp_eq_u32 s20, 3
s_cbranch_scc1 L_pre_f3
v_mov_b32 v92, 0
v_mov_b32 v93, 0
v_mov_b32 v94, 0
v_mov_b32 v95, 0
v_mov_b32 v96, 0
v_mov_b32 v97, 0
v_mov_b32 v98, 0
v_mov_b32 v99, 0
v_mov_b32 v100, 0
v_mov_b32 v101, 0
v_mov_b32 v102, 0
v_mov_b32 v103, 0
v_mov_b32 v104, 0
v_mov_b32 v105, 0
v_mov_b32 v106, 0
v_mov_b32 v107, 0
v_mov_b32 v108, 0
v_mov_b32 v109, 0
v_mov_b32 v110, 0
v_mov_b32 v111, 0
v_mov_b32 v112, 0
v_mov_b32 v113, 0
v_mov_b32 v114, 0
v_mov_b32 v115, 0
v_min_u32 v232, -2, v232
v_min_u32 v233, -2, v233
buffer_store_dwordx2 v[232:233], v21, s[4:7], s37 offen
s_branch L_s1d_f0
.p2align 6
L_loop_f0:
v_mov_b32 v108, 0
v_mov_b32 v109, 0
v_mov_b32 v110, 0
v_mov_b32 v111, 0
v_mov_b32 v112, 0
v_mov_b32 v113, 0
v_mov_b32 v114, 0
v_mov_b32 v115, 0
s_nop 15
s_nop 15
s_nop 15
s_nop 15
s_nop 15
s_nop 15
s_nop 15
L_p1_f0:
buffer_load_dwordx4 v[116:119], v17, s[4:7], s43 offen sc1
buffer_load_dwordx4 v[120:123], v18, s[4:7], s43 offen sc1
buffer_load_dwordx4 v[124:127], v19, s[4:7], s43 offen sc1
s_sub_u32 s28, s28, 1
s_cbranch_scc1 L_end
s_waitcnt vmcnt(2)
v_pk_add_f32 v[164:165], v[116:117], v[228:229]
v_pk_add_f32 v[166:167], v[118:119], v[230:231]
s_waitcnt vmcnt(0)
v_pk_add_f32 v[120:121], v[120:121], v[124:125]
v_pk_add_f32 v[122:123], v[122:123], v[126:127]
v_pk_add_f32 v[164:165], v[164:165], v[120:121]
v_pk_add_f32 v[166:167], v[166:167], v[122:123]
v_max3_u32 v55, v164, v165, v166
v_max_u32 v55, v55, v167
v_cmpx_ne_u32 vcc, -1, v55
v_cvt_pk_bf16_f32 v232, v164, v165
v_cvt_pk_bf16_f32 v233, v166, v167
buffer_store_dwordx2 v[232:233], v21, s[4:7], s37 offen
s_mov_b64 exec, -1
s_cmp_eq_u64 vcc, -1
s_cbranch_scc0 L_p1_f0
L_s1d_f0:
s_barrier
s_nop 15
s_nop 15
L_mr0_f0:
buffer_load_dwordx4 v[60:63], v22, s[4:7], s37 offen offset:0 sc1
L_mr1_f0:
buffer_load_dwordx4 v[64:67], v22, s[4:7], s37 offen offset:1024 sc1
L_mr2_f0:
buffer_load_dwordx4 v[68:71], v22, s[4:7], s37 offen offset:2048 sc1
L_mr3_f0:
buffer_load_dwordx4 v[72:75], v22, s[4:7], s37 offen offset:3072 sc1
s_sub_u32 s28, s28, 1
s_cbranch_scc1 L_end
s_nop 4
v_mov_b32 v92, 0
v_mov_b32 v93, 0
v_mov_b32 v94, 0
v_mov_b32 v95, 0
v_mov_b32 v96, 0
v_mov_b32 v97, 0
v_mov_b32 v98, 0
v_mov_b32 v99, 0
v_mov_b32 v100, 0
v_mov_b32 v101, 0
v_mov_b32 v102, 0
v_mov_b32 v103, 0
v_mov_b32 v104, 0
v_mov_b32 v105, 0
v_mov_b32 v106, 0
v_mov_b32 v107, 0
L_ms_f0:
L_mw0_f0:
s_waitcnt vmcnt(3)
v_max3_u32 v55, v60, v61, v62
v_max_u32 v55, v55, v63
v_cmp_eq_u32 vcc, -1, v55
v_smfmac_f32_16x16x64_bf16 v[92:95], v[60:63], a[0:7], v54
v_smfmac_f32_16x16x64_bf16 v[96:99], v[60:63], a[32:39], v54
s_cbranch_vccnz L_mr0_f0
v_smfmac_f32_16x16x64_bf16 v[100:103], v[60:63], a[64:71], v54
v_smfmac_f32_16x16x64_bf16 v[104:107], v[60:63], a[96:103], v54
L_mw1_f0:
s_waitcnt vmcnt(2)
v_max3_u32 v55, v64, v65, v66
v_max_u32 v55, v55, v67
v_cmp_eq_u32 vcc, -1, v55
v_smfmac_f32_16x16x64_bf16 v[92:95], v[64:67], a[8:15], v54
v_smfmac_f32_16x16x64_bf16 v[96:99], v[64:67], a[40:47], v54
s_cbranch_vccnz L_mr1_f0
v_smfmac_f32_16x16x64_bf16 v[100:103], v[64:67], a[72:79], v54
v_smfmac_f32_16x16x64_bf16 v[104:107], v[64:67], a[104:111], v54
L_mw2_f0:
s_waitcnt vmcnt(1)
v_max3_u32 v55, v68, v69, v70
v_max_u32 v55, v55, v71
v_cmp_eq_u32 vcc, -1, v55
v_smfmac_f32_16x16x64_bf16 v[92:95], v[68:71], a[16:23], v54
v_smfmac_f32_16x16x64_bf16 v[96:99], v[68:71], a[48:55], v54
s_cbranch_vccnz L_mr2_f0
v_smfmac_f32_16x16x64_bf16 v[100:103], v[68:71], a[80:87], v54
v_smfmac_f32_16x16x64_bf16 v[104:107], v[68:71], a[112:119], v54
L_mw3_f0:
s_waitcnt vmcnt(0)
v_max3_u32 v55, v72, v73, v74
v_max_u32 v55, v55, v75
v_cmp_eq_u32 vcc, -1, v55
v_smfmac_f32_16x16x64_bf16 v[92:95], v[72:75], a[24:31], v54
v_smfmac_f32_16x16x64_bf16 v[96:99], v[72:75], a[56:63], v54
s_cbranch_vccnz L_mr3_f0
v_smfmac_f32_16x16x64_bf16 v[100:103], v[72:75], a[88:95], v54
v_smfmac_f32_16x16x64_bf16 v[104:107], v[72:75], a[120:127], v54
L_md_f0:
v_permlane32_swap_b32 v92, v96
v_permlane32_swap_b32 v93, v97
v_pk_add_f32 v[92:93], v[92:93], v[96:97]
ds_write2_b32 v47, v92, v93 offset0:0 offset1:36
v_permlane32_swap_b32 v94, v98
v_permlane32_swap_b32 v95, v99
v_pk_add_f32 v[94:95], v[94:95], v[98:99]
ds_write2_b32 v47, v94, v95 offset0:72 offset1:108
v_permlane32_swap_b32 v100, v104
v_permlane32_swap_b32 v101, v105
v_pk_add_f32 v[100:101], v[100:101], v[104:105]
ds_write2_b32 v48, v100, v101 offset0:0 offset1:36
v_permlane32_swap_b32 v102, v106
v_permlane32_swap_b32 v103, v107
v_pk_add_f32 v[102:103], v[102:103], v[106:107]
ds_write2_b32 v48, v102, v103 offset0:72 offset1:108
v_smfmac_f32_16x16x64_bf16 v[108:111], v[60:63], a[128:135], v54
v_smfmac_f32_16x16x64_bf16 v[112:115], v[60:63], a[160:167], v54
v_smfmac_f32_16x16x64_bf16 v[108:111], v[64:67], a[136:143], v54
s_waitcnt lgkmcnt(0)
s_barrier
v_smfmac_f32_16x16x64_bf16 v[112:115], v[64:67], a[168:175], v54
v_smfmac_f32_16x16x64_bf16 v[108:111], v[68:71], a[144:151], v54
v_smfmac_f32_16x16x64_bf16 v[112:115], v[68:71], a[176:183], v54
v_smfmac_f32_16x16x64_bf16 v[108:111], v[72:75], a[152:159], v54
v_smfmac_f32_16x16x64_bf16 v[112:115], v[72:75], a[184:191], v54
s_nop 7
v_permlane32_swap_b32 v108, v112
v_permlane32_swap_b32 v109, v113
v_permlane32_swap_b32 v110, v114
v_permlane32_swap_b32 v111, v115
v_pk_add_f32 v[108:109], v[108:109], v[112:113]
v_pk_add_f32 v[110:111], v[110:111], v[114:115]
ds_write_b128 v50, v[108:111]
s_waitcnt lgkmcnt(0)
s_barrier
s_cmp_eq_u32 s39, 63
s_cbranch_scc1 L_last_f0
s_barrier
s_nop 15
s_nop 15
L_or0_f0:
buffer_load_dwordx4 v[60:63], v23, s[4:7], s37 offen offset:0 sc1
L_or1_f0:
buffer_load_dwordx4 v[64:67], v23, s[4:7], s37 offen offset:1024 sc1
L_or2_f0:
buffer_load_dwordx4 v[68:71], v23, s[4:7], s37 offen offset:2048 sc1
L_or3_f0:
buffer_load_dwordx4 v[72:75], v23, s[4:7], s37 offen offset:3072 sc1
s_sub_u32 s28, s28, 1
s_cbranch_scc1 L_end
s_nop 4
v_mov_b32 v92, 0
v_mov_b32 v93, 0
v_mov_b32 v94, 0
v_mov_b32 v95, 0
v_mov_b32 v96, 0
v_mov_b32 v97, 0
v_mov_b32 v98, 0
v_mov_b32 v99, 0
L_os_f0:
L_ow0_f0:
s_waitcnt vmcnt(3)
v_max3_u32 v55, v60, v61, v62
v_max_u32 v55, v55, v63
v_cmp_eq_u32 vcc, -1, v55
v_smfmac_f32_16x16x64_bf16 v[92:95], v[60:63], a[192:199], v54
v_smfmac_f32_16x16x64_bf16 v[96:99], v[60:63], a[224:231], v54
s_cbranch_vccnz L_or0_f0
L_ow1_f0:
s_waitcnt vmcnt(2)
v_max3_u32 v55, v64, v65, v66
v_max_u32 v55, v55, v67
v_cmp_eq_u32 vcc, -1, v55
v_smfmac_f32_16x16x64_bf16 v[92:95], v[64:67], a[200:207], v54
v_smfmac_f32_16x16x64_bf16 v[96:99], v[64:67], a[232:239], v54
s_cbranch_vccnz L_or1_f0
L_ow2_f0:
s_waitcnt vmcnt(1)
v_max3_u32 v55, v68, v69, v70
v_max_u32 v55, v55, v71
v_cmp_eq_u32 vcc, -1, v55
v_smfmac_f32_16x16x64_bf16 v[92:95], v[68:71], a[208:215], v54
v_smfmac_f32_16x16x64_bf16 v[96:99], v[68:71], a[240:247], v54
s_cbranch_vccnz L_or2_f0
L_ow3_f0:
s_waitcnt vmcnt(0)
v_max3_u32 v55, v72, v73, v74
v_max_u32 v55, v55, v75
v_cmp_eq_u32 vcc, -1, v55
v_smfmac_f32_16x16x64_bf16 v[92:95], v[72:75], a[216:223], v54
v_smfmac_f32_16x16x64_bf16 v[96:99], v[72:75], a[248:255], v54
s_cbranch_vccnz L_or3_f0
L_od_f0:
s_nop 6
v_permlane32_swap_b32 v92, v96
v_permlane32_swap_b32 v93, v97
v_pk_add_f32 v[92:93], v[92:93], v[96:97]
ds_write2_b32 v52, v92, v93 offset0:0 offset1:36
v_permlane32_swap_b32 v94, v98
v_permlane32_swap_b32 v95, v99
v_pk_add_f32 v[94:95], v[94:95], v[98:99]
ds_write2_b32 v52, v94, v95 offset0:72 offset1:108
s_waitcnt lgkmcnt(0)
s_barrier
ds_read_b128 v[116:119], v53 offset:0
ds_read_b128 v[120:123], v53 offset:1152
ds_read_b128 v[124:127], v53 offset:2304
ds_read_b128 v[128:131], v53 offset:3456
s_waitcnt lgkmcnt(2)
v_pk_add_f32 v[116:117], v[116:117], v[120:121]
v_pk_add_f32 v[118:119], v[118:119], v[122:123]
s_waitcnt lgkmcnt(1)
v_pk_add_f32 v[116:117], v[116:117], v[124:125]
v_pk_add_f32 v[118:119], v[118:119], v[126:127]
s_waitcnt lgkmcnt(0)
v_pk_add_f32 v[228:229], v[116:117], v[128:129]
v_pk_add_f32 v[230:231], v[118:119], v[130:131]
buffer_store_dwordx4 v[228:231], v20, s[4:7], s45 offen sc1
s_add_u32 s37, s37, 294912
s_cmp_eq_u32 s37, 1245184
s_cselect_b32 s37, 65536, s37
s_add_u32 s62, s62, 294912
s_cmp_eq_u32 s62, 1245184
s_cselect_b32 s62, 65536, s62
s_mov_b32 s43, s45
s_mov_b32 s45, s38
s_add_u32 s31, s31, 524288
s_add_u32 s39, s39, 1
s_lshr_b32 s38, s31, 8
s_and_b32 s38, s38, 0x2000
s_xor_b32 s38, s38, s63
s_or_b32 s38, s38, s31
s_branch L_loop_f0
L_last_f0:
s_branch L_rt7
L_pre_f1:
.p2align 6
L_loop_f1:
s_cmp_eq_u32 s39, 0
s_cbranch_scc1 L_nokvm_f1
ds_write_b32 v39, v204
ds_write_b32 v39, v208 offset:256
s_waitcnt lgkmcnt(0)
s_mov_b64 exec, s[92:93]
ds_read_b128 v[172:175], v44
s_mov_b64 exec, -1
s_sub_u32 s27, s39, 1
v_mov_b32 v46, s27
s_waitcnt lgkmcnt(0)
buffer_store_dwordx4 v[172:175], v38, s[4:7], s45 offen sc1
buffer_store_dword v46, v45, s[4:7], 0 offen sc1
L_nokvm_f1:
v_mov_b32 v108, 0
v_mov_b32 v109, 0
v_mov_b32 v110, 0
v_mov_b32 v111, 0
v_mov_b32 v112, 0
v_mov_b32 v113, 0
v_mov_b32 v114, 0
v_mov_b32 v115, 0
s_barrier
ds_read_b128 v[176:179], v2 offset:18432
ds_read_b128 v[180:183], v2 offset:19456
ds_read_b128 v[184:187], v2 offset:20480
ds_read_b128 v[188:191], v2 offset:21504
s_nop 15
s_nop 11
L_mr0_f1:
buffer_load_dwordx4 v[60:63], v22, s[4:7], s37 offen offset:0 sc1
L_mr1_f1:
buffer_load_dwordx4 v[64:67], v22, s[4:7], s37 offen offset:1024 sc1
L_mr2_f1:
buffer_load_dwordx4 v[68:71], v22, s[4:7], s37 offen offset:2048 sc1
L_mr3_f1:
buffer_load_dwordx4 v[72:75], v22, s[4:7], s37 offen offset:3072 sc1
s_sub_u32 s28, s28, 1
s_cbranch_scc1 L_end
s_nop 4
v_mov_b32 v92, 0
v_mov_b32 v93, 0
v_mov_b32 v94, 0
v_mov_b32 v95, 0
v_mov_b32 v96, 0
v_mov_b32 v97, 0
v_mov_b32 v98, 0
v_mov_b32 v99, 0
v_mov_b32 v100, 0
v_mov_b32 v101, 0
v_mov_b32 v102, 0
v_mov_b32 v103, 0
v_mov_b32 v104, 0
v_mov_b32 v105, 0
v_mov_b32 v106, 0
v_mov_b32 v107, 0
L_ms_f1:
L_mw0_f1:
s_waitcnt vmcnt(3)
v_max3_u32 v55, v60, v61, v62
v_max_u32 v55, v55, v63
v_cmp_eq_u32 vcc, -1, v55
v_smfmac_f32_16x16x64_bf16 v[92:95], v[60:63], a[0:7], v54
v_smfmac_f32_16x16x64_bf16 v[96:99], v[60:63], a[32:39], v54
s_cbranch_vccnz L_mr0_f1
v_smfmac_f32_16x16x64_bf16 v[100:103], v[60:63], a[64:71], v54
v_smfmac_f32_16x16x64_bf16 v[104:107], v[60:63], a[96:103], v54
L_mw1_f1:
s_waitcnt vmcnt(2)
v_max3_u32 v55, v64, v65, v66
v_max_u32 v55, v55, v67
v_cmp_eq_u32 vcc, -1, v55
v_smfmac_f32_16x16x64_bf16 v[92:95], v[64:67], a[8:15], v54
v_smfmac_f32_16x16x64_bf16 v[96:99], v[64:67], a[40:47], v54
s_cbranch_vccnz L_mr1_f1
v_smfmac_f32_16x16x64_bf16 v[100:103], v[64:67], a[72:79], v54
v_smfmac_f32_16x16x64_bf16 v[104:107], v[64:67], a[104:111], v54
L_mw2_f1:
s_waitcnt vmcnt(1)
v_max3_u32 v55, v68, v69, v70
v_max_u32 v55, v55, v71
v_cmp_eq_u32 vcc, -1, v55
v_smfmac_f32_16x16x64_bf16 v[92:95], v[68:71], a[16:23], v54
v_smfmac_f32_16x16x64_bf16 v[96:99], v[68:71], a[48:55], v54
s_cbranch_vccnz L_mr2_f1
v_smfmac_f32_16x16x64_bf16 v[100:103], v[68:71], a[80:87], v54
v_smfmac_f32_16x16x64_bf16 v[104:107], v[68:71], a[112:119], v54
L_mw3_f1:
s_waitcnt vmcnt(0)
v_max3_u32 v55, v72, v73, v74
v_max_u32 v55, v55, v75
v_cmp_eq_u32 vcc, -1, v55
v_smfmac_f32_16x16x64_bf16 v[92:95], v[72:75], a[24:31], v54
v_smfmac_f32_16x16x64_bf16 v[96:99], v[72:75], a[56:63], v54
s_cbranch_vccnz L_mr3_f1
v_smfmac_f32_16x16x64_bf16 v[100:103], v[72:75], a[88:95], v54
v_smfmac_f32_16x16x64_bf16 v[104:107], v[72:75], a[120:127], v54
L_md_f1:
v_permlane32_swap_b32 v92, v96
v_permlane32_swap_b32 v93, v97
v_pk_add_f32 v[92:93], v[92:93], v[96:97]
ds_write2_b32 v47, v92, v93 offset0:0 offset1:36
v_permlane32_swap_b32 v94, v98
v_permlane32_swap_b32 v95, v99
v_pk_add_f32 v[94:95], v[94:95], v[98:99]
ds_write2_b32 v47, v94, v95 offset0:72 offset1:108
v_permlane32_swap_b32 v100, v104
v_permlane32_swap_b32 v101, v105
v_pk_add_f32 v[100:101], v[100:101], v[104:105]
ds_write2_b32 v48, v100, v101 offset0:0 offset1:36
v_permlane32_swap_b32 v102, v106
v_permlane32_swap_b32 v103, v107
v_pk_add_f32 v[102:103], v[102:103], v[106:107]
ds_write2_b32 v48, v102, v103 offset0:72 offset1:108
v_smfmac_f32_16x16x64_bf16 v[108:111], v[60:63], a[128:135], v54
v_smfmac_f32_16x16x64_bf16 v[112:115], v[60:63], a[160:167], v54
v_smfmac_f32_16x16x64_bf16 v[108:111], v[64:67], a[136:143], v54
s_waitcnt lgkmcnt(0)
s_barrier
ds_read_b128 v[116:119], v49 offset:0
ds_read_b128 v[120:123], v49 offset:16
ds_read_b128 v[124:127], v49 offset:2304
ds_read_b128 v[128:131], v49 offset:2320
ds_read_b128 v[132:135], v49 offset:4608
ds_read_b128 v[136:139], v49 offset:4624
ds_read_b128 v[140:143], v49 offset:6912
ds_read_b128 v[144:147], v49 offset:6928
v_smfmac_f32_16x16x64_bf16 v[112:115], v[64:67], a[168:175], v54
v_smfmac_f32_16x16x64_bf16 v[108:111], v[68:71], a[144:151], v54
s_waitcnt lgkmcnt(4)
v_pk_add_f32 v[116:117], v[116:117], v[124:125]
v_pk_add_f32 v[118:119], v[118:119], v[126:127]
v_pk_add_f32 v[120:121], v[120:121], v[128:129]
v_pk_add_f32 v[122:123], v[122:123], v[130:131]
v_smfmac_f32_16x16x64_bf16 v[112:115], v[68:71], a[176:183], v54
s_waitcnt lgkmcnt(2)
v_pk_add_f32 v[116:117], v[116:117], v[132:133]
v_pk_add_f32 v[118:119], v[118:119], v[134:135]
v_pk_add_f32 v[120:121], v[120:121], v[136:137]
v_pk_add_f32 v[122:123], v[122:123], v[138:139]
s_waitcnt lgkmcnt(0)
v_pk_add_f32 v[116:117], v[116:117], v[140:141]
v_cvt_pk_bf16_f32 v172, v116, v117
v_pk_add_f32 v[118:119], v[118:119], v[142:143]
v_cvt_pk_bf16_f32 v173, v118, v119
v_pk_add_f32 v[120:121], v[120:121], v[144:145]
v_cvt_pk_bf16_f32 v174, v120, v121
v_pk_add_f32 v[122:123], v[122:123], v[146:147]
v_cvt_pk_bf16_f32 v175, v122, v123
s_nop 1
v_mfma_f32_16x16x32_bf16 v[192:195], v[176:179], v[172:175], 0
v_mfma_f32_16x16x32_bf16 v[196:199], v[180:183], v[172:175], 0
v_mfma_f32_16x16x32_bf16 v[200:203], v[172:175], v[172:175], 0
buffer_store_dwordx4 v[192:195], v24, s[4:7], s37 offen
v_smfmac_f32_16x16x64_bf16 v[108:111], v[72:75], a[152:159], v54
buffer_store_dwordx4 v[196:199], v24, s[4:7], s37 offen offset:128
v_smfmac_f32_16x16x64_bf16 v[112:115], v[72:75], a[184:191], v54
buffer_store_dwordx4 v[200:203], v25, s[4:7], s37 offen
ds_write_b128 v2, v[200:203] offset:23552
v_mov_b32_dpp v192, v196 row_ror:8 row_mask:0xf bank_mask:0xc
v_mov_b32_dpp v193, v197 row_ror:8 row_mask:0xf bank_mask:0xc
v_mov_b32_dpp v194, v198 row_ror:8 row_mask:0xf bank_mask:0xc
v_mov_b32_dpp v195, v199 row_ror:8 row_mask:0xf bank_mask:0xc
s_nop 1
v_permlane32_swap_b32 v108, v112
v_permlane32_swap_b32 v109, v113
v_permlane32_swap_b32 v110, v114
v_permlane32_swap_b32 v111, v115
v_pk_add_f32 v[108:109], v[108:109], v[112:113]
v_pk_add_f32 v[110:111], v[110:111], v[114:115]
ds_write_b128 v50, v[108:111]
s_waitcnt lgkmcnt(0)
s_barrier
buffer_load_dwordx4 v[120:123], v27, s[4:7], s37 offen sc1
buffer_load_dword v225, v31, s[4:7], s37 offen sc1
buffer_load_dwordx4 v[124:127], v28, s[4:7], s37 offen sc1
buffer_load_dword v226, v32, s[4:7], s37 offen sc1
buffer_load_dwordx4 v[128:131], v29, s[4:7], s37 offen sc1
buffer_load_dword v227, v33, s[4:7], s37 offen sc1
ds_read_b32 v224, v30
ds_read_b64 v[132:133], v51 offset:0
ds_read_b64 v[134:135], v51 offset:1024
ds_read_b64 v[136:137], v51 offset:2048
ds_read_b64 v[138:139], v51 offset:3072
ds_read_b64 v[140:141], v51 offset:128
ds_read_b64 v[142:143], v51 offset:1152
ds_read_b64 v[144:145], v51 offset:2176
ds_read_b64 v[146:147], v51 offset:3200
s_waitcnt lgkmcnt(0)
v_pk_add_f32 v[132:133], v[132:133], v[136:137]
v_pk_add_f32 v[134:135], v[134:135], v[138:139]
v_pk_add_f32 v[132:133], v[132:133], v[134:135]
v_cvt_pk_bf16_f32 v204, v132, v133
v_pk_add_f32 v[140:141], v[140:141], v[144:145]
v_pk_add_f32 v[142:143], v[142:143], v[146:147]
v_pk_add_f32 v[140:141], v[140:141], v[142:143]
v_cvt_pk_bf16_f32 v208, v140, v141
s_cmp_eq_u32 s39, 63
s_cbranch_scc1 L_last_f1
buffer_load_dwordx4 v[152:155], v27, s[4:7], s37 offen sc1
buffer_load_dword v169, v31, s[4:7], s37 offen sc1
buffer_load_dwordx4 v[156:159], v28, s[4:7], s37 offen sc1
buffer_load_dword v170, v32, s[4:7], s37 offen sc1
buffer_load_dwordx4 v[160:163], v29, s[4:7], s37 offen sc1
buffer_load_dword v171, v33, s[4:7], s37 offen sc1
s_waitcnt vmcnt(10)
v_pk_add_f32 v[132:133], v[192:193], v[120:121]
v_pk_add_f32 v[134:135], v[194:195], v[122:123]
v_add_f32 v136, v224, v225
s_waitcnt vmcnt(6)
v_pk_add_f32 v[124:125], v[124:125], v[128:129]
v_pk_add_f32 v[126:127], v[126:127], v[130:131]
v_add_f32 v226, v226, v227
v_pk_add_f32 v[132:133], v[132:133], v[124:125]
v_pk_add_f32 v[134:135], v[134:135], v[126:127]
v_add_f32 v136, v136, v226
v_max3_u32 v55, v132, v133, v134
v_max3_u32 v55, v55, v135, v136
v_cmp_eq_u32 vcc, -1, v55
v_max3_f32 v236, v132, v133, v134
v_max3_f32 v236, v236, v135, v136
s_nop 1
v_max_f32_dpp v236, v236, v236 row_ror:8 row_mask:0xf bank_mask:0xf
v_mov_b32 v237, v236
s_cbranch_vccnz L_p3r_f1
L_p3ok_f1:
s_nop 0
v_permlane16_swap_b32 v236, v237
v_max_f32 v236, v236, v237
v_mov_b32 v237, v236
s_nop 1
v_permlane32_swap_b32 v236, v237
v_max_f32 v236, v236, v237
v_mul_f32 v236, s44, v236
v_fma_f32 v132, v132, s44, -v236
v_fma_f32 v133, v133, s44, -v236
v_fma_f32 v134, v134, s44, -v236
v_fma_f32 v135, v135, s44, -v236
v_fma_f32 v136, v136, s44, -v236
v_exp_f32 v132, v132
v_exp_f32 v133, v133
v_exp_f32 v134, v134
v_exp_f32 v135, v135
v_cvt_pk_bf16_f32 v216, v132, v133
v_cvt_pk_bf16_f32 v217, v134, v135
v_exp_f32 v136, v136
v_mov_b32_dpp v218, v216 row_ror:8 row_mask:0xf bank_mask:0xf
v_mov_b32_dpp v219, v217 row_ror:8 row_mask:0xf bank_mask:0xf
v_mov_b32_dpp v237, v136 row_ror:8 row_mask:0xf bank_mask:0xf
v_cvt_pk_bf16_f32 v220, v136, v237
v_mfma_f32_16x16x32_bf16 v[200:203], v[212:215], v[216:219], 0
v_mfma_f32_16x16x32_bf16 v[200:203], v[212:215], v[220:223], v[200:203]
v_mfma_f32_16x16x32_bf16 v[192:195], v[184:187], v[216:219], 0
v_mfma_f32_16x16x32_bf16 v[192:195], v[204:207], v[220:223], v[192:195]
v_rcp_f32 v238, v200
v_mfma_f32_16x16x32_bf16 v[196:199], v[188:191], v[216:219], 0
v_mfma_f32_16x16x32_bf16 v[196:199], v[208:211], v[220:223], v[196:199]
v_pk_mul_f32 v[192:193], v[192:193], v[238:239] op_sel_hi:[1,0]
v_cvt_pk_bf16_f32 v232, v192, v193
v_pk_mul_f32 v[194:195], v[194:195], v[238:239] op_sel_hi:[1,0]
v_cvt_pk_bf16_f32 v233, v194, v195
s_nop 3
v_pk_mul_f32 v[196:197], v[196:197], v[238:239] op_sel_hi:[1,0]
v_cvt_pk_bf16_f32 v234, v196, v197
v_pk_mul_f32 v[198:199], v[198:199], v[238:239] op_sel_hi:[1,0]
v_cvt_pk_bf16_f32 v235, v198, v199
buffer_store_dwordx4 v[232:235], v34, s[4:7], s37 offen
s_barrier
s_nop 15
s_nop 15
L_or0_f1:
buffer_load_dwordx4 v[60:63], v23, s[4:7], s37 offen offset:0 sc1
L_or1_f1:
buffer_load_dwordx4 v[64:67], v23, s[4:7], s37 offen offset:1024 sc1
L_or2_f1:
buffer_load_dwordx4 v[68:71], v23, s[4:7], s37 offen offset:2048 sc1
L_or3_f1:
buffer_load_dwordx4 v[72:75], v23, s[4:7], s37 offen offset:3072 sc1
s_sub_u32 s28, s28, 1
s_cbranch_scc1 L_end
s_nop 4
v_mov_b32 v92, 0
v_mov_b32 v93, 0
v_mov_b32 v94, 0
v_mov_b32 v95, 0
v_mov_b32 v96, 0
v_mov_b32 v97, 0
v_mov_b32 v98, 0
v_mov_b32 v99, 0
L_os_f1:
L_ow0_f1:
s_waitcnt vmcnt(3)
v_max3_u32 v55, v60, v61, v62
v_max_u32 v55, v55, v63
v_cmp_eq_u32 vcc, -1, v55
v_smfmac_f32_16x16x64_bf16 v[92:95], v[60:63], a[192:199], v54
v_smfmac_f32_16x16x64_bf16 v[96:99], v[60:63], a[224:231], v54
s_cbranch_vccnz L_or0_f1
L_ow1_f1:
s_waitcnt vmcnt(2)
v_max3_u32 v55, v64, v65, v66
v_max_u32 v55, v55, v67
v_cmp_eq_u32 vcc, -1, v55
v_smfmac_f32_16x16x64_bf16 v[92:95], v[64:67], a[200:207], v54
v_smfmac_f32_16x16x64_bf16 v[96:99], v[64:67], a[232:239], v54
s_cbranch_vccnz L_or1_f1
L_ow2_f1:
s_waitcnt vmcnt(1)
v_max3_u32 v55, v68, v69, v70
v_max_u32 v55, v55, v71
v_cmp_eq_u32 vcc, -1, v55
v_smfmac_f32_16x16x64_bf16 v[92:95], v[68:71], a[208:215], v54
v_smfmac_f32_16x16x64_bf16 v[96:99], v[68:71], a[240:247], v54
s_cbranch_vccnz L_or2_f1
L_ow3_f1:
s_waitcnt vmcnt(0)
v_max3_u32 v55, v72, v73, v74
v_max_u32 v55, v55, v75
v_cmp_eq_u32 vcc, -1, v55
v_smfmac_f32_16x16x64_bf16 v[92:95], v[72:75], a[216:223], v54
v_smfmac_f32_16x16x64_bf16 v[96:99], v[72:75], a[248:255], v54
s_cbranch_vccnz L_or3_f1
L_od_f1:
s_nop 6
v_permlane32_swap_b32 v92, v96
v_permlane32_swap_b32 v93, v97
v_pk_add_f32 v[92:93], v[92:93], v[96:97]
ds_write2_b32 v52, v92, v93 offset0:0 offset1:36
v_permlane32_swap_b32 v94, v98
v_permlane32_swap_b32 v95, v99
v_pk_add_f32 v[94:95], v[94:95], v[98:99]
ds_write2_b32 v52, v94, v95 offset0:72 offset1:108
s_waitcnt lgkmcnt(0)
s_barrier
s_add_u32 s37, s37, 294912
s_cmp_eq_u32 s37, 1245184
s_cselect_b32 s37, 65536, s37
s_add_u32 s62, s62, 294912
s_cmp_eq_u32 s62, 1245184
s_cselect_b32 s62, 65536, s62
s_mov_b32 s43, s45
s_mov_b32 s45, s38
s_add_u32 s31, s31, 524288
s_add_u32 s39, s39, 1
s_lshr_b32 s38, s31, 8
s_and_b32 s38, s38, 0x2000
s_xor_b32 s38, s38, s63
s_or_b32 s38, s38, s31
s_branch L_loop_f1
L_last_f1:
ds_write_b32 v39, v204
ds_write_b32 v39, v208 offset:256
s_waitcnt lgkmcnt(0)
s_mov_b64 exec, s[92:93]
ds_read_b128 v[172:175], v44
s_mov_b64 exec, -1
s_waitcnt lgkmcnt(0)
buffer_store_dwordx4 v[172:175], v38, s[4:7], s38 offen sc1
s_branch L_rt7
L_p3r_f1:
buffer_load_dwordx4 v[120:123], v27, s[4:7], s37 offen sc1
buffer_load_dword v225, v31, s[4:7], s37 offen sc1
buffer_load_dwordx4 v[124:127], v28, s[4:7], s37 offen sc1
buffer_load_dword v226, v32, s[4:7], s37 offen sc1
buffer_load_dwordx4 v[128:131], v29, s[4:7], s37 offen sc1
buffer_load_dword v227, v33, s[4:7], s37 offen sc1
s_waitcnt vmcnt(10)
v_pk_add_f32 v[132:133], v[192:193], v[152:153]
v_pk_add_f32 v[134:135], v[194:195], v[154:155]
v_add_f32 v136, v224, v169
s_waitcnt vmcnt(6)
v_pk_add_f32 v[156:157], v[156:157], v[160:161]
v_pk_add_f32 v[158:159], v[158:159], v[162:163]
v_add_f32 v170, v170, v171
v_pk_add_f32 v[132:133], v[132:133], v[156:157]
v_pk_add_f32 v[134:135], v[134:135], v[158:159]
v_add_f32 v136, v136, v170
v_max3_u32 v55, v132, v133, v134
v_max3_u32 v55, v55, v135, v136
v_cmp_eq_u32 vcc, -1, v55
v_max3_f32 v236, v132, v133, v134
v_max3_f32 v236, v236, v135, v136
s_nop 1
v_max_f32_dpp v236, v236, v236 row_ror:8 row_mask:0xf bank_mask:0xf
v_mov_b32 v237, v236
s_nop 0
s_cbranch_vccz L_p3ok_f1
L_p3s_f1:
buffer_load_dwordx4 v[152:155], v27, s[4:7], s37 offen sc1
buffer_load_dword v169, v31, s[4:7], s37 offen sc1
buffer_load_dwordx4 v[156:159], v28, s[4:7], s37 offen sc1
buffer_load_dword v170, v32, s[4:7], s37 offen sc1
buffer_load_dwordx4 v[160:163], v29, s[4:7], s37 offen sc1
buffer_load_dword v171, v33, s[4:7], s37 offen sc1
s_sub_u32 s28, s28, 1
s_cbranch_scc1 L_end
s_waitcnt vmcnt(10)
v_pk_add_f32 v[132:133], v[192:193], v[120:121]
v_pk_add_f32 v[134:135], v[194:195], v[122:123]
v_add_f32 v136, v224, v225
s_waitcnt vmcnt(6)
v_pk_add_f32 v[124:125], v[124:125], v[128:129]
v_pk_add_f32 v[126:127], v[126:127], v[130:131]
v_add_f32 v226, v226, v227
v_pk_add_f32 v[132:133], v[132:133], v[124:125]
v_pk_add_f32 v[134:135], v[134:135], v[126:127]
v_add_f32 v136, v136, v226
v_max3_u32 v55, v132, v133, v134
v_max3_u32 v55, v55, v135, v136
v_cmp_eq_u32 vcc, -1, v55
v_max3_f32 v236, v132, v133, v134
v_max3_f32 v236, v236, v135, v136
s_nop 1
v_max_f32_dpp v236, v236, v236 row_ror:8 row_mask:0xf bank_mask:0xf
v_mov_b32 v237, v236
s_nop 0
s_cbranch_vccz L_p3ok_f1
buffer_load_dwordx4 v[120:123], v27, s[4:7], s37 offen sc1
buffer_load_dword v225, v31, s[4:7], s37 offen sc1
buffer_load_dwordx4 v[124:127], v28, s[4:7], s37 offen sc1
buffer_load_dword v226, v32, s[4:7], s37 offen sc1
buffer_load_dwordx4 v[128:131], v29, s[4:7], s37 offen sc1
buffer_load_dword v227, v33, s[4:7], s37 offen sc1
s_waitcnt vmcnt(10)
v_pk_add_f32 v[132:133], v[192:193], v[152:153]
v_pk_add_f32 v[134:135], v[194:195], v[154:155]
v_add_f32 v136, v224, v169
s_waitcnt vmcnt(6)
v_pk_add_f32 v[156:157], v[156:157], v[160:161]
v_pk_add_f32 v[158:159], v[158:159], v[162:163]
v_add_f32 v170, v170, v171
v_pk_add_f32 v[132:133], v[132:133], v[156:157]
v_pk_add_f32 v[134:135], v[134:135], v[158:159]
v_add_f32 v136, v136, v170
v_max3_u32 v55, v132, v133, v134
v_max3_u32 v55, v55, v135, v136
v_cmp_eq_u32 vcc, -1, v55
v_max3_f32 v236, v132, v133, v134
v_max3_f32 v236, v236, v135, v136
s_nop 1
v_max_f32_dpp v236, v236, v236 row_ror:8 row_mask:0xf bank_mask:0xf
v_mov_b32 v237, v236
s_nop 0
s_cbranch_vccz L_p3ok_f1
s_branch L_p3s_f1
.p2align 6
L_loop_f2:
v_mov_b32 v108, 0
v_mov_b32 v109, 0
v_mov_b32 v110, 0
v_mov_b32 v111, 0
v_mov_b32 v112, 0
v_mov_b32 v113, 0
v_mov_b32 v114, 0
v_mov_b32 v115, 0
s_barrier
s_nop 15
s_nop 15
L_mr0_f2:
buffer_load_dwordx4 v[60:63], v22, s[4:7], s37 offen offset:0 sc1
L_mr1_f2:
buffer_load_dwordx4 v[64:67], v22, s[4:7], s37 offen offset:1024 sc1
L_mr2_f2:
buffer_load_dwordx4 v[68:71], v22, s[4:7], s37 offen offset:2048 sc1
L_mr3_f2:
buffer_load_dwordx4 v[72:75], v22, s[4:7], s37 offen offset:3072 sc1
s_sub_u32 s28, s28, 1
s_cbranch_scc1 L_end
s_nop 4
v_mov_b32 v92, 0
v_mov_b32 v93, 0
v_mov_b32 v94, 0
v_mov_b32 v95, 0
v_mov_b32 v96, 0
v_mov_b32 v97, 0
v_mov_b32 v98, 0
v_mov_b32 v99, 0
v_mov_b32 v100, 0
v_mov_b32 v101, 0
v_mov_b32 v102, 0
v_mov_b32 v103, 0
v_mov_b32 v104, 0
v_mov_b32 v105, 0
v_mov_b32 v106, 0
v_mov_b32 v107, 0
L_ms_f2:
L_mw0_f2:
s_waitcnt vmcnt(3)
v_max3_u32 v55, v60, v61, v62
v_max_u32 v55, v55, v63
v_cmp_eq_u32 vcc, -1, v55
v_smfmac_f32_16x16x64_bf16 v[92:95], v[60:63], a[0:7], v54
v_smfmac_f32_16x16x64_bf16 v[96:99], v[60:63], a[32:39], v54
s_cbranch_vccnz L_mr0_f2
v_smfmac_f32_16x16x64_bf16 v[100:103], v[60:63], a[64:71], v54
v_smfmac_f32_16x16x64_bf16 v[104:107], v[60:63], a[96:103], v54
L_mw1_f2:
s_waitcnt vmcnt(2)
v_max3_u32 v55, v64, v65, v66
v_max_u32 v55, v55, v67
v_cmp_eq_u32 vcc, -1, v55
v_smfmac_f32_16x16x64_bf16 v[92:95], v[64:67], a[8:15], v54
v_smfmac_f32_16x16x64_bf16 v[96:99], v[64:67], a[40:47], v54
s_cbranch_vccnz L_mr1_f2
v_smfmac_f32_16x16x64_bf16 v[100:103], v[64:67], a[72:79], v54
v_smfmac_f32_16x16x64_bf16 v[104:107], v[64:67], a[104:111], v54
L_mw2_f2:
s_waitcnt vmcnt(1)
v_max3_u32 v55, v68, v69, v70
v_max_u32 v55, v55, v71
v_cmp_eq_u32 vcc, -1, v55
v_smfmac_f32_16x16x64_bf16 v[92:95], v[68:71], a[16:23], v54
v_smfmac_f32_16x16x64_bf16 v[96:99], v[68:71], a[48:55], v54
s_cbranch_vccnz L_mr2_f2
v_smfmac_f32_16x16x64_bf16 v[100:103], v[68:71], a[80:87], v54
v_smfmac_f32_16x16x64_bf16 v[104:107], v[68:71], a[112:119], v54
L_mw3_f2:
s_waitcnt vmcnt(0)
v_max3_u32 v55, v72, v73, v74
v_max_u32 v55, v55, v75
v_cmp_eq_u32 vcc, -1, v55
v_smfmac_f32_16x16x64_bf16 v[92:95], v[72:75], a[24:31], v54
v_smfmac_f32_16x16x64_bf16 v[96:99], v[72:75], a[56:63], v54
s_cbranch_vccnz L_mr3_f2
v_smfmac_f32_16x16x64_bf16 v[100:103], v[72:75], a[88:95], v54
v_smfmac_f32_16x16x64_bf16 v[104:107], v[72:75], a[120:127], v54
L_md_f2:
v_permlane32_swap_b32 v92, v96
v_permlane32_swap_b32 v93, v97
v_pk_add_f32 v[92:93], v[92:93], v[96:97]
ds_write2_b32 v47, v92, v93 offset0:0 offset1:36
v_permlane32_swap_b32 v94, v98
v_permlane32_swap_b32 v95, v99
v_pk_add_f32 v[94:95], v[94:95], v[98:99]
ds_write2_b32 v47, v94, v95 offset0:72 offset1:108
v_permlane32_swap_b32 v100, v104
v_permlane32_swap_b32 v101, v105
v_pk_add_f32 v[100:101], v[100:101], v[104:105]
ds_write2_b32 v48, v100, v101 offset0:0 offset1:36
v_permlane32_swap_b32 v102, v106
v_permlane32_swap_b32 v103, v107
v_pk_add_f32 v[102:103], v[102:103], v[106:107]
ds_write2_b32 v48, v102, v103 offset0:72 offset1:108
v_smfmac_f32_16x16x64_bf16 v[108:111], v[60:63], a[128:135], v54
v_smfmac_f32_16x16x64_bf16 v[112:115], v[60:63], a[160:167], v54
v_smfmac_f32_16x16x64_bf16 v[108:111], v[64:67], a[136:143], v54
s_waitcnt lgkmcnt(0)
s_barrier
buffer_store_dwordx4 v[8:11], v41, s[4:7], s62 offen
buffer_store_dwordx4 v[8:11], v42, s[4:7], s62 offen
buffer_store_dwordx4 v[8:11], v43, s[4:7], s62 offen
v_smfmac_f32_16x16x64_bf16 v[112:115], v[64:67], a[168:175], v54
v_smfmac_f32_16x16x64_bf16 v[108:111], v[68:71], a[144:151], v54
v_smfmac_f32_16x16x64_bf16 v[112:115], v[68:71], a[176:183], v54
v_smfmac_f32_16x16x64_bf16 v[108:111], v[72:75], a[152:159], v54
v_smfmac_f32_16x16x64_bf16 v[112:115], v[72:75], a[184:191], v54
s_nop 7
v_permlane32_swap_b32 v108, v112
v_permlane32_swap_b32 v109, v113
v_permlane32_swap_b32 v110, v114
v_permlane32_swap_b32 v111, v115
v_pk_add_f32 v[108:109], v[108:109], v[112:113]
v_pk_add_f32 v[110:111], v[110:111], v[114:115]
ds_write_b128 v50, v[108:111]
s_waitcnt lgkmcnt(0)
s_barrier
s_cmp_eq_u32 s39, 63
s_cbranch_scc1 L_last_f2
s_barrier
s_nop 15
s_nop 15
L_or0_f2:
buffer_load_dwordx4 v[60:63], v23, s[4:7], s37 offen offset:0 sc1
L_or1_f2:
buffer_load_dwordx4 v[64:67], v23, s[4:7], s37 offen offset:1024 sc1
L_or2_f2:
buffer_load_dwordx4 v[68:71], v23, s[4:7], s37 offen offset:2048 sc1
L_or3_f2:
buffer_load_dwordx4 v[72:75], v23, s[4:7], s37 offen offset:3072 sc1
s_sub_u32 s28, s28, 1
s_cbranch_scc1 L_end
s_nop 4
v_mov_b32 v92, 0
v_mov_b32 v93, 0
v_mov_b32 v94, 0
v_mov_b32 v95, 0
v_mov_b32 v96, 0
v_mov_b32 v97, 0
v_mov_b32 v98, 0
v_mov_b32 v99, 0
L_os_f2:
L_ow0_f2:
s_waitcnt vmcnt(3)
v_max3_u32 v55, v60, v61, v62
v_max_u32 v55, v55, v63
v_cmp_eq_u32 vcc, -1, v55
v_smfmac_f32_16x16x64_bf16 v[92:95], v[60:63], a[192:199], v54
v_smfmac_f32_16x16x64_bf16 v[96:99], v[60:63], a[224:231], v54
s_cbranch_vccnz L_or0_f2
L_ow1_f2:
s_waitcnt vmcnt(2)
v_max3_u32 v55, v64, v65, v66
v_max_u32 v55, v55, v67
v_cmp_eq_u32 vcc, -1, v55
v_smfmac_f32_16x16x64_bf16 v[92:95], v[64:67], a[200:207], v54
v_smfmac_f32_16x16x64_bf16 v[96:99], v[64:67], a[232:239], v54
s_cbranch_vccnz L_or1_f2
L_ow2_f2:
s_waitcnt vmcnt(1)
v_max3_u32 v55, v68, v69, v70
v_max_u32 v55, v55, v71
v_cmp_eq_u32 vcc, -1, v55
v_smfmac_f32_16x16x64_bf16 v[92:95], v[68:71], a[208:215], v54
v_smfmac_f32_16x16x64_bf16 v[96:99], v[68:71], a[240:247], v54
s_cbranch_vccnz L_or2_f2
L_ow3_f2:
s_waitcnt vmcnt(0)
v_max3_u32 v55, v72, v73, v74
v_max_u32 v55, v55, v75
v_cmp_eq_u32 vcc, -1, v55
v_smfmac_f32_16x16x64_bf16 v[92:95], v[72:75], a[216:223], v54
v_smfmac_f32_16x16x64_bf16 v[96:99], v[72:75], a[248:255], v54
s_cbranch_vccnz L_or3_f2
L_od_f2:
s_nop 6
v_permlane32_swap_b32 v92, v96
v_permlane32_swap_b32 v93, v97
v_pk_add_f32 v[92:93], v[92:93], v[96:97]
ds_write2_b32 v52, v92, v93 offset0:0 offset1:36
v_permlane32_swap_b32 v94, v98
v_permlane32_swap_b32 v95, v99
v_pk_add_f32 v[94:95], v[94:95], v[98:99]
ds_write2_b32 v52, v94, v95 offset0:72 offset1:108
s_waitcnt lgkmcnt(0)
s_barrier
s_add_u32 s37, s37, 294912
s_cmp_eq_u32 s37, 1245184
s_cselect_b32 s37, 65536, s37
s_add_u32 s62, s62, 294912
s_cmp_eq_u32 s62, 1245184
s_cselect_b32 s62, 65536, s62
s_mov_b32 s43, s45
s_mov_b32 s45, s38
s_add_u32 s31, s31, 524288
s_add_u32 s39, s39, 1
s_branch L_loop_f2
L_last_f2:
s_branch L_rt7
L_pre_f3:
v_mov_b32 v7, v252
s_mov_b32 s30, 0
s_nop 0
.p2align 6
L_loop_f3:
v_readlane_b32 s24, v7, 0
v_readlane_b32 s25, v7, 1
s_nop 0
s_min_i32 s40, s24, s25
s_cmp_eq_u32 s30, 1
s_cbranch_scc1 L_have_f3
s_cmp_gt_i32 s40, s39
s_cbranch_scc1 L_flok_f3
L_fl_f3:
buffer_load_dword v7, v37, s[4:7], 0 offen sc1
s_sub_u32 s28, s28, 1
s_cbranch_scc1 L_end
s_waitcnt vmcnt(0)
v_readlane_b32 s24, v7, 0
v_readlane_b32 s25, v7, 1
s_nop 0
s_min_i32 s40, s24, s25
s_cmp_gt_i32 s40, s39
s_cbranch_scc0 L_fl_f3
L_flok_f3:
s_mov_b32 s24, s38
buffer_load_dwordx4 v[176:179], v35, s[4:7], s24 offen offset:0 sc1
buffer_load_dwordx4 v[180:183], v35, s[4:7], s24 offen offset:1024 sc1
buffer_load_dwordx4 v[184:187], v36, s[4:7], s24 offen offset:0 sc1
buffer_load_dwordx4 v[188:191], v36, s[4:7], s24 offen offset:1024 sc1
s_waitcnt vmcnt(0)
L_have_f3:
ds_write_b128 v2, v[176:179] offset:18432
ds_write_b128 v2, v[180:183] offset:19456
ds_write_b128 v2, v[184:187] offset:20480
ds_write_b128 v2, v[188:191] offset:21504
s_add_u32 s24, s39, 5
s_min_i32 s24, s24, 64
s_cmp_ge_i32 s40, s24
s_cbranch_scc1 L_nofl_f3
buffer_load_dword v7, v37, s[4:7], 0 offen sc1
L_nofl_f3:
s_add_u32 s25, s31, 524288
s_lshr_b32 s43, s25, 8
s_and_b32 s43, s43, 0x2000
s_xor_b32 s43, s43, s63
s_or_b32 s43, s43, s25
s_add_u32 s24, s39, 1
s_cmp_gt_i32 s40, s24
s_cselect_b32 s30, 1, 0
s_cselect_b32 s43, s43, 2147483648
v_mov_b32 v108, 0
v_mov_b32 v109, 0
v_mov_b32 v110, 0
v_mov_b32 v111, 0
v_mov_b32 v112, 0
v_mov_b32 v113, 0
v_mov_b32 v114, 0
v_mov_b32 v115, 0
s_waitcnt lgkmcnt(0)
s_barrier
s_nop 15
s_nop 15
L_mr0_f3:
buffer_load_dwordx4 v[60:63], v22, s[4:7], s37 offen offset:0 sc1
L_mr1_f3:
buffer_load_dwordx4 v[64:67], v22, s[4:7], s37 offen offset:1024 sc1
L_mr2_f3:
buffer_load_dwordx4 v[68:71], v22, s[4:7], s37 offen offset:2048 sc1
L_mr3_f3:
buffer_load_dwordx4 v[72:75], v22, s[4:7], s37 offen offset:3072 sc1
s_sub_u32 s28, s28, 1
s_cbranch_scc1 L_end
s_nop 4
v_mov_b32 v92, 0
v_mov_b32 v93, 0
v_mov_b32 v94, 0
v_mov_b32 v95, 0
v_mov_b32 v96, 0
v_mov_b32 v97, 0
v_mov_b32 v98, 0
v_mov_b32 v99, 0
v_mov_b32 v100, 0
v_mov_b32 v101, 0
v_mov_b32 v102, 0
v_mov_b32 v103, 0
v_mov_b32 v104, 0
v_mov_b32 v105, 0
v_mov_b32 v106, 0
v_mov_b32 v107, 0
L_ms_f3:
L_mw0_f3:
s_waitcnt vmcnt(3)
v_max3_u32 v55, v60, v61, v62
v_max_u32 v55, v55, v63
v_cmp_eq_u32 vcc, -1, v55
v_smfmac_f32_16x16x64_bf16 v[92:95], v[60:63], a[0:7], v54
v_smfmac_f32_16x16x64_bf16 v[96:99], v[60:63], a[32:39], v54
s_cbranch_vccnz L_mr0_f3
v_smfmac_f32_16x16x64_bf16 v[100:103], v[60:63], a[64:71], v54
v_smfmac_f32_16x16x64_bf16 v[104:107], v[60:63], a[96:103], v54
L_mw1_f3:
s_waitcnt vmcnt(2)
v_max3_u32 v55, v64, v65, v66
v_max_u32 v55, v55, v67
v_cmp_eq_u32 vcc, -1, v55
v_smfmac_f32_16x16x64_bf16 v[92:95], v[64:67], a[8:15], v54
v_smfmac_f32_16x16x64_bf16 v[96:99], v[64:67], a[40:47], v54
s_cbranch_vccnz L_mr1_f3
v_smfmac_f32_16x16x64_bf16 v[100:103], v[64:67], a[72:79], v54
v_smfmac_f32_16x16x64_bf16 v[104:107], v[64:67], a[104:111], v54
L_mw2_f3:
s_waitcnt vmcnt(1)
v_max3_u32 v55, v68, v69, v70
v_max_u32 v55, v55, v71
v_cmp_eq_u32 vcc, -1, v55
v_smfmac_f32_16x16x64_bf16 v[92:95], v[68:71], a[16:23], v54
v_smfmac_f32_16x16x64_bf16 v[96:99], v[68:71], a[48:55], v54
s_cbranch_vccnz L_mr2_f3
v_smfmac_f32_16x16x64_bf16 v[100:103], v[68:71], a[80:87], v54
v_smfmac_f32_16x16x64_bf16 v[104:107], v[68:71], a[112:119], v54
L_mw3_f3:
s_waitcnt vmcnt(0)
v_max3_u32 v55, v72, v73, v74
v_max_u32 v55, v55, v75
v_cmp_eq_u32 vcc, -1, v55
v_smfmac_f32_16x16x64_bf16 v[92:95], v[72:75], a[24:31], v54
v_smfmac_f32_16x16x64_bf16 v[96:99], v[72:75], a[56:63], v54
s_cbranch_vccnz L_mr3_f3
v_smfmac_f32_16x16x64_bf16 v[100:103], v[72:75], a[88:95], v54
v_smfmac_f32_16x16x64_bf16 v[104:107], v[72:75], a[120:127], v54
L_md_f3:
v_permlane32_swap_b32 v92, v96
v_permlane32_swap_b32 v93, v97
v_pk_add_f32 v[92:93], v[92:93], v[96:97]
ds_write2_b32 v47, v92, v93 offset0:0 offset1:36
v_permlane32_swap_b32 v94, v98
v_permlane32_swap_b32 v95, v99
v_pk_add_f32 v[94:95], v[94:95], v[98:99]
ds_write2_b32 v47, v94, v95 offset0:72 offset1:108
v_permlane32_swap_b32 v100, v104
v_permlane32_swap_b32 v101, v105
v_pk_add_f32 v[100:101], v[100:101], v[104:105]
ds_write2_b32 v48, v100, v101 offset0:0 offset1:36
v_permlane32_swap_b32 v102, v106
v_permlane32_swap_b32 v103, v107
v_pk_add_f32 v[102:103], v[102:103], v[106:107]
ds_write2_b32 v48, v102, v103 offset0:72 offset1:108
v_smfmac_f32_16x16x64_bf16 v[108:111], v[60:63], a[128:135], v54
v_smfmac_f32_16x16x64_bf16 v[112:115], v[60:63], a[160:167], v54
v_smfmac_f32_16x16x64_bf16 v[108:111], v[64:67], a[136:143], v54
s_waitcnt lgkmcnt(0)
s_barrier
buffer_load_dwordx4 v[176:179], v35, s[4:7], s43 offen offset:0 sc1
buffer_load_dwordx4 v[180:183], v35, s[4:7], s43 offen offset:1024 sc1
v_smfmac_f32_16x16x64_bf16 v[112:115], v[64:67], a[168:175], v54
v_smfmac_f32_16x16x64_bf16 v[108:111], v[68:71], a[144:151], v54
v_smfmac_f32_16x16x64_bf16 v[112:115], v[68:71], a[176:183], v54
v_smfmac_f32_16x16x64_bf16 v[108:111], v[72:75], a[152:159], v54
v_smfmac_f32_16x16x64_bf16 v[112:115], v[72:75], a[184:191], v54
s_nop 7
v_permlane32_swap_b32 v108, v112
v_permlane32_swap_b32 v109, v113
v_permlane32_swap_b32 v110, v114
v_permlane32_swap_b32 v111, v115
v_pk_add_f32 v[108:109], v[108:109], v[112:113]
v_pk_add_f32 v[110:111], v[110:111], v[114:115]
ds_write_b128 v50, v[108:111]
s_waitcnt lgkmcnt(0)
s_barrier
s_cmp_eq_u32 s39, 63
s_cbranch_scc1 L_last_f3
s_nop 15
s_nop 15
s_nop 15
s_nop 15
s_nop 15
s_nop 15
buffer_load_dwordx4 v[184:187], v36, s[4:7], s43 offen offset:0 sc1
buffer_load_dwordx4 v[188:191], v36, s[4:7], s43 offen offset:1024 sc1
s_barrier
s_nop 15
s_nop 15
L_or0_f3:
buffer_load_dwordx4 v[60:63], v23, s[4:7], s37 offen offset:0 sc1
L_or1_f3:
buffer_load_dwordx4 v[64:67], v23, s[4:7], s37 offen offset:1024 sc1
L_or2_f3:
buffer_load_dwordx4 v[68:71], v23, s[4:7], s37 offen offset:2048 sc1
L_or3_f3:
buffer_load_dwordx4 v[72:75], v23, s[4:7], s37 offen offset:3072 sc1
s_sub_u32 s28, s28, 1
s_cbranch_scc1 L_end
s_nop 4
v_mov_b32 v92, 0
v_mov_b32 v93, 0
v_mov_b32 v94, 0
v_mov_b32 v95, 0
v_mov_b32 v96, 0
v_mov_b32 v97, 0
v_mov_b32 v98, 0
v_mov_b32 v99, 0
L_os_f3:
L_ow0_f3:
s_waitcnt vmcnt(3)
v_max3_u32 v55, v60, v61, v62
v_max_u32 v55, v55, v63
v_cmp_eq_u32 vcc, -1, v55
v_smfmac_f32_16x16x64_bf16 v[92:95], v[60:63], a[192:199], v54
v_smfmac_f32_16x16x64_bf16 v[96:99], v[60:63], a[224:231], v54
s_cbranch_vccnz L_or0_f3
L_ow1_f3:
s_waitcnt vmcnt(2)
v_max3_u32 v55, v64, v65, v66
v_max_u32 v55, v55, v67
v_cmp_eq_u32 vcc, -1, v55
v_smfmac_f32_16x16x64_bf16 v[92:95], v[64:67], a[200:207], v54
v_smfmac_f32_16x16x64_bf16 v[96:99], v[64:67], a[232:239], v54
s_cbranch_vccnz L_or1_f3
L_ow2_f3:
s_waitcnt vmcnt(1)
v_max3_u32 v55, v68, v69, v70
v_max_u32 v55, v55, v71
v_cmp_eq_u32 vcc, -1, v55
v_smfmac_f32_16x16x64_bf16 v[92:95], v[68:71], a[208:215], v54
v_smfmac_f32_16x16x64_bf16 v[96:99], v[68:71], a[240:247], v54
s_cbranch_vccnz L_or2_f3
L_ow3_f3:
s_waitcnt vmcnt(0)
v_max3_u32 v55, v72, v73, v74
v_max_u32 v55, v55, v75
v_cmp_eq_u32 vcc, -1, v55
v_smfmac_f32_16x16x64_bf16 v[92:95], v[72:75], a[216:223], v54
v_smfmac_f32_16x16x64_bf16 v[96:99], v[72:75], a[248:255], v54
s_cbranch_vccnz L_or3_f3
L_od_f3:
s_nop 6
v_permlane32_swap_b32 v92, v96
v_permlane32_swap_b32 v93, v97
v_pk_add_f32 v[92:93], v[92:93], v[96:97]
ds_write2_b32 v52, v92, v93 offset0:0 offset1:36
v_permlane32_swap_b32 v94, v98
v_permlane32_swap_b32 v95, v99
v_pk_add_f32 v[94:95], v[94:95], v[98:99]
ds_write2_b32 v52, v94, v95 offset0:72 offset1:108
s_waitcnt lgkmcnt(0)
s_barrier
s_add_u32 s37, s37, 294912
s_cmp_eq_u32 s37, 1245184
s_cselect_b32 s37, 65536, s37
s_add_u32 s62, s62, 294912
s_cmp_eq_u32 s62, 1245184
s_cselect_b32 s62, 65536, s62
s_mov_b32 s43, s45
s_mov_b32 s45, s38
s_add_u32 s31, s31, 524288
s_add_u32 s39, s39, 1
s_lshr_b32 s38, s31, 8
s_and_b32 s38, s38, 0x2000
s_xor_b32 s38, s38, s63
s_or_b32 s38, s38, s31
s_branch L_loop_f3
L_last_f3:
s_branch L_rt7
L_r_safe:
s_cmp_eq_u32 s20, 1
s_cbranch_scc1 L_pre_s1
s_cmp_eq_u32 s20, 2
s_cbranch_scc1 L_loop_s2
s_cmp_eq_u32 s20, 3
s_cbranch_scc1 L_pre_s3
v_mov_b32 v92, 0
v_mov_b32 v93, 0
v_mov_b32 v94, 0
v_mov_b32 v95, 0
v_mov_b32 v96, 0
v_mov_b32 v97, 0
v_mov_b32 v98, 0
v_mov_b32 v99, 0
v_mov_b32 v100, 0
v_mov_b32 v101, 0
v_mov_b32 v102, 0
v_mov_b32 v103, 0
v_mov_b32 v104, 0
v_mov_b32 v105, 0
v_mov_b32 v106, 0
v_mov_b32 v107, 0
v_mov_b32 v108, 0
v_mov_b32 v109, 0
v_mov_b32 v110, 0
v_mov_b32 v111, 0
v_mov_b32 v112, 0
v_mov_b32 v113, 0
v_mov_b32 v114, 0
v_mov_b32 v115, 0
v_min_u32 v232, -2, v232
v_min_u32 v233, -2, v233
buffer_store_dwordx2 v[232:233], v21, s[4:7], s37 offen sc1
s_branch L_s1d_s0
.p2align 6
L_loop_s0:
v_mov_b32 v108, 0
v_mov_b32 v109, 0
v_mov_b32 v110, 0
v_mov_b32 v111, 0
v_mov_b32 v112, 0
v_mov_b32 v113, 0
v_mov_b32 v114, 0
v_mov_b32 v115, 0
s_nop 15
s_nop 15
s_nop 15
s_nop 15
s_nop 15
s_nop 15
s_nop 15
L_p1_s0:
buffer_load_dwordx4 v[116:119], v17, s[4:7], s43 offen sc1
buffer_load_dwordx4 v[120:123], v18, s[4:7], s43 offen sc1
buffer_load_dwordx4 v[124:127], v19, s[4:7], s43 offen sc1
s_sub_u32 s28, s28, 1
s_cbranch_scc1 L_end
s_waitcnt vmcnt(2)
v_pk_add_f32 v[164:165], v[116:117], v[228:229]
v_pk_add_f32 v[166:167], v[118:119], v[230:231]
s_waitcnt vmcnt(0)
v_pk_add_f32 v[120:121], v[120:121], v[124:125]
v_pk_add_f32 v[122:123], v[122:123], v[126:127]
v_pk_add_f32 v[164:165], v[164:165], v[120:121]
v_pk_add_f32 v[166:167], v[166:167], v[122:123]
v_max3_u32 v55, v164, v165, v166
v_max_u32 v55, v55, v167
v_cmpx_ne_u32 vcc, -1, v55
v_cvt_pk_bf16_f32 v232, v164, v165
v_cvt_pk_bf16_f32 v233, v166, v167
buffer_store_dwordx2 v[232:233], v21, s[4:7], s37 offen sc1
s_mov_b64 exec, -1
s_cmp_eq_u64 vcc, -1
s_cbranch_scc0 L_p1_s0
L_s1d_s0:
s_barrier
s_nop 15
s_nop 15
L_mr0_s0:
buffer_load_dwordx4 v[60:63], v22, s[4:7], s37 offen offset:0 sc1
L_mr1_s0:
buffer_load_dwordx4 v[64:67], v22, s[4:7], s37 offen offset:1024 sc1
L_mr2_s0:
buffer_load_dwordx4 v[68:71], v22, s[4:7], s37 offen offset:2048 sc1
L_mr3_s0:
buffer_load_dwordx4 v[72:75], v22, s[4:7], s37 offen offset:3072 sc1
s_sub_u32 s28, s28, 1
s_cbranch_scc1 L_end
s_nop 4
v_mov_b32 v92, 0
v_mov_b32 v93, 0
v_mov_b32 v94, 0
v_mov_b32 v95, 0
v_mov_b32 v96, 0
v_mov_b32 v97, 0
v_mov_b32 v98, 0
v_mov_b32 v99, 0
v_mov_b32 v100, 0
v_mov_b32 v101, 0
v_mov_b32 v102, 0
v_mov_b32 v103, 0
v_mov_b32 v104, 0
v_mov_b32 v105, 0
v_mov_b32 v106, 0
v_mov_b32 v107, 0
L_ms_s0:
L_mw0_s0:
s_waitcnt vmcnt(3)
v_max3_u32 v55, v60, v61, v62
v_max_u32 v55, v55, v63
v_cmp_eq_u32 vcc, -1, v55
v_smfmac_f32_16x16x64_bf16 v[92:95], v[60:63], a[0:7], v54
v_smfmac_f32_16x16x64_bf16 v[96:99], v[60:63], a[32:39], v54
s_cbranch_vccnz L_mr0_s0
v_smfmac_f32_16x16x64_bf16 v[100:103], v[60:63], a[64:71], v54
v_smfmac_f32_16x16x64_bf16 v[104:107], v[60:63], a[96:103], v54
L_mw1_s0:
s_waitcnt vmcnt(2)
v_max3_u32 v55, v64, v65, v66
v_max_u32 v55, v55, v67
v_cmp_eq_u32 vcc, -1, v55
v_smfmac_f32_16x16x64_bf16 v[92:95], v[64:67], a[8:15], v54
v_smfmac_f32_16x16x64_bf16 v[96:99], v[64:67], a[40:47], v54
s_cbranch_vccnz L_mr1_s0
v_smfmac_f32_16x16x64_bf16 v[100:103], v[64:67], a[72:79], v54
v_smfmac_f32_16x16x64_bf16 v[104:107], v[64:67], a[104:111], v54
L_mw2_s0:
s_waitcnt vmcnt(1)
v_max3_u32 v55, v68, v69, v70
v_max_u32 v55, v55, v71
v_cmp_eq_u32 vcc, -1, v55
v_smfmac_f32_16x16x64_bf16 v[92:95], v[68:71], a[16:23], v54
v_smfmac_f32_16x16x64_bf16 v[96:99], v[68:71], a[48:55], v54
s_cbranch_vccnz L_mr2_s0
v_smfmac_f32_16x16x64_bf16 v[100:103], v[68:71], a[80:87], v54
v_smfmac_f32_16x16x64_bf16 v[104:107], v[68:71], a[112:119], v54
L_mw3_s0:
s_waitcnt vmcnt(0)
v_max3_u32 v55, v72, v73, v74
v_max_u32 v55, v55, v75
v_cmp_eq_u32 vcc, -1, v55
v_smfmac_f32_16x16x64_bf16 v[92:95], v[72:75], a[24:31], v54
v_smfmac_f32_16x16x64_bf16 v[96:99], v[72:75], a[56:63], v54
s_cbranch_vccnz L_mr3_s0
v_smfmac_f32_16x16x64_bf16 v[100:103], v[72:75], a[88:95], v54
v_smfmac_f32_16x16x64_bf16 v[104:107], v[72:75], a[120:127], v54
L_md_s0:
v_permlane32_swap_b32 v92, v96
v_permlane32_swap_b32 v93, v97
v_pk_add_f32 v[92:93], v[92:93], v[96:97]
ds_write2_b32 v47, v92, v93 offset0:0 offset1:36
v_permlane32_swap_b32 v94, v98
v_permlane32_swap_b32 v95, v99
v_pk_add_f32 v[94:95], v[94:95], v[98:99]
ds_write2_b32 v47, v94, v95 offset0:72 offset1:108
v_permlane32_swap_b32 v100, v104
v_permlane32_swap_b32 v101, v105
v_pk_add_f32 v[100:101], v[100:101], v[104:105]
ds_write2_b32 v48, v100, v101 offset0:0 offset1:36
v_permlane32_swap_b32 v102, v106
v_permlane32_swap_b32 v103, v107
v_pk_add_f32 v[102:103], v[102:103], v[106:107]
ds_write2_b32 v48, v102, v103 offset0:72 offset1:108
v_smfmac_f32_16x16x64_bf16 v[108:111], v[60:63], a[128:135], v54
v_smfmac_f32_16x16x64_bf16 v[112:115], v[60:63], a[160:167], v54
v_smfmac_f32_16x16x64_bf16 v[108:111], v[64:67], a[136:143], v54
s_waitcnt lgkmcnt(0)
s_barrier
v_smfmac_f32_16x16x64_bf16 v[112:115], v[64:67], a[168:175], v54
v_smfmac_f32_16x16x64_bf16 v[108:111], v[68:71], a[144:151], v54
v_smfmac_f32_16x16x64_bf16 v[112:115], v[68:71], a[176:183], v54
v_smfmac_f32_16x16x64_bf16 v[108:111], v[72:75], a[152:159], v54
v_smfmac_f32_16x16x64_bf16 v[112:115], v[72:75], a[184:191], v54
s_nop 7
v_permlane32_swap_b32 v108, v112
v_permlane32_swap_b32 v109, v113
v_permlane32_swap_b32 v110, v114
v_permlane32_swap_b32 v111, v115
v_pk_add_f32 v[108:109], v[108:109], v[112:113]
v_pk_add_f32 v[110:111], v[110:111], v[114:115]
ds_write_b128 v50, v[108:111]
s_waitcnt lgkmcnt(0)
s_barrier
s_cmp_eq_u32 s39, 63
s_cbranch_scc1 L_last_s0
s_barrier
s_nop 15
s_nop 15
L_or0_s0:
buffer_load_dwordx4 v[60:63], v23, s[4:7], s37 offen offset:0 sc1
L_or1_s0:
buffer_load_dwordx4 v[64:67], v23, s[4:7], s37 offen offset:1024 sc1
L_or2_s0:
buffer_load_dwordx4 v[68:71], v23, s[4:7], s37 offen offset:2048 sc1
L_or3_s0:
buffer_load_dwordx4 v[72:75], v23, s[4:7], s37 offen offset:3072 sc1
s_sub_u32 s28, s28, 1
s_cbranch_scc1 L_end
s_nop 4
v_mov_b32 v92, 0
v_mov_b32 v93, 0
v_mov_b32 v94, 0
v_mov_b32 v95, 0
v_mov_b32 v96, 0
v_mov_b32 v97, 0
v_mov_b32 v98, 0
v_mov_b32 v99, 0
L_os_s0:
L_ow0_s0:
s_waitcnt vmcnt(3)
v_max3_u32 v55, v60, v61, v62
v_max_u32 v55, v55, v63
v_cmp_eq_u32 vcc, -1, v55
v_smfmac_f32_16x16x64_bf16 v[92:95], v[60:63], a[192:199], v54
v_smfmac_f32_16x16x64_bf16 v[96:99], v[60:63], a[224:231], v54
s_cbranch_vccnz L_or0_s0
L_ow1_s0:
s_waitcnt vmcnt(2)
v_max3_u32 v55, v64, v65, v66
v_max_u32 v55, v55, v67
v_cmp_eq_u32 vcc, -1, v55
v_smfmac_f32_16x16x64_bf16 v[92:95], v[64:67], a[200:207], v54
v_smfmac_f32_16x16x64_bf16 v[96:99], v[64:67], a[232:239], v54
s_cbranch_vccnz L_or1_s0
L_ow2_s0:
s_waitcnt vmcnt(1)
v_max3_u32 v55, v68, v69, v70
v_max_u32 v55, v55, v71
v_cmp_eq_u32 vcc, -1, v55
v_smfmac_f32_16x16x64_bf16 v[92:95], v[68:71], a[208:215], v54
v_smfmac_f32_16x16x64_bf16 v[96:99], v[68:71], a[240:247], v54
s_cbranch_vccnz L_or2_s0
L_ow3_s0:
s_waitcnt vmcnt(0)
v_max3_u32 v55, v72, v73, v74
v_max_u32 v55, v55, v75
v_cmp_eq_u32 vcc, -1, v55
v_smfmac_f32_16x16x64_bf16 v[92:95], v[72:75], a[216:223], v54
v_smfmac_f32_16x16x64_bf16 v[96:99], v[72:75], a[248:255], v54
s_cbranch_vccnz L_or3_s0
L_od_s0:
s_nop 6
v_permlane32_swap_b32 v92, v96
v_permlane32_swap_b32 v93, v97
v_pk_add_f32 v[92:93], v[92:93], v[96:97]
ds_write2_b32 v52, v92, v93 offset0:0 offset1:36
v_permlane32_swap_b32 v94, v98
v_permlane32_swap_b32 v95, v99
v_pk_add_f32 v[94:95], v[94:95], v[98:99]
ds_write2_b32 v52, v94, v95 offset0:72 offset1:108
s_waitcnt lgkmcnt(0)
s_barrier
ds_read_b128 v[116:119], v53 offset:0
ds_read_b128 v[120:123], v53 offset:1152
ds_read_b128 v[124:127], v53 offset:2304
ds_read_b128 v[128:131], v53 offset:3456
s_waitcnt lgkmcnt(2)
v_pk_add_f32 v[116:117], v[116:117], v[120:121]
v_pk_add_f32 v[118:119], v[118:119], v[122:123]
s_waitcnt lgkmcnt(1)
v_pk_add_f32 v[116:117], v[116:117], v[124:125]
v_pk_add_f32 v[118:119], v[118:119], v[126:127]
s_waitcnt lgkmcnt(0)
v_pk_add_f32 v[228:229], v[116:117], v[128:129]
v_pk_add_f32 v[230:231], v[118:119], v[130:131]
buffer_store_dwordx4 v[228:231], v20, s[4:7], s45 offen sc1
s_add_u32 s37, s37, 294912
s_cmp_eq_u32 s37, 1245184
s_cselect_b32 s37, 65536, s37
s_add_u32 s62, s62, 294912
s_cmp_eq_u32 s62, 1245184
s_cselect_b32 s62, 65536, s62
s_mov_b32 s43, s45
s_mov_b32 s45, s38
s_add_u32 s31, s31, 524288
s_add_u32 s39, s39, 1
s_lshr_b32 s38, s31, 8
s_and_b32 s38, s38, 0x2000
s_xor_b32 s38, s38, s63
s_or_b32 s38, s38, s31
s_branch L_loop_s0
L_last_s0:
s_branch L_rt7
L_pre_s1:
.p2align 6
L_loop_s1:
s_cmp_eq_u32 s39, 0
s_cbranch_scc1 L_nokvm_s1
ds_write_b32 v39, v204
ds_write_b32 v39, v208 offset:256
s_waitcnt lgkmcnt(0)
s_mov_b64 exec, s[92:93]
ds_read_b128 v[172:175], v44
s_mov_b64 exec, -1
s_sub_u32 s27, s39, 1
v_mov_b32 v46, s27
s_waitcnt lgkmcnt(0)
buffer_store_dwordx4 v[172:175], v38, s[4:7], s45 offen sc1
buffer_store_dword v46, v45, s[4:7], 0 offen sc1
L_nokvm_s1:
v_mov_b32 v108, 0
v_mov_b32 v109, 0
v_mov_b32 v110, 0
v_mov_b32 v111, 0
v_mov_b32 v112, 0
v_mov_b32 v113, 0
v_mov_b32 v114, 0
v_mov_b32 v115, 0
s_barrier
ds_read_b128 v[176:179], v2 offset:18432
ds_read_b128 v[180:183], v2 offset:19456
ds_read_b128 v[184:187], v2 offset:20480
ds_read_b128 v[188:191], v2 offset:21504
s_nop 15
s_nop 11
L_mr0_s1:
buffer_load_dwordx4 v[60:63], v22, s[4:7], s37 offen offset:0 sc1
L_mr1_s1:
buffer_load_dwordx4 v[64:67], v22, s[4:7], s37 offen offset:1024 sc1
L_mr2_s1:
buffer_load_dwordx4 v[68:71], v22, s[4:7], s37 offen offset:2048 sc1
L_mr3_s1:
buffer_load_dwordx4 v[72:75], v22, s[4:7], s37 offen offset:3072 sc1
s_sub_u32 s28, s28, 1
s_cbranch_scc1 L_end
s_nop 4
v_mov_b32 v92, 0
v_mov_b32 v93, 0
v_mov_b32 v94, 0
v_mov_b32 v95, 0
v_mov_b32 v96, 0
v_mov_b32 v97, 0
v_mov_b32 v98, 0
v_mov_b32 v99, 0
v_mov_b32 v100, 0
v_mov_b32 v101, 0
v_mov_b32 v102, 0
v_mov_b32 v103, 0
v_mov_b32 v104, 0
v_mov_b32 v105, 0
v_mov_b32 v106, 0
v_mov_b32 v107, 0
L_ms_s1:
L_mw0_s1:
s_waitcnt vmcnt(3)
v_max3_u32 v55, v60, v61, v62
v_max_u32 v55, v55, v63
v_cmp_eq_u32 vcc, -1, v55
v_smfmac_f32_16x16x64_bf16 v[92:95], v[60:63], a[0:7], v54
v_smfmac_f32_16x16x64_bf16 v[96:99], v[60:63], a[32:39], v54
s_cbranch_vccnz L_mr0_s1
v_smfmac_f32_16x16x64_bf16 v[100:103], v[60:63], a[64:71], v54
v_smfmac_f32_16x16x64_bf16 v[104:107], v[60:63], a[96:103], v54
L_mw1_s1:
s_waitcnt vmcnt(2)
v_max3_u32 v55, v64, v65, v66
v_max_u32 v55, v55, v67
v_cmp_eq_u32 vcc, -1, v55
v_smfmac_f32_16x16x64_bf16 v[92:95], v[64:67], a[8:15], v54
v_smfmac_f32_16x16x64_bf16 v[96:99], v[64:67], a[40:47], v54
s_cbranch_vccnz L_mr1_s1
v_smfmac_f32_16x16x64_bf16 v[100:103], v[64:67], a[72:79], v54
v_smfmac_f32_16x16x64_bf16 v[104:107], v[64:67], a[104:111], v54
L_mw2_s1:
s_waitcnt vmcnt(1)
v_max3_u32 v55, v68, v69, v70
v_max_u32 v55, v55, v71
v_cmp_eq_u32 vcc, -1, v55
v_smfmac_f32_16x16x64_bf16 v[92:95], v[68:71], a[16:23], v54
v_smfmac_f32_16x16x64_bf16 v[96:99], v[68:71], a[48:55], v54
s_cbranch_vccnz L_mr2_s1
v_smfmac_f32_16x16x64_bf16 v[100:103], v[68:71], a[80:87], v54
v_smfmac_f32_16x16x64_bf16 v[104:107], v[68:71], a[112:119], v54
L_mw3_s1:
s_waitcnt vmcnt(0)
v_max3_u32 v55, v72, v73, v74
v_max_u32 v55, v55, v75
v_cmp_eq_u32 vcc, -1, v55
v_smfmac_f32_16x16x64_bf16 v[92:95], v[72:75], a[24:31], v54
v_smfmac_f32_16x16x64_bf16 v[96:99], v[72:75], a[56:63], v54
s_cbranch_vccnz L_mr3_s1
v_smfmac_f32_16x16x64_bf16 v[100:103], v[72:75], a[88:95], v54
v_smfmac_f32_16x16x64_bf16 v[104:107], v[72:75], a[120:127], v54
L_md_s1:
v_permlane32_swap_b32 v92, v96
v_permlane32_swap_b32 v93, v97
v_pk_add_f32 v[92:93], v[92:93], v[96:97]
ds_write2_b32 v47, v92, v93 offset0:0 offset1:36
v_permlane32_swap_b32 v94, v98
v_permlane32_swap_b32 v95, v99
v_pk_add_f32 v[94:95], v[94:95], v[98:99]
ds_write2_b32 v47, v94, v95 offset0:72 offset1:108
v_permlane32_swap_b32 v100, v104
v_permlane32_swap_b32 v101, v105
v_pk_add_f32 v[100:101], v[100:101], v[104:105]
ds_write2_b32 v48, v100, v101 offset0:0 offset1:36
v_permlane32_swap_b32 v102, v106
v_permlane32_swap_b32 v103, v107
v_pk_add_f32 v[102:103], v[102:103], v[106:107]
ds_write2_b32 v48, v102, v103 offset0:72 offset1:108
v_smfmac_f32_16x16x64_bf16 v[108:111], v[60:63], a[128:135], v54
v_smfmac_f32_16x16x64_bf16 v[112:115], v[60:63], a[160:167], v54
v_smfmac_f32_16x16x64_bf16 v[108:111], v[64:67], a[136:143], v54
s_waitcnt lgkmcnt(0)
s_barrier
ds_read_b128 v[116:119], v49 offset:0
ds_read_b128 v[120:123], v49 offset:16
ds_read_b128 v[124:127], v49 offset:2304
ds_read_b128 v[128:131], v49 offset:2320
ds_read_b128 v[132:135], v49 offset:4608
ds_read_b128 v[136:139], v49 offset:4624
ds_read_b128 v[140:143], v49 offset:6912
ds_read_b128 v[144:147], v49 offset:6928
v_smfmac_f32_16x16x64_bf16 v[112:115], v[64:67], a[168:175], v54
v_smfmac_f32_16x16x64_bf16 v[108:111], v[68:71], a[144:151], v54
s_waitcnt lgkmcnt(4)
v_pk_add_f32 v[116:117], v[116:117], v[124:125]
v_pk_add_f32 v[118:119], v[118:119], v[126:127]
v_pk_add_f32 v[120:121], v[120:121], v[128:129]
v_pk_add_f32 v[122:123], v[122:123], v[130:131]
v_smfmac_f32_16x16x64_bf16 v[112:115], v[68:71], a[176:183], v54
s_waitcnt lgkmcnt(2)
v_pk_add_f32 v[116:117], v[116:117], v[132:133]
v_pk_add_f32 v[118:119], v[118:119], v[134:135]
v_pk_add_f32 v[120:121], v[120:121], v[136:137]
v_pk_add_f32 v[122:123], v[122:123], v[138:139]
s_waitcnt lgkmcnt(0)
v_pk_add_f32 v[116:117], v[116:117], v[140:141]
v_cvt_pk_bf16_f32 v172, v116, v117
v_pk_add_f32 v[118:119], v[118:119], v[142:143]
v_cvt_pk_bf16_f32 v173, v118, v119
v_pk_add_f32 v[120:121], v[120:121], v[144:145]
v_cvt_pk_bf16_f32 v174, v120, v121
v_pk_add_f32 v[122:123], v[122:123], v[146:147]
v_cvt_pk_bf16_f32 v175, v122, v123
s_nop 1
v_mfma_f32_16x16x32_bf16 v[192:195], v[176:179], v[172:175], 0
v_mfma_f32_16x16x32_bf16 v[196:199], v[180:183], v[172:175], 0
v_mfma_f32_16x16x32_bf16 v[200:203], v[172:175], v[172:175], 0
buffer_store_dwordx4 v[192:195], v24, s[4:7], s37 offen sc1
v_smfmac_f32_16x16x64_bf16 v[108:111], v[72:75], a[152:159], v54
buffer_store_dwordx4 v[196:199], v24, s[4:7], s37 offen offset:128 sc1
v_smfmac_f32_16x16x64_bf16 v[112:115], v[72:75], a[184:191], v54
buffer_store_dwordx4 v[200:203], v25, s[4:7], s37 offen sc1
ds_write_b128 v2, v[200:203] offset:23552
v_mov_b32_dpp v192, v196 row_ror:8 row_mask:0xf bank_mask:0xc
v_mov_b32_dpp v193, v197 row_ror:8 row_mask:0xf bank_mask:0xc
v_mov_b32_dpp v194, v198 row_ror:8 row_mask:0xf bank_mask:0xc
v_mov_b32_dpp v195, v199 row_ror:8 row_mask:0xf bank_mask:0xc
s_nop 1
v_permlane32_swap_b32 v108, v112
v_permlane32_swap_b32 v109, v113
v_permlane32_swap_b32 v110, v114
v_permlane32_swap_b32 v111, v115
v_pk_add_f32 v[108:109], v[108:109], v[112:113]
v_pk_add_f32 v[110:111], v[110:111], v[114:115]
ds_write_b128 v50, v[108:111]
s_waitcnt lgkmcnt(0)
s_barrier
buffer_load_dwordx4 v[120:123], v27, s[4:7], s37 offen sc1
buffer_load_dword v225, v31, s[4:7], s37 offen sc1
buffer_load_dwordx4 v[124:127], v28, s[4:7], s37 offen sc1
buffer_load_dword v226, v32, s[4:7], s37 offen sc1
buffer_load_dwordx4 v[128:131], v29, s[4:7], s37 offen sc1
buffer_load_dword v227, v33, s[4:7], s37 offen sc1
ds_read_b32 v224, v30
ds_read_b64 v[132:133], v51 offset:0
ds_read_b64 v[134:135], v51 offset:1024
ds_read_b64 v[136:137], v51 offset:2048
ds_read_b64 v[138:139], v51 offset:3072
ds_read_b64 v[140:141], v51 offset:128
ds_read_b64 v[142:143], v51 offset:1152
ds_read_b64 v[144:145], v51 offset:2176
ds_read_b64 v[146:147], v51 offset:3200
s_waitcnt lgkmcnt(0)
v_pk_add_f32 v[132:133], v[132:133], v[136:137]
v_pk_add_f32 v[134:135], v[134:135], v[138:139]
v_pk_add_f32 v[132:133], v[132:133], v[134:135]
v_cvt_pk_bf16_f32 v204, v132, v133
v_pk_add_f32 v[140:141], v[140:141], v[144:145]
v_pk_add_f32 v[142:143], v[142:143], v[146:147]
v_pk_add_f32 v[140:141], v[140:141], v[142:143]
v_cvt_pk_bf16_f32 v208, v140, v141
s_cmp_eq_u32 s39, 63
s_cbranch_scc1 L_last_s1
buffer_load_dwordx4 v[152:155], v27, s[4:7], s37 offen sc1
buffer_load_dword v169, v31, s[4:7], s37 offen sc1
buffer_load_dwordx4 v[156:159], v28, s[4:7], s37 offen sc1
buffer_load_dword v170, v32, s[4:7], s37 offen sc1
buffer_load_dwordx4 v[160:163], v29, s[4:7], s37 offen sc1
buffer_load_dword v171, v33, s[4:7], s37 offen sc1
s_waitcnt vmcnt(10)
v_pk_add_f32 v[132:133], v[192:193], v[120:121]
v_pk_add_f32 v[134:135], v[194:195], v[122:123]
v_add_f32 v136, v224, v225
s_waitcnt vmcnt(6)
v_pk_add_f32 v[124:125], v[124:125], v[128:129]
v_pk_add_f32 v[126:127], v[126:127], v[130:131]
v_add_f32 v226, v226, v227
v_pk_add_f32 v[132:133], v[132:133], v[124:125]
v_pk_add_f32 v[134:135], v[134:135], v[126:127]
v_add_f32 v136, v136, v226
v_max3_u32 v55, v132, v133, v134
v_max3_u32 v55, v55, v135, v136
v_cmp_eq_u32 vcc, -1, v55
v_max3_f32 v236, v132, v133, v134
v_max3_f32 v236, v236, v135, v136
s_nop 1
v_max_f32_dpp v236, v236, v236 row_ror:8 row_mask:0xf bank_mask:0xf
v_mov_b32 v237, v236
s_cbranch_vccnz L_p3r_s1
L_p3ok_s1:
s_nop 0
v_permlane16_swap_b32 v236, v237
v_max_f32 v236, v236, v237
v_mov_b32 v237, v236
s_nop 1
v_permlane32_swap_b32 v236, v237
v_max_f32 v236, v236, v237
v_mul_f32 v236, s44, v236
v_fma_f32 v132, v132, s44, -v236
v_fma_f32 v133, v133, s44, -v236
v_fma_f32 v134, v134, s44, -v236
v_fma_f32 v135, v135, s44, -v236
v_fma_f32 v136, v136, s44, -v236
v_exp_f32 v132, v132
v_exp_f32 v133, v133
v_exp_f32 v134, v134
v_exp_f32 v135, v135
v_cvt_pk_bf16_f32 v216, v132, v133
v_cvt_pk_bf16_f32 v217, v134, v135
v_exp_f32 v136, v136
v_mov_b32_dpp v218, v216 row_ror:8 row_mask:0xf bank_mask:0xf
v_mov_b32_dpp v219, v217 row_ror:8 row_mask:0xf bank_mask:0xf
v_mov_b32_dpp v237, v136 row_ror:8 row_mask:0xf bank_mask:0xf
v_cvt_pk_bf16_f32 v220, v136, v237
v_mfma_f32_16x16x32_bf16 v[200:203], v[212:215], v[216:219], 0
v_mfma_f32_16x16x32_bf16 v[200:203], v[212:215], v[220:223], v[200:203]
v_mfma_f32_16x16x32_bf16 v[192:195], v[184:187], v[216:219], 0
v_mfma_f32_16x16x32_bf16 v[192:195], v[204:207], v[220:223], v[192:195]
v_rcp_f32 v238, v200
v_mfma_f32_16x16x32_bf16 v[196:199], v[188:191], v[216:219], 0
v_mfma_f32_16x16x32_bf16 v[196:199], v[208:211], v[220:223], v[196:199]
v_pk_mul_f32 v[192:193], v[192:193], v[238:239] op_sel_hi:[1,0]
v_cvt_pk_bf16_f32 v232, v192, v193
v_pk_mul_f32 v[194:195], v[194:195], v[238:239] op_sel_hi:[1,0]
v_cvt_pk_bf16_f32 v233, v194, v195
s_nop 3
v_pk_mul_f32 v[196:197], v[196:197], v[238:239] op_sel_hi:[1,0]
v_cvt_pk_bf16_f32 v234, v196, v197
v_pk_mul_f32 v[198:199], v[198:199], v[238:239] op_sel_hi:[1,0]
v_cvt_pk_bf16_f32 v235, v198, v199
buffer_store_dwordx4 v[232:235], v34, s[4:7], s37 offen sc1
s_barrier
s_nop 15
s_nop 15
L_or0_s1:
buffer_load_dwordx4 v[60:63], v23, s[4:7], s37 offen offset:0 sc1
L_or1_s1:
buffer_load_dwordx4 v[64:67], v23, s[4:7], s37 offen offset:1024 sc1
L_or2_s1:
buffer_load_dwordx4 v[68:71], v23, s[4:7], s37 offen offset:2048 sc1
L_or3_s1:
buffer_load_dwordx4 v[72:75], v23, s[4:7], s37 offen offset:3072 sc1
s_sub_u32 s28, s28, 1
s_cbranch_scc1 L_end
s_nop 4
v_mov_b32 v92, 0
v_mov_b32 v93, 0
v_mov_b32 v94, 0
v_mov_b32 v95, 0
v_mov_b32 v96, 0
v_mov_b32 v97, 0
v_mov_b32 v98, 0
v_mov_b32 v99, 0
L_os_s1:
L_ow0_s1:
s_waitcnt vmcnt(3)
v_max3_u32 v55, v60, v61, v62
v_max_u32 v55, v55, v63
v_cmp_eq_u32 vcc, -1, v55
v_smfmac_f32_16x16x64_bf16 v[92:95], v[60:63], a[192:199], v54
v_smfmac_f32_16x16x64_bf16 v[96:99], v[60:63], a[224:231], v54
s_cbranch_vccnz L_or0_s1
L_ow1_s1:
s_waitcnt vmcnt(2)
v_max3_u32 v55, v64, v65, v66
v_max_u32 v55, v55, v67
v_cmp_eq_u32 vcc, -1, v55
v_smfmac_f32_16x16x64_bf16 v[92:95], v[64:67], a[200:207], v54
v_smfmac_f32_16x16x64_bf16 v[96:99], v[64:67], a[232:239], v54
s_cbranch_vccnz L_or1_s1
L_ow2_s1:
s_waitcnt vmcnt(1)
v_max3_u32 v55, v68, v69, v70
v_max_u32 v55, v55, v71
v_cmp_eq_u32 vcc, -1, v55
v_smfmac_f32_16x16x64_bf16 v[92:95], v[68:71], a[208:215], v54
v_smfmac_f32_16x16x64_bf16 v[96:99], v[68:71], a[240:247], v54
s_cbranch_vccnz L_or2_s1
L_ow3_s1:
s_waitcnt vmcnt(0)
v_max3_u32 v55, v72, v73, v74
v_max_u32 v55, v55, v75
v_cmp_eq_u32 vcc, -1, v55
v_smfmac_f32_16x16x64_bf16 v[92:95], v[72:75], a[216:223], v54
v_smfmac_f32_16x16x64_bf16 v[96:99], v[72:75], a[248:255], v54
s_cbranch_vccnz L_or3_s1
L_od_s1:
s_nop 6
v_permlane32_swap_b32 v92, v96
v_permlane32_swap_b32 v93, v97
v_pk_add_f32 v[92:93], v[92:93], v[96:97]
ds_write2_b32 v52, v92, v93 offset0:0 offset1:36
v_permlane32_swap_b32 v94, v98
v_permlane32_swap_b32 v95, v99
v_pk_add_f32 v[94:95], v[94:95], v[98:99]
ds_write2_b32 v52, v94, v95 offset0:72 offset1:108
s_waitcnt lgkmcnt(0)
s_barrier
s_add_u32 s37, s37, 294912
s_cmp_eq_u32 s37, 1245184
s_cselect_b32 s37, 65536, s37
s_add_u32 s62, s62, 294912
s_cmp_eq_u32 s62, 1245184
s_cselect_b32 s62, 65536, s62
s_mov_b32 s43, s45
s_mov_b32 s45, s38
s_add_u32 s31, s31, 524288
s_add_u32 s39, s39, 1
s_lshr_b32 s38, s31, 8
s_and_b32 s38, s38, 0x2000
s_xor_b32 s38, s38, s63
s_or_b32 s38, s38, s31
s_branch L_loop_s1
L_last_s1:
ds_write_b32 v39, v204
ds_write_b32 v39, v208 offset:256
s_waitcnt lgkmcnt(0)
s_mov_b64 exec, s[92:93]
ds_read_b128 v[172:175], v44
s_mov_b64 exec, -1
s_waitcnt lgkmcnt(0)
buffer_store_dwordx4 v[172:175], v38, s[4:7], s38 offen sc1
s_branch L_rt7
L_p3r_s1:
buffer_load_dwordx4 v[120:123], v27, s[4:7], s37 offen sc1
buffer_load_dword v225, v31, s[4:7], s37 offen sc1
buffer_load_dwordx4 v[124:127], v28, s[4:7], s37 offen sc1
buffer_load_dword v226, v32, s[4:7], s37 offen sc1
buffer_load_dwordx4 v[128:131], v29, s[4:7], s37 offen sc1
buffer_load_dword v227, v33, s[4:7], s37 offen sc1
s_waitcnt vmcnt(10)
v_pk_add_f32 v[132:133], v[192:193], v[152:153]
v_pk_add_f32 v[134:135], v[194:195], v[154:155]
v_add_f32 v136, v224, v169
s_waitcnt vmcnt(6)
v_pk_add_f32 v[156:157], v[156:157], v[160:161]
v_pk_add_f32 v[158:159], v[158:159], v[162:163]
v_add_f32 v170, v170, v171
v_pk_add_f32 v[132:133], v[132:133], v[156:157]
v_pk_add_f32 v[134:135], v[134:135], v[158:159]
v_add_f32 v136, v136, v170
v_max3_u32 v55, v132, v133, v134
v_max3_u32 v55, v55, v135, v136
v_cmp_eq_u32 vcc, -1, v55
v_max3_f32 v236, v132, v133, v134
v_max3_f32 v236, v236, v135, v136
s_nop 1
v_max_f32_dpp v236, v236, v236 row_ror:8 row_mask:0xf bank_mask:0xf
v_mov_b32 v237, v236
s_nop 0
s_cbranch_vccz L_p3ok_s1
L_p3s_s1:
buffer_load_dwordx4 v[152:155], v27, s[4:7], s37 offen sc1
buffer_load_dword v169, v31, s[4:7], s37 offen sc1
buffer_load_dwordx4 v[156:159], v28, s[4:7], s37 offen sc1
buffer_load_dword v170, v32, s[4:7], s37 offen sc1
buffer_load_dwordx4 v[160:163], v29, s[4:7], s37 offen sc1
buffer_load_dword v171, v33, s[4:7], s37 offen sc1
s_sub_u32 s28, s28, 1
s_cbranch_scc1 L_end
s_waitcnt vmcnt(10)
v_pk_add_f32 v[132:133], v[192:193], v[120:121]
v_pk_add_f32 v[134:135], v[194:195], v[122:123]
v_add_f32 v136, v224, v225
s_waitcnt vmcnt(6)
v_pk_add_f32 v[124:125], v[124:125], v[128:129]
v_pk_add_f32 v[126:127], v[126:127], v[130:131]
v_add_f32 v226, v226, v227
v_pk_add_f32 v[132:133], v[132:133], v[124:125]
v_pk_add_f32 v[134:135], v[134:135], v[126:127]
v_add_f32 v136, v136, v226
v_max3_u32 v55, v132, v133, v134
v_max3_u32 v55, v55, v135, v136
v_cmp_eq_u32 vcc, -1, v55
v_max3_f32 v236, v132, v133, v134
v_max3_f32 v236, v236, v135, v136
s_nop 1
v_max_f32_dpp v236, v236, v236 row_ror:8 row_mask:0xf bank_mask:0xf
v_mov_b32 v237, v236
s_nop 0
s_cbranch_vccz L_p3ok_s1
buffer_load_dwordx4 v[120:123], v27, s[4:7], s37 offen sc1
buffer_load_dword v225, v31, s[4:7], s37 offen sc1
buffer_load_dwordx4 v[124:127], v28, s[4:7], s37 offen sc1
buffer_load_dword v226, v32, s[4:7], s37 offen sc1
buffer_load_dwordx4 v[128:131], v29, s[4:7], s37 offen sc1
buffer_load_dword v227, v33, s[4:7], s37 offen sc1
s_waitcnt vmcnt(10)
v_pk_add_f32 v[132:133], v[192:193], v[152:153]
v_pk_add_f32 v[134:135], v[194:195], v[154:155]
v_add_f32 v136, v224, v169
s_waitcnt vmcnt(6)
v_pk_add_f32 v[156:157], v[156:157], v[160:161]
v_pk_add_f32 v[158:159], v[158:159], v[162:163]
v_add_f32 v170, v170, v171
v_pk_add_f32 v[132:133], v[132:133], v[156:157]
v_pk_add_f32 v[134:135], v[134:135], v[158:159]
v_add_f32 v136, v136, v170
v_max3_u32 v55, v132, v133, v134
v_max3_u32 v55, v55, v135, v136
v_cmp_eq_u32 vcc, -1, v55
v_max3_f32 v236, v132, v133, v134
v_max3_f32 v236, v236, v135, v136
s_nop 1
v_max_f32_dpp v236, v236, v236 row_ror:8 row_mask:0xf bank_mask:0xf
v_mov_b32 v237, v236
s_nop 0
s_cbranch_vccz L_p3ok_s1
s_branch L_p3s_s1
.p2align 6
L_loop_s2:
v_mov_b32 v108, 0
v_mov_b32 v109, 0
v_mov_b32 v110, 0
v_mov_b32 v111, 0
v_mov_b32 v112, 0
v_mov_b32 v113, 0
v_mov_b32 v114, 0
v_mov_b32 v115, 0
s_barrier
s_nop 15
s_nop 15
L_mr0_s2:
buffer_load_dwordx4 v[60:63], v22, s[4:7], s37 offen offset:0 sc1
L_mr1_s2:
buffer_load_dwordx4 v[64:67], v22, s[4:7], s37 offen offset:1024 sc1
L_mr2_s2:
buffer_load_dwordx4 v[68:71], v22, s[4:7], s37 offen offset:2048 sc1
L_mr3_s2:
buffer_load_dwordx4 v[72:75], v22, s[4:7], s37 offen offset:3072 sc1
s_sub_u32 s28, s28, 1
s_cbranch_scc1 L_end
s_nop 4
v_mov_b32 v92, 0
v_mov_b32 v93, 0
v_mov_b32 v94, 0
v_mov_b32 v95, 0
v_mov_b32 v96, 0
v_mov_b32 v97, 0
v_mov_b32 v98, 0
v_mov_b32 v99, 0
v_mov_b32 v100, 0
v_mov_b32 v101, 0
v_mov_b32 v102, 0
v_mov_b32 v103, 0
v_mov_b32 v104, 0
v_mov_b32 v105, 0
v_mov_b32 v106, 0
v_mov_b32 v107, 0
L_ms_s2:
L_mw0_s2:
s_waitcnt vmcnt(3)
v_max3_u32 v55, v60, v61, v62
v_max_u32 v55, v55, v63
v_cmp_eq_u32 vcc, -1, v55
v_smfmac_f32_16x16x64_bf16 v[92:95], v[60:63], a[0:7], v54
v_smfmac_f32_16x16x64_bf16 v[96:99], v[60:63], a[32:39], v54
s_cbranch_vccnz L_mr0_s2
v_smfmac_f32_16x16x64_bf16 v[100:103], v[60:63], a[64:71], v54
v_smfmac_f32_16x16x64_bf16 v[104:107], v[60:63], a[96:103], v54
L_mw1_s2:
s_waitcnt vmcnt(2)
v_max3_u32 v55, v64, v65, v66
v_max_u32 v55, v55, v67
v_cmp_eq_u32 vcc, -1, v55
v_smfmac_f32_16x16x64_bf16 v[92:95], v[64:67], a[8:15], v54
v_smfmac_f32_16x16x64_bf16 v[96:99], v[64:67], a[40:47], v54
s_cbranch_vccnz L_mr1_s2
v_smfmac_f32_16x16x64_bf16 v[100:103], v[64:67], a[72:79], v54
v_smfmac_f32_16x16x64_bf16 v[104:107], v[64:67], a[104:111], v54
L_mw2_s2:
s_waitcnt vmcnt(1)
v_max3_u32 v55, v68, v69, v70
v_max_u32 v55, v55, v71
v_cmp_eq_u32 vcc, -1, v55
v_smfmac_f32_16x16x64_bf16 v[92:95], v[68:71], a[16:23], v54
v_smfmac_f32_16x16x64_bf16 v[96:99], v[68:71], a[48:55], v54
s_cbranch_vccnz L_mr2_s2
v_smfmac_f32_16x16x64_bf16 v[100:103], v[68:71], a[80:87], v54
v_smfmac_f32_16x16x64_bf16 v[104:107], v[68:71], a[112:119], v54
L_mw3_s2:
s_waitcnt vmcnt(0)
v_max3_u32 v55, v72, v73, v74
v_max_u32 v55, v55, v75
v_cmp_eq_u32 vcc, -1, v55
v_smfmac_f32_16x16x64_bf16 v[92:95], v[72:75], a[24:31], v54
v_smfmac_f32_16x16x64_bf16 v[96:99], v[72:75], a[56:63], v54
s_cbranch_vccnz L_mr3_s2
v_smfmac_f32_16x16x64_bf16 v[100:103], v[72:75], a[88:95], v54
v_smfmac_f32_16x16x64_bf16 v[104:107], v[72:75], a[120:127], v54
L_md_s2:
v_permlane32_swap_b32 v92, v96
v_permlane32_swap_b32 v93, v97
v_pk_add_f32 v[92:93], v[92:93], v[96:97]
ds_write2_b32 v47, v92, v93 offset0:0 offset1:36
v_permlane32_swap_b32 v94, v98
v_permlane32_swap_b32 v95, v99
v_pk_add_f32 v[94:95], v[94:95], v[98:99]
ds_write2_b32 v47, v94, v95 offset0:72 offset1:108
v_permlane32_swap_b32 v100, v104
v_permlane32_swap_b32 v101, v105
v_pk_add_f32 v[100:101], v[100:101], v[104:105]
ds_write2_b32 v48, v100, v101 offset0:0 offset1:36
v_permlane32_swap_b32 v102, v106
v_permlane32_swap_b32 v103, v107
v_pk_add_f32 v[102:103], v[102:103], v[106:107]
ds_write2_b32 v48, v102, v103 offset0:72 offset1:108
v_smfmac_f32_16x16x64_bf16 v[108:111], v[60:63], a[128:135], v54
v_smfmac_f32_16x16x64_bf16 v[112:115], v[60:63], a[160:167], v54
v_smfmac_f32_16x16x64_bf16 v[108:111], v[64:67], a[136:143], v54
s_waitcnt lgkmcnt(0)
s_barrier
buffer_store_dwordx4 v[8:11], v41, s[4:7], s62 offen sc1
buffer_store_dwordx4 v[8:11], v42, s[4:7], s62 offen sc1
buffer_store_dwordx4 v[8:11], v43, s[4:7], s62 offen sc1
v_smfmac_f32_16x16x64_bf16 v[112:115], v[64:67], a[168:175], v54
v_smfmac_f32_16x16x64_bf16 v[108:111], v[68:71], a[144:151], v54
v_smfmac_f32_16x16x64_bf16 v[112:115], v[68:71], a[176:183], v54
v_smfmac_f32_16x16x64_bf16 v[108:111], v[72:75], a[152:159], v54
v_smfmac_f32_16x16x64_bf16 v[112:115], v[72:75], a[184:191], v54
s_nop 7
v_permlane32_swap_b32 v108, v112
v_permlane32_swap_b32 v109, v113
v_permlane32_swap_b32 v110, v114
v_permlane32_swap_b32 v111, v115
v_pk_add_f32 v[108:109], v[108:109], v[112:113]
v_pk_add_f32 v[110:111], v[110:111], v[114:115]
ds_write_b128 v50, v[108:111]
s_waitcnt lgkmcnt(0)
s_barrier
s_cmp_eq_u32 s39, 63
s_cbranch_scc1 L_last_s2
s_barrier
s_nop 15
s_nop 15
L_or0_s2:
buffer_load_dwordx4 v[60:63], v23, s[4:7], s37 offen offset:0 sc1
L_or1_s2:
buffer_load_dwordx4 v[64:67], v23, s[4:7], s37 offen offset:1024 sc1
L_or2_s2:
buffer_load_dwordx4 v[68:71], v23, s[4:7], s37 offen offset:2048 sc1
L_or3_s2:
buffer_load_dwordx4 v[72:75], v23, s[4:7], s37 offen offset:3072 sc1
s_sub_u32 s28, s28, 1
s_cbranch_scc1 L_end
s_nop 4
v_mov_b32 v92, 0
v_mov_b32 v93, 0
v_mov_b32 v94, 0
v_mov_b32 v95, 0
v_mov_b32 v96, 0
v_mov_b32 v97, 0
v_mov_b32 v98, 0
v_mov_b32 v99, 0
L_os_s2:
L_ow0_s2:
s_waitcnt vmcnt(3)
v_max3_u32 v55, v60, v61, v62
v_max_u32 v55, v55, v63
v_cmp_eq_u32 vcc, -1, v55
v_smfmac_f32_16x16x64_bf16 v[92:95], v[60:63], a[192:199], v54
v_smfmac_f32_16x16x64_bf16 v[96:99], v[60:63], a[224:231], v54
s_cbranch_vccnz L_or0_s2
L_ow1_s2:
s_waitcnt vmcnt(2)
v_max3_u32 v55, v64, v65, v66
v_max_u32 v55, v55, v67
v_cmp_eq_u32 vcc, -1, v55
v_smfmac_f32_16x16x64_bf16 v[92:95], v[64:67], a[200:207], v54
v_smfmac_f32_16x16x64_bf16 v[96:99], v[64:67], a[232:239], v54
s_cbranch_vccnz L_or1_s2
L_ow2_s2:
s_waitcnt vmcnt(1)
v_max3_u32 v55, v68, v69, v70
v_max_u32 v55, v55, v71
v_cmp_eq_u32 vcc, -1, v55
v_smfmac_f32_16x16x64_bf16 v[92:95], v[68:71], a[208:215], v54
v_smfmac_f32_16x16x64_bf16 v[96:99], v[68:71], a[240:247], v54
s_cbranch_vccnz L_or2_s2
L_ow3_s2:
s_waitcnt vmcnt(0)
v_max3_u32 v55, v72, v73, v74
v_max_u32 v55, v55, v75
v_cmp_eq_u32 vcc, -1, v55
v_smfmac_f32_16x16x64_bf16 v[92:95], v[72:75], a[216:223], v54
v_smfmac_f32_16x16x64_bf16 v[96:99], v[72:75], a[248:255], v54
s_cbranch_vccnz L_or3_s2
L_od_s2:
s_nop 6
v_permlane32_swap_b32 v92, v96
v_permlane32_swap_b32 v93, v97
v_pk_add_f32 v[92:93], v[92:93], v[96:97]
ds_write2_b32 v52, v92, v93 offset0:0 offset1:36
v_permlane32_swap_b32 v94, v98
v_permlane32_swap_b32 v95, v99
v_pk_add_f32 v[94:95], v[94:95], v[98:99]
ds_write2_b32 v52, v94, v95 offset0:72 offset1:108
s_waitcnt lgkmcnt(0)
s_barrier
s_add_u32 s37, s37, 294912
s_cmp_eq_u32 s37, 1245184
s_cselect_b32 s37, 65536, s37
s_add_u32 s62, s62, 294912
s_cmp_eq_u32 s62, 1245184
s_cselect_b32 s62, 65536, s62
s_mov_b32 s43, s45
s_mov_b32 s45, s38
s_add_u32 s31, s31, 524288
s_add_u32 s39, s39, 1
s_branch L_loop_s2
L_last_s2:
s_branch L_rt7
L_pre_s3:
v_mov_b32 v7, v252
s_mov_b32 s30, 0
s_nop 0
.p2align 6
L_loop_s3:
v_readlane_b32 s24, v7, 0
v_readlane_b32 s25, v7, 1
s_nop 0
s_min_i32 s40, s24, s25
s_cmp_eq_u32 s30, 1
s_cbranch_scc1 L_have_s3
s_cmp_gt_i32 s40, s39
s_cbranch_scc1 L_flok_s3
L_fl_s3:
buffer_load_dword v7, v37, s[4:7], 0 offen sc1
s_sub_u32 s28, s28, 1
s_cbranch_scc1 L_end
s_waitcnt vmcnt(0)
v_readlane_b32 s24, v7, 0
v_readlane_b32 s25, v7, 1
s_nop 0
s_min_i32 s40, s24, s25
s_cmp_gt_i32 s40, s39
s_cbranch_scc0 L_fl_s3
L_flok_s3:
s_mov_b32 s24, s38
buffer_load_dwordx4 v[176:179], v35, s[4:7], s24 offen offset:0 sc1
buffer_load_dwordx4 v[180:183], v35, s[4:7], s24 offen offset:1024 sc1
buffer_load_dwordx4 v[184:187], v36, s[4:7], s24 offen offset:0 sc1
buffer_load_dwordx4 v[188:191], v36, s[4:7], s24 offen offset:1024 sc1
s_waitcnt vmcnt(0)
L_have_s3:
ds_write_b128 v2, v[176:179] offset:18432
ds_write_b128 v2, v[180:183] offset:19456
ds_write_b128 v2, v[184:187] offset:20480
ds_write_b128 v2, v[188:191] offset:21504
s_add_u32 s24, s39, 5
s_min_i32 s24, s24, 64
s_cmp_ge_i32 s40, s24
s_cbranch_scc1 L_nofl_s3
buffer_load_dword v7, v37, s[4:7], 0 offen sc1
L_nofl_s3:
s_add_u32 s25, s31, 524288
s_lshr_b32 s43, s25, 8
s_and_b32 s43, s43, 0x2000
s_xor_b32 s43, s43, s63
s_or_b32 s43, s43, s25
s_add_u32 s24, s39, 1
s_cmp_gt_i32 s40, s24
s_cselect_b32 s30, 1, 0
s_cselect_b32 s43, s43, 2147483648
v_mov_b32 v108, 0
v_mov_b32 v109, 0
v_mov_b32 v110, 0
v_mov_b32 v111, 0
v_mov_b32 v112, 0
v_mov_b32 v113, 0
v_mov_b32 v114, 0
v_mov_b32 v115, 0
s_waitcnt lgkmcnt(0)
s_barrier
s_nop 15
s_nop 15
L_mr0_s3:
buffer_load_dwordx4 v[60:63], v22, s[4:7], s37 offen offset:0 sc1
L_mr1_s3:
buffer_load_dwordx4 v[64:67], v22, s[4:7], s37 offen offset:1024 sc1
L_mr2_s3:
buffer_load_dwordx4 v[68:71], v22, s[4:7], s37 offen offset:2048 sc1
L_mr3_s3:
buffer_load_dwordx4 v[72:75], v22, s[4:7], s37 offen offset:3072 sc1
s_sub_u32 s28, s28, 1
s_cbranch_scc1 L_end
s_nop 4
v_mov_b32 v92, 0
v_mov_b32 v93, 0
v_mov_b32 v94, 0
v_mov_b32 v95, 0
v_mov_b32 v96, 0
v_mov_b32 v97, 0
v_mov_b32 v98, 0
v_mov_b32 v99, 0
v_mov_b32 v100, 0
v_mov_b32 v101, 0
v_mov_b32 v102, 0
v_mov_b32 v103, 0
v_mov_b32 v104, 0
v_mov_b32 v105, 0
v_mov_b32 v106, 0
v_mov_b32 v107, 0
L_ms_s3:
L_mw0_s3:
s_waitcnt vmcnt(3)
v_max3_u32 v55, v60, v61, v62
v_max_u32 v55, v55, v63
v_cmp_eq_u32 vcc, -1, v55
v_smfmac_f32_16x16x64_bf16 v[92:95], v[60:63], a[0:7], v54
v_smfmac_f32_16x16x64_bf16 v[96:99], v[60:63], a[32:39], v54
s_cbranch_vccnz L_mr0_s3
v_smfmac_f32_16x16x64_bf16 v[100:103], v[60:63], a[64:71], v54
v_smfmac_f32_16x16x64_bf16 v[104:107], v[60:63], a[96:103], v54
L_mw1_s3:
s_waitcnt vmcnt(2)
v_max3_u32 v55, v64, v65, v66
v_max_u32 v55, v55, v67
v_cmp_eq_u32 vcc, -1, v55
v_smfmac_f32_16x16x64_bf16 v[92:95], v[64:67], a[8:15], v54
v_smfmac_f32_16x16x64_bf16 v[96:99], v[64:67], a[40:47], v54
s_cbranch_vccnz L_mr1_s3
v_smfmac_f32_16x16x64_bf16 v[100:103], v[64:67], a[72:79], v54
v_smfmac_f32_16x16x64_bf16 v[104:107], v[64:67], a[104:111], v54
L_mw2_s3:
s_waitcnt vmcnt(1)
v_max3_u32 v55, v68, v69, v70
v_max_u32 v55, v55, v71
v_cmp_eq_u32 vcc, -1, v55
v_smfmac_f32_16x16x64_bf16 v[92:95], v[68:71], a[16:23], v54
v_smfmac_f32_16x16x64_bf16 v[96:99], v[68:71], a[48:55], v54
s_cbranch_vccnz L_mr2_s3
v_smfmac_f32_16x16x64_bf16 v[100:103], v[68:71], a[80:87], v54
v_smfmac_f32_16x16x64_bf16 v[104:107], v[68:71], a[112:119], v54
L_mw3_s3:
s_waitcnt vmcnt(0)
v_max3_u32 v55, v72, v73, v74
v_max_u32 v55, v55, v75
v_cmp_eq_u32 vcc, -1, v55
v_smfmac_f32_16x16x64_bf16 v[92:95], v[72:75], a[24:31], v54
v_smfmac_f32_16x16x64_bf16 v[96:99], v[72:75], a[56:63], v54
s_cbranch_vccnz L_mr3_s3
v_smfmac_f32_16x16x64_bf16 v[100:103], v[72:75], a[88:95], v54
v_smfmac_f32_16x16x64_bf16 v[104:107], v[72:75], a[120:127], v54
L_md_s3:
v_permlane32_swap_b32 v92, v96
v_permlane32_swap_b32 v93, v97
v_pk_add_f32 v[92:93], v[92:93], v[96:97]
ds_write2_b32 v47, v92, v93 offset0:0 offset1:36
v_permlane32_swap_b32 v94, v98
v_permlane32_swap_b32 v95, v99
v_pk_add_f32 v[94:95], v[94:95], v[98:99]
ds_write2_b32 v47, v94, v95 offset0:72 offset1:108
v_permlane32_swap_b32 v100, v104
v_permlane32_swap_b32 v101, v105
v_pk_add_f32 v[100:101], v[100:101], v[104:105]
ds_write2_b32 v48, v100, v101 offset0:0 offset1:36
v_permlane32_swap_b32 v102, v106
v_permlane32_swap_b32 v103, v107
v_pk_add_f32 v[102:103], v[102:103], v[106:107]
ds_write2_b32 v48, v102, v103 offset0:72 offset1:108
v_smfmac_f32_16x16x64_bf16 v[108:111], v[60:63], a[128:135], v54
v_smfmac_f32_16x16x64_bf16 v[112:115], v[60:63], a[160:167], v54
v_smfmac_f32_16x16x64_bf16 v[108:111], v[64:67], a[136:143], v54
s_waitcnt lgkmcnt(0)
s_barrier
buffer_load_dwordx4 v[176:179], v35, s[4:7], s43 offen offset:0 sc1
buffer_load_dwordx4 v[180:183], v35, s[4:7], s43 offen offset:1024 sc1
v_smfmac_f32_16x16x64_bf16 v[112:115], v[64:67], a[168:175], v54
v_smfmac_f32_16x16x64_bf16 v[108:111], v[68:71], a[144:151], v54
v_smfmac_f32_16x16x64_bf16 v[112:115], v[68:71], a[176:183], v54
v_smfmac_f32_16x16x64_bf16 v[108:111], v[72:75], a[152:159], v54
v_smfmac_f32_16x16x64_bf16 v[112:115], v[72:75], a[184:191], v54
s_nop 7
v_permlane32_swap_b32 v108, v112
v_permlane32_swap_b32 v109, v113
v_permlane32_swap_b32 v110, v114
v_permlane32_swap_b32 v111, v115
v_pk_add_f32 v[108:109], v[108:109], v[112:113]
v_pk_add_f32 v[110:111], v[110:111], v[114:115]
ds_write_b128 v50, v[108:111]
s_waitcnt lgkmcnt(0)
s_barrier
s_cmp_eq_u32 s39, 63
s_cbranch_scc1 L_last_s3
s_nop 15
s_nop 15
s_nop 15
s_nop 15
s_nop 15
s_nop 15
buffer_load_dwordx4 v[184:187], v36, s[4:7], s43 offen offset:0 sc1
buffer_load_dwordx4 v[188:191], v36, s[4:7], s43 offen offset:1024 sc1
s_barrier
s_nop 15
s_nop 15
L_or0_s3:
buffer_load_dwordx4 v[60:63], v23, s[4:7], s37 offen offset:0 sc1
L_or1_s3:
buffer_load_dwordx4 v[64:67], v23, s[4:7], s37 offen offset:1024 sc1
L_or2_s3:
buffer_load_dwordx4 v[68:71], v23, s[4:7], s37 offen offset:2048 sc1
L_or3_s3:
buffer_load_dwordx4 v[72:75], v23, s[4:7], s37 offen offset:3072 sc1
s_sub_u32 s28, s28, 1
s_cbranch_scc1 L_end
s_nop 4
v_mov_b32 v92, 0
v_mov_b32 v93, 0
v_mov_b32 v94, 0
v_mov_b32 v95, 0
v_mov_b32 v96, 0
v_mov_b32 v97, 0
v_mov_b32 v98, 0
v_mov_b32 v99, 0
L_os_s3:
L_ow0_s3:
s_waitcnt vmcnt(3)
v_max3_u32 v55, v60, v61, v62
v_max_u32 v55, v55, v63
v_cmp_eq_u32 vcc, -1, v55
v_smfmac_f32_16x16x64_bf16 v[92:95], v[60:63], a[192:199], v54
v_smfmac_f32_16x16x64_bf16 v[96:99], v[60:63], a[224:231], v54
s_cbranch_vccnz L_or0_s3
L_ow1_s3:
s_waitcnt vmcnt(2)
v_max3_u32 v55, v64, v65, v66
v_max_u32 v55, v55, v67
v_cmp_eq_u32 vcc, -1, v55
v_smfmac_f32_16x16x64_bf16 v[92:95], v[64:67], a[200:207], v54
v_smfmac_f32_16x16x64_bf16 v[96:99], v[64:67], a[232:239], v54
s_cbranch_vccnz L_or1_s3
L_ow2_s3:
s_waitcnt vmcnt(1)
v_max3_u32 v55, v68, v69, v70
v_max_u32 v55, v55, v71
v_cmp_eq_u32 vcc, -1, v55
v_smfmac_f32_16x16x64_bf16 v[92:95], v[68:71], a[208:215], v54
v_smfmac_f32_16x16x64_bf16 v[96:99], v[68:71], a[240:247], v54
s_cbranch_vccnz L_or2_s3
L_ow3_s3:
s_waitcnt vmcnt(0)
v_max3_u32 v55, v72, v73, v74
v_max_u32 v55, v55, v75
v_cmp_eq_u32 vcc, -1, v55
v_smfmac_f32_16x16x64_bf16 v[92:95], v[72:75], a[216:223], v54
v_smfmac_f32_16x16x64_bf16 v[96:99], v[72:75], a[248:255], v54
s_cbranch_vccnz L_or3_s3
L_od_s3:
s_nop 6
v_permlane32_swap_b32 v92, v96
v_permlane32_swap_b32 v93, v97
v_pk_add_f32 v[92:93], v[92:93], v[96:97]
ds_write2_b32 v52, v92, v93 offset0:0 offset1:36
v_permlane32_swap_b32 v94, v98
v_permlane32_swap_b32 v95, v99
v_pk_add_f32 v[94:95], v[94:95], v[98:99]
ds_write2_b32 v52, v94, v95 offset0:72 offset1:108
s_waitcnt lgkmcnt(0)
s_barrier
s_add_u32 s37, s37, 294912
s_cmp_eq_u32 s37, 1245184
s_cselect_b32 s37, 65536, s37
s_add_u32 s62, s62, 294912
s_cmp_eq_u32 s62, 1245184
s_cselect_b32 s62, 65536, s62
s_mov_b32 s43, s45
s_mov_b32 s45, s38
s_add_u32 s31, s31, 524288
s_add_u32 s39, s39, 1
s_lshr_b32 s38, s31, 8
s_and_b32 s38, s38, 0x2000
s_xor_b32 s38, s38, s63
s_or_b32 s38, s38, s31
s_branch L_loop_s3
L_last_s3:
s_branch L_rt7
L_rt7:
s_load_dwordx16 s[64:79], s[0:1], 0
s_load_dwordx8 s[80:87], s[0:1], 64
s_load_dwordx2 s[88:89], s[0:1], 96
s_waitcnt vmcnt(0)
v_lshrrev_b32 v6, 1, v3
v_lshlrev_b32 v5, 10, v6
v_and_b32 v6, 1, v3
v_lshl_add_u32 v5, v6, 9, v5
v_bfe_u32 v6, v1, 3, 1
v_lshl_add_u32 v5, v6, 8, v5
v_and_b32 v6, 7, v1
v_lshl_add_u32 v5, v6, 4, v5
s_lshl_b32 s24, s32, 16
s_lshl_b32 s25, s20, 14
s_add_u32 s24, s24, s25
s_add_u32 s24, s24, s63
s_add_u32 s24, s24, 141557760
v_add_u32 v57, s24, v5
v_and_b32 v5, 31, v1
v_lshlrev_b32 v5, 2, v5
s_lshl_b32 s24, s32, 7
s_add_u32 s24, s24, 32768
s_xor_b32 s25, s63, 0x2000
s_add_u32 s24, s24, s25
v_add_u32 v58, s24, v5
v_add_u32 v60, 11264, v52
s_mul_i32 s24, s20, 4608
s_add_u32 s24, s24, 11264
v_add_u32 v61, s24, v53
s_lshl_b32 s24, s20, 14
s_add_u32 s24, s24, 65536
v_add_u32 v64, s24, v2
s_lshl_b32 s24, s20, 18
s_add_u32 s24, s24, s63
s_add_u32 s24, s24, 180355072
s_cmp_eq_u32 s20, s32
s_cselect_b32 s25, s24, 1073741824
s_cselect_b32 s24, 1073741824, s24
v_add_u32 v65, s25, v17
v_add_u32 v66, s25, v18
v_add_u32 v67, s25, v19
v_add_u32 v62, s24, v20
v_bfe_u32 v5, v1, 3, 1
v_lshlrev_b32 v5, 15, v5
v_bfe_u32 v6, v1, 1, 2
v_lshl_add_u32 v5, v6, 12, v5
v_lshl_add_u32 v5, v3, 4, v5
v_and_b32 v6, 1, v4
v_lshl_add_u32 v5, v6, 3, v5
s_lshl_b32 s24, s33, 6
s_xor_b32 s24, s24, 128
s_and_b32 s25, s20, 1
s_lshl_b32 s25, s25, 16
s_add_u32 s24, s24, s25
s_lshr_b32 s25, s20, 1
s_lshl_b32 s25, s25, 14
s_add_u32 s24, s24, s25
s_add_u32 s24, s24, 8126464
s_cmp_eq_u32 s20, s32
s_cselect_b32 s24, s24, 1073741824
v_add_u32 v63, s24, v5
s_waitcnt lgkmcnt(0)
s_mov_b32 s16, s84
s_mov_b32 s17, s85
s_mov_b32 s18, 8388608
s_mov_b32 s19, 0x20000
s_mov_b32 s46, 62
s_mov_b32 s47, 0
s_mov_b32 s49, 0
v_mov_b32 v7, v64
L_rtl:
v_mov_b32 v196, 0
v_mov_b32 v197, 0
v_mov_b32 v198, 0
v_mov_b32 v199, 0
v_mov_b32 v200, 0
v_mov_b32 v201, 0
v_mov_b32 v202, 0
v_mov_b32 v203, 0
v_mov_b32 v204, 0
v_mov_b32 v205, 0
v_mov_b32 v206, 0
v_mov_b32 v207, 0
v_mov_b32 v208, 0
v_mov_b32 v209, 0
v_mov_b32 v210, 0
v_mov_b32 v211, 0
v_mov_b32 v212, 0
v_mov_b32 v213, 0
v_mov_b32 v214, 0
v_mov_b32 v215, 0
v_mov_b32 v216, 0
v_mov_b32 v217, 0
v_mov_b32 v218, 0
v_mov_b32 v219, 0
v_mov_b32 v220, 0
v_mov_b32 v221, 0
v_mov_b32 v222, 0
v_mov_b32 v223, 0
v_mov_b32 v224, 0
v_mov_b32 v225, 0
v_mov_b32 v226, 0
v_mov_b32 v227, 0
s_cmp_lg_u32 s20, 0
s_cbranch_scc1 L_rtwd
s_branch L_rtwg
L_rtw:
s_sleep 1
L_rtwg:
buffer_load_dword v59, v58, s[4:7], 0 offen sc1
s_sub_u32 s28, s28, 1
s_cbranch_scc1 L_end
s_waitcnt vmcnt(0)
v_cmp_ge_i32 vcc, s46, v59
s_cbranch_vccnz L_rtw
L_rtwd:
s_barrier
s_add_u32 s48, s47, 0
buffer_load_dwordx4 v[68:71], v57, s[4:7], s48 offen offset:0
buffer_load_dwordx4 v[72:75], v57, s[4:7], s48 offen offset:128
s_add_u32 s48, s47, 262144
buffer_load_dwordx4 v[76:79], v57, s[4:7], s48 offen offset:0
buffer_load_dwordx4 v[80:83], v57, s[4:7], s48 offen offset:128
s_add_u32 s48, s47, 0
buffer_load_dwordx4 v[84:87], v57, s[4:7], s48 offen offset:2048
buffer_load_dwordx4 v[88:91], v57, s[4:7], s48 offen offset:2176
s_add_u32 s48, s47, 262144
buffer_load_dwordx4 v[92:95], v57, s[4:7], s48 offen offset:2048
buffer_load_dwordx4 v[96:99], v57, s[4:7], s48 offen offset:2176
s_add_u32 s48, s47, 4096
buffer_load_dwordx4 v[100:103], v57, s[4:7], s48 offen offset:0
buffer_load_dwordx4 v[104:107], v57, s[4:7], s48 offen offset:128
s_add_u32 s48, s47, 266240
buffer_load_dwordx4 v[108:111], v57, s[4:7], s48 offen offset:0
buffer_load_dwordx4 v[112:115], v57, s[4:7], s48 offen offset:128
s_add_u32 s48, s47, 4096
buffer_load_dwordx4 v[116:119], v57, s[4:7], s48 offen offset:2048
buffer_load_dwordx4 v[120:123], v57, s[4:7], s48 offen offset:2176
s_add_u32 s48, s47, 266240
buffer_load_dwordx4 v[124:127], v57, s[4:7], s48 offen offset:2048
buffer_load_dwordx4 v[128:131], v57, s[4:7], s48 offen offset:2176
s_waitcnt vmcnt(12)
v_smfmac_f32_16x16x64_bf16 v[196:199], v[68:71], a[192:199], v54
v_smfmac_f32_16x16x64_bf16 v[200:203], v[68:71], a[224:231], v54
v_smfmac_f32_16x16x64_bf16 v[204:207], v[72:75], a[192:199], v54
v_smfmac_f32_16x16x64_bf16 v[208:211], v[72:75], a[224:231], v54
v_smfmac_f32_16x16x64_bf16 v[212:215], v[76:79], a[192:199], v54
v_smfmac_f32_16x16x64_bf16 v[216:219], v[76:79], a[224:231], v54
v_smfmac_f32_16x16x64_bf16 v[220:223], v[80:83], a[192:199], v54
v_smfmac_f32_16x16x64_bf16 v[224:227], v[80:83], a[224:231], v54
s_waitcnt vmcnt(8)
v_smfmac_f32_16x16x64_bf16 v[196:199], v[84:87], a[200:207], v54
v_smfmac_f32_16x16x64_bf16 v[200:203], v[84:87], a[232:239], v54
v_smfmac_f32_16x16x64_bf16 v[204:207], v[88:91], a[200:207], v54
v_smfmac_f32_16x16x64_bf16 v[208:211], v[88:91], a[232:239], v54
v_smfmac_f32_16x16x64_bf16 v[212:215], v[92:95], a[200:207], v54
v_smfmac_f32_16x16x64_bf16 v[216:219], v[92:95], a[232:239], v54
v_smfmac_f32_16x16x64_bf16 v[220:223], v[96:99], a[200:207], v54
v_smfmac_f32_16x16x64_bf16 v[224:227], v[96:99], a[232:239], v54
s_waitcnt vmcnt(4)
v_smfmac_f32_16x16x64_bf16 v[196:199], v[100:103], a[208:215], v54
v_smfmac_f32_16x16x64_bf16 v[200:203], v[100:103], a[240:247], v54
v_smfmac_f32_16x16x64_bf16 v[204:207], v[104:107], a[208:215], v54
v_smfmac_f32_16x16x64_bf16 v[208:211], v[104:107], a[240:247], v54
v_smfmac_f32_16x16x64_bf16 v[212:215], v[108:111], a[208:215], v54
v_smfmac_f32_16x16x64_bf16 v[216:219], v[108:111], a[240:247], v54
v_smfmac_f32_16x16x64_bf16 v[220:223], v[112:115], a[208:215], v54
v_smfmac_f32_16x16x64_bf16 v[224:227], v[112:115], a[240:247], v54
s_waitcnt vmcnt(0)
v_smfmac_f32_16x16x64_bf16 v[196:199], v[116:119], a[216:223], v54
v_smfmac_f32_16x16x64_bf16 v[200:203], v[116:119], a[248:255], v54
v_smfmac_f32_16x16x64_bf16 v[204:207], v[120:123], a[216:223], v54
v_smfmac_f32_16x16x64_bf16 v[208:211], v[120:123], a[248:255], v54
v_smfmac_f32_16x16x64_bf16 v[212:215], v[124:127], a[216:223], v54
v_smfmac_f32_16x16x64_bf16 v[216:219], v[124:127], a[248:255], v54
v_smfmac_f32_16x16x64_bf16 v[220:223], v[128:131], a[216:223], v54
v_smfmac_f32_16x16x64_bf16 v[224:227], v[128:131], a[248:255], v54
v_permlane32_swap_b32 v196, v200
v_permlane32_swap_b32 v197, v201
v_pk_add_f32 v[196:197], v[196:197], v[200:201]
ds_write_b32 v60, v196 offset:0
ds_write_b32 v60, v197 offset:144
v_permlane32_swap_b32 v198, v202
v_permlane32_swap_b32 v199, v203
v_pk_add_f32 v[198:199], v[198:199], v[202:203]
ds_write_b32 v60, v198 offset:288
ds_write_b32 v60, v199 offset:432
v_permlane32_swap_b32 v204, v208
v_permlane32_swap_b32 v205, v209
v_pk_add_f32 v[204:205], v[204:205], v[208:209]
ds_write_b32 v60, v204 offset:4608
ds_write_b32 v60, v205 offset:4752
v_permlane32_swap_b32 v206, v210
v_permlane32_swap_b32 v207, v211
v_pk_add_f32 v[206:207], v[206:207], v[210:211]
ds_write_b32 v60, v206 offset:4896
ds_write_b32 v60, v207 offset:5040
v_permlane32_swap_b32 v212, v216
v_permlane32_swap_b32 v213, v217
v_pk_add_f32 v[212:213], v[212:213], v[216:217]
ds_write_b32 v60, v212 offset:9216
ds_write_b32 v60, v213 offset:9360
v_permlane32_swap_b32 v214, v218
v_permlane32_swap_b32 v215, v219
v_pk_add_f32 v[214:215], v[214:215], v[218:219]
ds_write_b32 v60, v214 offset:9504
ds_write_b32 v60, v215 offset:9648
v_permlane32_swap_b32 v220, v224
v_permlane32_swap_b32 v221, v225
v_pk_add_f32 v[220:221], v[220:221], v[224:225]
ds_write_b32 v60, v220 offset:13824
ds_write_b32 v60, v221 offset:13968
v_permlane32_swap_b32 v222, v226
v_permlane32_swap_b32 v223, v227
v_pk_add_f32 v[222:223], v[222:223], v[226:227]
ds_write_b32 v60, v222 offset:14112
ds_write_b32 v60, v223 offset:14256
s_waitcnt lgkmcnt(0)
s_barrier
ds_read_b128 v[196:199], v61 offset:0
ds_read_b128 v[200:203], v61 offset:1152
ds_read_b128 v[204:207], v61 offset:2304
ds_read_b128 v[208:211], v61 offset:3456
s_waitcnt lgkmcnt(0)
v_pk_add_f32 v[196:197], v[196:197], v[200:201]
v_pk_add_f32 v[198:199], v[198:199], v[202:203]
v_pk_add_f32 v[204:205], v[204:205], v[208:209]
v_pk_add_f32 v[206:207], v[206:207], v[210:211]
v_pk_add_f32 v[228:229], v[196:197], v[204:205]
v_pk_add_f32 v[230:231], v[198:199], v[206:207]
buffer_store_dwordx4 v[228:231], v62, s[4:7], s49 offen sc1
ds_write_b128 v7, v[228:231]
v_add_u32 v7, 1024, v7
s_add_u32 s47, s47, 524288
s_add_u32 s49, s49, 4194304
s_add_u32 s46, s46, 1
s_cmp_lt_u32 s46, 64
s_cbranch_scc1 L_rtl
s_mov_b32 s50, 0
s_mov_b32 s51, 0
s_cmp_lg_u32 s20, s32
s_cbranch_scc1 L_end
s_nop 15
s_nop 15
s_nop 15
s_nop 15
s_nop 15
L_rtg:
s_add_u32 s48, s50, 0
buffer_load_dwordx4 v[68:71], v65, s[4:7], s48 offen sc1
buffer_load_dwordx4 v[72:75], v66, s[4:7], s48 offen sc1
buffer_load_dwordx4 v[76:79], v67, s[4:7], s48 offen sc1
s_add_u32 s48, s50, 4194304
buffer_load_dwordx4 v[80:83], v65, s[4:7], s48 offen sc1
buffer_load_dwordx4 v[84:87], v66, s[4:7], s48 offen sc1
buffer_load_dwordx4 v[88:91], v67, s[4:7], s48 offen sc1
s_sub_u32 s28, s28, 1
s_cbranch_scc1 L_end
s_waitcnt vmcnt(0)
v_pk_add_f32 v[68:69], v[68:69], v[72:73]
v_pk_add_f32 v[70:71], v[70:71], v[74:75]
v_pk_add_f32 v[68:69], v[68:69], v[76:77]
v_pk_add_f32 v[70:71], v[70:71], v[78:79]
ds_read_b128 v[72:75], v64 offset:0
v_pk_add_f32 v[80:81], v[80:81], v[84:85]
v_pk_add_f32 v[82:83], v[82:83], v[86:87]
v_pk_add_f32 v[80:81], v[80:81], v[88:89]
v_pk_add_f32 v[82:83], v[82:83], v[90:91]
ds_read_b128 v[84:87], v64 offset:1024
v_max3_u32 v55, v68, v69, v70
v_max3_u32 v55, v55, v71, v80
v_max3_u32 v55, v55, v81, v82
v_max_u32 v55, v55, v83
v_cmp_eq_u32 vcc, -1, v55
s_waitcnt lgkmcnt(0)
s_cbranch_vccnz L_rtg
v_pk_add_f32 v[68:69], v[68:69], v[72:73]
v_pk_add_f32 v[70:71], v[70:71], v[74:75]
v_cvt_pk_bf16_f32 v76, v68, v69
v_cvt_pk_bf16_f32 v77, v70, v71
s_add_u32 s48, s51, 0
buffer_store_dwordx2 v[76:77], v63, s[16:19], s48 offen sc1
v_pk_add_f32 v[80:81], v[80:81], v[84:85]
v_pk_add_f32 v[82:83], v[82:83], v[86:87]
v_cvt_pk_bf16_f32 v88, v80, v81
v_cvt_pk_bf16_f32 v89, v82, v83
s_add_u32 s48, s51, 131072
buffer_store_dwordx2 v[88:89], v63, s[16:19], s48 offen sc1
L_rtdone:
L_end:
s_endpgm
L_grole:
s_sub_u32 s32, s21, 128
s_lshr_b32 s24, s32, 5
s_and_b32 s25, s32, 31
s_lshr_b32 s26, s25, 3
s_lshl_b32 s26, s26, 5
s_lshl_b32 s27, s24, 3
s_add_u32 s26, s26, s27
s_and_b32 s27, s25, 7
s_add_u32 s32, s26, s27
s_mul_i32 s26, s24, 6
s_add_u32 s26, s26, s25
s_add_u32 s26, s26, 72
s_cmp_ge_u32 s25, 24
s_cselect_b32 s32, s26, s32
s_lshl_b32 s26, s24, 1
s_add_u32 s26, s26, s25
s_add_u32 s26, s26, 90
s_cmp_ge_u32 s25, 30
s_cselect_b32 s32, s26, s32
s_add_u32 s31, s32, 128
s_mov_b32 s54, 0
v_mov_b32 v8, 2147483648
v_mov_b32 v9, 2147483648
v_mov_b32 v10, 2147483648
v_mov_b32 v11, 2147483648
v_mov_b32 v12, 2147483648
v_mov_b32 v13, 2147483648
v_mov_b32 v14, 2147483648
v_mov_b32 v15, 2147483648
v_mov_b32 v16, 2147483648
v_mov_b32 v17, 2147483648
v_mov_b32 v18, 2147483648
v_mov_b32 v19, 2147483648
v_mov_b32 v20, 2147483648
v_mov_b32 v21, 2147483648
v_mov_b32 v22, 2147483648
v_mov_b32 v23, 2147483648
v_mov_b32 v24, 2147483648
v_mov_b32 v25, 2147483648
v_mov_b32 v26, 2147483648
v_mov_b32 v27, 2147483648
v_mov_b32 v28, 2147483648
v_mov_b32 v29, 2147483648
v_mov_b32 v30, 2147483648
v_mov_b32 v31, 2147483648
v_mov_b32 v32, 2147483648
v_mov_b32 v33, 2147483648
v_mov_b32 v34, 2147483648
v_mov_b32 v35, 2147483648
s_lshl_b32 s44, s20, 13
s_cmp_ge_u32 s32, 120
s_cbranch_scc1 L_b2role
s_mov_b32 s45, 0
s_cmp_ge_u32 s32, 96
s_cbranch_scc1 L_gB
s_lshr_b32 s24, s32, 5
s_and_b32 s25, s32, 31
s_mov_b32 s12, s70
s_mov_b32 s13, s71
s_mov_b32 s35, 75497472
s_mov_b32 s37, 0
s_cmp_eq_u32 s24, 1
s_cselect_b32 s12, s72, s12
s_cselect_b32 s13, s73, s13
s_cselect_b32 s35, 109051904, s35
s_cselect_b32 s37, 1, 0
s_cmp_eq_u32 s24, 2
s_cselect_b32 s12, s68, s12
s_cselect_b32 s13, s69, s13
s_cselect_b32 s35, 75497472, s35
s_cselect_b32 s45, 1, 0
s_mov_b32 s14, 8388608
s_mov_b32 s33, 8192
s_lshl_b32 s34, s25, 8
s_lshl_b32 s25, s25, 1
s_mov_b32 s36, 524288
s_mov_b32 s16, s64
s_mov_b32 s17, s65
s_branch L_gP
L_gB:
s_sub_u32 s26, s32, 96
s_lshr_b32 s24, s26, 3
s_and_b32 s25, s26, 7
s_mov_b32 s12, s80
s_mov_b32 s13, s81
s_mov_b32 s14, 6291456
s_mov_b32 s33, 6144
s_lshl_b32 s34, s26, 8
s_mov_b32 s36, 0x10000
s_lshl_b32 s35, s24, 22
s_add_u32 s35, s35, 159383552
s_cmp_eq_u32 s24, 2
s_cselect_b32 s37, 1, 0
s_mov_b32 s16, s78
s_mov_b32 s17, s79
L_gP:
s_mov_b32 s18, 4194304
s_lshl_b32 s25, s25, 2
s_add_u32 s25, s25, s20
s_lshl_b32 s25, s25, 11
s_add_u32 s25, s25, s35
v_add_u32 v22, s25, v2
s_lshl_b32 s25, s32, 2
s_add_u32 s25, s25, s20
s_lshl_b32 s25, s25, 6
v_mov_b32 v5, s25
v_mov_b32 v6, 2147483648
v_cmp_eq_u32 vcc, 0, v1
s_nop 1
v_cndmask_b32 v23, v6, v5, vcc
s_lshr_b32 s25, s25, 6
s_and_b32 s25, s25, 127
s_lshl_b32 s24, s37, 1
s_xor_b32 s25, s25, s24
s_lshr_b32 s24, s25, 3
s_lshl_b32 s24, s24, 14
s_and_b32 s25, s25, 7
s_lshl_b32 s25, s25, 10
s_add_u32 s25, s25, s24
s_lshl_b32 s24, s37, 18
s_add_u32 s25, s25, s24
s_add_u32 s25, s25, 8388608
s_cmp_lt_u32 s32, 64
s_cselect_b32 s25, s25, 1073741824
v_add_u32 v30, s25, v2
s_lshl_b32 s24, s32, 8
v_lshlrev_b32 v5, 6, v1
v_add_u32 v5, s24, v5
v_mov_b32 v6, 2147483648
v_cmp_gt_u32 vcc, 4, v0
s_nop 1
v_cndmask_b32 v32, v6, v5, vcc
v_mov_b32 v36, -1
v_mov_b32 v37, -1
v_mov_b32 v38, -1
v_mov_b32 v39, -1
v_lshrrev_b32 v5, 2, v4
v_lshlrev_b32 v5, 3, v5
v_and_b32 v6, 3, v4
v_add_u32 v5, v5, v6
v_lshlrev_b32 v5, 10, v5
v_xor_b32 v6, v3, v4
v_xor_b32 v7, 0, v6
v_lshl_add_u32 v14, v7, 4, v5
v_add_u32 v18, 65536, v14
v_xor_b32 v7, 4, v6
v_lshl_add_u32 v15, v7, 4, v5
v_add_u32 v19, 65536, v15
v_xor_b32 v7, 8, v6
v_lshl_add_u32 v16, v7, 4, v5
v_add_u32 v20, 65536, v16
v_xor_b32 v7, 12, v6
v_lshl_add_u32 v17, v7, 4, v5
v_add_u32 v21, 65536, v17
s_lshl_b32 s24, s20, 6
s_add_u32 s25, s24, 0
v_xor_b32 v10, s25, v2
v_add_u32 v10, 0, v10
s_add_u32 s25, s24, 16
v_xor_b32 v11, s25, v2
v_add_u32 v11, 1024, v11
s_add_u32 s25, s24, 32
v_xor_b32 v12, s25, v2
v_add_u32 v12, 2048, v12
s_add_u32 s25, s24, 48
v_xor_b32 v13, s25, v2
v_add_u32 v13, 3072, v13
s_lshl_b32 s39, s20, 14
s_lshl_b32 s44, s20, 13
s_add_u32 m0, s44, 0
s_add_u32 s29, s39, 0
buffer_load_dwordx4 v10, s[16:19], s29 offen offset:0 lds
buffer_load_dwordx4 v11, s[16:19], s29 offen offset:1024 lds
buffer_load_dwordx4 v12, s[16:19], s29 offen offset:2048 lds
buffer_load_dwordx4 v13, s[16:19], s29 offen offset:3072 lds
s_add_u32 m0, s44, 4096
s_add_u32 s29, s39, 8192
buffer_load_dwordx4 v10, s[16:19], s29 offen offset:0 lds
buffer_load_dwordx4 v11, s[16:19], s29 offen offset:1024 lds
buffer_load_dwordx4 v12, s[16:19], s29 offen offset:2048 lds
buffer_load_dwordx4 v13, s[16:19], s29 offen offset:3072 lds
s_add_u32 m0, s44, 32768
s_add_u32 s29, s39, 1024
buffer_load_dwordx4 v10, s[16:19], s29 offen offset:0 lds
buffer_load_dwordx4 v11, s[16:19], s29 offen offset:1024 lds
buffer_load_dwordx4 v12, s[16:19], s29 offen offset:2048 lds
buffer_load_dwordx4 v13, s[16:19], s29 offen offset:3072 lds
s_add_u32 m0, s44, 36864
s_add_u32 s29, s39, 9216
buffer_load_dwordx4 v10, s[16:19], s29 offen offset:0 lds
buffer_load_dwordx4 v11, s[16:19], s29 offen offset:1024 lds
buffer_load_dwordx4 v12, s[16:19], s29 offen offset:2048 lds
buffer_load_dwordx4 v13, s[16:19], s29 offen offset:3072 lds
s_lshl_b32 s25, s21, 1
s_add_u32 s25, s25, s20
s_cmp_ge_u32 s32, 999
s_cselect_b32 s24, s25, s32
s_cselect_b32 s26, 128, 64
s_and_b32 s24, s24, 7
s_lshl_b32 s24, s24, 13
s_add_u32 s24, s24, 65536
s_sub_u32 s24, s24, s39
v_lshlrev_b32 v5, 7, v1
v_add_u32 v5, s24, v5
v_mov_b32 v6, 2147483648
v_cmp_gt_u32 vcc, s26, v0
s_nop 1
v_cndmask_b32 v25, v6, v5, vcc
s_add_u32 s43, s39, 0
buffer_load_dword v26, v25, s[16:19], s43 offen
s_add_u32 s43, s39, 65536
buffer_load_dword v26, v25, s[16:19], s43 offen
s_add_u32 s43, s39, 131072
buffer_load_dword v26, v25, s[16:19], s43 offen
s_add_u32 s43, s39, 196608
buffer_load_dword v26, v25, s[16:19], s43 offen
s_add_u32 s43, s39, 262144
buffer_load_dword v26, v25, s[16:19], s43 offen
s_add_u32 s43, s39, 327680
buffer_load_dword v26, v25, s[16:19], s43 offen
v_add_u32 v25, 327680, v25
s_lshr_b32 s24, s32, 5
s_lshr_b32 s24, 9, s24
s_and_b32 s24, s24, 1
s_cmp_eq_u32 s24, 1
s_cbranch_scc1 L_pfk
v_mov_b32 v25, 2147483648
L_pfk:
s_mov_b32 s42, s34
v_mul_lo_u32 v5, v3, s33
v_lshlrev_b32 v6, 2, v3
v_xor_b32 v6, v6, v4
v_lshl_add_u32 v8, v6, 4, v5
s_lshl_b32 s24, s20, 5
s_mul_i32 s24, s24, s33
s_add_u32 s42, s42, s24
s_lshl_b32 s33, s33, 2
s_lshl_b32 s41, s20, 13
s_add_u32 s41, s41, 65536
v_bfe_u32 v5, v1, 2, 2
v_lshl_add_u32 v5, v3, 3, v5
v_lshlrev_b32 v5, 8, v5
v_and_b32 v6, 3, v1
v_lshl_add_u32 v5, v6, 4, v5
v_bfe_u32 v6, v1, 2, 2
v_xor_b32 v6, s20, v6
v_lshl_add_u32 v5, v6, 6, v5
v_add_u32 v9, 65536, v5
s_add_u32 m0, s41, 0
s_nop 0
buffer_load_dwordx4 v8, s[12:15], s42 offen lds
s_add_u32 s42, s42, s33
s_add_u32 m0, s41, 1024
s_nop 0
buffer_load_dwordx4 v8, s[12:15], s42 offen lds
s_add_u32 s42, s42, s33
s_add_u32 m0, s41, 2048
s_nop 0
buffer_load_dwordx4 v8, s[12:15], s42 offen lds
s_add_u32 s42, s42, s33
s_add_u32 m0, s41, 3072
s_nop 0
buffer_load_dwordx4 v8, s[12:15], s42 offen lds
s_add_u32 s42, s42, s33
s_add_u32 m0, s41, 4096
s_nop 0
buffer_load_dwordx4 v8, s[12:15], s42 offen lds
s_add_u32 s42, s42, s33
s_add_u32 m0, s41, 5120
s_nop 0
buffer_load_dwordx4 v8, s[12:15], s42 offen lds
s_add_u32 s42, s42, s33
s_add_u32 m0, s41, 6144
s_nop 0
buffer_load_dwordx4 v8, s[12:15], s42 offen lds
s_add_u32 s42, s42, s33
s_add_u32 m0, s41, 7168
s_nop 0
buffer_load_dwordx4 v8, s[12:15], s42 offen lds
s_add_u32 s42, s42, s33
s_mul_i32 s24, s33, 24
s_add_u32 s42, s42, s24
s_add_u32 m0, s41, 32768
s_nop 0
buffer_load_dwordx4 v8, s[12:15], s42 offen lds
s_add_u32 s42, s42, s33
s_add_u32 m0, s41, 33792
s_nop 0
buffer_load_dwordx4 v8, s[12:15], s42 offen lds
s_add_u32 s42, s42, s33
s_add_u32 m0, s41, 34816
s_nop 0
buffer_load_dwordx4 v8, s[12:15], s42 offen lds
s_add_u32 s42, s42, s33
s_add_u32 m0, s41, 35840
s_nop 0
buffer_load_dwordx4 v8, s[12:15], s42 offen lds
s_add_u32 s42, s42, s33
s_add_u32 m0, s41, 36864
s_nop 0
buffer_load_dwordx4 v8, s[12:15], s42 offen lds
s_add_u32 s42, s42, s33
s_add_u32 m0, s41, 37888
s_nop 0
buffer_load_dwordx4 v8, s[12:15], s42 offen lds
s_add_u32 s42, s42, s33
s_add_u32 m0, s41, 38912
s_nop 0
buffer_load_dwordx4 v8, s[12:15], s42 offen lds
s_add_u32 s42, s42, s33
s_add_u32 m0, s41, 39936
s_nop 0
buffer_load_dwordx4 v8, s[12:15], s42 offen lds
s_add_u32 s42, s42, s33
s_mul_i32 s24, s33, 24
s_add_u32 s42, s42, s24
s_add_u32 m0, s41, 65536
s_nop 0
buffer_load_dwordx4 v8, s[12:15], s42 offen lds
s_add_u32 s42, s42, s33
s_add_u32 m0, s41, 66560
s_nop 0
buffer_load_dwordx4 v8, s[12:15], s42 offen lds
s_add_u32 s42, s42, s33
s_add_u32 m0, s41, 67584
s_nop 0
buffer_load_dwordx4 v8, s[12:15], s42 offen lds
s_add_u32 s42, s42, s33
s_add_u32 m0, s41, 68608
s_nop 0
buffer_load_dwordx4 v8, s[12:15], s42 offen lds
s_add_u32 s42, s42, s33
s_add_u32 m0, s41, 69632
s_nop 0
buffer_load_dwordx4 v8, s[12:15], s42 offen lds
s_add_u32 s42, s42, s33
s_add_u32 m0, s41, 70656
s_nop 0
buffer_load_dwordx4 v8, s[12:15], s42 offen lds
s_add_u32 s42, s42, s33
s_add_u32 m0, s41, 71680
s_nop 0
buffer_load_dwordx4 v8, s[12:15], s42 offen lds
s_add_u32 s42, s42, s33
s_add_u32 m0, s41, 72704
s_nop 0
buffer_load_dwordx4 v8, s[12:15], s42 offen lds
s_add_u32 s42, s42, s33
s_mul_i32 s24, s33, 24
s_add_u32 s42, s42, s24
s_waitcnt vmcnt(16)
s_barrier
ds_read_b64_tr_b16 a[0:1], v9 offset:0
ds_read_b64_tr_b16 a[2:3], v9 offset:1024
ds_read_b64_tr_b16 a[128:129], v9 offset:8
ds_read_b64_tr_b16 a[130:131], v9 offset:1032
ds_read_b64_tr_b16 a[4:5], v9 offset:8192
ds_read_b64_tr_b16 a[6:7], v9 offset:9216
ds_read_b64_tr_b16 a[132:133], v9 offset:8200
ds_read_b64_tr_b16 a[134:135], v9 offset:9224
ds_read_b64_tr_b16 a[8:9], v9 offset:16384
ds_read_b64_tr_b16 a[10:11], v9 offset:17408
ds_read_b64_tr_b16 a[136:137], v9 offset:16392
ds_read_b64_tr_b16 a[138:139], v9 offset:17416
ds_read_b64_tr_b16 a[12:13], v9 offset:24576
ds_read_b64_tr_b16 a[14:15], v9 offset:25600
ds_read_b64_tr_b16 a[140:141], v9 offset:24584
ds_read_b64_tr_b16 a[142:143], v9 offset:25608
s_waitcnt lgkmcnt(0)
ds_read_b128 v[56:59], v14 offset:0
ds_read_b128 v[60:63], v14 offset:4096
ds_read_b128 v[64:67], v15 offset:0
ds_read_b128 v[68:71], v15 offset:4096
ds_read_b128 v[72:75], v16 offset:0
ds_read_b128 v[76:79], v16 offset:4096
ds_read_b128 v[80:83], v17 offset:0
ds_read_b128 v[84:87], v17 offset:4096
s_waitcnt lgkmcnt(0)
s_cmp_eq_u32 s37, 1
s_cbranch_scc1 L_f0n0
v_mfma_f32_16x16x32_bf16 v[104:107], a[0:3], v[56:59], 0
v_mfma_f32_16x16x32_bf16 v[108:111], a[128:131], v[56:59], 0
v_mfma_f32_16x16x32_bf16 v[112:115], a[0:3], v[60:63], 0
v_mfma_f32_16x16x32_bf16 v[116:119], a[128:131], v[60:63], 0
v_mfma_f32_16x16x32_bf16 v[104:107], a[4:7], v[64:67], v[104:107]
v_mfma_f32_16x16x32_bf16 v[108:111], a[132:135], v[64:67], v[108:111]
v_mfma_f32_16x16x32_bf16 v[112:115], a[4:7], v[68:71], v[112:115]
v_mfma_f32_16x16x32_bf16 v[116:119], a[132:135], v[68:71], v[116:119]
v_mfma_f32_16x16x32_bf16 v[104:107], a[8:11], v[72:75], v[104:107]
v_mfma_f32_16x16x32_bf16 v[108:111], a[136:139], v[72:75], v[108:111]
v_mfma_f32_16x16x32_bf16 v[112:115], a[8:11], v[76:79], v[112:115]
v_mfma_f32_16x16x32_bf16 v[116:119], a[136:139], v[76:79], v[116:119]
v_mfma_f32_16x16x32_bf16 v[104:107], a[12:15], v[80:83], v[104:107]
v_mfma_f32_16x16x32_bf16 v[108:111], a[140:143], v[80:83], v[108:111]
v_mfma_f32_16x16x32_bf16 v[112:115], a[12:15], v[84:87], v[112:115]
v_mfma_f32_16x16x32_bf16 v[116:119], a[140:143], v[84:87], v[116:119]
s_branch L_f0d0
L_f0n0:
v_mfma_f32_16x16x32_bf16 v[104:107], v[56:59], a[0:3], 0
v_mfma_f32_16x16x32_bf16 v[108:111], v[56:59], a[128:131], 0
v_mfma_f32_16x16x32_bf16 v[112:115], v[60:63], a[0:3], 0
v_mfma_f32_16x16x32_bf16 v[116:119], v[60:63], a[128:131], 0
v_mfma_f32_16x16x32_bf16 v[104:107], v[64:67], a[4:7], v[104:107]
v_mfma_f32_16x16x32_bf16 v[108:111], v[64:67], a[132:135], v[108:111]
v_mfma_f32_16x16x32_bf16 v[112:115], v[68:71], a[4:7], v[112:115]
v_mfma_f32_16x16x32_bf16 v[116:119], v[68:71], a[132:135], v[116:119]
v_mfma_f32_16x16x32_bf16 v[104:107], v[72:75], a[8:11], v[104:107]
v_mfma_f32_16x16x32_bf16 v[108:111], v[72:75], a[136:139], v[108:111]
v_mfma_f32_16x16x32_bf16 v[112:115], v[76:79], a[8:11], v[112:115]
v_mfma_f32_16x16x32_bf16 v[116:119], v[76:79], a[136:139], v[116:119]
v_mfma_f32_16x16x32_bf16 v[104:107], v[80:83], a[12:15], v[104:107]
v_mfma_f32_16x16x32_bf16 v[108:111], v[80:83], a[140:143], v[108:111]
v_mfma_f32_16x16x32_bf16 v[112:115], v[84:87], a[12:15], v[112:115]
v_mfma_f32_16x16x32_bf16 v[116:119], v[84:87], a[140:143], v[116:119]
L_f0d0:
s_waitcnt vmcnt(8)
s_barrier
s_add_u32 m0, s41, 0
s_nop 0
buffer_load_dwordx4 v8, s[12:15], s42 offen lds
s_add_u32 s42, s42, s33
s_add_u32 m0, s41, 1024
s_nop 0
buffer_load_dwordx4 v8, s[12:15], s42 offen lds
s_add_u32 s42, s42, s33
s_add_u32 m0, s41, 2048
s_nop 0
buffer_load_dwordx4 v8, s[12:15], s42 offen lds
s_add_u32 s42, s42, s33
s_add_u32 m0, s41, 3072
s_nop 0
buffer_load_dwordx4 v8, s[12:15], s42 offen lds
s_add_u32 s42, s42, s33
s_add_u32 m0, s41, 4096
s_nop 0
buffer_load_dwordx4 v8, s[12:15], s42 offen lds
s_add_u32 s42, s42, s33
s_add_u32 m0, s41, 5120
s_nop 0
buffer_load_dwordx4 v8, s[12:15], s42 offen lds
s_add_u32 s42, s42, s33
s_add_u32 m0, s41, 6144
s_nop 0
buffer_load_dwordx4 v8, s[12:15], s42 offen lds
s_add_u32 s42, s42, s33
s_add_u32 m0, s41, 7168
s_nop 0
buffer_load_dwordx4 v8, s[12:15], s42 offen lds
s_add_u32 s42, s42, s33
s_mul_i32 s24, s33, 24
s_add_u32 s42, s42, s24
ds_read_b64_tr_b16 a[16:17], v9 offset:32768
ds_read_b64_tr_b16 a[18:19], v9 offset:33792
ds_read_b64_tr_b16 a[144:145], v9 offset:32776
ds_read_b64_tr_b16 a[146:147], v9 offset:33800
ds_read_b64_tr_b16 a[20:21], v9 offset:40960
ds_read_b64_tr_b16 a[22:23], v9 offset:41984
ds_read_b64_tr_b16 a[148:149], v9 offset:40968
ds_read_b64_tr_b16 a[150:151], v9 offset:41992
ds_read_b64_tr_b16 a[24:25], v9 offset:49152
ds_read_b64_tr_b16 a[26:27], v9 offset:50176
ds_read_b64_tr_b16 a[152:153], v9 offset:49160
ds_read_b64_tr_b16 a[154:155], v9 offset:50184
ds_read_b64_tr_b16 a[28:29], v9 offset:57344
ds_read_b64_tr_b16 a[30:31], v9 offset:58368
ds_read_b64_tr_b16 a[156:157], v9 offset:57352
ds_read_b64_tr_b16 a[158:159], v9 offset:58376
s_waitcnt lgkmcnt(0)
ds_read_b128 v[56:59], v14 offset:256
ds_read_b128 v[60:63], v14 offset:4352
ds_read_b128 v[64:67], v15 offset:256
ds_read_b128 v[68:71], v15 offset:4352
ds_read_b128 v[72:75], v16 offset:256
ds_read_b128 v[76:79], v16 offset:4352
ds_read_b128 v[80:83], v17 offset:256
ds_read_b128 v[84:87], v17 offset:4352
s_waitcnt lgkmcnt(0)
s_cmp_eq_u32 s37, 1
s_cbranch_scc1 L_f0n1
v_mfma_f32_16x16x32_bf16 v[104:107], a[16:19], v[56:59], v[104:107]
v_mfma_f32_16x16x32_bf16 v[108:111], a[144:147], v[56:59], v[108:111]
v_mfma_f32_16x16x32_bf16 v[112:115], a[16:19], v[60:63], v[112:115]
v_mfma_f32_16x16x32_bf16 v[116:119], a[144:147], v[60:63], v[116:119]
v_mfma_f32_16x16x32_bf16 v[104:107], a[20:23], v[64:67], v[104:107]
v_mfma_f32_16x16x32_bf16 v[108:111], a[148:151], v[64:67], v[108:111]
v_mfma_f32_16x16x32_bf16 v[112:115], a[20:23], v[68:71], v[112:115]
v_mfma_f32_16x16x32_bf16 v[116:119], a[148:151], v[68:71], v[116:119]
v_mfma_f32_16x16x32_bf16 v[104:107], a[24:27], v[72:75], v[104:107]
v_mfma_f32_16x16x32_bf16 v[108:111], a[152:155], v[72:75], v[108:111]
v_mfma_f32_16x16x32_bf16 v[112:115], a[24:27], v[76:79], v[112:115]
v_mfma_f32_16x16x32_bf16 v[116:119], a[152:155], v[76:79], v[116:119]
v_mfma_f32_16x16x32_bf16 v[104:107], a[28:31], v[80:83], v[104:107]
v_mfma_f32_16x16x32_bf16 v[108:111], a[156:159], v[80:83], v[108:111]
v_mfma_f32_16x16x32_bf16 v[112:115], a[28:31], v[84:87], v[112:115]
v_mfma_f32_16x16x32_bf16 v[116:119], a[156:159], v[84:87], v[116:119]
s_branch L_f0d1
L_f0n1:
v_mfma_f32_16x16x32_bf16 v[104:107], v[56:59], a[16:19], v[104:107]
v_mfma_f32_16x16x32_bf16 v[108:111], v[56:59], a[144:147], v[108:111]
v_mfma_f32_16x16x32_bf16 v[112:115], v[60:63], a[16:19], v[112:115]
v_mfma_f32_16x16x32_bf16 v[116:119], v[60:63], a[144:147], v[116:119]
v_mfma_f32_16x16x32_bf16 v[104:107], v[64:67], a[20:23], v[104:107]
v_mfma_f32_16x16x32_bf16 v[108:111], v[64:67], a[148:151], v[108:111]
v_mfma_f32_16x16x32_bf16 v[112:115], v[68:71], a[20:23], v[112:115]
v_mfma_f32_16x16x32_bf16 v[116:119], v[68:71], a[148:151], v[116:119]
v_mfma_f32_16x16x32_bf16 v[104:107], v[72:75], a[24:27], v[104:107]
v_mfma_f32_16x16x32_bf16 v[108:111], v[72:75], a[152:155], v[108:111]
v_mfma_f32_16x16x32_bf16 v[112:115], v[76:79], a[24:27], v[112:115]
v_mfma_f32_16x16x32_bf16 v[116:119], v[76:79], a[152:155], v[116:119]
v_mfma_f32_16x16x32_bf16 v[104:107], v[80:83], a[28:31], v[104:107]
v_mfma_f32_16x16x32_bf16 v[108:111], v[80:83], a[156:159], v[108:111]
v_mfma_f32_16x16x32_bf16 v[112:115], v[84:87], a[28:31], v[112:115]
v_mfma_f32_16x16x32_bf16 v[116:119], v[84:87], a[156:159], v[116:119]
L_f0d1:
s_waitcnt vmcnt(8)
s_barrier
s_add_u32 m0, s41, 32768
s_nop 0
buffer_load_dwordx4 v8, s[12:15], s42 offen lds
s_add_u32 s42, s42, s33
s_add_u32 m0, s41, 33792
s_nop 0
buffer_load_dwordx4 v8, s[12:15], s42 offen lds
s_add_u32 s42, s42, s33
s_add_u32 m0, s41, 34816
s_nop 0
buffer_load_dwordx4 v8, s[12:15], s42 offen lds
s_add_u32 s42, s42, s33
s_add_u32 m0, s41, 35840
s_nop 0
buffer_load_dwordx4 v8, s[12:15], s42 offen lds
s_add_u32 s42, s42, s33
s_add_u32 m0, s41, 36864
s_nop 0
buffer_load_dwordx4 v8, s[12:15], s42 offen lds
s_add_u32 s42, s42, s33
s_add_u32 m0, s41, 37888
s_nop 0
buffer_load_dwordx4 v8, s[12:15], s42 offen lds
s_add_u32 s42, s42, s33
s_add_u32 m0, s41, 38912
s_nop 0
buffer_load_dwordx4 v8, s[12:15], s42 offen lds
s_add_u32 s42, s42, s33
s_add_u32 m0, s41, 39936
s_nop 0
buffer_load_dwordx4 v8, s[12:15], s42 offen lds
s_add_u32 s42, s42, s33
s_mul_i32 s24, s33, 24
s_add_u32 s42, s42, s24
v_add_u32 v9, 65536, v9
ds_read_b64_tr_b16 a[32:33], v9 offset:0
ds_read_b64_tr_b16 a[34:35], v9 offset:1024
ds_read_b64_tr_b16 a[160:161], v9 offset:8
ds_read_b64_tr_b16 a[162:163], v9 offset:1032
ds_read_b64_tr_b16 a[36:37], v9 offset:8192
ds_read_b64_tr_b16 a[38:39], v9 offset:9216
ds_read_b64_tr_b16 a[164:165], v9 offset:8200
ds_read_b64_tr_b16 a[166:167], v9 offset:9224
ds_read_b64_tr_b16 a[40:41], v9 offset:16384
ds_read_b64_tr_b16 a[42:43], v9 offset:17408
ds_read_b64_tr_b16 a[168:169], v9 offset:16392
ds_read_b64_tr_b16 a[170:171], v9 offset:17416
ds_read_b64_tr_b16 a[44:45], v9 offset:24576
ds_read_b64_tr_b16 a[46:47], v9 offset:25600
ds_read_b64_tr_b16 a[172:173], v9 offset:24584
ds_read_b64_tr_b16 a[174:175], v9 offset:25608
s_waitcnt lgkmcnt(0)
ds_read_b128 v[56:59], v14 offset:512
ds_read_b128 v[60:63], v14 offset:4608
ds_read_b128 v[64:67], v15 offset:512
ds_read_b128 v[68:71], v15 offset:4608
ds_read_b128 v[72:75], v16 offset:512
ds_read_b128 v[76:79], v16 offset:4608
ds_read_b128 v[80:83], v17 offset:512
ds_read_b128 v[84:87], v17 offset:4608
s_waitcnt lgkmcnt(0)
s_cmp_eq_u32 s37, 1
s_cbranch_scc1 L_f0n2
v_mfma_f32_16x16x32_bf16 v[104:107], a[32:35], v[56:59], v[104:107]
v_mfma_f32_16x16x32_bf16 v[108:111], a[160:163], v[56:59], v[108:111]
v_mfma_f32_16x16x32_bf16 v[112:115], a[32:35], v[60:63], v[112:115]
v_mfma_f32_16x16x32_bf16 v[116:119], a[160:163], v[60:63], v[116:119]
v_mfma_f32_16x16x32_bf16 v[104:107], a[36:39], v[64:67], v[104:107]
v_mfma_f32_16x16x32_bf16 v[108:111], a[164:167], v[64:67], v[108:111]
v_mfma_f32_16x16x32_bf16 v[112:115], a[36:39], v[68:71], v[112:115]
v_mfma_f32_16x16x32_bf16 v[116:119], a[164:167], v[68:71], v[116:119]
v_mfma_f32_16x16x32_bf16 v[104:107], a[40:43], v[72:75], v[104:107]
v_mfma_f32_16x16x32_bf16 v[108:111], a[168:171], v[72:75], v[108:111]
v_mfma_f32_16x16x32_bf16 v[112:115], a[40:43], v[76:79], v[112:115]
v_mfma_f32_16x16x32_bf16 v[116:119], a[168:171], v[76:79], v[116:119]
v_mfma_f32_16x16x32_bf16 v[104:107], a[44:47], v[80:83], v[104:107]
v_mfma_f32_16x16x32_bf16 v[108:111], a[172:175], v[80:83], v[108:111]
v_mfma_f32_16x16x32_bf16 v[112:115], a[44:47], v[84:87], v[112:115]
v_mfma_f32_16x16x32_bf16 v[116:119], a[172:175], v[84:87], v[116:119]
s_branch L_f0d2
L_f0n2:
v_mfma_f32_16x16x32_bf16 v[104:107], v[56:59], a[32:35], v[104:107]
v_mfma_f32_16x16x32_bf16 v[108:111], v[56:59], a[160:163], v[108:111]
v_mfma_f32_16x16x32_bf16 v[112:115], v[60:63], a[32:35], v[112:115]
v_mfma_f32_16x16x32_bf16 v[116:119], v[60:63], a[160:163], v[116:119]
v_mfma_f32_16x16x32_bf16 v[104:107], v[64:67], a[36:39], v[104:107]
v_mfma_f32_16x16x32_bf16 v[108:111], v[64:67], a[164:167], v[108:111]
v_mfma_f32_16x16x32_bf16 v[112:115], v[68:71], a[36:39], v[112:115]
v_mfma_f32_16x16x32_bf16 v[116:119], v[68:71], a[164:167], v[116:119]
v_mfma_f32_16x16x32_bf16 v[104:107], v[72:75], a[40:43], v[104:107]
v_mfma_f32_16x16x32_bf16 v[108:111], v[72:75], a[168:171], v[108:111]
v_mfma_f32_16x16x32_bf16 v[112:115], v[76:79], a[40:43], v[112:115]
v_mfma_f32_16x16x32_bf16 v[116:119], v[76:79], a[168:171], v[116:119]
v_mfma_f32_16x16x32_bf16 v[104:107], v[80:83], a[44:47], v[104:107]
v_mfma_f32_16x16x32_bf16 v[108:111], v[80:83], a[172:175], v[108:111]
v_mfma_f32_16x16x32_bf16 v[112:115], v[84:87], a[44:47], v[112:115]
v_mfma_f32_16x16x32_bf16 v[116:119], v[84:87], a[172:175], v[116:119]
L_f0d2:
s_waitcnt vmcnt(8)
s_barrier
s_add_u32 m0, s41, 65536
s_nop 0
buffer_load_dwordx4 v8, s[12:15], s42 offen lds
s_add_u32 s42, s42, s33
s_add_u32 m0, s41, 66560
s_nop 0
buffer_load_dwordx4 v8, s[12:15], s42 offen lds
s_add_u32 s42, s42, s33
s_add_u32 m0, s41, 67584
s_nop 0
buffer_load_dwordx4 v8, s[12:15], s42 offen lds
s_add_u32 s42, s42, s33
s_add_u32 m0, s41, 68608
s_nop 0
buffer_load_dwordx4 v8, s[12:15], s42 offen lds
s_add_u32 s42, s42, s33
s_add_u32 m0, s41, 69632
s_nop 0
buffer_load_dwordx4 v8, s[12:15], s42 offen lds
s_add_u32 s42, s42, s33
s_add_u32 m0, s41, 70656
s_nop 0
buffer_load_dwordx4 v8, s[12:15], s42 offen lds
s_add_u32 s42, s42, s33
s_add_u32 m0, s41, 71680
s_nop 0
buffer_load_dwordx4 v8, s[12:15], s42 offen lds
s_add_u32 s42, s42, s33
s_add_u32 m0, s41, 72704
s_nop 0
buffer_load_dwordx4 v8, s[12:15], s42 offen lds
s_add_u32 s42, s42, s33
s_mul_i32 s24, s33, 24
s_add_u32 s42, s42, s24
v_subrev_u32 v9, 65536, v9
ds_read_b64_tr_b16 a[48:49], v9 offset:0
ds_read_b64_tr_b16 a[50:51], v9 offset:1024
ds_read_b64_tr_b16 a[176:177], v9 offset:8
ds_read_b64_tr_b16 a[178:179], v9 offset:1032
ds_read_b64_tr_b16 a[52:53], v9 offset:8192
ds_read_b64_tr_b16 a[54:55], v9 offset:9216
ds_read_b64_tr_b16 a[180:181], v9 offset:8200
ds_read_b64_tr_b16 a[182:183], v9 offset:9224
ds_read_b64_tr_b16 a[56:57], v9 offset:16384
ds_read_b64_tr_b16 a[58:59], v9 offset:17408
ds_read_b64_tr_b16 a[184:185], v9 offset:16392
ds_read_b64_tr_b16 a[186:187], v9 offset:17416
ds_read_b64_tr_b16 a[60:61], v9 offset:24576
ds_read_b64_tr_b16 a[62:63], v9 offset:25600
ds_read_b64_tr_b16 a[188:189], v9 offset:24584
ds_read_b64_tr_b16 a[190:191], v9 offset:25608
s_waitcnt lgkmcnt(0)
ds_read_b128 v[56:59], v14 offset:768
ds_read_b128 v[60:63], v14 offset:4864
ds_read_b128 v[64:67], v15 offset:768
ds_read_b128 v[68:71], v15 offset:4864
ds_read_b128 v[72:75], v16 offset:768
ds_read_b128 v[76:79], v16 offset:4864
ds_read_b128 v[80:83], v17 offset:768
ds_read_b128 v[84:87], v17 offset:4864
s_waitcnt lgkmcnt(0)
s_cmp_eq_u32 s37, 1
s_cbranch_scc1 L_f0n3
v_mfma_f32_16x16x32_bf16 v[104:107], a[48:51], v[56:59], v[104:107]
v_mfma_f32_16x16x32_bf16 v[108:111], a[176:179], v[56:59], v[108:111]
v_mfma_f32_16x16x32_bf16 v[112:115], a[48:51], v[60:63], v[112:115]
v_mfma_f32_16x16x32_bf16 v[116:119], a[176:179], v[60:63], v[116:119]
v_mfma_f32_16x16x32_bf16 v[104:107], a[52:55], v[64:67], v[104:107]
v_mfma_f32_16x16x32_bf16 v[108:111], a[180:183], v[64:67], v[108:111]
v_mfma_f32_16x16x32_bf16 v[112:115], a[52:55], v[68:71], v[112:115]
v_mfma_f32_16x16x32_bf16 v[116:119], a[180:183], v[68:71], v[116:119]
v_mfma_f32_16x16x32_bf16 v[104:107], a[56:59], v[72:75], v[104:107]
v_mfma_f32_16x16x32_bf16 v[108:111], a[184:187], v[72:75], v[108:111]
v_mfma_f32_16x16x32_bf16 v[112:115], a[56:59], v[76:79], v[112:115]
v_mfma_f32_16x16x32_bf16 v[116:119], a[184:187], v[76:79], v[116:119]
v_mfma_f32_16x16x32_bf16 v[104:107], a[60:63], v[80:83], v[104:107]
v_mfma_f32_16x16x32_bf16 v[108:111], a[188:191], v[80:83], v[108:111]
v_mfma_f32_16x16x32_bf16 v[112:115], a[60:63], v[84:87], v[112:115]
v_mfma_f32_16x16x32_bf16 v[116:119], a[188:191], v[84:87], v[116:119]
s_branch L_f0d3
L_f0n3:
v_mfma_f32_16x16x32_bf16 v[104:107], v[56:59], a[48:51], v[104:107]
v_mfma_f32_16x16x32_bf16 v[108:111], v[56:59], a[176:179], v[108:111]
v_mfma_f32_16x16x32_bf16 v[112:115], v[60:63], a[48:51], v[112:115]
v_mfma_f32_16x16x32_bf16 v[116:119], v[60:63], a[176:179], v[116:119]
v_mfma_f32_16x16x32_bf16 v[104:107], v[64:67], a[52:55], v[104:107]
v_mfma_f32_16x16x32_bf16 v[108:111], v[64:67], a[180:183], v[108:111]
v_mfma_f32_16x16x32_bf16 v[112:115], v[68:71], a[52:55], v[112:115]
v_mfma_f32_16x16x32_bf16 v[116:119], v[68:71], a[180:183], v[116:119]
v_mfma_f32_16x16x32_bf16 v[104:107], v[72:75], a[56:59], v[104:107]
v_mfma_f32_16x16x32_bf16 v[108:111], v[72:75], a[184:187], v[108:111]
v_mfma_f32_16x16x32_bf16 v[112:115], v[76:79], a[56:59], v[112:115]
v_mfma_f32_16x16x32_bf16 v[116:119], v[76:79], a[184:187], v[116:119]
v_mfma_f32_16x16x32_bf16 v[104:107], v[80:83], a[60:63], v[104:107]
v_mfma_f32_16x16x32_bf16 v[108:111], v[80:83], a[188:191], v[108:111]
v_mfma_f32_16x16x32_bf16 v[112:115], v[84:87], a[60:63], v[112:115]
v_mfma_f32_16x16x32_bf16 v[116:119], v[84:87], a[188:191], v[116:119]
L_f0d3:
s_waitcnt vmcnt(8)
s_barrier
s_add_u32 m0, s41, 0
s_nop 0
buffer_load_dwordx4 v8, s[12:15], s42 offen lds
s_add_u32 s42, s42, s33
s_add_u32 m0, s41, 1024
s_nop 0
buffer_load_dwordx4 v8, s[12:15], s42 offen lds
s_add_u32 s42, s42, s33
s_add_u32 m0, s41, 2048
s_nop 0
buffer_load_dwordx4 v8, s[12:15], s42 offen lds
s_add_u32 s42, s42, s33
s_add_u32 m0, s41, 3072
s_nop 0
buffer_load_dwordx4 v8, s[12:15], s42 offen lds
s_add_u32 s42, s42, s33
s_add_u32 m0, s41, 4096
s_nop 0
buffer_load_dwordx4 v8, s[12:15], s42 offen lds
s_add_u32 s42, s42, s33
s_add_u32 m0, s41, 5120
s_nop 0
buffer_load_dwordx4 v8, s[12:15], s42 offen lds
s_add_u32 s42, s42, s33
s_add_u32 m0, s41, 6144
s_nop 0
buffer_load_dwordx4 v8, s[12:15], s42 offen lds
s_add_u32 s42, s42, s33
s_add_u32 m0, s41, 7168
s_nop 0
buffer_load_dwordx4 v8, s[12:15], s42 offen lds
s_add_u32 s42, s42, s33
s_mul_i32 s24, s33, 24
s_add_u32 s42, s42, s24
ds_read_b64_tr_b16 a[64:65], v9 offset:32768
ds_read_b64_tr_b16 a[66:67], v9 offset:33792
ds_read_b64_tr_b16 a[192:193], v9 offset:32776
ds_read_b64_tr_b16 a[194:195], v9 offset:33800
ds_read_b64_tr_b16 a[68:69], v9 offset:40960
ds_read_b64_tr_b16 a[70:71], v9 offset:41984
ds_read_b64_tr_b16 a[196:197], v9 offset:40968
ds_read_b64_tr_b16 a[198:199], v9 offset:41992
ds_read_b64_tr_b16 a[72:73], v9 offset:49152
ds_read_b64_tr_b16 a[74:75], v9 offset:50176
ds_read_b64_tr_b16 a[200:201], v9 offset:49160
ds_read_b64_tr_b16 a[202:203], v9 offset:50184
ds_read_b64_tr_b16 a[76:77], v9 offset:57344
ds_read_b64_tr_b16 a[78:79], v9 offset:58368
ds_read_b64_tr_b16 a[204:205], v9 offset:57352
ds_read_b64_tr_b16 a[206:207], v9 offset:58376
s_waitcnt lgkmcnt(0)
s_add_u32 s39, s39, 65536
v_lshlrev_b32 v5, 2, v1
buffer_load_dword v128, v5, s[8:11], 0 offen sc1
s_add_u32 m0, s44, 0
s_add_u32 s29, s39, 0
buffer_load_dwordx4 v10, s[16:19], s29 offen offset:0 lds
buffer_load_dwordx4 v11, s[16:19], s29 offen offset:1024 lds
buffer_load_dwordx4 v12, s[16:19], s29 offen offset:2048 lds
buffer_load_dwordx4 v13, s[16:19], s29 offen offset:3072 lds
s_add_u32 m0, s44, 4096
s_add_u32 s29, s39, 8192
buffer_load_dwordx4 v10, s[16:19], s29 offen offset:0 lds
buffer_load_dwordx4 v11, s[16:19], s29 offen offset:1024 lds
buffer_load_dwordx4 v12, s[16:19], s29 offen offset:2048 lds
buffer_load_dwordx4 v13, s[16:19], s29 offen offset:3072 lds
ds_read_b128 v[56:59], v14 offset:32768
ds_read_b128 v[60:63], v14 offset:36864
ds_read_b128 v[64:67], v15 offset:32768
ds_read_b128 v[68:71], v15 offset:36864
ds_read_b128 v[72:75], v16 offset:32768
ds_read_b128 v[76:79], v16 offset:36864
ds_read_b128 v[80:83], v17 offset:32768
ds_read_b128 v[84:87], v17 offset:36864
s_waitcnt lgkmcnt(0)
s_cmp_eq_u32 s37, 1
s_cbranch_scc1 L_f0n4
v_mfma_f32_16x16x32_bf16 v[104:107], a[64:67], v[56:59], v[104:107]
v_mfma_f32_16x16x32_bf16 v[108:111], a[192:195], v[56:59], v[108:111]
v_mfma_f32_16x16x32_bf16 v[112:115], a[64:67], v[60:63], v[112:115]
v_mfma_f32_16x16x32_bf16 v[116:119], a[192:195], v[60:63], v[116:119]
v_mfma_f32_16x16x32_bf16 v[104:107], a[68:71], v[64:67], v[104:107]
v_mfma_f32_16x16x32_bf16 v[108:111], a[196:199], v[64:67], v[108:111]
v_mfma_f32_16x16x32_bf16 v[112:115], a[68:71], v[68:71], v[112:115]
v_mfma_f32_16x16x32_bf16 v[116:119], a[196:199], v[68:71], v[116:119]
v_mfma_f32_16x16x32_bf16 v[104:107], a[72:75], v[72:75], v[104:107]
v_mfma_f32_16x16x32_bf16 v[108:111], a[200:203], v[72:75], v[108:111]
v_mfma_f32_16x16x32_bf16 v[112:115], a[72:75], v[76:79], v[112:115]
v_mfma_f32_16x16x32_bf16 v[116:119], a[200:203], v[76:79], v[116:119]
v_mfma_f32_16x16x32_bf16 v[104:107], a[76:79], v[80:83], v[104:107]
v_mfma_f32_16x16x32_bf16 v[108:111], a[204:207], v[80:83], v[108:111]
v_mfma_f32_16x16x32_bf16 v[112:115], a[76:79], v[84:87], v[112:115]
v_mfma_f32_16x16x32_bf16 v[116:119], a[204:207], v[84:87], v[116:119]
s_branch L_f0d4
L_f0n4:
v_mfma_f32_16x16x32_bf16 v[104:107], v[56:59], a[64:67], v[104:107]
v_mfma_f32_16x16x32_bf16 v[108:111], v[56:59], a[192:195], v[108:111]
v_mfma_f32_16x16x32_bf16 v[112:115], v[60:63], a[64:67], v[112:115]
v_mfma_f32_16x16x32_bf16 v[116:119], v[60:63], a[192:195], v[116:119]
v_mfma_f32_16x16x32_bf16 v[104:107], v[64:67], a[68:71], v[104:107]
v_mfma_f32_16x16x32_bf16 v[108:111], v[64:67], a[196:199], v[108:111]
v_mfma_f32_16x16x32_bf16 v[112:115], v[68:71], a[68:71], v[112:115]
v_mfma_f32_16x16x32_bf16 v[116:119], v[68:71], a[196:199], v[116:119]
v_mfma_f32_16x16x32_bf16 v[104:107], v[72:75], a[72:75], v[104:107]
v_mfma_f32_16x16x32_bf16 v[108:111], v[72:75], a[200:203], v[108:111]
v_mfma_f32_16x16x32_bf16 v[112:115], v[76:79], a[72:75], v[112:115]
v_mfma_f32_16x16x32_bf16 v[116:119], v[76:79], a[200:203], v[116:119]
v_mfma_f32_16x16x32_bf16 v[104:107], v[80:83], a[76:79], v[104:107]
v_mfma_f32_16x16x32_bf16 v[108:111], v[80:83], a[204:207], v[108:111]
v_mfma_f32_16x16x32_bf16 v[112:115], v[84:87], a[76:79], v[112:115]
v_mfma_f32_16x16x32_bf16 v[116:119], v[84:87], a[204:207], v[116:119]
L_f0d4:
s_waitcnt vmcnt(17)
s_barrier
s_add_u32 m0, s41, 32768
s_nop 0
buffer_load_dwordx4 v8, s[12:15], s42 offen lds
s_add_u32 s42, s42, s33
s_add_u32 m0, s41, 33792
s_nop 0
buffer_load_dwordx4 v8, s[12:15], s42 offen lds
s_add_u32 s42, s42, s33
s_add_u32 m0, s41, 34816
s_nop 0
buffer_load_dwordx4 v8, s[12:15], s42 offen lds
s_add_u32 s42, s42, s33
s_add_u32 m0, s41, 35840
s_nop 0
buffer_load_dwordx4 v8, s[12:15], s42 offen lds
s_add_u32 s42, s42, s33
s_add_u32 m0, s41, 36864
s_nop 0
buffer_load_dwordx4 v8, s[12:15], s42 offen lds
s_add_u32 s42, s42, s33
s_add_u32 m0, s41, 37888
s_nop 0
buffer_load_dwordx4 v8, s[12:15], s42 offen lds
s_add_u32 s42, s42, s33
s_add_u32 m0, s41, 38912
s_nop 0
buffer_load_dwordx4 v8, s[12:15], s42 offen lds
s_add_u32 s42, s42, s33
s_add_u32 m0, s41, 39936
s_nop 0
buffer_load_dwordx4 v8, s[12:15], s42 offen lds
s_add_u32 s42, s42, s33
s_mul_i32 s24, s33, 24
s_add_u32 s42, s42, s24
v_add_u32 v9, 65536, v9
ds_read_b64_tr_b16 a[80:81], v9 offset:0
ds_read_b64_tr_b16 a[82:83], v9 offset:1024
ds_read_b64_tr_b16 a[208:209], v9 offset:8
ds_read_b64_tr_b16 a[210:211], v9 offset:1032
ds_read_b64_tr_b16 a[84:85], v9 offset:8192
ds_read_b64_tr_b16 a[86:87], v9 offset:9216
ds_read_b64_tr_b16 a[212:213], v9 offset:8200
ds_read_b64_tr_b16 a[214:215], v9 offset:9224
ds_read_b64_tr_b16 a[88:89], v9 offset:16384
ds_read_b64_tr_b16 a[90:91], v9 offset:17408
ds_read_b64_tr_b16 a[216:217], v9 offset:16392
ds_read_b64_tr_b16 a[218:219], v9 offset:17416
ds_read_b64_tr_b16 a[92:93], v9 offset:24576
ds_read_b64_tr_b16 a[94:95], v9 offset:25600
ds_read_b64_tr_b16 a[220:221], v9 offset:24584
ds_read_b64_tr_b16 a[222:223], v9 offset:25608
s_waitcnt lgkmcnt(0)
ds_read_b128 v[56:59], v14 offset:33024
ds_read_b128 v[60:63], v14 offset:37120
ds_read_b128 v[64:67], v15 offset:33024
ds_read_b128 v[68:71], v15 offset:37120
ds_read_b128 v[72:75], v16 offset:33024
ds_read_b128 v[76:79], v16 offset:37120
ds_read_b128 v[80:83], v17 offset:33024
ds_read_b128 v[84:87], v17 offset:37120
s_waitcnt lgkmcnt(0)
s_cmp_eq_u32 s37, 1
s_cbranch_scc1 L_f0n5
v_mfma_f32_16x16x32_bf16 v[104:107], a[80:83], v[56:59], v[104:107]
v_mfma_f32_16x16x32_bf16 v[108:111], a[208:211], v[56:59], v[108:111]
v_mfma_f32_16x16x32_bf16 v[112:115], a[80:83], v[60:63], v[112:115]
v_mfma_f32_16x16x32_bf16 v[116:119], a[208:211], v[60:63], v[116:119]
v_mfma_f32_16x16x32_bf16 v[104:107], a[84:87], v[64:67], v[104:107]
v_mfma_f32_16x16x32_bf16 v[108:111], a[212:215], v[64:67], v[108:111]
v_mfma_f32_16x16x32_bf16 v[112:115], a[84:87], v[68:71], v[112:115]
v_mfma_f32_16x16x32_bf16 v[116:119], a[212:215], v[68:71], v[116:119]
v_mfma_f32_16x16x32_bf16 v[104:107], a[88:91], v[72:75], v[104:107]
v_mfma_f32_16x16x32_bf16 v[108:111], a[216:219], v[72:75], v[108:111]
v_mfma_f32_16x16x32_bf16 v[112:115], a[88:91], v[76:79], v[112:115]
v_mfma_f32_16x16x32_bf16 v[116:119], a[216:219], v[76:79], v[116:119]
v_mfma_f32_16x16x32_bf16 v[104:107], a[92:95], v[80:83], v[104:107]
v_mfma_f32_16x16x32_bf16 v[108:111], a[220:223], v[80:83], v[108:111]
v_mfma_f32_16x16x32_bf16 v[112:115], a[92:95], v[84:87], v[112:115]
v_mfma_f32_16x16x32_bf16 v[116:119], a[220:223], v[84:87], v[116:119]
s_branch L_f0d5
L_f0n5:
v_mfma_f32_16x16x32_bf16 v[104:107], v[56:59], a[80:83], v[104:107]
v_mfma_f32_16x16x32_bf16 v[108:111], v[56:59], a[208:211], v[108:111]
v_mfma_f32_16x16x32_bf16 v[112:115], v[60:63], a[80:83], v[112:115]
v_mfma_f32_16x16x32_bf16 v[116:119], v[60:63], a[208:211], v[116:119]
v_mfma_f32_16x16x32_bf16 v[104:107], v[64:67], a[84:87], v[104:107]
v_mfma_f32_16x16x32_bf16 v[108:111], v[64:67], a[212:215], v[108:111]
v_mfma_f32_16x16x32_bf16 v[112:115], v[68:71], a[84:87], v[112:115]
v_mfma_f32_16x16x32_bf16 v[116:119], v[68:71], a[212:215], v[116:119]
v_mfma_f32_16x16x32_bf16 v[104:107], v[72:75], a[88:91], v[104:107]
v_mfma_f32_16x16x32_bf16 v[108:111], v[72:75], a[216:219], v[108:111]
v_mfma_f32_16x16x32_bf16 v[112:115], v[76:79], a[88:91], v[112:115]
v_mfma_f32_16x16x32_bf16 v[116:119], v[76:79], a[216:219], v[116:119]
v_mfma_f32_16x16x32_bf16 v[104:107], v[80:83], a[92:95], v[104:107]
v_mfma_f32_16x16x32_bf16 v[108:111], v[80:83], a[220:223], v[108:111]
v_mfma_f32_16x16x32_bf16 v[112:115], v[84:87], a[92:95], v[112:115]
v_mfma_f32_16x16x32_bf16 v[116:119], v[84:87], a[220:223], v[116:119]
L_f0d5:
s_waitcnt vmcnt(17)
s_barrier
v_subrev_u32 v9, 65536, v9
ds_read_b64_tr_b16 a[96:97], v9 offset:0
ds_read_b64_tr_b16 a[98:99], v9 offset:1024
ds_read_b64_tr_b16 a[224:225], v9 offset:8
ds_read_b64_tr_b16 a[226:227], v9 offset:1032
ds_read_b64_tr_b16 a[100:101], v9 offset:8192
ds_read_b64_tr_b16 a[102:103], v9 offset:9216
ds_read_b64_tr_b16 a[228:229], v9 offset:8200
ds_read_b64_tr_b16 a[230:231], v9 offset:9224
ds_read_b64_tr_b16 a[104:105], v9 offset:16384
ds_read_b64_tr_b16 a[106:107], v9 offset:17408
ds_read_b64_tr_b16 a[232:233], v9 offset:16392
ds_read_b64_tr_b16 a[234:235], v9 offset:17416
ds_read_b64_tr_b16 a[108:109], v9 offset:24576
ds_read_b64_tr_b16 a[110:111], v9 offset:25600
ds_read_b64_tr_b16 a[236:237], v9 offset:24584
ds_read_b64_tr_b16 a[238:239], v9 offset:25608
s_waitcnt lgkmcnt(0)
ds_read_b128 v[56:59], v14 offset:33280
ds_read_b128 v[60:63], v14 offset:37376
ds_read_b128 v[64:67], v15 offset:33280
ds_read_b128 v[68:71], v15 offset:37376
ds_read_b128 v[72:75], v16 offset:33280
ds_read_b128 v[76:79], v16 offset:37376
ds_read_b128 v[80:83], v17 offset:33280
ds_read_b128 v[84:87], v17 offset:37376
s_waitcnt lgkmcnt(0)
s_cmp_eq_u32 s37, 1
s_cbranch_scc1 L_f0n6
v_mfma_f32_16x16x32_bf16 v[104:107], a[96:99], v[56:59], v[104:107]
v_mfma_f32_16x16x32_bf16 v[108:111], a[224:227], v[56:59], v[108:111]
v_mfma_f32_16x16x32_bf16 v[112:115], a[96:99], v[60:63], v[112:115]
v_mfma_f32_16x16x32_bf16 v[116:119], a[224:227], v[60:63], v[116:119]
v_mfma_f32_16x16x32_bf16 v[104:107], a[100:103], v[64:67], v[104:107]
v_mfma_f32_16x16x32_bf16 v[108:111], a[228:231], v[64:67], v[108:111]
v_mfma_f32_16x16x32_bf16 v[112:115], a[100:103], v[68:71], v[112:115]
v_mfma_f32_16x16x32_bf16 v[116:119], a[228:231], v[68:71], v[116:119]
v_mfma_f32_16x16x32_bf16 v[104:107], a[104:107], v[72:75], v[104:107]
v_mfma_f32_16x16x32_bf16 v[108:111], a[232:235], v[72:75], v[108:111]
v_mfma_f32_16x16x32_bf16 v[112:115], a[104:107], v[76:79], v[112:115]
v_mfma_f32_16x16x32_bf16 v[116:119], a[232:235], v[76:79], v[116:119]
v_mfma_f32_16x16x32_bf16 v[104:107], a[108:111], v[80:83], v[104:107]
v_mfma_f32_16x16x32_bf16 v[108:111], a[236:239], v[80:83], v[108:111]
v_mfma_f32_16x16x32_bf16 v[112:115], a[108:111], v[84:87], v[112:115]
v_mfma_f32_16x16x32_bf16 v[116:119], a[236:239], v[84:87], v[116:119]
s_branch L_f0d6
L_f0n6:
v_mfma_f32_16x16x32_bf16 v[104:107], v[56:59], a[96:99], v[104:107]
v_mfma_f32_16x16x32_bf16 v[108:111], v[56:59], a[224:227], v[108:111]
v_mfma_f32_16x16x32_bf16 v[112:115], v[60:63], a[96:99], v[112:115]
v_mfma_f32_16x16x32_bf16 v[116:119], v[60:63], a[224:227], v[116:119]
v_mfma_f32_16x16x32_bf16 v[104:107], v[64:67], a[100:103], v[104:107]
v_mfma_f32_16x16x32_bf16 v[108:111], v[64:67], a[228:231], v[108:111]
v_mfma_f32_16x16x32_bf16 v[112:115], v[68:71], a[100:103], v[112:115]
v_mfma_f32_16x16x32_bf16 v[116:119], v[68:71], a[228:231], v[116:119]
v_mfma_f32_16x16x32_bf16 v[104:107], v[72:75], a[104:107], v[104:107]
v_mfma_f32_16x16x32_bf16 v[108:111], v[72:75], a[232:235], v[108:111]
v_mfma_f32_16x16x32_bf16 v[112:115], v[76:79], a[104:107], v[112:115]
v_mfma_f32_16x16x32_bf16 v[116:119], v[76:79], a[232:235], v[116:119]
v_mfma_f32_16x16x32_bf16 v[104:107], v[80:83], a[108:111], v[104:107]
v_mfma_f32_16x16x32_bf16 v[108:111], v[80:83], a[236:239], v[108:111]
v_mfma_f32_16x16x32_bf16 v[112:115], v[84:87], a[108:111], v[112:115]
v_mfma_f32_16x16x32_bf16 v[116:119], v[84:87], a[236:239], v[116:119]
L_f0d6:
s_waitcnt vmcnt(0)
s_barrier
ds_read_b64_tr_b16 a[112:113], v9 offset:32768
ds_read_b64_tr_b16 a[114:115], v9 offset:33792
ds_read_b64_tr_b16 a[240:241], v9 offset:32776
ds_read_b64_tr_b16 a[242:243], v9 offset:33800
ds_read_b64_tr_b16 a[116:117], v9 offset:40960
ds_read_b64_tr_b16 a[118:119], v9 offset:41984
ds_read_b64_tr_b16 a[244:245], v9 offset:40968
ds_read_b64_tr_b16 a[246:247], v9 offset:41992
ds_read_b64_tr_b16 a[120:121], v9 offset:49152
ds_read_b64_tr_b16 a[122:123], v9 offset:50176
ds_read_b64_tr_b16 a[248:249], v9 offset:49160
ds_read_b64_tr_b16 a[250:251], v9 offset:50184
ds_read_b64_tr_b16 a[124:125], v9 offset:57344
ds_read_b64_tr_b16 a[126:127], v9 offset:58368
ds_read_b64_tr_b16 a[252:253], v9 offset:57352
ds_read_b64_tr_b16 a[254:255], v9 offset:58376
s_waitcnt lgkmcnt(0)
v_and_b32 v5, 31, v1
v_lshlrev_b32 v5, 2, v5
v_add_u32 v5, 49664, v5
buffer_load_dword v129, v5, s[4:7], 0 offen sc1
ds_read_b128 v[56:59], v14 offset:33536
ds_read_b128 v[60:63], v14 offset:37632
ds_read_b128 v[64:67], v15 offset:33536
ds_read_b128 v[68:71], v15 offset:37632
ds_read_b128 v[72:75], v16 offset:33536
ds_read_b128 v[76:79], v16 offset:37632
ds_read_b128 v[80:83], v17 offset:33536
ds_read_b128 v[84:87], v17 offset:37632
s_waitcnt lgkmcnt(0)
s_cmp_eq_u32 s37, 1
s_cbranch_scc1 L_f0n7
v_mfma_f32_16x16x32_bf16 v[104:107], a[112:115], v[56:59], v[104:107]
v_mfma_f32_16x16x32_bf16 v[108:111], a[240:243], v[56:59], v[108:111]
v_mfma_f32_16x16x32_bf16 v[112:115], a[112:115], v[60:63], v[112:115]
v_mfma_f32_16x16x32_bf16 v[116:119], a[240:243], v[60:63], v[116:119]
v_mfma_f32_16x16x32_bf16 v[104:107], a[116:119], v[64:67], v[104:107]
v_mfma_f32_16x16x32_bf16 v[108:111], a[244:247], v[64:67], v[108:111]
v_mfma_f32_16x16x32_bf16 v[112:115], a[116:119], v[68:71], v[112:115]
v_mfma_f32_16x16x32_bf16 v[116:119], a[244:247], v[68:71], v[116:119]
v_mfma_f32_16x16x32_bf16 v[104:107], a[120:123], v[72:75], v[104:107]
v_mfma_f32_16x16x32_bf16 v[108:111], a[248:251], v[72:75], v[108:111]
v_mfma_f32_16x16x32_bf16 v[112:115], a[120:123], v[76:79], v[112:115]
v_mfma_f32_16x16x32_bf16 v[116:119], a[248:251], v[76:79], v[116:119]
v_mfma_f32_16x16x32_bf16 v[104:107], a[124:127], v[80:83], v[104:107]
v_mfma_f32_16x16x32_bf16 v[108:111], a[252:255], v[80:83], v[108:111]
v_mfma_f32_16x16x32_bf16 v[112:115], a[124:127], v[84:87], v[112:115]
v_mfma_f32_16x16x32_bf16 v[116:119], a[252:255], v[84:87], v[116:119]
s_branch L_f0d7
L_f0n7:
v_mfma_f32_16x16x32_bf16 v[104:107], v[56:59], a[112:115], v[104:107]
v_mfma_f32_16x16x32_bf16 v[108:111], v[56:59], a[240:243], v[108:111]
v_mfma_f32_16x16x32_bf16 v[112:115], v[60:63], a[112:115], v[112:115]
v_mfma_f32_16x16x32_bf16 v[116:119], v[60:63], a[240:243], v[116:119]
v_mfma_f32_16x16x32_bf16 v[104:107], v[64:67], a[116:119], v[104:107]
v_mfma_f32_16x16x32_bf16 v[108:111], v[64:67], a[244:247], v[108:111]
v_mfma_f32_16x16x32_bf16 v[112:115], v[68:71], a[116:119], v[112:115]
v_mfma_f32_16x16x32_bf16 v[116:119], v[68:71], a[244:247], v[116:119]
v_mfma_f32_16x16x32_bf16 v[104:107], v[72:75], a[120:123], v[104:107]
v_mfma_f32_16x16x32_bf16 v[108:111], v[72:75], a[248:251], v[108:111]
v_mfma_f32_16x16x32_bf16 v[112:115], v[76:79], a[120:123], v[112:115]
v_mfma_f32_16x16x32_bf16 v[116:119], v[76:79], a[248:251], v[116:119]
v_mfma_f32_16x16x32_bf16 v[104:107], v[80:83], a[124:127], v[104:107]
v_mfma_f32_16x16x32_bf16 v[108:111], v[80:83], a[252:255], v[108:111]
v_mfma_f32_16x16x32_bf16 v[112:115], v[84:87], a[124:127], v[112:115]
v_mfma_f32_16x16x32_bf16 v[116:119], v[84:87], a[252:255], v[116:119]
L_f0d7:
s_cmp_lg_u32 s22, 0
s_cbranch_scc1 L_conf_ok_g
v_lshlrev_b32 v5, 2, v1
s_waitcnt vmcnt(0) lgkmcnt(0)
v_mov_b32 v6, v128
s_branch L_conf_ev_g
L_conf_poll_g:
s_sleep 8
v_mov_b32 v129, -1
L_conf_go_g:
buffer_load_dword v6, v5, s[8:11], 0 offen sc1
s_sub_u32 s28, s28, 1
s_cbranch_scc1 L_end
s_waitcnt vmcnt(0) lgkmcnt(0)
L_conf_ev_g:
v_bcnt_u32_b32 v7, v6, 0
v_cmp_ne_u32 vcc, 4, v7
s_cbranch_vccnz L_conf_poll_g
v_lshrrev_b32 v7, 16, v6
v_or_b32 v7, v7, v6
v_lshrrev_b32 v5, 8, v7
v_or_b32 v7, v7, v5
v_and_b32 v7, 0xff, v7
s_nop 1
v_or_b32_dpp v7, v7, v7 quad_perm:[1,0,3,2] row_mask:0xf bank_mask:0xf
s_mov_b32 s22, 1
v_cmp_ne_u32 vcc, 0xff, v7
s_cbranch_vccnz L_respec
L_conf_ok_g:
s_waitcnt vmcnt(0)
s_mov_b32 s56, 0
s_mov_b32 s54, 0
s_mov_b32 s55, 0
s_mov_b32 s40, 0
s_cmp_ge_u32 s32, 96
s_cbranch_scc1 L_nomask
v_and_b32 v5, 31, v1
v_lshlrev_b32 v5, 2, v5
v_add_u32 v5, 49664, v5
v_mov_b32 v6, v129
s_branch L_gm_ev_g
L_gm_g:
s_sleep 4
L_gm_go_g:
buffer_load_dword v6, v5, s[4:7], 0 offen sc1
s_sub_u32 s28, s28, 1
s_cbranch_scc1 L_end
s_waitcnt vmcnt(0)
L_gm_ev_g:
v_cmp_gt_i32 vcc, 0, v6
s_cbranch_vccnz L_gm_g
v_cmp_eq_u32 vcc, 1, v6
s_nop 1
s_bcnt1_i32_b32 s54, vcc_lo
s_cmp_gt_u32 s54, 16
s_cselect_b32 s54, 0x2000, 0
s_mov_b32 s55, 0x2000
s_lshl_b32 s40, s45, 13
s_xor_b32 s40, s40, s54
s_mov_b32 s56, s40
s_xor_b32 s24, s54, 0x2000
s_lshl_b32 s25, s32, 6
s_add_u32 s24, s24, s25
v_lshlrev_b32 v5, 2, v1
v_add_u32 v5, s24, v5
v_mov_b32 v6, 2147483648
v_cmp_gt_u32 vcc, 4, v0
s_nop 1
v_cndmask_b32 v32, v6, v5, vcc
s_lshl_b32 s25, s20, 2
s_add_u32 s24, s24, s25
v_mov_b32 v5, s24
v_mov_b32 v6, 2147483648
v_cmp_eq_u32 vcc, 0, v1
s_nop 1
v_cndmask_b32 v23, v6, v5, vcc
L_nomask:
s_nop 7
s_cmp_eq_u32 s37, 1
s_cbranch_scc1 L_f0en
v_cvt_pk_bf16_f32 v120, v104, v105
v_cvt_pk_bf16_f32 v121, v106, v107
v_cvt_pk_bf16_f32 v122, v108, v109
v_cvt_pk_bf16_f32 v123, v110, v111
v_cvt_pk_bf16_f32 v124, v112, v113
v_cvt_pk_bf16_f32 v125, v114, v115
v_cvt_pk_bf16_f32 v126, v116, v117
v_cvt_pk_bf16_f32 v127, v118, v119
s_branch L_f0ed
L_f0en:
v_cvt_pk_bf16_f32 v120, v104, v105
v_cvt_pk_bf16_f32 v121, v106, v107
v_cvt_pk_bf16_f32 v122, v112, v113
v_cvt_pk_bf16_f32 v123, v114, v115
v_cvt_pk_bf16_f32 v124, v108, v109
v_cvt_pk_bf16_f32 v125, v110, v111
v_cvt_pk_bf16_f32 v126, v116, v117
v_cvt_pk_bf16_f32 v127, v118, v119
L_f0ed:
buffer_store_dwordx4 v[120:123], v22, s[4:7], s40 offen offset:0 sc1
buffer_store_dwordx4 v[124:127], v22, s[4:7], s40 offen offset:1024 sc1
buffer_store_dwordx4 v[36:39], v30, s[4:7], s40 offen sc1
v_mov_b32 v24, 1
s_waitcnt vmcnt(0)
buffer_store_dword v24, v23, s[4:7], 0 offen sc1
s_mov_b32 s38, 1
s_mov_b32 s40, 2147483648
s_mov_b32 s47, s36
s_mov_b32 s12, s74
s_mov_b32 s13, s75
s_mov_b32 s14, 8388608
s_bfe_u32 s24, s32, 0x20003
s_lshl_b32 s24, s24, 21
s_and_b32 s25, s32, 7
s_xor_b32 s25, s25, 1
s_lshl_b32 s25, s25, 2
s_add_u32 s25, s25, s20
s_lshl_b32 s25, s25, 6
s_add_u32 s24, s24, s25
s_cmp_lt_u32 s32, 64
s_cselect_b32 s24, s24, 1073741824
v_lshlrev_b32 v31, 11, v1
v_add_u32 v31, s24, v31
s_cmp_eq_u32 s45, 0
s_cbranch_scc1 L_noq
v_lshrrev_b32 v5, 2, v4
v_sub_u32 v5, v5, v3
v_lshlrev_b32 v5, 3, v5
v_and_b32 v6, 3, v4
v_add_u32 v44, v5, v6
v_add_u32 v45, 4, v44
v_mov_b32 v46, 0xf149f2ca
v_mov_b32 v52, 0x3f803f80
v_mov_b32 v53, 0x3f803f80
v_mov_b32 v54, 0x3f803f80
v_mov_b32 v55, 0x3f803f80
v_cmp_le_i32 s[64:65], 0, v44
v_cmp_le_i32 s[66:67], 1, v44
v_cmp_le_i32 s[68:69], 2, v44
v_cmp_le_i32 s[70:71], 3, v44
v_cmp_le_i32 s[72:73], 4, v44
v_cmp_le_i32 s[74:75], 5, v44
v_cmp_le_i32 s[76:77], 6, v44
v_cmp_le_i32 s[78:79], 7, v44
v_cmp_le_i32 s[80:81], 0, v45
v_cmp_le_i32 s[82:83], 1, v45
v_cmp_le_i32 s[84:85], 2, v45
v_cmp_le_i32 s[86:87], 3, v45
v_cmp_le_i32 s[88:89], 4, v45
v_cmp_le_i32 s[90:91], 5, v45
v_cmp_le_i32 s[92:93], 6, v45
v_cmp_le_i32 s[94:95], 7, v45
s_and_b32 s26, s32, 31
s_lshl_b32 s25, s26, 7
s_add_u32 s25, s25, 4194304
s_add_u32 s25, s25, s54
v_mov_b32 v27, s25
s_lshl_b32 s24, s26, 4
s_lshl_b32 s25, s20, 2
s_add_u32 s24, s24, s25
s_add_u32 s24, s24, 32768
s_add_u32 s24, s24, s56
v_mov_b32 v5, s24
v_mov_b32 v6, 2147483648
v_cmp_eq_u32 vcc, 0, v1
s_nop 1
v_cndmask_b32 v28, v6, v5, vcc
s_lshl_b32 s48, s20, 5
s_add_u32 s48, s48, s26
s_add_u32 s49, s20, 1
s_mov_b32 s50, 0
v_bfe_u32 v5, v1, 2, 1
v_lshlrev_b32 v5, 11, v5
v_and_b32 v6, 3, v1
v_lshl_add_u32 v5, v6, 2, v5
s_lshl_b32 s24, s26, 6
s_add_u32 s24, s24, s56
v_add_u32 v29, s24, v5
s_mov_b32 s51, 0
v_lshrrev_b32 v5, 2, v4
v_lshlrev_b32 v5, 1, v5
v_and_b32 v6, 1, v4
v_add_u32 v5, v5, v6
v_lshl_add_u32 v5, v3, 3, v5
v_lshlrev_b32 v5, 4, v5
v_and_b32 v6, 2, v4
v_cmp_eq_u32 vcc, 0, v6
v_mov_b32 v6, 2147483648
s_nop 0
v_cndmask_b32 v8, v6, v5, vcc
v_lshlrev_b32 v9, 2, v1
v_mov_b32 v241, 0
v_mov_b32 v243, 0
v_mov_b32 v245, 0
v_mov_b32 v247, 0
v_mov_b32 v249, 0
v_mov_b32 v251, 0
v_mov_b32 v253, 0
v_mov_b32 v255, 0
s_mov_b32 s52, 0
s_mov_b32 s53, 0
v_mov_b32 v40, -1
v_mov_b32 v41, -1
v_mov_b32 v42, -1
v_mov_b32 v43, -1
L_noq:
s_barrier
s_add_u32 m0, s44, 32768
s_add_u32 s29, s39, 1024
buffer_load_dwordx4 v10, s[16:19], s29 offen offset:0 lds
buffer_load_dwordx4 v11, s[16:19], s29 offen offset:1024 lds
buffer_load_dwordx4 v12, s[16:19], s29 offen offset:2048 lds
buffer_load_dwordx4 v13, s[16:19], s29 offen offset:3072 lds
s_add_u32 m0, s44, 36864
s_add_u32 s29, s39, 9216
buffer_load_dwordx4 v10, s[16:19], s29 offen offset:0 lds
buffer_load_dwordx4 v11, s[16:19], s29 offen offset:1024 lds
buffer_load_dwordx4 v12, s[16:19], s29 offen offset:2048 lds
buffer_load_dwordx4 v13, s[16:19], s29 offen offset:3072 lds
s_mov_b32 s24, 2147483648
buffer_load_dword v26, v2, s[4:7], s24 offen
s_add_u32 m0, s44, 65536
s_add_u32 s29, s39, 65536
buffer_load_dwordx4 v10, s[16:19], s29 offen offset:0 lds
buffer_load_dwordx4 v11, s[16:19], s29 offen offset:1024 lds
L_grd:
ds_read_b128 v[56:59], v14 offset:0
ds_read_b128 v[60:63], v14 offset:4096
ds_read_b128 v[64:67], v15 offset:0
ds_read_b128 v[68:71], v15 offset:4096
ds_read_b128 v[72:75], v16 offset:0
ds_read_b128 v[76:79], v16 offset:4096
ds_read_b128 v[80:83], v17 offset:0
ds_read_b128 v[84:87], v17 offset:4096
s_cmp_eq_u32 s37, 1
s_cbranch_scc1 L_gl_N
L_gl_T:
s_cmp_eq_u32 s20, 1
s_cbranch_scc1 L_gl_T1
s_cmp_eq_u32 s20, 2
s_cbranch_scc1 L_gl_T2
s_cmp_eq_u32 s20, 3
s_cbranch_scc1 L_gl_T3
.p2align 6
L_gl_T0:
s_waitcnt lgkmcnt(6)
v_mfma_f32_16x16x32_bf16 v[88:91], a[0:3], v[56:59], 0
buffer_load_dwordx4 v12, s[16:19], s29 offen offset:2048 lds
v_mfma_f32_16x16x32_bf16 v[92:95], a[128:131], v[56:59], 0
ds_read_b128 v[56:59], v14 offset:256
v_mfma_f32_16x16x32_bf16 v[96:99], a[0:3], v[60:63], 0
v_mfma_f32_16x16x32_bf16 v[100:103], a[128:131], v[60:63], 0
ds_read_b128 v[60:63], v14 offset:4352
s_waitcnt lgkmcnt(6)
v_mfma_f32_16x16x32_bf16 v[88:91], a[4:7], v[64:67], v[88:91]
v_cvt_pk_bf16_f32 v120, v104, v105
v_cvt_pk_bf16_f32 v121, v106, v107
v_mfma_f32_16x16x32_bf16 v[92:95], a[132:135], v[64:67], v[92:95]
v_cvt_pk_bf16_f32 v122, v108, v109
ds_read_b128 v[64:67], v15 offset:256
v_mfma_f32_16x16x32_bf16 v[96:99], a[4:7], v[68:71], v[96:99]
v_cvt_pk_bf16_f32 v123, v110, v111
buffer_store_dwordx4 v[120:123], v22, s[4:7], s40 offen offset:0 sc1
v_mfma_f32_16x16x32_bf16 v[100:103], a[132:135], v[68:71], v[100:103]
ds_read_b128 v[68:71], v15 offset:4352
s_waitcnt lgkmcnt(6)
v_mfma_f32_16x16x32_bf16 v[88:91], a[8:11], v[72:75], v[88:91]
buffer_load_dwordx4 v13, s[16:19], s29 offen offset:3072 lds
v_mfma_f32_16x16x32_bf16 v[92:95], a[136:139], v[72:75], v[92:95]
v_cvt_pk_bf16_f32 v124, v112, v113
ds_read_b128 v[72:75], v16 offset:256
v_mfma_f32_16x16x32_bf16 v[96:99], a[8:11], v[76:79], v[96:99]
v_cvt_pk_bf16_f32 v125, v114, v115
v_cvt_pk_bf16_f32 v126, v116, v117
v_mfma_f32_16x16x32_bf16 v[100:103], a[136:139], v[76:79], v[100:103]
ds_read_b128 v[76:79], v16 offset:4352
s_waitcnt lgkmcnt(6)
v_mfma_f32_16x16x32_bf16 v[88:91], a[12:15], v[80:83], v[88:91]
v_cvt_pk_bf16_f32 v127, v118, v119
buffer_store_dwordx4 v[36:39], v30, s[4:7], s40 offen sc1
v_mfma_f32_16x16x32_bf16 v[92:95], a[140:143], v[80:83], v[92:95]
buffer_store_dwordx4 v[124:127], v22, s[4:7], s40 offen offset:1024 sc1
ds_read_b128 v[80:83], v17 offset:256
v_mfma_f32_16x16x32_bf16 v[96:99], a[12:15], v[84:87], v[96:99]
s_lshr_b32 s40, s47, 8
s_xor_b32 s40, s40, s56
v_mfma_f32_16x16x32_bf16 v[100:103], a[140:143], v[84:87], v[100:103]
ds_read_b128 v[84:87], v17 offset:4352
s_waitcnt lgkmcnt(6)
s_add_u32 m0, s44, 69632
s_add_u32 s29, s39, 73728
v_mfma_f32_16x16x32_bf16 v[88:91], a[16:19], v[56:59], v[88:91]
buffer_load_dwordx4 v10, s[16:19], s29 offen offset:0 lds
v_mfma_f32_16x16x32_bf16 v[92:95], a[144:147], v[56:59], v[92:95]
s_and_b32 s40, s40, s55
ds_read_b128 v[56:59], v14 offset:512
v_mfma_f32_16x16x32_bf16 v[96:99], a[16:19], v[60:63], v[96:99]
s_or_b32 s40, s40, s47
s_add_u32 s47, s47, s36
v_mfma_f32_16x16x32_bf16 v[100:103], a[144:147], v[60:63], v[100:103]
ds_read_b128 v[60:63], v14 offset:4608
s_waitcnt lgkmcnt(6)
v_mfma_f32_16x16x32_bf16 v[88:91], a[20:23], v[64:67], v[88:91]
v_mfma_f32_16x16x32_bf16 v[92:95], a[148:151], v[64:67], v[92:95]
ds_read_b128 v[64:67], v15 offset:512
v_mfma_f32_16x16x32_bf16 v[96:99], a[20:23], v[68:71], v[96:99]
v_mfma_f32_16x16x32_bf16 v[100:103], a[148:151], v[68:71], v[100:103]
ds_read_b128 v[68:71], v15 offset:4608
s_waitcnt lgkmcnt(6)
v_mfma_f32_16x16x32_bf16 v[88:91], a[24:27], v[72:75], v[88:91]
buffer_load_dwordx4 v11, s[16:19], s29 offen offset:1024 lds
v_mfma_f32_16x16x32_bf16 v[92:95], a[152:155], v[72:75], v[92:95]
ds_read_b128 v[72:75], v16 offset:512
v_mfma_f32_16x16x32_bf16 v[96:99], a[24:27], v[76:79], v[96:99]
v_mfma_f32_16x16x32_bf16 v[100:103], a[152:155], v[76:79], v[100:103]
ds_read_b128 v[76:79], v16 offset:4608
s_waitcnt lgkmcnt(6)
v_mfma_f32_16x16x32_bf16 v[88:91], a[28:31], v[80:83], v[88:91]
v_mfma_f32_16x16x32_bf16 v[92:95], a[156:159], v[80:83], v[92:95]
ds_read_b128 v[80:83], v17 offset:512
v_mfma_f32_16x16x32_bf16 v[96:99], a[28:31], v[84:87], v[96:99]
v_mfma_f32_16x16x32_bf16 v[100:103], a[156:159], v[84:87], v[100:103]
ds_read_b128 v[84:87], v17 offset:4608
s_waitcnt lgkmcnt(6)
v_mfma_f32_16x16x32_bf16 v[88:91], a[32:35], v[56:59], v[88:91]
buffer_load_dwordx4 v12, s[16:19], s29 offen offset:2048 lds
v_mfma_f32_16x16x32_bf16 v[92:95], a[160:163], v[56:59], v[92:95]
ds_read_b128 v[56:59], v14 offset:768
v_mfma_f32_16x16x32_bf16 v[96:99], a[32:35], v[60:63], v[96:99]
v_mfma_f32_16x16x32_bf16 v[100:103], a[160:163], v[60:63], v[100:103]
ds_read_b128 v[60:63], v14 offset:4864
s_waitcnt lgkmcnt(6)
v_mfma_f32_16x16x32_bf16 v[88:91], a[36:39], v[64:67], v[88:91]
v_mfma_f32_16x16x32_bf16 v[92:95], a[164:167], v[64:67], v[92:95]
ds_read_b128 v[64:67], v15 offset:768
v_mfma_f32_16x16x32_bf16 v[96:99], a[36:39], v[68:71], v[96:99]
v_mfma_f32_16x16x32_bf16 v[100:103], a[164:167], v[68:71], v[100:103]
ds_read_b128 v[68:71], v15 offset:4864
s_waitcnt lgkmcnt(6)
v_mfma_f32_16x16x32_bf16 v[88:91], a[40:43], v[72:75], v[88:91]
buffer_load_dwordx4 v13, s[16:19], s29 offen offset:3072 lds
v_mfma_f32_16x16x32_bf16 v[92:95], a[168:171], v[72:75], v[92:95]
ds_read_b128 v[72:75], v16 offset:768
v_mfma_f32_16x16x32_bf16 v[96:99], a[40:43], v[76:79], v[96:99]
v_mfma_f32_16x16x32_bf16 v[100:103], a[168:171], v[76:79], v[100:103]
ds_read_b128 v[76:79], v16 offset:4864
s_waitcnt lgkmcnt(6)
v_mfma_f32_16x16x32_bf16 v[88:91], a[44:47], v[80:83], v[88:91]
v_mfma_f32_16x16x32_bf16 v[92:95], a[172:175], v[80:83], v[92:95]
ds_read_b128 v[80:83], v17 offset:768
v_mfma_f32_16x16x32_bf16 v[96:99], a[44:47], v[84:87], v[96:99]
v_mfma_f32_16x16x32_bf16 v[100:103], a[172:175], v[84:87], v[100:103]
ds_read_b128 v[84:87], v17 offset:4864
s_waitcnt vmcnt(12)
s_barrier
s_waitcnt lgkmcnt(6)
s_add_u32 m0, s44, 98304
s_add_u32 s29, s39, 66560
v_mfma_f32_16x16x32_bf16 v[88:91], a[48:51], v[56:59], v[88:91]
s_add_u32 s43, s39, 0
buffer_load_dword v26, v25, s[16:19], s43 offen
buffer_load_dwordx4 v10, s[16:19], s29 offen offset:0 lds
v_mfma_f32_16x16x32_bf16 v[92:95], a[176:179], v[56:59], v[92:95]
ds_read_b128 v[56:59], v14 offset:32768
v_mfma_f32_16x16x32_bf16 v[96:99], a[48:51], v[60:63], v[96:99]
v_mfma_f32_16x16x32_bf16 v[100:103], a[176:179], v[60:63], v[100:103]
ds_read_b128 v[60:63], v14 offset:36864
s_waitcnt lgkmcnt(6)
v_mfma_f32_16x16x32_bf16 v[88:91], a[52:55], v[64:67], v[88:91]
v_mfma_f32_16x16x32_bf16 v[92:95], a[180:183], v[64:67], v[92:95]
ds_read_b128 v[64:67], v15 offset:32768
v_mfma_f32_16x16x32_bf16 v[96:99], a[52:55], v[68:71], v[96:99]
v_mfma_f32_16x16x32_bf16 v[100:103], a[180:183], v[68:71], v[100:103]
ds_read_b128 v[68:71], v15 offset:36864
s_waitcnt lgkmcnt(6)
v_mfma_f32_16x16x32_bf16 v[88:91], a[56:59], v[72:75], v[88:91]
buffer_load_dwordx4 v11, s[16:19], s29 offen offset:1024 lds
v_mfma_f32_16x16x32_bf16 v[92:95], a[184:187], v[72:75], v[92:95]
ds_read_b128 v[72:75], v16 offset:32768
v_mfma_f32_16x16x32_bf16 v[96:99], a[56:59], v[76:79], v[96:99]
v_mfma_f32_16x16x32_bf16 v[100:103], a[184:187], v[76:79], v[100:103]
ds_read_b128 v[76:79], v16 offset:36864
s_waitcnt lgkmcnt(6)
v_mfma_f32_16x16x32_bf16 v[88:91], a[60:63], v[80:83], v[88:91]
v_mfma_f32_16x16x32_bf16 v[92:95], a[188:191], v[80:83], v[92:95]
ds_read_b128 v[80:83], v17 offset:32768
v_mfma_f32_16x16x32_bf16 v[96:99], a[60:63], v[84:87], v[96:99]
v_mfma_f32_16x16x32_bf16 v[100:103], a[188:191], v[84:87], v[100:103]
ds_read_b128 v[84:87], v17 offset:36864
s_waitcnt lgkmcnt(6)
v_mfma_f32_16x16x32_bf16 v[88:91], a[64:67], v[56:59], v[88:91]
buffer_load_dwordx4 v12, s[16:19], s29 offen offset:2048 lds
v_mfma_f32_16x16x32_bf16 v[92:95], a[192:195], v[56:59], v[92:95]
ds_read_b128 v[56:59], v14 offset:33024
v_mfma_f32_16x16x32_bf16 v[96:99], a[64:67], v[60:63], v[96:99]
v_mfma_f32_16x16x32_bf16 v[100:103], a[192:195], v[60:63], v[100:103]
ds_read_b128 v[60:63], v14 offset:37120
s_waitcnt lgkmcnt(6)
v_mfma_f32_16x16x32_bf16 v[88:91], a[68:71], v[64:67], v[88:91]
v_mfma_f32_16x16x32_bf16 v[92:95], a[196:199], v[64:67], v[92:95]
ds_read_b128 v[64:67], v15 offset:33024
v_mfma_f32_16x16x32_bf16 v[96:99], a[68:71], v[68:71], v[96:99]
v_mfma_f32_16x16x32_bf16 v[100:103], a[196:199], v[68:71], v[100:103]
ds_read_b128 v[68:71], v15 offset:37120
s_waitcnt lgkmcnt(6)
v_mfma_f32_16x16x32_bf16 v[88:91], a[72:75], v[72:75], v[88:91]
buffer_load_dwordx4 v13, s[16:19], s29 offen offset:3072 lds
v_mfma_f32_16x16x32_bf16 v[92:95], a[200:203], v[72:75], v[92:95]
ds_read_b128 v[72:75], v16 offset:33024
v_mfma_f32_16x16x32_bf16 v[96:99], a[72:75], v[76:79], v[96:99]
v_mfma_f32_16x16x32_bf16 v[100:103], a[200:203], v[76:79], v[100:103]
ds_read_b128 v[76:79], v16 offset:37120
s_waitcnt lgkmcnt(6)
v_mfma_f32_16x16x32_bf16 v[88:91], a[76:79], v[80:83], v[88:91]
v_mfma_f32_16x16x32_bf16 v[92:95], a[204:207], v[80:83], v[92:95]
ds_read_b128 v[80:83], v17 offset:33024
v_mfma_f32_16x16x32_bf16 v[96:99], a[76:79], v[84:87], v[96:99]
v_mfma_f32_16x16x32_bf16 v[100:103], a[204:207], v[84:87], v[100:103]
ds_read_b128 v[84:87], v17 offset:37120
s_waitcnt lgkmcnt(6)
s_add_u32 m0, s44, 102400
s_add_u32 s29, s39, 74752
v_mfma_f32_16x16x32_bf16 v[88:91], a[80:83], v[56:59], v[88:91]
s_cmp_lt_u32 s38, 64
s_cbranch_scc1 L_wpT10
s_sub_u32 s46, s38, 64
s_lshl_b32 s46, s46, 17
buffer_load_dword v26, v31, s[12:15], s46 offen
L_wpT10:
buffer_load_dwordx4 v10, s[16:19], s29 offen offset:0 lds
v_mfma_f32_16x16x32_bf16 v[92:95], a[208:211], v[56:59], v[92:95]
ds_read_b128 v[56:59], v14 offset:33280
v_mfma_f32_16x16x32_bf16 v[96:99], a[80:83], v[60:63], v[96:99]
v_mfma_f32_16x16x32_bf16 v[100:103], a[208:211], v[60:63], v[100:103]
ds_read_b128 v[60:63], v14 offset:37376
s_waitcnt lgkmcnt(6)
v_mfma_f32_16x16x32_bf16 v[88:91], a[84:87], v[64:67], v[88:91]
v_mfma_f32_16x16x32_bf16 v[92:95], a[212:215], v[64:67], v[92:95]
ds_read_b128 v[64:67], v15 offset:33280
v_mfma_f32_16x16x32_bf16 v[96:99], a[84:87], v[68:71], v[96:99]
v_mfma_f32_16x16x32_bf16 v[100:103], a[212:215], v[68:71], v[100:103]
ds_read_b128 v[68:71], v15 offset:37376
s_waitcnt lgkmcnt(6)
v_mfma_f32_16x16x32_bf16 v[88:91], a[88:91], v[72:75], v[88:91]
buffer_load_dwordx4 v11, s[16:19], s29 offen offset:1024 lds
v_mfma_f32_16x16x32_bf16 v[92:95], a[216:219], v[72:75], v[92:95]
ds_read_b128 v[72:75], v16 offset:33280
v_mfma_f32_16x16x32_bf16 v[96:99], a[88:91], v[76:79], v[96:99]
v_mfma_f32_16x16x32_bf16 v[100:103], a[216:219], v[76:79], v[100:103]
ds_read_b128 v[76:79], v16 offset:37376
s_waitcnt lgkmcnt(6)
v_mfma_f32_16x16x32_bf16 v[88:91], a[92:95], v[80:83], v[88:91]
v_mfma_f32_16x16x32_bf16 v[92:95], a[220:223], v[80:83], v[92:95]
ds_read_b128 v[80:83], v17 offset:33280
v_mfma_f32_16x16x32_bf16 v[96:99], a[92:95], v[84:87], v[96:99]
v_mfma_f32_16x16x32_bf16 v[100:103], a[220:223], v[84:87], v[100:103]
ds_read_b128 v[84:87], v17 offset:37376
s_waitcnt lgkmcnt(6)
v_mfma_f32_16x16x32_bf16 v[88:91], a[96:99], v[56:59], v[88:91]
buffer_load_dwordx4 v12, s[16:19], s29 offen offset:2048 lds
v_mfma_f32_16x16x32_bf16 v[92:95], a[224:227], v[56:59], v[92:95]
ds_read_b128 v[56:59], v14 offset:33536
v_mfma_f32_16x16x32_bf16 v[96:99], a[96:99], v[60:63], v[96:99]
v_mfma_f32_16x16x32_bf16 v[100:103], a[224:227], v[60:63], v[100:103]
ds_read_b128 v[60:63], v14 offset:37632
s_waitcnt lgkmcnt(6)
v_mfma_f32_16x16x32_bf16 v[88:91], a[100:103], v[64:67], v[88:91]
v_mfma_f32_16x16x32_bf16 v[92:95], a[228:231], v[64:67], v[92:95]
ds_read_b128 v[64:67], v15 offset:33536
v_mfma_f32_16x16x32_bf16 v[96:99], a[100:103], v[68:71], v[96:99]
v_mfma_f32_16x16x32_bf16 v[100:103], a[228:231], v[68:71], v[100:103]
ds_read_b128 v[68:71], v15 offset:37632
s_waitcnt lgkmcnt(6)
v_mfma_f32_16x16x32_bf16 v[88:91], a[104:107], v[72:75], v[88:91]
buffer_load_dwordx4 v13, s[16:19], s29 offen offset:3072 lds
v_mfma_f32_16x16x32_bf16 v[92:95], a[232:235], v[72:75], v[92:95]
ds_read_b128 v[72:75], v16 offset:33536
v_mfma_f32_16x16x32_bf16 v[96:99], a[104:107], v[76:79], v[96:99]
v_mfma_f32_16x16x32_bf16 v[100:103], a[232:235], v[76:79], v[100:103]
ds_read_b128 v[76:79], v16 offset:37632
s_waitcnt lgkmcnt(6)
v_mfma_f32_16x16x32_bf16 v[88:91], a[108:111], v[80:83], v[88:91]
v_mfma_f32_16x16x32_bf16 v[92:95], a[236:239], v[80:83], v[92:95]
ds_read_b128 v[80:83], v17 offset:33536
v_mfma_f32_16x16x32_bf16 v[96:99], a[108:111], v[84:87], v[96:99]
v_mfma_f32_16x16x32_bf16 v[100:103], a[236:239], v[84:87], v[100:103]
ds_read_b128 v[84:87], v17 offset:37632
s_waitcnt vmcnt(9)
s_barrier
s_waitcnt lgkmcnt(6)
s_add_u32 m0, s44, 0
s_add_u32 s29, s39, 131072
v_mfma_f32_16x16x32_bf16 v[88:91], a[112:115], v[56:59], v[88:91]
v_mov_b32 v24, s38
buffer_store_dword v24, v32, s[4:7], 0 offen sc1
s_add_u32 s38, s38, 1
buffer_load_dwordx4 v10, s[16:19], s29 offen offset:0 lds
v_mfma_f32_16x16x32_bf16 v[92:95], a[240:243], v[56:59], v[92:95]
ds_read_b128 v[56:59], v18 offset:0
v_mfma_f32_16x16x32_bf16 v[96:99], a[112:115], v[60:63], v[96:99]
v_mfma_f32_16x16x32_bf16 v[100:103], a[240:243], v[60:63], v[100:103]
ds_read_b128 v[60:63], v18 offset:4096
s_waitcnt lgkmcnt(6)
v_mfma_f32_16x16x32_bf16 v[88:91], a[116:119], v[64:67], v[88:91]
v_mfma_f32_16x16x32_bf16 v[92:95], a[244:247], v[64:67], v[92:95]
ds_read_b128 v[64:67], v19 offset:0
v_mfma_f32_16x16x32_bf16 v[96:99], a[116:119], v[68:71], v[96:99]
v_mfma_f32_16x16x32_bf16 v[100:103], a[244:247], v[68:71], v[100:103]
ds_read_b128 v[68:71], v19 offset:4096
s_waitcnt lgkmcnt(6)
v_mfma_f32_16x16x32_bf16 v[88:91], a[120:123], v[72:75], v[88:91]
buffer_load_dwordx4 v11, s[16:19], s29 offen offset:1024 lds
v_mfma_f32_16x16x32_bf16 v[92:95], a[248:251], v[72:75], v[92:95]
ds_read_b128 v[72:75], v20 offset:0
v_mfma_f32_16x16x32_bf16 v[96:99], a[120:123], v[76:79], v[96:99]
v_mfma_f32_16x16x32_bf16 v[100:103], a[248:251], v[76:79], v[100:103]
ds_read_b128 v[76:79], v20 offset:4096
s_waitcnt lgkmcnt(6)
v_mfma_f32_16x16x32_bf16 v[88:91], a[124:127], v[80:83], v[88:91]
v_mfma_f32_16x16x32_bf16 v[92:95], a[252:255], v[80:83], v[92:95]
ds_read_b128 v[80:83], v21 offset:0
v_mfma_f32_16x16x32_bf16 v[96:99], a[124:127], v[84:87], v[96:99]
v_mfma_f32_16x16x32_bf16 v[100:103], a[252:255], v[84:87], v[100:103]
ds_read_b128 v[84:87], v21 offset:4096
s_cmp_eq_u32 s38, 64
s_cbranch_scc1 L_gx_T
s_waitcnt lgkmcnt(6)
v_mfma_f32_16x16x32_bf16 v[104:107], a[0:3], v[56:59], 0
buffer_load_dwordx4 v12, s[16:19], s29 offen offset:2048 lds
v_mfma_f32_16x16x32_bf16 v[108:111], a[128:131], v[56:59], 0
ds_read_b128 v[56:59], v18 offset:256
v_mfma_f32_16x16x32_bf16 v[112:115], a[0:3], v[60:63], 0
v_mfma_f32_16x16x32_bf16 v[116:119], a[128:131], v[60:63], 0
ds_read_b128 v[60:63], v18 offset:4352
s_waitcnt lgkmcnt(6)
v_mfma_f32_16x16x32_bf16 v[104:107], a[4:7], v[64:67], v[104:107]
v_cvt_pk_bf16_f32 v120, v88, v89
v_cvt_pk_bf16_f32 v121, v90, v91
v_mfma_f32_16x16x32_bf16 v[108:111], a[132:135], v[64:67], v[108:111]
v_cvt_pk_bf16_f32 v122, v92, v93
ds_read_b128 v[64:67], v19 offset:256
v_mfma_f32_16x16x32_bf16 v[112:115], a[4:7], v[68:71], v[112:115]
v_cvt_pk_bf16_f32 v123, v94, v95
buffer_store_dwordx4 v[120:123], v22, s[4:7], s40 offen offset:0 sc1
v_mfma_f32_16x16x32_bf16 v[116:119], a[132:135], v[68:71], v[116:119]
ds_read_b128 v[68:71], v19 offset:4352
s_waitcnt lgkmcnt(6)
v_mfma_f32_16x16x32_bf16 v[104:107], a[8:11], v[72:75], v[104:107]
buffer_load_dwordx4 v13, s[16:19], s29 offen offset:3072 lds
v_mfma_f32_16x16x32_bf16 v[108:111], a[136:139], v[72:75], v[108:111]
v_cvt_pk_bf16_f32 v124, v96, v97
ds_read_b128 v[72:75], v20 offset:256
v_mfma_f32_16x16x32_bf16 v[112:115], a[8:11], v[76:79], v[112:115]
v_cvt_pk_bf16_f32 v125, v98, v99
v_cvt_pk_bf16_f32 v126, v100, v101
v_mfma_f32_16x16x32_bf16 v[116:119], a[136:139], v[76:79], v[116:119]
ds_read_b128 v[76:79], v20 offset:4352
s_waitcnt lgkmcnt(6)
v_mfma_f32_16x16x32_bf16 v[104:107], a[12:15], v[80:83], v[104:107]
v_cvt_pk_bf16_f32 v127, v102, v103
buffer_store_dwordx4 v[36:39], v30, s[4:7], s40 offen sc1
v_mfma_f32_16x16x32_bf16 v[108:111], a[140:143], v[80:83], v[108:111]
buffer_store_dwordx4 v[124:127], v22, s[4:7], s40 offen offset:1024 sc1
ds_read_b128 v[80:83], v21 offset:256
v_mfma_f32_16x16x32_bf16 v[112:115], a[12:15], v[84:87], v[112:115]
s_lshr_b32 s40, s47, 8
s_xor_b32 s40, s40, s56
v_mfma_f32_16x16x32_bf16 v[116:119], a[140:143], v[84:87], v[116:119]
ds_read_b128 v[84:87], v21 offset:4352
s_waitcnt lgkmcnt(6)
s_add_u32 m0, s44, 4096
s_add_u32 s29, s39, 139264
v_mfma_f32_16x16x32_bf16 v[104:107], a[16:19], v[56:59], v[104:107]
buffer_load_dwordx4 v10, s[16:19], s29 offen offset:0 lds
v_mfma_f32_16x16x32_bf16 v[108:111], a[144:147], v[56:59], v[108:111]
s_and_b32 s40, s40, s55
ds_read_b128 v[56:59], v18 offset:512
v_mfma_f32_16x16x32_bf16 v[112:115], a[16:19], v[60:63], v[112:115]
s_or_b32 s40, s40, s47
s_add_u32 s47, s47, s36
v_mfma_f32_16x16x32_bf16 v[116:119], a[144:147], v[60:63], v[116:119]
ds_read_b128 v[60:63], v18 offset:4608
s_waitcnt lgkmcnt(6)
v_mfma_f32_16x16x32_bf16 v[104:107], a[20:23], v[64:67], v[104:107]
v_mfma_f32_16x16x32_bf16 v[108:111], a[148:151], v[64:67], v[108:111]
ds_read_b128 v[64:67], v19 offset:512
v_mfma_f32_16x16x32_bf16 v[112:115], a[20:23], v[68:71], v[112:115]
v_mfma_f32_16x16x32_bf16 v[116:119], a[148:151], v[68:71], v[116:119]
ds_read_b128 v[68:71], v19 offset:4608
s_waitcnt lgkmcnt(6)
v_mfma_f32_16x16x32_bf16 v[104:107], a[24:27], v[72:75], v[104:107]
buffer_load_dwordx4 v11, s[16:19], s29 offen offset:1024 lds
v_mfma_f32_16x16x32_bf16 v[108:111], a[152:155], v[72:75], v[108:111]
ds_read_b128 v[72:75], v20 offset:512
v_mfma_f32_16x16x32_bf16 v[112:115], a[24:27], v[76:79], v[112:115]
v_mfma_f32_16x16x32_bf16 v[116:119], a[152:155], v[76:79], v[116:119]
ds_read_b128 v[76:79], v20 offset:4608
s_waitcnt lgkmcnt(6)
v_mfma_f32_16x16x32_bf16 v[104:107], a[28:31], v[80:83], v[104:107]
v_mfma_f32_16x16x32_bf16 v[108:111], a[156:159], v[80:83], v[108:111]
ds_read_b128 v[80:83], v21 offset:512
v_mfma_f32_16x16x32_bf16 v[112:115], a[28:31], v[84:87], v[112:115]
v_mfma_f32_16x16x32_bf16 v[116:119], a[156:159], v[84:87], v[116:119]
ds_read_b128 v[84:87], v21 offset:4608
s_waitcnt lgkmcnt(6)
v_mfma_f32_16x16x32_bf16 v[104:107], a[32:35], v[56:59], v[104:107]
buffer_load_dwordx4 v12, s[16:19], s29 offen offset:2048 lds
v_mfma_f32_16x16x32_bf16 v[108:111], a[160:163], v[56:59], v[108:111]
ds_read_b128 v[56:59], v18 offset:768
v_mfma_f32_16x16x32_bf16 v[112:115], a[32:35], v[60:63], v[112:115]
v_mfma_f32_16x16x32_bf16 v[116:119], a[160:163], v[60:63], v[116:119]
ds_read_b128 v[60:63], v18 offset:4864
s_waitcnt lgkmcnt(6)
v_mfma_f32_16x16x32_bf16 v[104:107], a[36:39], v[64:67], v[104:107]
v_mfma_f32_16x16x32_bf16 v[108:111], a[164:167], v[64:67], v[108:111]
ds_read_b128 v[64:67], v19 offset:768
v_mfma_f32_16x16x32_bf16 v[112:115], a[36:39], v[68:71], v[112:115]
v_mfma_f32_16x16x32_bf16 v[116:119], a[164:167], v[68:71], v[116:119]
ds_read_b128 v[68:71], v19 offset:4864
s_waitcnt lgkmcnt(6)
v_mfma_f32_16x16x32_bf16 v[104:107], a[40:43], v[72:75], v[104:107]
buffer_load_dwordx4 v13, s[16:19], s29 offen offset:3072 lds
v_mfma_f32_16x16x32_bf16 v[108:111], a[168:171], v[72:75], v[108:111]
ds_read_b128 v[72:75], v20 offset:768
v_mfma_f32_16x16x32_bf16 v[112:115], a[40:43], v[76:79], v[112:115]
v_mfma_f32_16x16x32_bf16 v[116:119], a[168:171], v[76:79], v[116:119]
ds_read_b128 v[76:79], v20 offset:4864
s_waitcnt lgkmcnt(6)
v_mfma_f32_16x16x32_bf16 v[104:107], a[44:47], v[80:83], v[104:107]
v_mfma_f32_16x16x32_bf16 v[108:111], a[172:175], v[80:83], v[108:111]
ds_read_b128 v[80:83], v21 offset:768
v_mfma_f32_16x16x32_bf16 v[112:115], a[44:47], v[84:87], v[112:115]
v_mfma_f32_16x16x32_bf16 v[116:119], a[172:175], v[84:87], v[116:119]
ds_read_b128 v[84:87], v21 offset:4864
s_waitcnt vmcnt(12)
s_barrier
s_waitcnt lgkmcnt(6)
s_add_u32 m0, s44, 32768
s_add_u32 s29, s39, 132096
v_mfma_f32_16x16x32_bf16 v[104:107], a[48:51], v[56:59], v[104:107]
s_add_u32 s43, s39, 65536
buffer_load_dword v26, v25, s[16:19], s43 offen
buffer_load_dwordx4 v10, s[16:19], s29 offen offset:0 lds
v_mfma_f32_16x16x32_bf16 v[108:111], a[176:179], v[56:59], v[108:111]
ds_read_b128 v[56:59], v18 offset:32768
v_mfma_f32_16x16x32_bf16 v[112:115], a[48:51], v[60:63], v[112:115]
v_mfma_f32_16x16x32_bf16 v[116:119], a[176:179], v[60:63], v[116:119]
ds_read_b128 v[60:63], v18 offset:36864
s_waitcnt lgkmcnt(6)
v_mfma_f32_16x16x32_bf16 v[104:107], a[52:55], v[64:67], v[104:107]
v_mfma_f32_16x16x32_bf16 v[108:111], a[180:183], v[64:67], v[108:111]
ds_read_b128 v[64:67], v19 offset:32768
v_mfma_f32_16x16x32_bf16 v[112:115], a[52:55], v[68:71], v[112:115]
v_mfma_f32_16x16x32_bf16 v[116:119], a[180:183], v[68:71], v[116:119]
ds_read_b128 v[68:71], v19 offset:36864
s_waitcnt lgkmcnt(6)
v_mfma_f32_16x16x32_bf16 v[104:107], a[56:59], v[72:75], v[104:107]
buffer_load_dwordx4 v11, s[16:19], s29 offen offset:1024 lds
v_mfma_f32_16x16x32_bf16 v[108:111], a[184:187], v[72:75], v[108:111]
ds_read_b128 v[72:75], v20 offset:32768
v_mfma_f32_16x16x32_bf16 v[112:115], a[56:59], v[76:79], v[112:115]
v_mfma_f32_16x16x32_bf16 v[116:119], a[184:187], v[76:79], v[116:119]
ds_read_b128 v[76:79], v20 offset:36864
s_waitcnt lgkmcnt(6)
v_mfma_f32_16x16x32_bf16 v[104:107], a[60:63], v[80:83], v[104:107]
v_mfma_f32_16x16x32_bf16 v[108:111], a[188:191], v[80:83], v[108:111]
ds_read_b128 v[80:83], v21 offset:32768
v_mfma_f32_16x16x32_bf16 v[112:115], a[60:63], v[84:87], v[112:115]
v_mfma_f32_16x16x32_bf16 v[116:119], a[188:191], v[84:87], v[116:119]
ds_read_b128 v[84:87], v21 offset:36864
s_waitcnt lgkmcnt(6)
v_mfma_f32_16x16x32_bf16 v[104:107], a[64:67], v[56:59], v[104:107]
buffer_load_dwordx4 v12, s[16:19], s29 offen offset:2048 lds
v_mfma_f32_16x16x32_bf16 v[108:111], a[192:195], v[56:59], v[108:111]
ds_read_b128 v[56:59], v18 offset:33024
v_mfma_f32_16x16x32_bf16 v[112:115], a[64:67], v[60:63], v[112:115]
v_mfma_f32_16x16x32_bf16 v[116:119], a[192:195], v[60:63], v[116:119]
ds_read_b128 v[60:63], v18 offset:37120
s_waitcnt lgkmcnt(6)
v_mfma_f32_16x16x32_bf16 v[104:107], a[68:71], v[64:67], v[104:107]
v_mfma_f32_16x16x32_bf16 v[108:111], a[196:199], v[64:67], v[108:111]
ds_read_b128 v[64:67], v19 offset:33024
v_mfma_f32_16x16x32_bf16 v[112:115], a[68:71], v[68:71], v[112:115]
v_mfma_f32_16x16x32_bf16 v[116:119], a[196:199], v[68:71], v[116:119]
ds_read_b128 v[68:71], v19 offset:37120
s_waitcnt lgkmcnt(6)
v_mfma_f32_16x16x32_bf16 v[104:107], a[72:75], v[72:75], v[104:107]
buffer_load_dwordx4 v13, s[16:19], s29 offen offset:3072 lds
v_mfma_f32_16x16x32_bf16 v[108:111], a[200:203], v[72:75], v[108:111]
ds_read_b128 v[72:75], v20 offset:33024
v_mfma_f32_16x16x32_bf16 v[112:115], a[72:75], v[76:79], v[112:115]
v_mfma_f32_16x16x32_bf16 v[116:119], a[200:203], v[76:79], v[116:119]
ds_read_b128 v[76:79], v20 offset:37120
s_waitcnt lgkmcnt(6)
v_mfma_f32_16x16x32_bf16 v[104:107], a[76:79], v[80:83], v[104:107]
v_mfma_f32_16x16x32_bf16 v[108:111], a[204:207], v[80:83], v[108:111]
ds_read_b128 v[80:83], v21 offset:33024
v_mfma_f32_16x16x32_bf16 v[112:115], a[76:79], v[84:87], v[112:115]
v_mfma_f32_16x16x32_bf16 v[116:119], a[204:207], v[84:87], v[116:119]
ds_read_b128 v[84:87], v21 offset:37120
s_waitcnt lgkmcnt(6)
s_add_u32 m0, s44, 36864
s_add_u32 s29, s39, 140288
v_mfma_f32_16x16x32_bf16 v[104:107], a[80:83], v[56:59], v[104:107]
s_cmp_lt_u32 s38, 64
s_cbranch_scc1 L_wpT30
s_sub_u32 s46, s38, 64
s_lshl_b32 s46, s46, 17
buffer_load_dword v26, v31, s[12:15], s46 offen
L_wpT30:
buffer_load_dwordx4 v10, s[16:19], s29 offen offset:0 lds
v_mfma_f32_16x16x32_bf16 v[108:111], a[208:211], v[56:59], v[108:111]
ds_read_b128 v[56:59], v18 offset:33280
v_mfma_f32_16x16x32_bf16 v[112:115], a[80:83], v[60:63], v[112:115]
v_mfma_f32_16x16x32_bf16 v[116:119], a[208:211], v[60:63], v[116:119]
ds_read_b128 v[60:63], v18 offset:37376
s_waitcnt lgkmcnt(6)
v_mfma_f32_16x16x32_bf16 v[104:107], a[84:87], v[64:67], v[104:107]
v_mfma_f32_16x16x32_bf16 v[108:111], a[212:215], v[64:67], v[108:111]
ds_read_b128 v[64:67], v19 offset:33280
v_mfma_f32_16x16x32_bf16 v[112:115], a[84:87], v[68:71], v[112:115]
v_mfma_f32_16x16x32_bf16 v[116:119], a[212:215], v[68:71], v[116:119]
ds_read_b128 v[68:71], v19 offset:37376
s_waitcnt lgkmcnt(6)
v_mfma_f32_16x16x32_bf16 v[104:107], a[88:91], v[72:75], v[104:107]
buffer_load_dwordx4 v11, s[16:19], s29 offen offset:1024 lds
v_mfma_f32_16x16x32_bf16 v[108:111], a[216:219], v[72:75], v[108:111]
ds_read_b128 v[72:75], v20 offset:33280
v_mfma_f32_16x16x32_bf16 v[112:115], a[88:91], v[76:79], v[112:115]
v_mfma_f32_16x16x32_bf16 v[116:119], a[216:219], v[76:79], v[116:119]
ds_read_b128 v[76:79], v20 offset:37376
s_waitcnt lgkmcnt(6)
v_mfma_f32_16x16x32_bf16 v[104:107], a[92:95], v[80:83], v[104:107]
v_mfma_f32_16x16x32_bf16 v[108:111], a[220:223], v[80:83], v[108:111]
ds_read_b128 v[80:83], v21 offset:33280
v_mfma_f32_16x16x32_bf16 v[112:115], a[92:95], v[84:87], v[112:115]
v_mfma_f32_16x16x32_bf16 v[116:119], a[220:223], v[84:87], v[116:119]
ds_read_b128 v[84:87], v21 offset:37376
s_waitcnt lgkmcnt(6)
v_mfma_f32_16x16x32_bf16 v[104:107], a[96:99], v[56:59], v[104:107]
buffer_load_dwordx4 v12, s[16:19], s29 offen offset:2048 lds
v_mfma_f32_16x16x32_bf16 v[108:111], a[224:227], v[56:59], v[108:111]
ds_read_b128 v[56:59], v18 offset:33536
v_mfma_f32_16x16x32_bf16 v[112:115], a[96:99], v[60:63], v[112:115]
v_mfma_f32_16x16x32_bf16 v[116:119], a[224:227], v[60:63], v[116:119]
ds_read_b128 v[60:63], v18 offset:37632
s_waitcnt lgkmcnt(6)
v_mfma_f32_16x16x32_bf16 v[104:107], a[100:103], v[64:67], v[104:107]
v_mfma_f32_16x16x32_bf16 v[108:111], a[228:231], v[64:67], v[108:111]
ds_read_b128 v[64:67], v19 offset:33536
v_mfma_f32_16x16x32_bf16 v[112:115], a[100:103], v[68:71], v[112:115]
v_mfma_f32_16x16x32_bf16 v[116:119], a[228:231], v[68:71], v[116:119]
ds_read_b128 v[68:71], v19 offset:37632
s_waitcnt lgkmcnt(6)
v_mfma_f32_16x16x32_bf16 v[104:107], a[104:107], v[72:75], v[104:107]
buffer_load_dwordx4 v13, s[16:19], s29 offen offset:3072 lds
v_mfma_f32_16x16x32_bf16 v[108:111], a[232:235], v[72:75], v[108:111]
ds_read_b128 v[72:75], v20 offset:33536
v_mfma_f32_16x16x32_bf16 v[112:115], a[104:107], v[76:79], v[112:115]
v_mfma_f32_16x16x32_bf16 v[116:119], a[232:235], v[76:79], v[116:119]
ds_read_b128 v[76:79], v20 offset:37632
s_waitcnt lgkmcnt(6)
v_mfma_f32_16x16x32_bf16 v[104:107], a[108:111], v[80:83], v[104:107]
v_mfma_f32_16x16x32_bf16 v[108:111], a[236:239], v[80:83], v[108:111]
ds_read_b128 v[80:83], v21 offset:33536
v_mfma_f32_16x16x32_bf16 v[112:115], a[108:111], v[84:87], v[112:115]
v_mfma_f32_16x16x32_bf16 v[116:119], a[236:239], v[84:87], v[116:119]
ds_read_b128 v[84:87], v21 offset:37632
s_waitcnt vmcnt(9)
s_barrier
s_waitcnt lgkmcnt(6)
s_add_u32 m0, s44, 65536
s_add_u32 s29, s39, 196608
v_mfma_f32_16x16x32_bf16 v[104:107], a[112:115], v[56:59], v[104:107]
v_mov_b32 v24, s38
buffer_store_dword v24, v32, s[4:7], 0 offen sc1
s_add_u32 s38, s38, 1
buffer_load_dwordx4 v10, s[16:19], s29 offen offset:0 lds
v_mfma_f32_16x16x32_bf16 v[108:111], a[240:243], v[56:59], v[108:111]
ds_read_b128 v[56:59], v14 offset:0
v_mfma_f32_16x16x32_bf16 v[112:115], a[112:115], v[60:63], v[112:115]
v_mfma_f32_16x16x32_bf16 v[116:119], a[240:243], v[60:63], v[116:119]
ds_read_b128 v[60:63], v14 offset:4096
s_waitcnt lgkmcnt(6)
v_mfma_f32_16x16x32_bf16 v[104:107], a[116:119], v[64:67], v[104:107]
v_mfma_f32_16x16x32_bf16 v[108:111], a[244:247], v[64:67], v[108:111]
ds_read_b128 v[64:67], v15 offset:0
v_mfma_f32_16x16x32_bf16 v[112:115], a[116:119], v[68:71], v[112:115]
v_mfma_f32_16x16x32_bf16 v[116:119], a[244:247], v[68:71], v[116:119]
ds_read_b128 v[68:71], v15 offset:4096
s_waitcnt lgkmcnt(6)
v_mfma_f32_16x16x32_bf16 v[104:107], a[120:123], v[72:75], v[104:107]
buffer_load_dwordx4 v11, s[16:19], s29 offen offset:1024 lds
v_mfma_f32_16x16x32_bf16 v[108:111], a[248:251], v[72:75], v[108:111]
ds_read_b128 v[72:75], v16 offset:0
v_mfma_f32_16x16x32_bf16 v[112:115], a[120:123], v[76:79], v[112:115]
v_mfma_f32_16x16x32_bf16 v[116:119], a[248:251], v[76:79], v[116:119]
ds_read_b128 v[76:79], v16 offset:4096
s_waitcnt lgkmcnt(6)
v_mfma_f32_16x16x32_bf16 v[104:107], a[124:127], v[80:83], v[104:107]
v_mfma_f32_16x16x32_bf16 v[108:111], a[252:255], v[80:83], v[108:111]
ds_read_b128 v[80:83], v17 offset:0
v_mfma_f32_16x16x32_bf16 v[112:115], a[124:127], v[84:87], v[112:115]
v_mfma_f32_16x16x32_bf16 v[116:119], a[252:255], v[84:87], v[116:119]
ds_read_b128 v[84:87], v17 offset:4096
s_add_u32 s39, s39, 131072
s_cmp_eq_u32 s45, 1
s_cbranch_scc1 L_qhook
s_branch L_gl_T0
.p2align 6
L_gl_T1:
s_waitcnt lgkmcnt(6)
v_mfma_f32_16x16x32_bf16 v[88:91], a[0:3], v[56:59], 0
v_mfma_f32_16x16x32_bf16 v[92:95], a[128:131], v[56:59], 0
ds_read_b128 v[56:59], v14 offset:256
v_mfma_f32_16x16x32_bf16 v[96:99], a[0:3], v[60:63], 0
buffer_load_dwordx4 v12, s[16:19], s29 offen offset:2048 lds
v_mfma_f32_16x16x32_bf16 v[100:103], a[128:131], v[60:63], 0
ds_read_b128 v[60:63], v14 offset:4352
s_waitcnt lgkmcnt(6)
v_mfma_f32_16x16x32_bf16 v[88:91], a[4:7], v[64:67], v[88:91]
v_mfma_f32_16x16x32_bf16 v[92:95], a[132:135], v[64:67], v[92:95]
ds_read_b128 v[64:67], v15 offset:256
v_mfma_f32_16x16x32_bf16 v[96:99], a[4:7], v[68:71], v[96:99]
v_mfma_f32_16x16x32_bf16 v[100:103], a[132:135], v[68:71], v[100:103]
ds_read_b128 v[68:71], v15 offset:4352
s_waitcnt lgkmcnt(6)
v_mfma_f32_16x16x32_bf16 v[88:91], a[8:11], v[72:75], v[88:91]
v_cvt_pk_bf16_f32 v120, v104, v105
v_cvt_pk_bf16_f32 v121, v106, v107
v_mfma_f32_16x16x32_bf16 v[92:95], a[136:139], v[72:75], v[92:95]
v_cvt_pk_bf16_f32 v122, v108, v109
ds_read_b128 v[72:75], v16 offset:256
v_mfma_f32_16x16x32_bf16 v[96:99], a[8:11], v[76:79], v[96:99]
buffer_load_dwordx4 v13, s[16:19], s29 offen offset:3072 lds
v_mfma_f32_16x16x32_bf16 v[100:103], a[136:139], v[76:79], v[100:103]
ds_read_b128 v[76:79], v16 offset:4352
s_waitcnt lgkmcnt(6)
v_mfma_f32_16x16x32_bf16 v[88:91], a[12:15], v[80:83], v[88:91]
v_cvt_pk_bf16_f32 v123, v110, v111
buffer_store_dwordx4 v[120:123], v22, s[4:7], s40 offen offset:0 sc1
v_mfma_f32_16x16x32_bf16 v[92:95], a[140:143], v[80:83], v[92:95]
v_cvt_pk_bf16_f32 v124, v112, v113
ds_read_b128 v[80:83], v17 offset:256
v_mfma_f32_16x16x32_bf16 v[96:99], a[12:15], v[84:87], v[96:99]
v_cvt_pk_bf16_f32 v125, v114, v115
v_cvt_pk_bf16_f32 v126, v116, v117
v_mfma_f32_16x16x32_bf16 v[100:103], a[140:143], v[84:87], v[100:103]
ds_read_b128 v[84:87], v17 offset:4352
s_waitcnt lgkmcnt(6)
v_mfma_f32_16x16x32_bf16 v[88:91], a[16:19], v[56:59], v[88:91]
v_cvt_pk_bf16_f32 v127, v118, v119
buffer_store_dwordx4 v[36:39], v30, s[4:7], s40 offen sc1
v_mfma_f32_16x16x32_bf16 v[92:95], a[144:147], v[56:59], v[92:95]
buffer_store_dwordx4 v[124:127], v22, s[4:7], s40 offen offset:1024 sc1
ds_read_b128 v[56:59], v14 offset:512
s_add_u32 m0, s44, 69632
s_add_u32 s29, s39, 73728
v_mfma_f32_16x16x32_bf16 v[96:99], a[16:19], v[60:63], v[96:99]
buffer_load_dwordx4 v10, s[16:19], s29 offen offset:0 lds
v_mfma_f32_16x16x32_bf16 v[100:103], a[144:147], v[60:63], v[100:103]
ds_read_b128 v[60:63], v14 offset:4608
s_waitcnt lgkmcnt(6)
v_mfma_f32_16x16x32_bf16 v[88:91], a[20:23], v[64:67], v[88:91]
s_lshr_b32 s40, s47, 8
s_xor_b32 s40, s40, s56
v_mfma_f32_16x16x32_bf16 v[92:95], a[148:151], v[64:67], v[92:95]
s_and_b32 s40, s40, s55
ds_read_b128 v[64:67], v15 offset:512
v_mfma_f32_16x16x32_bf16 v[96:99], a[20:23], v[68:71], v[96:99]
s_or_b32 s40, s40, s47
s_add_u32 s47, s47, s36
v_mfma_f32_16x16x32_bf16 v[100:103], a[148:151], v[68:71], v[100:103]
ds_read_b128 v[68:71], v15 offset:4608
s_waitcnt lgkmcnt(6)
v_mfma_f32_16x16x32_bf16 v[88:91], a[24:27], v[72:75], v[88:91]
v_mfma_f32_16x16x32_bf16 v[92:95], a[152:155], v[72:75], v[92:95]
ds_read_b128 v[72:75], v16 offset:512
v_mfma_f32_16x16x32_bf16 v[96:99], a[24:27], v[76:79], v[96:99]
buffer_load_dwordx4 v11, s[16:19], s29 offen offset:1024 lds
v_mfma_f32_16x16x32_bf16 v[100:103], a[152:155], v[76:79], v[100:103]
ds_read_b128 v[76:79], v16 offset:4608
s_waitcnt lgkmcnt(6)
v_mfma_f32_16x16x32_bf16 v[88:91], a[28:31], v[80:83], v[88:91]
v_mfma_f32_16x16x32_bf16 v[92:95], a[156:159], v[80:83], v[92:95]
ds_read_b128 v[80:83], v17 offset:512
v_mfma_f32_16x16x32_bf16 v[96:99], a[28:31], v[84:87], v[96:99]
v_mfma_f32_16x16x32_bf16 v[100:103], a[156:159], v[84:87], v[100:103]
ds_read_b128 v[84:87], v17 offset:4608
s_waitcnt lgkmcnt(6)
v_mfma_f32_16x16x32_bf16 v[88:91], a[32:35], v[56:59], v[88:91]
v_mfma_f32_16x16x32_bf16 v[92:95], a[160:163], v[56:59], v[92:95]
ds_read_b128 v[56:59], v14 offset:768
v_mfma_f32_16x16x32_bf16 v[96:99], a[32:35], v[60:63], v[96:99]
buffer_load_dwordx4 v12, s[16:19], s29 offen offset:2048 lds
v_mfma_f32_16x16x32_bf16 v[100:103], a[160:163], v[60:63], v[100:103]
ds_read_b128 v[60:63], v14 offset:4864
s_waitcnt lgkmcnt(6)
v_mfma_f32_16x16x32_bf16 v[88:91], a[36:39], v[64:67], v[88:91]
v_mfma_f32_16x16x32_bf16 v[92:95], a[164:167], v[64:67], v[92:95]
ds_read_b128 v[64:67], v15 offset:768
v_mfma_f32_16x16x32_bf16 v[96:99], a[36:39], v[68:71], v[96:99]
v_mfma_f32_16x16x32_bf16 v[100:103], a[164:167], v[68:71], v[100:103]
ds_read_b128 v[68:71], v15 offset:4864
s_waitcnt lgkmcnt(6)
v_mfma_f32_16x16x32_bf16 v[88:91], a[40:43], v[72:75], v[88:91]
v_mfma_f32_16x16x32_bf16 v[92:95], a[168:171], v[72:75], v[92:95]
ds_read_b128 v[72:75], v16 offset:768
v_mfma_f32_16x16x32_bf16 v[96:99], a[40:43], v[76:79], v[96:99]
buffer_load_dwordx4 v13, s[16:19], s29 offen offset:3072 lds
v_mfma_f32_16x16x32_bf16 v[100:103], a[168:171], v[76:79], v[100:103]
ds_read_b128 v[76:79], v16 offset:4864
s_waitcnt lgkmcnt(6)
v_mfma_f32_16x16x32_bf16 v[88:91], a[44:47], v[80:83], v[88:91]
v_mfma_f32_16x16x32_bf16 v[92:95], a[172:175], v[80:83], v[92:95]
ds_read_b128 v[80:83], v17 offset:768
v_mfma_f32_16x16x32_bf16 v[96:99], a[44:47], v[84:87], v[96:99]
v_mfma_f32_16x16x32_bf16 v[100:103], a[172:175], v[84:87], v[100:103]
ds_read_b128 v[84:87], v17 offset:4864
s_waitcnt vmcnt(11)
s_barrier
s_waitcnt lgkmcnt(6)
v_mfma_f32_16x16x32_bf16 v[88:91], a[48:51], v[56:59], v[88:91]
v_mfma_f32_16x16x32_bf16 v[92:95], a[176:179], v[56:59], v[92:95]
ds_read_b128 v[56:59], v14 offset:32768
s_add_u32 m0, s44, 98304
s_add_u32 s29, s39, 66560
v_mfma_f32_16x16x32_bf16 v[96:99], a[48:51], v[60:63], v[96:99]
buffer_load_dwordx4 v10, s[16:19], s29 offen offset:0 lds
v_mfma_f32_16x16x32_bf16 v[100:103], a[176:179], v[60:63], v[100:103]
ds_read_b128 v[60:63], v14 offset:36864
s_waitcnt lgkmcnt(6)
v_mfma_f32_16x16x32_bf16 v[88:91], a[52:55], v[64:67], v[88:91]
v_mfma_f32_16x16x32_bf16 v[92:95], a[180:183], v[64:67], v[92:95]
ds_read_b128 v[64:67], v15 offset:32768
v_mfma_f32_16x16x32_bf16 v[96:99], a[52:55], v[68:71], v[96:99]
v_mfma_f32_16x16x32_bf16 v[100:103], a[180:183], v[68:71], v[100:103]
ds_read_b128 v[68:71], v15 offset:36864
s_waitcnt lgkmcnt(6)
v_mfma_f32_16x16x32_bf16 v[88:91], a[56:59], v[72:75], v[88:91]
v_mfma_f32_16x16x32_bf16 v[92:95], a[184:187], v[72:75], v[92:95]
ds_read_b128 v[72:75], v16 offset:32768
v_mfma_f32_16x16x32_bf16 v[96:99], a[56:59], v[76:79], v[96:99]
buffer_load_dwordx4 v11, s[16:19], s29 offen offset:1024 lds
v_mfma_f32_16x16x32_bf16 v[100:103], a[184:187], v[76:79], v[100:103]
ds_read_b128 v[76:79], v16 offset:36864
s_waitcnt lgkmcnt(6)
v_mfma_f32_16x16x32_bf16 v[88:91], a[60:63], v[80:83], v[88:91]
v_mfma_f32_16x16x32_bf16 v[92:95], a[188:191], v[80:83], v[92:95]
ds_read_b128 v[80:83], v17 offset:32768
v_mfma_f32_16x16x32_bf16 v[96:99], a[60:63], v[84:87], v[96:99]
v_mfma_f32_16x16x32_bf16 v[100:103], a[188:191], v[84:87], v[100:103]
ds_read_b128 v[84:87], v17 offset:36864
s_waitcnt lgkmcnt(6)
v_mfma_f32_16x16x32_bf16 v[88:91], a[64:67], v[56:59], v[88:91]
v_mfma_f32_16x16x32_bf16 v[92:95], a[192:195], v[56:59], v[92:95]
ds_read_b128 v[56:59], v14 offset:33024
v_mfma_f32_16x16x32_bf16 v[96:99], a[64:67], v[60:63], v[96:99]
buffer_load_dwordx4 v12, s[16:19], s29 offen offset:2048 lds
v_mfma_f32_16x16x32_bf16 v[100:103], a[192:195], v[60:63], v[100:103]
ds_read_b128 v[60:63], v14 offset:37120
s_waitcnt lgkmcnt(6)
v_mfma_f32_16x16x32_bf16 v[88:91], a[68:71], v[64:67], v[88:91]
v_mfma_f32_16x16x32_bf16 v[92:95], a[196:199], v[64:67], v[92:95]
ds_read_b128 v[64:67], v15 offset:33024
v_mfma_f32_16x16x32_bf16 v[96:99], a[68:71], v[68:71], v[96:99]
v_mfma_f32_16x16x32_bf16 v[100:103], a[196:199], v[68:71], v[100:103]
ds_read_b128 v[68:71], v15 offset:37120
s_waitcnt lgkmcnt(6)
v_mfma_f32_16x16x32_bf16 v[88:91], a[72:75], v[72:75], v[88:91]
v_mfma_f32_16x16x32_bf16 v[92:95], a[200:203], v[72:75], v[92:95]
ds_read_b128 v[72:75], v16 offset:33024
v_mfma_f32_16x16x32_bf16 v[96:99], a[72:75], v[76:79], v[96:99]
buffer_load_dwordx4 v13, s[16:19], s29 offen offset:3072 lds
v_mfma_f32_16x16x32_bf16 v[100:103], a[200:203], v[76:79], v[100:103]
ds_read_b128 v[76:79], v16 offset:37120
s_waitcnt lgkmcnt(6)
v_mfma_f32_16x16x32_bf16 v[88:91], a[76:79], v[80:83], v[88:91]
v_mfma_f32_16x16x32_bf16 v[92:95], a[204:207], v[80:83], v[92:95]
ds_read_b128 v[80:83], v17 offset:33024
v_mfma_f32_16x16x32_bf16 v[96:99], a[76:79], v[84:87], v[96:99]
v_mfma_f32_16x16x32_bf16 v[100:103], a[204:207], v[84:87], v[100:103]
ds_read_b128 v[84:87], v17 offset:37120
s_waitcnt lgkmcnt(6)
v_mfma_f32_16x16x32_bf16 v[88:91], a[80:83], v[56:59], v[88:91]
s_cmp_lt_u32 s38, 64
s_cbranch_scc1 L_wpT11
s_sub_u32 s46, s38, 64
s_lshl_b32 s46, s46, 17
buffer_load_dword v26, v31, s[12:15], s46 offen
L_wpT11:
v_mfma_f32_16x16x32_bf16 v[92:95], a[208:211], v[56:59], v[92:95]
ds_read_b128 v[56:59], v14 offset:33280
s_add_u32 m0, s44, 102400
s_add_u32 s29, s39, 74752
v_mfma_f32_16x16x32_bf16 v[96:99], a[80:83], v[60:63], v[96:99]
buffer_load_dwordx4 v10, s[16:19], s29 offen offset:0 lds
v_mfma_f32_16x16x32_bf16 v[100:103], a[208:211], v[60:63], v[100:103]
ds_read_b128 v[60:63], v14 offset:37376
s_waitcnt lgkmcnt(6)
v_mfma_f32_16x16x32_bf16 v[88:91], a[84:87], v[64:67], v[88:91]
v_mfma_f32_16x16x32_bf16 v[92:95], a[212:215], v[64:67], v[92:95]
ds_read_b128 v[64:67], v15 offset:33280
v_mfma_f32_16x16x32_bf16 v[96:99], a[84:87], v[68:71], v[96:99]
v_mfma_f32_16x16x32_bf16 v[100:103], a[212:215], v[68:71], v[100:103]
ds_read_b128 v[68:71], v15 offset:37376
s_waitcnt lgkmcnt(6)
v_mfma_f32_16x16x32_bf16 v[88:91], a[88:91], v[72:75], v[88:91]
v_mfma_f32_16x16x32_bf16 v[92:95], a[216:219], v[72:75], v[92:95]
ds_read_b128 v[72:75], v16 offset:33280
v_mfma_f32_16x16x32_bf16 v[96:99], a[88:91], v[76:79], v[96:99]
buffer_load_dwordx4 v11, s[16:19], s29 offen offset:1024 lds
v_mfma_f32_16x16x32_bf16 v[100:103], a[216:219], v[76:79], v[100:103]
ds_read_b128 v[76:79], v16 offset:37376
s_waitcnt lgkmcnt(6)
v_mfma_f32_16x16x32_bf16 v[88:91], a[92:95], v[80:83], v[88:91]
v_mfma_f32_16x16x32_bf16 v[92:95], a[220:223], v[80:83], v[92:95]
ds_read_b128 v[80:83], v17 offset:33280
v_mfma_f32_16x16x32_bf16 v[96:99], a[92:95], v[84:87], v[96:99]
v_mfma_f32_16x16x32_bf16 v[100:103], a[220:223], v[84:87], v[100:103]
ds_read_b128 v[84:87], v17 offset:37376
s_waitcnt lgkmcnt(6)
v_mfma_f32_16x16x32_bf16 v[88:91], a[96:99], v[56:59], v[88:91]
v_mfma_f32_16x16x32_bf16 v[92:95], a[224:227], v[56:59], v[92:95]
ds_read_b128 v[56:59], v14 offset:33536
v_mfma_f32_16x16x32_bf16 v[96:99], a[96:99], v[60:63], v[96:99]
buffer_load_dwordx4 v12, s[16:19], s29 offen offset:2048 lds
v_mfma_f32_16x16x32_bf16 v[100:103], a[224:227], v[60:63], v[100:103]
ds_read_b128 v[60:63], v14 offset:37632
s_waitcnt lgkmcnt(6)
v_mfma_f32_16x16x32_bf16 v[88:91], a[100:103], v[64:67], v[88:91]
v_mfma_f32_16x16x32_bf16 v[92:95], a[228:231], v[64:67], v[92:95]
ds_read_b128 v[64:67], v15 offset:33536
v_mfma_f32_16x16x32_bf16 v[96:99], a[100:103], v[68:71], v[96:99]
v_mfma_f32_16x16x32_bf16 v[100:103], a[228:231], v[68:71], v[100:103]
ds_read_b128 v[68:71], v15 offset:37632
s_waitcnt lgkmcnt(6)
v_mfma_f32_16x16x32_bf16 v[88:91], a[104:107], v[72:75], v[88:91]
v_mfma_f32_16x16x32_bf16 v[92:95], a[232:235], v[72:75], v[92:95]
ds_read_b128 v[72:75], v16 offset:33536
v_mfma_f32_16x16x32_bf16 v[96:99], a[104:107], v[76:79], v[96:99]
buffer_load_dwordx4 v13, s[16:19], s29 offen offset:3072 lds
v_mfma_f32_16x16x32_bf16 v[100:103], a[232:235], v[76:79], v[100:103]
ds_read_b128 v[76:79], v16 offset:37632
s_waitcnt lgkmcnt(6)
v_mfma_f32_16x16x32_bf16 v[88:91], a[108:111], v[80:83], v[88:91]
v_mfma_f32_16x16x32_bf16 v[92:95], a[236:239], v[80:83], v[92:95]
ds_read_b128 v[80:83], v17 offset:33536
v_mfma_f32_16x16x32_bf16 v[96:99], a[108:111], v[84:87], v[96:99]
v_mfma_f32_16x16x32_bf16 v[100:103], a[236:239], v[84:87], v[100:103]
ds_read_b128 v[84:87], v17 offset:37632
s_waitcnt vmcnt(8)
s_barrier
s_waitcnt lgkmcnt(6)
v_mfma_f32_16x16x32_bf16 v[88:91], a[112:115], v[56:59], v[88:91]
s_add_u32 s38, s38, 1
v_mfma_f32_16x16x32_bf16 v[92:95], a[240:243], v[56:59], v[92:95]
ds_read_b128 v[56:59], v18 offset:0
s_add_u32 m0, s44, 0
s_add_u32 s29, s39, 131072
v_mfma_f32_16x16x32_bf16 v[96:99], a[112:115], v[60:63], v[96:99]
buffer_load_dwordx4 v10, s[16:19], s29 offen offset:0 lds
v_mfma_f32_16x16x32_bf16 v[100:103], a[240:243], v[60:63], v[100:103]
ds_read_b128 v[60:63], v18 offset:4096
s_waitcnt lgkmcnt(6)
v_mfma_f32_16x16x32_bf16 v[88:91], a[116:119], v[64:67], v[88:91]
v_mfma_f32_16x16x32_bf16 v[92:95], a[244:247], v[64:67], v[92:95]
ds_read_b128 v[64:67], v19 offset:0
v_mfma_f32_16x16x32_bf16 v[96:99], a[116:119], v[68:71], v[96:99]
v_mfma_f32_16x16x32_bf16 v[100:103], a[244:247], v[68:71], v[100:103]
ds_read_b128 v[68:71], v19 offset:4096
s_waitcnt lgkmcnt(6)
v_mfma_f32_16x16x32_bf16 v[88:91], a[120:123], v[72:75], v[88:91]
v_mfma_f32_16x16x32_bf16 v[92:95], a[248:251], v[72:75], v[92:95]
ds_read_b128 v[72:75], v20 offset:0
v_mfma_f32_16x16x32_bf16 v[96:99], a[120:123], v[76:79], v[96:99]
buffer_load_dwordx4 v11, s[16:19], s29 offen offset:1024 lds
v_mfma_f32_16x16x32_bf16 v[100:103], a[248:251], v[76:79], v[100:103]
ds_read_b128 v[76:79], v20 offset:4096
s_waitcnt lgkmcnt(6)
v_mfma_f32_16x16x32_bf16 v[88:91], a[124:127], v[80:83], v[88:91]
v_mfma_f32_16x16x32_bf16 v[92:95], a[252:255], v[80:83], v[92:95]
ds_read_b128 v[80:83], v21 offset:0
v_mfma_f32_16x16x32_bf16 v[96:99], a[124:127], v[84:87], v[96:99]
v_mfma_f32_16x16x32_bf16 v[100:103], a[252:255], v[84:87], v[100:103]
ds_read_b128 v[84:87], v21 offset:4096
s_cmp_eq_u32 s38, 64
s_cbranch_scc1 L_gx_T
s_waitcnt lgkmcnt(6)
v_mfma_f32_16x16x32_bf16 v[104:107], a[0:3], v[56:59], 0
v_mfma_f32_16x16x32_bf16 v[108:111], a[128:131], v[56:59], 0
ds_read_b128 v[56:59], v18 offset:256
v_mfma_f32_16x16x32_bf16 v[112:115], a[0:3], v[60:63], 0
buffer_load_dwordx4 v12, s[16:19], s29 offen offset:2048 lds
v_mfma_f32_16x16x32_bf16 v[116:119], a[128:131], v[60:63], 0
ds_read_b128 v[60:63], v18 offset:4352
s_waitcnt lgkmcnt(6)
v_mfma_f32_16x16x32_bf16 v[104:107], a[4:7], v[64:67], v[104:107]
v_mfma_f32_16x16x32_bf16 v[108:111], a[132:135], v[64:67], v[108:111]
ds_read_b128 v[64:67], v19 offset:256
v_mfma_f32_16x16x32_bf16 v[112:115], a[4:7], v[68:71], v[112:115]
v_mfma_f32_16x16x32_bf16 v[116:119], a[132:135], v[68:71], v[116:119]
ds_read_b128 v[68:71], v19 offset:4352
s_waitcnt lgkmcnt(6)
v_mfma_f32_16x16x32_bf16 v[104:107], a[8:11], v[72:75], v[104:107]
v_cvt_pk_bf16_f32 v120, v88, v89
v_cvt_pk_bf16_f32 v121, v90, v91
v_mfma_f32_16x16x32_bf16 v[108:111], a[136:139], v[72:75], v[108:111]
v_cvt_pk_bf16_f32 v122, v92, v93
ds_read_b128 v[72:75], v20 offset:256
v_mfma_f32_16x16x32_bf16 v[112:115], a[8:11], v[76:79], v[112:115]
buffer_load_dwordx4 v13, s[16:19], s29 offen offset:3072 lds
v_mfma_f32_16x16x32_bf16 v[116:119], a[136:139], v[76:79], v[116:119]
ds_read_b128 v[76:79], v20 offset:4352
s_waitcnt lgkmcnt(6)
v_mfma_f32_16x16x32_bf16 v[104:107], a[12:15], v[80:83], v[104:107]
v_cvt_pk_bf16_f32 v123, v94, v95
buffer_store_dwordx4 v[120:123], v22, s[4:7], s40 offen offset:0 sc1
v_mfma_f32_16x16x32_bf16 v[108:111], a[140:143], v[80:83], v[108:111]
v_cvt_pk_bf16_f32 v124, v96, v97
ds_read_b128 v[80:83], v21 offset:256
v_mfma_f32_16x16x32_bf16 v[112:115], a[12:15], v[84:87], v[112:115]
v_cvt_pk_bf16_f32 v125, v98, v99
v_cvt_pk_bf16_f32 v126, v100, v101
v_mfma_f32_16x16x32_bf16 v[116:119], a[140:143], v[84:87], v[116:119]
ds_read_b128 v[84:87], v21 offset:4352
s_waitcnt lgkmcnt(6)
v_mfma_f32_16x16x32_bf16 v[104:107], a[16:19], v[56:59], v[104:107]
v_cvt_pk_bf16_f32 v127, v102, v103
buffer_store_dwordx4 v[36:39], v30, s[4:7], s40 offen sc1
v_mfma_f32_16x16x32_bf16 v[108:111], a[144:147], v[56:59], v[108:111]
buffer_store_dwordx4 v[124:127], v22, s[4:7], s40 offen offset:1024 sc1
ds_read_b128 v[56:59], v18 offset:512
s_add_u32 m0, s44, 4096
s_add_u32 s29, s39, 139264
v_mfma_f32_16x16x32_bf16 v[112:115], a[16:19], v[60:63], v[112:115]
buffer_load_dwordx4 v10, s[16:19], s29 offen offset:0 lds
v_mfma_f32_16x16x32_bf16 v[116:119], a[144:147], v[60:63], v[116:119]
ds_read_b128 v[60:63], v18 offset:4608
s_waitcnt lgkmcnt(6)
v_mfma_f32_16x16x32_bf16 v[104:107], a[20:23], v[64:67], v[104:107]
s_lshr_b32 s40, s47, 8
s_xor_b32 s40, s40, s56
v_mfma_f32_16x16x32_bf16 v[108:111], a[148:151], v[64:67], v[108:111]
s_and_b32 s40, s40, s55
ds_read_b128 v[64:67], v19 offset:512
v_mfma_f32_16x16x32_bf16 v[112:115], a[20:23], v[68:71], v[112:115]
s_or_b32 s40, s40, s47
s_add_u32 s47, s47, s36
v_mfma_f32_16x16x32_bf16 v[116:119], a[148:151], v[68:71], v[116:119]
ds_read_b128 v[68:71], v19 offset:4608
s_waitcnt lgkmcnt(6)
v_mfma_f32_16x16x32_bf16 v[104:107], a[24:27], v[72:75], v[104:107]
v_mfma_f32_16x16x32_bf16 v[108:111], a[152:155], v[72:75], v[108:111]
ds_read_b128 v[72:75], v20 offset:512
v_mfma_f32_16x16x32_bf16 v[112:115], a[24:27], v[76:79], v[112:115]
buffer_load_dwordx4 v11, s[16:19], s29 offen offset:1024 lds
v_mfma_f32_16x16x32_bf16 v[116:119], a[152:155], v[76:79], v[116:119]
ds_read_b128 v[76:79], v20 offset:4608
s_waitcnt lgkmcnt(6)
v_mfma_f32_16x16x32_bf16 v[104:107], a[28:31], v[80:83], v[104:107]
v_mfma_f32_16x16x32_bf16 v[108:111], a[156:159], v[80:83], v[108:111]
ds_read_b128 v[80:83], v21 offset:512
v_mfma_f32_16x16x32_bf16 v[112:115], a[28:31], v[84:87], v[112:115]
v_mfma_f32_16x16x32_bf16 v[116:119], a[156:159], v[84:87], v[116:119]
ds_read_b128 v[84:87], v21 offset:4608
s_waitcnt lgkmcnt(6)
v_mfma_f32_16x16x32_bf16 v[104:107], a[32:35], v[56:59], v[104:107]
v_mfma_f32_16x16x32_bf16 v[108:111], a[160:163], v[56:59], v[108:111]
ds_read_b128 v[56:59], v18 offset:768
v_mfma_f32_16x16x32_bf16 v[112:115], a[32:35], v[60:63], v[112:115]
buffer_load_dwordx4 v12, s[16:19], s29 offen offset:2048 lds
v_mfma_f32_16x16x32_bf16 v[116:119], a[160:163], v[60:63], v[116:119]
ds_read_b128 v[60:63], v18 offset:4864
s_waitcnt lgkmcnt(6)
v_mfma_f32_16x16x32_bf16 v[104:107], a[36:39], v[64:67], v[104:107]
v_mfma_f32_16x16x32_bf16 v[108:111], a[164:167], v[64:67], v[108:111]
ds_read_b128 v[64:67], v19 offset:768
v_mfma_f32_16x16x32_bf16 v[112:115], a[36:39], v[68:71], v[112:115]
v_mfma_f32_16x16x32_bf16 v[116:119], a[164:167], v[68:71], v[116:119]
ds_read_b128 v[68:71], v19 offset:4864
s_waitcnt lgkmcnt(6)
v_mfma_f32_16x16x32_bf16 v[104:107], a[40:43], v[72:75], v[104:107]
v_mfma_f32_16x16x32_bf16 v[108:111], a[168:171], v[72:75], v[108:111]
ds_read_b128 v[72:75], v20 offset:768
v_mfma_f32_16x16x32_bf16 v[112:115], a[40:43], v[76:79], v[112:115]
buffer_load_dwordx4 v13, s[16:19], s29 offen offset:3072 lds
v_mfma_f32_16x16x32_bf16 v[116:119], a[168:171], v[76:79], v[116:119]
ds_read_b128 v[76:79], v20 offset:4864
s_waitcnt lgkmcnt(6)
v_mfma_f32_16x16x32_bf16 v[104:107], a[44:47], v[80:83], v[104:107]
v_mfma_f32_16x16x32_bf16 v[108:111], a[172:175], v[80:83], v[108:111]
ds_read_b128 v[80:83], v21 offset:768
v_mfma_f32_16x16x32_bf16 v[112:115], a[44:47], v[84:87], v[112:115]
v_mfma_f32_16x16x32_bf16 v[116:119], a[172:175], v[84:87], v[116:119]
ds_read_b128 v[84:87], v21 offset:4864
s_waitcnt vmcnt(11)
s_barrier
s_waitcnt lgkmcnt(6)
v_mfma_f32_16x16x32_bf16 v[104:107], a[48:51], v[56:59], v[104:107]
v_mfma_f32_16x16x32_bf16 v[108:111], a[176:179], v[56:59], v[108:111]
ds_read_b128 v[56:59], v18 offset:32768
s_add_u32 m0, s44, 32768
s_add_u32 s29, s39, 132096
v_mfma_f32_16x16x32_bf16 v[112:115], a[48:51], v[60:63], v[112:115]
buffer_load_dwordx4 v10, s[16:19], s29 offen offset:0 lds
v_mfma_f32_16x16x32_bf16 v[116:119], a[176:179], v[60:63], v[116:119]
ds_read_b128 v[60:63], v18 offset:36864
s_waitcnt lgkmcnt(6)
v_mfma_f32_16x16x32_bf16 v[104:107], a[52:55], v[64:67], v[104:107]
v_mfma_f32_16x16x32_bf16 v[108:111], a[180:183], v[64:67], v[108:111]
ds_read_b128 v[64:67], v19 offset:32768
v_mfma_f32_16x16x32_bf16 v[112:115], a[52:55], v[68:71], v[112:115]
v_mfma_f32_16x16x32_bf16 v[116:119], a[180:183], v[68:71], v[116:119]
ds_read_b128 v[68:71], v19 offset:36864
s_waitcnt lgkmcnt(6)
v_mfma_f32_16x16x32_bf16 v[104:107], a[56:59], v[72:75], v[104:107]
v_mfma_f32_16x16x32_bf16 v[108:111], a[184:187], v[72:75], v[108:111]
ds_read_b128 v[72:75], v20 offset:32768
v_mfma_f32_16x16x32_bf16 v[112:115], a[56:59], v[76:79], v[112:115]
buffer_load_dwordx4 v11, s[16:19], s29 offen offset:1024 lds
v_mfma_f32_16x16x32_bf16 v[116:119], a[184:187], v[76:79], v[116:119]
ds_read_b128 v[76:79], v20 offset:36864
s_waitcnt lgkmcnt(6)
v_mfma_f32_16x16x32_bf16 v[104:107], a[60:63], v[80:83], v[104:107]
v_mfma_f32_16x16x32_bf16 v[108:111], a[188:191], v[80:83], v[108:111]
ds_read_b128 v[80:83], v21 offset:32768
v_mfma_f32_16x16x32_bf16 v[112:115], a[60:63], v[84:87], v[112:115]
v_mfma_f32_16x16x32_bf16 v[116:119], a[188:191], v[84:87], v[116:119]
ds_read_b128 v[84:87], v21 offset:36864
s_waitcnt lgkmcnt(6)
v_mfma_f32_16x16x32_bf16 v[104:107], a[64:67], v[56:59], v[104:107]
v_mfma_f32_16x16x32_bf16 v[108:111], a[192:195], v[56:59], v[108:111]
ds_read_b128 v[56:59], v18 offset:33024
v_mfma_f32_16x16x32_bf16 v[112:115], a[64:67], v[60:63], v[112:115]
buffer_load_dwordx4 v12, s[16:19], s29 offen offset:2048 lds
v_mfma_f32_16x16x32_bf16 v[116:119], a[192:195], v[60:63], v[116:119]
ds_read_b128 v[60:63], v18 offset:37120
s_waitcnt lgkmcnt(6)
v_mfma_f32_16x16x32_bf16 v[104:107], a[68:71], v[64:67], v[104:107]
v_mfma_f32_16x16x32_bf16 v[108:111], a[196:199], v[64:67], v[108:111]
ds_read_b128 v[64:67], v19 offset:33024
v_mfma_f32_16x16x32_bf16 v[112:115], a[68:71], v[68:71], v[112:115]
v_mfma_f32_16x16x32_bf16 v[116:119], a[196:199], v[68:71], v[116:119]
ds_read_b128 v[68:71], v19 offset:37120
s_waitcnt lgkmcnt(6)
v_mfma_f32_16x16x32_bf16 v[104:107], a[72:75], v[72:75], v[104:107]
v_mfma_f32_16x16x32_bf16 v[108:111], a[200:203], v[72:75], v[108:111]
ds_read_b128 v[72:75], v20 offset:33024
v_mfma_f32_16x16x32_bf16 v[112:115], a[72:75], v[76:79], v[112:115]
buffer_load_dwordx4 v13, s[16:19], s29 offen offset:3072 lds
v_mfma_f32_16x16x32_bf16 v[116:119], a[200:203], v[76:79], v[116:119]
ds_read_b128 v[76:79], v20 offset:37120
s_waitcnt lgkmcnt(6)
v_mfma_f32_16x16x32_bf16 v[104:107], a[76:79], v[80:83], v[104:107]
v_mfma_f32_16x16x32_bf16 v[108:111], a[204:207], v[80:83], v[108:111]
ds_read_b128 v[80:83], v21 offset:33024
v_mfma_f32_16x16x32_bf16 v[112:115], a[76:79], v[84:87], v[112:115]
v_mfma_f32_16x16x32_bf16 v[116:119], a[204:207], v[84:87], v[116:119]
ds_read_b128 v[84:87], v21 offset:37120
s_waitcnt lgkmcnt(6)
v_mfma_f32_16x16x32_bf16 v[104:107], a[80:83], v[56:59], v[104:107]
s_cmp_lt_u32 s38, 64
s_cbranch_scc1 L_wpT31
s_sub_u32 s46, s38, 64
s_lshl_b32 s46, s46, 17
buffer_load_dword v26, v31, s[12:15], s46 offen
L_wpT31:
v_mfma_f32_16x16x32_bf16 v[108:111], a[208:211], v[56:59], v[108:111]
ds_read_b128 v[56:59], v18 offset:33280
s_add_u32 m0, s44, 36864
s_add_u32 s29, s39, 140288
v_mfma_f32_16x16x32_bf16 v[112:115], a[80:83], v[60:63], v[112:115]
buffer_load_dwordx4 v10, s[16:19], s29 offen offset:0 lds
v_mfma_f32_16x16x32_bf16 v[116:119], a[208:211], v[60:63], v[116:119]
ds_read_b128 v[60:63], v18 offset:37376
s_waitcnt lgkmcnt(6)
v_mfma_f32_16x16x32_bf16 v[104:107], a[84:87], v[64:67], v[104:107]
v_mfma_f32_16x16x32_bf16 v[108:111], a[212:215], v[64:67], v[108:111]
ds_read_b128 v[64:67], v19 offset:33280
v_mfma_f32_16x16x32_bf16 v[112:115], a[84:87], v[68:71], v[112:115]
v_mfma_f32_16x16x32_bf16 v[116:119], a[212:215], v[68:71], v[116:119]
ds_read_b128 v[68:71], v19 offset:37376
s_waitcnt lgkmcnt(6)
v_mfma_f32_16x16x32_bf16 v[104:107], a[88:91], v[72:75], v[104:107]
v_mfma_f32_16x16x32_bf16 v[108:111], a[216:219], v[72:75], v[108:111]
ds_read_b128 v[72:75], v20 offset:33280
v_mfma_f32_16x16x32_bf16 v[112:115], a[88:91], v[76:79], v[112:115]
buffer_load_dwordx4 v11, s[16:19], s29 offen offset:1024 lds
v_mfma_f32_16x16x32_bf16 v[116:119], a[216:219], v[76:79], v[116:119]
ds_read_b128 v[76:79], v20 offset:37376
s_waitcnt lgkmcnt(6)
v_mfma_f32_16x16x32_bf16 v[104:107], a[92:95], v[80:83], v[104:107]
v_mfma_f32_16x16x32_bf16 v[108:111], a[220:223], v[80:83], v[108:111]
ds_read_b128 v[80:83], v21 offset:33280
v_mfma_f32_16x16x32_bf16 v[112:115], a[92:95], v[84:87], v[112:115]
v_mfma_f32_16x16x32_bf16 v[116:119], a[220:223], v[84:87], v[116:119]
ds_read_b128 v[84:87], v21 offset:37376
s_waitcnt lgkmcnt(6)
v_mfma_f32_16x16x32_bf16 v[104:107], a[96:99], v[56:59], v[104:107]
v_mfma_f32_16x16x32_bf16 v[108:111], a[224:227], v[56:59], v[108:111]
ds_read_b128 v[56:59], v18 offset:33536
v_mfma_f32_16x16x32_bf16 v[112:115], a[96:99], v[60:63], v[112:115]
buffer_load_dwordx4 v12, s[16:19], s29 offen offset:2048 lds
v_mfma_f32_16x16x32_bf16 v[116:119], a[224:227], v[60:63], v[116:119]
ds_read_b128 v[60:63], v18 offset:37632
s_waitcnt lgkmcnt(6)
v_mfma_f32_16x16x32_bf16 v[104:107], a[100:103], v[64:67], v[104:107]
v_mfma_f32_16x16x32_bf16 v[108:111], a[228:231], v[64:67], v[108:111]
ds_read_b128 v[64:67], v19 offset:33536
v_mfma_f32_16x16x32_bf16 v[112:115], a[100:103], v[68:71], v[112:115]
v_mfma_f32_16x16x32_bf16 v[116:119], a[228:231], v[68:71], v[116:119]
ds_read_b128 v[68:71], v19 offset:37632
s_waitcnt lgkmcnt(6)
v_mfma_f32_16x16x32_bf16 v[104:107], a[104:107], v[72:75], v[104:107]
v_mfma_f32_16x16x32_bf16 v[108:111], a[232:235], v[72:75], v[108:111]
ds_read_b128 v[72:75], v20 offset:33536
v_mfma_f32_16x16x32_bf16 v[112:115], a[104:107], v[76:79], v[112:115]
buffer_load_dwordx4 v13, s[16:19], s29 offen offset:3072 lds
v_mfma_f32_16x16x32_bf16 v[116:119], a[232:235], v[76:79], v[116:119]
ds_read_b128 v[76:79], v20 offset:37632
s_waitcnt lgkmcnt(6)
v_mfma_f32_16x16x32_bf16 v[104:107], a[108:111], v[80:83], v[104:107]
v_mfma_f32_16x16x32_bf16 v[108:111], a[236:239], v[80:83], v[108:111]
ds_read_b128 v[80:83], v21 offset:33536
v_mfma_f32_16x16x32_bf16 v[112:115], a[108:111], v[84:87], v[112:115]
v_mfma_f32_16x16x32_bf16 v[116:119], a[236:239], v[84:87], v[116:119]
ds_read_b128 v[84:87], v21 offset:37632
s_waitcnt vmcnt(8)
s_barrier
s_waitcnt lgkmcnt(6)
v_mfma_f32_16x16x32_bf16 v[104:107], a[112:115], v[56:59], v[104:107]
s_add_u32 s38, s38, 1
v_mfma_f32_16x16x32_bf16 v[108:111], a[240:243], v[56:59], v[108:111]
ds_read_b128 v[56:59], v14 offset:0
s_add_u32 m0, s44, 65536
s_add_u32 s29, s39, 196608
v_mfma_f32_16x16x32_bf16 v[112:115], a[112:115], v[60:63], v[112:115]
buffer_load_dwordx4 v10, s[16:19], s29 offen offset:0 lds
v_mfma_f32_16x16x32_bf16 v[116:119], a[240:243], v[60:63], v[116:119]
ds_read_b128 v[60:63], v14 offset:4096
s_waitcnt lgkmcnt(6)
v_mfma_f32_16x16x32_bf16 v[104:107], a[116:119], v[64:67], v[104:107]
v_mfma_f32_16x16x32_bf16 v[108:111], a[244:247], v[64:67], v[108:111]
ds_read_b128 v[64:67], v15 offset:0
v_mfma_f32_16x16x32_bf16 v[112:115], a[116:119], v[68:71], v[112:115]
v_mfma_f32_16x16x32_bf16 v[116:119], a[244:247], v[68:71], v[116:119]
ds_read_b128 v[68:71], v15 offset:4096
s_waitcnt lgkmcnt(6)
v_mfma_f32_16x16x32_bf16 v[104:107], a[120:123], v[72:75], v[104:107]
v_mfma_f32_16x16x32_bf16 v[108:111], a[248:251], v[72:75], v[108:111]
ds_read_b128 v[72:75], v16 offset:0
v_mfma_f32_16x16x32_bf16 v[112:115], a[120:123], v[76:79], v[112:115]
buffer_load_dwordx4 v11, s[16:19], s29 offen offset:1024 lds
v_mfma_f32_16x16x32_bf16 v[116:119], a[248:251], v[76:79], v[116:119]
ds_read_b128 v[76:79], v16 offset:4096
s_waitcnt lgkmcnt(6)
v_mfma_f32_16x16x32_bf16 v[104:107], a[124:127], v[80:83], v[104:107]
v_mfma_f32_16x16x32_bf16 v[108:111], a[252:255], v[80:83], v[108:111]
ds_read_b128 v[80:83], v17 offset:0
v_mfma_f32_16x16x32_bf16 v[112:115], a[124:127], v[84:87], v[112:115]
v_mfma_f32_16x16x32_bf16 v[116:119], a[252:255], v[84:87], v[116:119]
ds_read_b128 v[84:87], v17 offset:4096
s_add_u32 s39, s39, 131072
s_cmp_eq_u32 s45, 1
s_cbranch_scc1 L_qhook
s_branch L_gl_T1
.p2align 6
L_gl_T2:
s_waitcnt lgkmcnt(6)
v_mfma_f32_16x16x32_bf16 v[88:91], a[0:3], v[56:59], 0
v_mfma_f32_16x16x32_bf16 v[92:95], a[128:131], v[56:59], 0
ds_read_b128 v[56:59], v14 offset:256
v_mfma_f32_16x16x32_bf16 v[96:99], a[0:3], v[60:63], 0
v_mfma_f32_16x16x32_bf16 v[100:103], a[128:131], v[60:63], 0
ds_read_b128 v[60:63], v14 offset:4352
s_waitcnt lgkmcnt(6)
v_mfma_f32_16x16x32_bf16 v[88:91], a[4:7], v[64:67], v[88:91]
buffer_load_dwordx4 v12, s[16:19], s29 offen offset:2048 lds
v_mfma_f32_16x16x32_bf16 v[92:95], a[132:135], v[64:67], v[92:95]
ds_read_b128 v[64:67], v15 offset:256
v_mfma_f32_16x16x32_bf16 v[96:99], a[4:7], v[68:71], v[96:99]
v_mfma_f32_16x16x32_bf16 v[100:103], a[132:135], v[68:71], v[100:103]
ds_read_b128 v[68:71], v15 offset:4352
s_waitcnt lgkmcnt(6)
v_mfma_f32_16x16x32_bf16 v[88:91], a[8:11], v[72:75], v[88:91]
v_mfma_f32_16x16x32_bf16 v[92:95], a[136:139], v[72:75], v[92:95]
ds_read_b128 v[72:75], v16 offset:256
v_mfma_f32_16x16x32_bf16 v[96:99], a[8:11], v[76:79], v[96:99]
v_mfma_f32_16x16x32_bf16 v[100:103], a[136:139], v[76:79], v[100:103]
ds_read_b128 v[76:79], v16 offset:4352
s_waitcnt lgkmcnt(6)
v_mfma_f32_16x16x32_bf16 v[88:91], a[12:15], v[80:83], v[88:91]
buffer_load_dwordx4 v13, s[16:19], s29 offen offset:3072 lds
v_mfma_f32_16x16x32_bf16 v[92:95], a[140:143], v[80:83], v[92:95]
v_cvt_pk_bf16_f32 v120, v104, v105
ds_read_b128 v[80:83], v17 offset:256
v_mfma_f32_16x16x32_bf16 v[96:99], a[12:15], v[84:87], v[96:99]
v_cvt_pk_bf16_f32 v121, v106, v107
v_cvt_pk_bf16_f32 v122, v108, v109
v_mfma_f32_16x16x32_bf16 v[100:103], a[140:143], v[84:87], v[100:103]
ds_read_b128 v[84:87], v17 offset:4352
s_waitcnt lgkmcnt(6)
v_mfma_f32_16x16x32_bf16 v[88:91], a[16:19], v[56:59], v[88:91]
v_cvt_pk_bf16_f32 v123, v110, v111
buffer_store_dwordx4 v[120:123], v22, s[4:7], s40 offen offset:0 sc1
v_mfma_f32_16x16x32_bf16 v[92:95], a[144:147], v[56:59], v[92:95]
v_cvt_pk_bf16_f32 v124, v112, v113
ds_read_b128 v[56:59], v14 offset:512
v_mfma_f32_16x16x32_bf16 v[96:99], a[16:19], v[60:63], v[96:99]
v_cvt_pk_bf16_f32 v125, v114, v115
v_cvt_pk_bf16_f32 v126, v116, v117
v_mfma_f32_16x16x32_bf16 v[100:103], a[144:147], v[60:63], v[100:103]
ds_read_b128 v[60:63], v14 offset:4608
s_waitcnt lgkmcnt(6)
s_add_u32 m0, s44, 69632
s_add_u32 s29, s39, 73728
v_mfma_f32_16x16x32_bf16 v[88:91], a[20:23], v[64:67], v[88:91]
buffer_load_dwordx4 v10, s[16:19], s29 offen offset:0 lds
v_mfma_f32_16x16x32_bf16 v[92:95], a[148:151], v[64:67], v[92:95]
v_cvt_pk_bf16_f32 v127, v118, v119
ds_read_b128 v[64:67], v15 offset:512
v_mfma_f32_16x16x32_bf16 v[96:99], a[20:23], v[68:71], v[96:99]
buffer_store_dwordx4 v[36:39], v30, s[4:7], s40 offen sc1
buffer_store_dwordx4 v[124:127], v22, s[4:7], s40 offen offset:1024 sc1
v_mfma_f32_16x16x32_bf16 v[100:103], a[148:151], v[68:71], v[100:103]
ds_read_b128 v[68:71], v15 offset:4608
s_waitcnt lgkmcnt(6)
v_mfma_f32_16x16x32_bf16 v[88:91], a[24:27], v[72:75], v[88:91]
s_lshr_b32 s40, s47, 8
s_xor_b32 s40, s40, s56
v_mfma_f32_16x16x32_bf16 v[92:95], a[152:155], v[72:75], v[92:95]
s_and_b32 s40, s40, s55
ds_read_b128 v[72:75], v16 offset:512
v_mfma_f32_16x16x32_bf16 v[96:99], a[24:27], v[76:79], v[96:99]
s_or_b32 s40, s40, s47
s_add_u32 s47, s47, s36
v_mfma_f32_16x16x32_bf16 v[100:103], a[152:155], v[76:79], v[100:103]
ds_read_b128 v[76:79], v16 offset:4608
s_waitcnt lgkmcnt(6)
v_mfma_f32_16x16x32_bf16 v[88:91], a[28:31], v[80:83], v[88:91]
buffer_load_dwordx4 v11, s[16:19], s29 offen offset:1024 lds
v_mfma_f32_16x16x32_bf16 v[92:95], a[156:159], v[80:83], v[92:95]
ds_read_b128 v[80:83], v17 offset:512
v_mfma_f32_16x16x32_bf16 v[96:99], a[28:31], v[84:87], v[96:99]
v_mfma_f32_16x16x32_bf16 v[100:103], a[156:159], v[84:87], v[100:103]
ds_read_b128 v[84:87], v17 offset:4608
s_waitcnt lgkmcnt(6)
v_mfma_f32_16x16x32_bf16 v[88:91], a[32:35], v[56:59], v[88:91]
v_mfma_f32_16x16x32_bf16 v[92:95], a[160:163], v[56:59], v[92:95]
ds_read_b128 v[56:59], v14 offset:768
v_mfma_f32_16x16x32_bf16 v[96:99], a[32:35], v[60:63], v[96:99]
v_mfma_f32_16x16x32_bf16 v[100:103], a[160:163], v[60:63], v[100:103]
ds_read_b128 v[60:63], v14 offset:4864
s_waitcnt lgkmcnt(6)
v_mfma_f32_16x16x32_bf16 v[88:91], a[36:39], v[64:67], v[88:91]
buffer_load_dwordx4 v12, s[16:19], s29 offen offset:2048 lds
v_mfma_f32_16x16x32_bf16 v[92:95], a[164:167], v[64:67], v[92:95]
ds_read_b128 v[64:67], v15 offset:768
v_mfma_f32_16x16x32_bf16 v[96:99], a[36:39], v[68:71], v[96:99]
v_mfma_f32_16x16x32_bf16 v[100:103], a[164:167], v[68:71], v[100:103]
ds_read_b128 v[68:71], v15 offset:4864
s_waitcnt lgkmcnt(6)
v_mfma_f32_16x16x32_bf16 v[88:91], a[40:43], v[72:75], v[88:91]
v_mfma_f32_16x16x32_bf16 v[92:95], a[168:171], v[72:75], v[92:95]
ds_read_b128 v[72:75], v16 offset:768
v_mfma_f32_16x16x32_bf16 v[96:99], a[40:43], v[76:79], v[96:99]
v_mfma_f32_16x16x32_bf16 v[100:103], a[168:171], v[76:79], v[100:103]
ds_read_b128 v[76:79], v16 offset:4864
s_waitcnt lgkmcnt(6)
v_mfma_f32_16x16x32_bf16 v[88:91], a[44:47], v[80:83], v[88:91]
buffer_load_dwordx4 v13, s[16:19], s29 offen offset:3072 lds
v_mfma_f32_16x16x32_bf16 v[92:95], a[172:175], v[80:83], v[92:95]
ds_read_b128 v[80:83], v17 offset:768
v_mfma_f32_16x16x32_bf16 v[96:99], a[44:47], v[84:87], v[96:99]
v_mfma_f32_16x16x32_bf16 v[100:103], a[172:175], v[84:87], v[100:103]
ds_read_b128 v[84:87], v17 offset:4864
s_waitcnt vmcnt(11)
s_barrier
s_waitcnt lgkmcnt(6)
v_mfma_f32_16x16x32_bf16 v[88:91], a[48:51], v[56:59], v[88:91]
v_mfma_f32_16x16x32_bf16 v[92:95], a[176:179], v[56:59], v[92:95]
ds_read_b128 v[56:59], v14 offset:32768
v_mfma_f32_16x16x32_bf16 v[96:99], a[48:51], v[60:63], v[96:99]
v_mfma_f32_16x16x32_bf16 v[100:103], a[176:179], v[60:63], v[100:103]
ds_read_b128 v[60:63], v14 offset:36864
s_waitcnt lgkmcnt(6)
s_add_u32 m0, s44, 98304
s_add_u32 s29, s39, 66560
v_mfma_f32_16x16x32_bf16 v[88:91], a[52:55], v[64:67], v[88:91]
buffer_load_dwordx4 v10, s[16:19], s29 offen offset:0 lds
v_mfma_f32_16x16x32_bf16 v[92:95], a[180:183], v[64:67], v[92:95]
ds_read_b128 v[64:67], v15 offset:32768
v_mfma_f32_16x16x32_bf16 v[96:99], a[52:55], v[68:71], v[96:99]
v_mfma_f32_16x16x32_bf16 v[100:103], a[180:183], v[68:71], v[100:103]
ds_read_b128 v[68:71], v15 offset:36864
s_waitcnt lgkmcnt(6)
v_mfma_f32_16x16x32_bf16 v[88:91], a[56:59], v[72:75], v[88:91]
v_mfma_f32_16x16x32_bf16 v[92:95], a[184:187], v[72:75], v[92:95]
ds_read_b128 v[72:75], v16 offset:32768
v_mfma_f32_16x16x32_bf16 v[96:99], a[56:59], v[76:79], v[96:99]
v_mfma_f32_16x16x32_bf16 v[100:103], a[184:187], v[76:79], v[100:103]
ds_read_b128 v[76:79], v16 offset:36864
s_waitcnt lgkmcnt(6)
v_mfma_f32_16x16x32_bf16 v[88:91], a[60:63], v[80:83], v[88:91]
buffer_load_dwordx4 v11, s[16:19], s29 offen offset:1024 lds
v_mfma_f32_16x16x32_bf16 v[92:95], a[188:191], v[80:83], v[92:95]
ds_read_b128 v[80:83], v17 offset:32768
v_mfma_f32_16x16x32_bf16 v[96:99], a[60:63], v[84:87], v[96:99]
v_mfma_f32_16x16x32_bf16 v[100:103], a[188:191], v[84:87], v[100:103]
ds_read_b128 v[84:87], v17 offset:36864
s_waitcnt lgkmcnt(6)
v_mfma_f32_16x16x32_bf16 v[88:91], a[64:67], v[56:59], v[88:91]
v_mfma_f32_16x16x32_bf16 v[92:95], a[192:195], v[56:59], v[92:95]
ds_read_b128 v[56:59], v14 offset:33024
v_mfma_f32_16x16x32_bf16 v[96:99], a[64:67], v[60:63], v[96:99]
v_mfma_f32_16x16x32_bf16 v[100:103], a[192:195], v[60:63], v[100:103]
ds_read_b128 v[60:63], v14 offset:37120
s_waitcnt lgkmcnt(6)
v_mfma_f32_16x16x32_bf16 v[88:91], a[68:71], v[64:67], v[88:91]
buffer_load_dwordx4 v12, s[16:19], s29 offen offset:2048 lds
v_mfma_f32_16x16x32_bf16 v[92:95], a[196:199], v[64:67], v[92:95]
ds_read_b128 v[64:67], v15 offset:33024
v_mfma_f32_16x16x32_bf16 v[96:99], a[68:71], v[68:71], v[96:99]
v_mfma_f32_16x16x32_bf16 v[100:103], a[196:199], v[68:71], v[100:103]
ds_read_b128 v[68:71], v15 offset:37120
s_waitcnt lgkmcnt(6)
v_mfma_f32_16x16x32_bf16 v[88:91], a[72:75], v[72:75], v[88:91]
v_mfma_f32_16x16x32_bf16 v[92:95], a[200:203], v[72:75], v[92:95]
ds_read_b128 v[72:75], v16 offset:33024
v_mfma_f32_16x16x32_bf16 v[96:99], a[72:75], v[76:79], v[96:99]
v_mfma_f32_16x16x32_bf16 v[100:103], a[200:203], v[76:79], v[100:103]
ds_read_b128 v[76:79], v16 offset:37120
s_waitcnt lgkmcnt(6)
v_mfma_f32_16x16x32_bf16 v[88:91], a[76:79], v[80:83], v[88:91]
buffer_load_dwordx4 v13, s[16:19], s29 offen offset:3072 lds
v_mfma_f32_16x16x32_bf16 v[92:95], a[204:207], v[80:83], v[92:95]
ds_read_b128 v[80:83], v17 offset:33024
v_mfma_f32_16x16x32_bf16 v[96:99], a[76:79], v[84:87], v[96:99]
v_mfma_f32_16x16x32_bf16 v[100:103], a[204:207], v[84:87], v[100:103]
ds_read_b128 v[84:87], v17 offset:37120
s_waitcnt lgkmcnt(6)
v_mfma_f32_16x16x32_bf16 v[88:91], a[80:83], v[56:59], v[88:91]
s_cmp_lt_u32 s38, 64
s_cbranch_scc1 L_wpT12
s_sub_u32 s46, s38, 64
s_lshl_b32 s46, s46, 17
buffer_load_dword v26, v31, s[12:15], s46 offen
L_wpT12:
v_mfma_f32_16x16x32_bf16 v[92:95], a[208:211], v[56:59], v[92:95]
ds_read_b128 v[56:59], v14 offset:33280
v_mfma_f32_16x16x32_bf16 v[96:99], a[80:83], v[60:63], v[96:99]
v_mfma_f32_16x16x32_bf16 v[100:103], a[208:211], v[60:63], v[100:103]
ds_read_b128 v[60:63], v14 offset:37376
s_waitcnt lgkmcnt(6)
s_add_u32 m0, s44, 102400
s_add_u32 s29, s39, 74752
v_mfma_f32_16x16x32_bf16 v[88:91], a[84:87], v[64:67], v[88:91]
buffer_load_dwordx4 v10, s[16:19], s29 offen offset:0 lds
v_mfma_f32_16x16x32_bf16 v[92:95], a[212:215], v[64:67], v[92:95]
ds_read_b128 v[64:67], v15 offset:33280
v_mfma_f32_16x16x32_bf16 v[96:99], a[84:87], v[68:71], v[96:99]
v_mfma_f32_16x16x32_bf16 v[100:103], a[212:215], v[68:71], v[100:103]
ds_read_b128 v[68:71], v15 offset:37376
s_waitcnt lgkmcnt(6)
v_mfma_f32_16x16x32_bf16 v[88:91], a[88:91], v[72:75], v[88:91]
v_mfma_f32_16x16x32_bf16 v[92:95], a[216:219], v[72:75], v[92:95]
ds_read_b128 v[72:75], v16 offset:33280
v_mfma_f32_16x16x32_bf16 v[96:99], a[88:91], v[76:79], v[96:99]
v_mfma_f32_16x16x32_bf16 v[100:103], a[216:219], v[76:79], v[100:103]
ds_read_b128 v[76:79], v16 offset:37376
s_waitcnt lgkmcnt(6)
v_mfma_f32_16x16x32_bf16 v[88:91], a[92:95], v[80:83], v[88:91]
buffer_load_dwordx4 v11, s[16:19], s29 offen offset:1024 lds
v_mfma_f32_16x16x32_bf16 v[92:95], a[220:223], v[80:83], v[92:95]
ds_read_b128 v[80:83], v17 offset:33280
v_mfma_f32_16x16x32_bf16 v[96:99], a[92:95], v[84:87], v[96:99]
v_mfma_f32_16x16x32_bf16 v[100:103], a[220:223], v[84:87], v[100:103]
ds_read_b128 v[84:87], v17 offset:37376
s_waitcnt lgkmcnt(6)
v_mfma_f32_16x16x32_bf16 v[88:91], a[96:99], v[56:59], v[88:91]
v_mfma_f32_16x16x32_bf16 v[92:95], a[224:227], v[56:59], v[92:95]
ds_read_b128 v[56:59], v14 offset:33536
v_mfma_f32_16x16x32_bf16 v[96:99], a[96:99], v[60:63], v[96:99]
v_mfma_f32_16x16x32_bf16 v[100:103], a[224:227], v[60:63], v[100:103]
ds_read_b128 v[60:63], v14 offset:37632
s_waitcnt lgkmcnt(6)
v_mfma_f32_16x16x32_bf16 v[88:91], a[100:103], v[64:67], v[88:91]
buffer_load_dwordx4 v12, s[16:19], s29 offen offset:2048 lds
v_mfma_f32_16x16x32_bf16 v[92:95], a[228:231], v[64:67], v[92:95]
ds_read_b128 v[64:67], v15 offset:33536
v_mfma_f32_16x16x32_bf16 v[96:99], a[100:103], v[68:71], v[96:99]
v_mfma_f32_16x16x32_bf16 v[100:103], a[228:231], v[68:71], v[100:103]
ds_read_b128 v[68:71], v15 offset:37632
s_waitcnt lgkmcnt(6)
v_mfma_f32_16x16x32_bf16 v[88:91], a[104:107], v[72:75], v[88:91]
v_mfma_f32_16x16x32_bf16 v[92:95], a[232:235], v[72:75], v[92:95]
ds_read_b128 v[72:75], v16 offset:33536
v_mfma_f32_16x16x32_bf16 v[96:99], a[104:107], v[76:79], v[96:99]
v_mfma_f32_16x16x32_bf16 v[100:103], a[232:235], v[76:79], v[100:103]
ds_read_b128 v[76:79], v16 offset:37632
s_waitcnt lgkmcnt(6)
v_mfma_f32_16x16x32_bf16 v[88:91], a[108:111], v[80:83], v[88:91]
buffer_load_dwordx4 v13, s[16:19], s29 offen offset:3072 lds
v_mfma_f32_16x16x32_bf16 v[92:95], a[236:239], v[80:83], v[92:95]
ds_read_b128 v[80:83], v17 offset:33536
v_mfma_f32_16x16x32_bf16 v[96:99], a[108:111], v[84:87], v[96:99]
v_mfma_f32_16x16x32_bf16 v[100:103], a[236:239], v[84:87], v[100:103]
ds_read_b128 v[84:87], v17 offset:37632
s_waitcnt vmcnt(8)
s_barrier
s_waitcnt lgkmcnt(6)
v_mfma_f32_16x16x32_bf16 v[88:91], a[112:115], v[56:59], v[88:91]
s_add_u32 s38, s38, 1
v_mfma_f32_16x16x32_bf16 v[92:95], a[240:243], v[56:59], v[92:95]
ds_read_b128 v[56:59], v18 offset:0
v_mfma_f32_16x16x32_bf16 v[96:99], a[112:115], v[60:63], v[96:99]
v_mfma_f32_16x16x32_bf16 v[100:103], a[240:243], v[60:63], v[100:103]
ds_read_b128 v[60:63], v18 offset:4096
s_waitcnt lgkmcnt(6)
s_add_u32 m0, s44, 0
s_add_u32 s29, s39, 131072
v_mfma_f32_16x16x32_bf16 v[88:91], a[116:119], v[64:67], v[88:91]
buffer_load_dwordx4 v10, s[16:19], s29 offen offset:0 lds
v_mfma_f32_16x16x32_bf16 v[92:95], a[244:247], v[64:67], v[92:95]
ds_read_b128 v[64:67], v19 offset:0
v_mfma_f32_16x16x32_bf16 v[96:99], a[116:119], v[68:71], v[96:99]
v_mfma_f32_16x16x32_bf16 v[100:103], a[244:247], v[68:71], v[100:103]
ds_read_b128 v[68:71], v19 offset:4096
s_waitcnt lgkmcnt(6)
v_mfma_f32_16x16x32_bf16 v[88:91], a[120:123], v[72:75], v[88:91]
v_mfma_f32_16x16x32_bf16 v[92:95], a[248:251], v[72:75], v[92:95]
ds_read_b128 v[72:75], v20 offset:0
v_mfma_f32_16x16x32_bf16 v[96:99], a[120:123], v[76:79], v[96:99]
v_mfma_f32_16x16x32_bf16 v[100:103], a[248:251], v[76:79], v[100:103]
ds_read_b128 v[76:79], v20 offset:4096
s_waitcnt lgkmcnt(6)
v_mfma_f32_16x16x32_bf16 v[88:91], a[124:127], v[80:83], v[88:91]
buffer_load_dwordx4 v11, s[16:19], s29 offen offset:1024 lds
v_mfma_f32_16x16x32_bf16 v[92:95], a[252:255], v[80:83], v[92:95]
ds_read_b128 v[80:83], v21 offset:0
v_mfma_f32_16x16x32_bf16 v[96:99], a[124:127], v[84:87], v[96:99]
v_mfma_f32_16x16x32_bf16 v[100:103], a[252:255], v[84:87], v[100:103]
ds_read_b128 v[84:87], v21 offset:4096
s_cmp_eq_u32 s38, 64
s_cbranch_scc1 L_gx_T
s_waitcnt lgkmcnt(6)
v_mfma_f32_16x16x32_bf16 v[104:107], a[0:3], v[56:59], 0
v_mfma_f32_16x16x32_bf16 v[108:111], a[128:131], v[56:59], 0
ds_read_b128 v[56:59], v18 offset:256
v_mfma_f32_16x16x32_bf16 v[112:115], a[0:3], v[60:63], 0
v_mfma_f32_16x16x32_bf16 v[116:119], a[128:131], v[60:63], 0
ds_read_b128 v[60:63], v18 offset:4352
s_waitcnt lgkmcnt(6)
v_mfma_f32_16x16x32_bf16 v[104:107], a[4:7], v[64:67], v[104:107]
buffer_load_dwordx4 v12, s[16:19], s29 offen offset:2048 lds
v_mfma_f32_16x16x32_bf16 v[108:111], a[132:135], v[64:67], v[108:111]
ds_read_b128 v[64:67], v19 offset:256
v_mfma_f32_16x16x32_bf16 v[112:115], a[4:7], v[68:71], v[112:115]
v_mfma_f32_16x16x32_bf16 v[116:119], a[132:135], v[68:71], v[116:119]
ds_read_b128 v[68:71], v19 offset:4352
s_waitcnt lgkmcnt(6)
v_mfma_f32_16x16x32_bf16 v[104:107], a[8:11], v[72:75], v[104:107]
v_mfma_f32_16x16x32_bf16 v[108:111], a[136:139], v[72:75], v[108:111]
ds_read_b128 v[72:75], v20 offset:256
v_mfma_f32_16x16x32_bf16 v[112:115], a[8:11], v[76:79], v[112:115]
v_mfma_f32_16x16x32_bf16 v[116:119], a[136:139], v[76:79], v[116:119]
ds_read_b128 v[76:79], v20 offset:4352
s_waitcnt lgkmcnt(6)
v_mfma_f32_16x16x32_bf16 v[104:107], a[12:15], v[80:83], v[104:107]
buffer_load_dwordx4 v13, s[16:19], s29 offen offset:3072 lds
v_mfma_f32_16x16x32_bf16 v[108:111], a[140:143], v[80:83], v[108:111]
v_cvt_pk_bf16_f32 v120, v88, v89
ds_read_b128 v[80:83], v21 offset:256
v_mfma_f32_16x16x32_bf16 v[112:115], a[12:15], v[84:87], v[112:115]
v_cvt_pk_bf16_f32 v121, v90, v91
v_cvt_pk_bf16_f32 v122, v92, v93
v_mfma_f32_16x16x32_bf16 v[116:119], a[140:143], v[84:87], v[116:119]
ds_read_b128 v[84:87], v21 offset:4352
s_waitcnt lgkmcnt(6)
v_mfma_f32_16x16x32_bf16 v[104:107], a[16:19], v[56:59], v[104:107]
v_cvt_pk_bf16_f32 v123, v94, v95
buffer_store_dwordx4 v[120:123], v22, s[4:7], s40 offen offset:0 sc1
v_mfma_f32_16x16x32_bf16 v[108:111], a[144:147], v[56:59], v[108:111]
v_cvt_pk_bf16_f32 v124, v96, v97
ds_read_b128 v[56:59], v18 offset:512
v_mfma_f32_16x16x32_bf16 v[112:115], a[16:19], v[60:63], v[112:115]
v_cvt_pk_bf16_f32 v125, v98, v99
v_cvt_pk_bf16_f32 v126, v100, v101
v_mfma_f32_16x16x32_bf16 v[116:119], a[144:147], v[60:63], v[116:119]
ds_read_b128 v[60:63], v18 offset:4608
s_waitcnt lgkmcnt(6)
s_add_u32 m0, s44, 4096
s_add_u32 s29, s39, 139264
v_mfma_f32_16x16x32_bf16 v[104:107], a[20:23], v[64:67], v[104:107]
buffer_load_dwordx4 v10, s[16:19], s29 offen offset:0 lds
v_mfma_f32_16x16x32_bf16 v[108:111], a[148:151], v[64:67], v[108:111]
v_cvt_pk_bf16_f32 v127, v102, v103
ds_read_b128 v[64:67], v19 offset:512
v_mfma_f32_16x16x32_bf16 v[112:115], a[20:23], v[68:71], v[112:115]
buffer_store_dwordx4 v[36:39], v30, s[4:7], s40 offen sc1
buffer_store_dwordx4 v[124:127], v22, s[4:7], s40 offen offset:1024 sc1
v_mfma_f32_16x16x32_bf16 v[116:119], a[148:151], v[68:71], v[116:119]
ds_read_b128 v[68:71], v19 offset:4608
s_waitcnt lgkmcnt(6)
v_mfma_f32_16x16x32_bf16 v[104:107], a[24:27], v[72:75], v[104:107]
s_lshr_b32 s40, s47, 8
s_xor_b32 s40, s40, s56
v_mfma_f32_16x16x32_bf16 v[108:111], a[152:155], v[72:75], v[108:111]
s_and_b32 s40, s40, s55
ds_read_b128 v[72:75], v20 offset:512
v_mfma_f32_16x16x32_bf16 v[112:115], a[24:27], v[76:79], v[112:115]
s_or_b32 s40, s40, s47
s_add_u32 s47, s47, s36
v_mfma_f32_16x16x32_bf16 v[116:119], a[152:155], v[76:79], v[116:119]
ds_read_b128 v[76:79], v20 offset:4608
s_waitcnt lgkmcnt(6)
v_mfma_f32_16x16x32_bf16 v[104:107], a[28:31], v[80:83], v[104:107]
buffer_load_dwordx4 v11, s[16:19], s29 offen offset:1024 lds
v_mfma_f32_16x16x32_bf16 v[108:111], a[156:159], v[80:83], v[108:111]
ds_read_b128 v[80:83], v21 offset:512
v_mfma_f32_16x16x32_bf16 v[112:115], a[28:31], v[84:87], v[112:115]
v_mfma_f32_16x16x32_bf16 v[116:119], a[156:159], v[84:87], v[116:119]
ds_read_b128 v[84:87], v21 offset:4608
s_waitcnt lgkmcnt(6)
v_mfma_f32_16x16x32_bf16 v[104:107], a[32:35], v[56:59], v[104:107]
v_mfma_f32_16x16x32_bf16 v[108:111], a[160:163], v[56:59], v[108:111]
ds_read_b128 v[56:59], v18 offset:768
v_mfma_f32_16x16x32_bf16 v[112:115], a[32:35], v[60:63], v[112:115]
v_mfma_f32_16x16x32_bf16 v[116:119], a[160:163], v[60:63], v[116:119]
ds_read_b128 v[60:63], v18 offset:4864
s_waitcnt lgkmcnt(6)
v_mfma_f32_16x16x32_bf16 v[104:107], a[36:39], v[64:67], v[104:107]
buffer_load_dwordx4 v12, s[16:19], s29 offen offset:2048 lds
v_mfma_f32_16x16x32_bf16 v[108:111], a[164:167], v[64:67], v[108:111]
ds_read_b128 v[64:67], v19 offset:768
v_mfma_f32_16x16x32_bf16 v[112:115], a[36:39], v[68:71], v[112:115]
v_mfma_f32_16x16x32_bf16 v[116:119], a[164:167], v[68:71], v[116:119]
ds_read_b128 v[68:71], v19 offset:4864
s_waitcnt lgkmcnt(6)
v_mfma_f32_16x16x32_bf16 v[104:107], a[40:43], v[72:75], v[104:107]
v_mfma_f32_16x16x32_bf16 v[108:111], a[168:171], v[72:75], v[108:111]
ds_read_b128 v[72:75], v20 offset:768
v_mfma_f32_16x16x32_bf16 v[112:115], a[40:43], v[76:79], v[112:115]
v_mfma_f32_16x16x32_bf16 v[116:119], a[168:171], v[76:79], v[116:119]
ds_read_b128 v[76:79], v20 offset:4864
s_waitcnt lgkmcnt(6)
v_mfma_f32_16x16x32_bf16 v[104:107], a[44:47], v[80:83], v[104:107]
buffer_load_dwordx4 v13, s[16:19], s29 offen offset:3072 lds
v_mfma_f32_16x16x32_bf16 v[108:111], a[172:175], v[80:83], v[108:111]
ds_read_b128 v[80:83], v21 offset:768
v_mfma_f32_16x16x32_bf16 v[112:115], a[44:47], v[84:87], v[112:115]
v_mfma_f32_16x16x32_bf16 v[116:119], a[172:175], v[84:87], v[116:119]
ds_read_b128 v[84:87], v21 offset:4864
s_waitcnt vmcnt(11)
s_barrier
s_waitcnt lgkmcnt(6)
v_mfma_f32_16x16x32_bf16 v[104:107], a[48:51], v[56:59], v[104:107]
v_mfma_f32_16x16x32_bf16 v[108:111], a[176:179], v[56:59], v[108:111]
ds_read_b128 v[56:59], v18 offset:32768
v_mfma_f32_16x16x32_bf16 v[112:115], a[48:51], v[60:63], v[112:115]
v_mfma_f32_16x16x32_bf16 v[116:119], a[176:179], v[60:63], v[116:119]
ds_read_b128 v[60:63], v18 offset:36864
s_waitcnt lgkmcnt(6)
s_add_u32 m0, s44, 32768
s_add_u32 s29, s39, 132096
v_mfma_f32_16x16x32_bf16 v[104:107], a[52:55], v[64:67], v[104:107]
buffer_load_dwordx4 v10, s[16:19], s29 offen offset:0 lds
v_mfma_f32_16x16x32_bf16 v[108:111], a[180:183], v[64:67], v[108:111]
ds_read_b128 v[64:67], v19 offset:32768
v_mfma_f32_16x16x32_bf16 v[112:115], a[52:55], v[68:71], v[112:115]
v_mfma_f32_16x16x32_bf16 v[116:119], a[180:183], v[68:71], v[116:119]
ds_read_b128 v[68:71], v19 offset:36864
s_waitcnt lgkmcnt(6)
v_mfma_f32_16x16x32_bf16 v[104:107], a[56:59], v[72:75], v[104:107]
v_mfma_f32_16x16x32_bf16 v[108:111], a[184:187], v[72:75], v[108:111]
ds_read_b128 v[72:75], v20 offset:32768
v_mfma_f32_16x16x32_bf16 v[112:115], a[56:59], v[76:79], v[112:115]
v_mfma_f32_16x16x32_bf16 v[116:119], a[184:187], v[76:79], v[116:119]
ds_read_b128 v[76:79], v20 offset:36864
s_waitcnt lgkmcnt(6)
v_mfma_f32_16x16x32_bf16 v[104:107], a[60:63], v[80:83], v[104:107]
buffer_load_dwordx4 v11, s[16:19], s29 offen offset:1024 lds
v_mfma_f32_16x16x32_bf16 v[108:111], a[188:191], v[80:83], v[108:111]
ds_read_b128 v[80:83], v21 offset:32768
v_mfma_f32_16x16x32_bf16 v[112:115], a[60:63], v[84:87], v[112:115]
v_mfma_f32_16x16x32_bf16 v[116:119], a[188:191], v[84:87], v[116:119]
ds_read_b128 v[84:87], v21 offset:36864
s_waitcnt lgkmcnt(6)
v_mfma_f32_16x16x32_bf16 v[104:107], a[64:67], v[56:59], v[104:107]
v_mfma_f32_16x16x32_bf16 v[108:111], a[192:195], v[56:59], v[108:111]
ds_read_b128 v[56:59], v18 offset:33024
v_mfma_f32_16x16x32_bf16 v[112:115], a[64:67], v[60:63], v[112:115]
v_mfma_f32_16x16x32_bf16 v[116:119], a[192:195], v[60:63], v[116:119]
ds_read_b128 v[60:63], v18 offset:37120
s_waitcnt lgkmcnt(6)
v_mfma_f32_16x16x32_bf16 v[104:107], a[68:71], v[64:67], v[104:107]
buffer_load_dwordx4 v12, s[16:19], s29 offen offset:2048 lds
v_mfma_f32_16x16x32_bf16 v[108:111], a[196:199], v[64:67], v[108:111]
ds_read_b128 v[64:67], v19 offset:33024
v_mfma_f32_16x16x32_bf16 v[112:115], a[68:71], v[68:71], v[112:115]
v_mfma_f32_16x16x32_bf16 v[116:119], a[196:199], v[68:71], v[116:119]
ds_read_b128 v[68:71], v19 offset:37120
s_waitcnt lgkmcnt(6)
v_mfma_f32_16x16x32_bf16 v[104:107], a[72:75], v[72:75], v[104:107]
v_mfma_f32_16x16x32_bf16 v[108:111], a[200:203], v[72:75], v[108:111]
ds_read_b128 v[72:75], v20 offset:33024
v_mfma_f32_16x16x32_bf16 v[112:115], a[72:75], v[76:79], v[112:115]
v_mfma_f32_16x16x32_bf16 v[116:119], a[200:203], v[76:79], v[116:119]
ds_read_b128 v[76:79], v20 offset:37120
s_waitcnt lgkmcnt(6)
v_mfma_f32_16x16x32_bf16 v[104:107], a[76:79], v[80:83], v[104:107]
buffer_load_dwordx4 v13, s[16:19], s29 offen offset:3072 lds
v_mfma_f32_16x16x32_bf16 v[108:111], a[204:207], v[80:83], v[108:111]
ds_read_b128 v[80:83], v21 offset:33024
v_mfma_f32_16x16x32_bf16 v[112:115], a[76:79], v[84:87], v[112:115]
v_mfma_f32_16x16x32_bf16 v[116:119], a[204:207], v[84:87], v[116:119]
ds_read_b128 v[84:87], v21 offset:37120
s_waitcnt lgkmcnt(6)
v_mfma_f32_16x16x32_bf16 v[104:107], a[80:83], v[56:59], v[104:107]
s_cmp_lt_u32 s38, 64
s_cbranch_scc1 L_wpT32
s_sub_u32 s46, s38, 64
s_lshl_b32 s46, s46, 17
buffer_load_dword v26, v31, s[12:15], s46 offen
L_wpT32:
v_mfma_f32_16x16x32_bf16 v[108:111], a[208:211], v[56:59], v[108:111]
ds_read_b128 v[56:59], v18 offset:33280
v_mfma_f32_16x16x32_bf16 v[112:115], a[80:83], v[60:63], v[112:115]
v_mfma_f32_16x16x32_bf16 v[116:119], a[208:211], v[60:63], v[116:119]
ds_read_b128 v[60:63], v18 offset:37376
s_waitcnt lgkmcnt(6)
s_add_u32 m0, s44, 36864
s_add_u32 s29, s39, 140288
v_mfma_f32_16x16x32_bf16 v[104:107], a[84:87], v[64:67], v[104:107]
buffer_load_dwordx4 v10, s[16:19], s29 offen offset:0 lds
v_mfma_f32_16x16x32_bf16 v[108:111], a[212:215], v[64:67], v[108:111]
ds_read_b128 v[64:67], v19 offset:33280
v_mfma_f32_16x16x32_bf16 v[112:115], a[84:87], v[68:71], v[112:115]
v_mfma_f32_16x16x32_bf16 v[116:119], a[212:215], v[68:71], v[116:119]
ds_read_b128 v[68:71], v19 offset:37376
s_waitcnt lgkmcnt(6)
v_mfma_f32_16x16x32_bf16 v[104:107], a[88:91], v[72:75], v[104:107]
v_mfma_f32_16x16x32_bf16 v[108:111], a[216:219], v[72:75], v[108:111]
ds_read_b128 v[72:75], v20 offset:33280
v_mfma_f32_16x16x32_bf16 v[112:115], a[88:91], v[76:79], v[112:115]
v_mfma_f32_16x16x32_bf16 v[116:119], a[216:219], v[76:79], v[116:119]
ds_read_b128 v[76:79], v20 offset:37376
s_waitcnt lgkmcnt(6)
v_mfma_f32_16x16x32_bf16 v[104:107], a[92:95], v[80:83], v[104:107]
buffer_load_dwordx4 v11, s[16:19], s29 offen offset:1024 lds
v_mfma_f32_16x16x32_bf16 v[108:111], a[220:223], v[80:83], v[108:111]
ds_read_b128 v[80:83], v21 offset:33280
v_mfma_f32_16x16x32_bf16 v[112:115], a[92:95], v[84:87], v[112:115]
v_mfma_f32_16x16x32_bf16 v[116:119], a[220:223], v[84:87], v[116:119]
ds_read_b128 v[84:87], v21 offset:37376
s_waitcnt lgkmcnt(6)
v_mfma_f32_16x16x32_bf16 v[104:107], a[96:99], v[56:59], v[104:107]
v_mfma_f32_16x16x32_bf16 v[108:111], a[224:227], v[56:59], v[108:111]
ds_read_b128 v[56:59], v18 offset:33536
v_mfma_f32_16x16x32_bf16 v[112:115], a[96:99], v[60:63], v[112:115]
v_mfma_f32_16x16x32_bf16 v[116:119], a[224:227], v[60:63], v[116:119]
ds_read_b128 v[60:63], v18 offset:37632
s_waitcnt lgkmcnt(6)
v_mfma_f32_16x16x32_bf16 v[104:107], a[100:103], v[64:67], v[104:107]
buffer_load_dwordx4 v12, s[16:19], s29 offen offset:2048 lds
v_mfma_f32_16x16x32_bf16 v[108:111], a[228:231], v[64:67], v[108:111]
ds_read_b128 v[64:67], v19 offset:33536
v_mfma_f32_16x16x32_bf16 v[112:115], a[100:103], v[68:71], v[112:115]
v_mfma_f32_16x16x32_bf16 v[116:119], a[228:231], v[68:71], v[116:119]
ds_read_b128 v[68:71], v19 offset:37632
s_waitcnt lgkmcnt(6)
v_mfma_f32_16x16x32_bf16 v[104:107], a[104:107], v[72:75], v[104:107]
v_mfma_f32_16x16x32_bf16 v[108:111], a[232:235], v[72:75], v[108:111]
ds_read_b128 v[72:75], v20 offset:33536
v_mfma_f32_16x16x32_bf16 v[112:115], a[104:107], v[76:79], v[112:115]
v_mfma_f32_16x16x32_bf16 v[116:119], a[232:235], v[76:79], v[116:119]
ds_read_b128 v[76:79], v20 offset:37632
s_waitcnt lgkmcnt(6)
v_mfma_f32_16x16x32_bf16 v[104:107], a[108:111], v[80:83], v[104:107]
buffer_load_dwordx4 v13, s[16:19], s29 offen offset:3072 lds
v_mfma_f32_16x16x32_bf16 v[108:111], a[236:239], v[80:83], v[108:111]
ds_read_b128 v[80:83], v21 offset:33536
v_mfma_f32_16x16x32_bf16 v[112:115], a[108:111], v[84:87], v[112:115]
v_mfma_f32_16x16x32_bf16 v[116:119], a[236:239], v[84:87], v[116:119]
ds_read_b128 v[84:87], v21 offset:37632
s_waitcnt vmcnt(8)
s_barrier
s_waitcnt lgkmcnt(6)
v_mfma_f32_16x16x32_bf16 v[104:107], a[112:115], v[56:59], v[104:107]
s_add_u32 s38, s38, 1
v_mfma_f32_16x16x32_bf16 v[108:111], a[240:243], v[56:59], v[108:111]
ds_read_b128 v[56:59], v14 offset:0
v_mfma_f32_16x16x32_bf16 v[112:115], a[112:115], v[60:63], v[112:115]
v_mfma_f32_16x16x32_bf16 v[116:119], a[240:243], v[60:63], v[116:119]
ds_read_b128 v[60:63], v14 offset:4096
s_waitcnt lgkmcnt(6)
s_add_u32 m0, s44, 65536
s_add_u32 s29, s39, 196608
v_mfma_f32_16x16x32_bf16 v[104:107], a[116:119], v[64:67], v[104:107]
buffer_load_dwordx4 v10, s[16:19], s29 offen offset:0 lds
v_mfma_f32_16x16x32_bf16 v[108:111], a[244:247], v[64:67], v[108:111]
ds_read_b128 v[64:67], v15 offset:0
v_mfma_f32_16x16x32_bf16 v[112:115], a[116:119], v[68:71], v[112:115]
v_mfma_f32_16x16x32_bf16 v[116:119], a[244:247], v[68:71], v[116:119]
ds_read_b128 v[68:71], v15 offset:4096
s_waitcnt lgkmcnt(6)
v_mfma_f32_16x16x32_bf16 v[104:107], a[120:123], v[72:75], v[104:107]
v_mfma_f32_16x16x32_bf16 v[108:111], a[248:251], v[72:75], v[108:111]
ds_read_b128 v[72:75], v16 offset:0
v_mfma_f32_16x16x32_bf16 v[112:115], a[120:123], v[76:79], v[112:115]
v_mfma_f32_16x16x32_bf16 v[116:119], a[248:251], v[76:79], v[116:119]
ds_read_b128 v[76:79], v16 offset:4096
s_waitcnt lgkmcnt(6)
v_mfma_f32_16x16x32_bf16 v[104:107], a[124:127], v[80:83], v[104:107]
buffer_load_dwordx4 v11, s[16:19], s29 offen offset:1024 lds
v_mfma_f32_16x16x32_bf16 v[108:111], a[252:255], v[80:83], v[108:111]
ds_read_b128 v[80:83], v17 offset:0
v_mfma_f32_16x16x32_bf16 v[112:115], a[124:127], v[84:87], v[112:115]
v_mfma_f32_16x16x32_bf16 v[116:119], a[252:255], v[84:87], v[116:119]
ds_read_b128 v[84:87], v17 offset:4096
s_add_u32 s39, s39, 131072
s_cmp_eq_u32 s45, 1
s_cbranch_scc1 L_qhook
s_branch L_gl_T2
.p2align 6
L_gl_T3:
s_waitcnt lgkmcnt(6)
v_mfma_f32_16x16x32_bf16 v[88:91], a[0:3], v[56:59], 0
v_mfma_f32_16x16x32_bf16 v[92:95], a[128:131], v[56:59], 0
ds_read_b128 v[56:59], v14 offset:256
v_mfma_f32_16x16x32_bf16 v[96:99], a[0:3], v[60:63], 0
v_mfma_f32_16x16x32_bf16 v[100:103], a[128:131], v[60:63], 0
ds_read_b128 v[60:63], v14 offset:4352
s_waitcnt lgkmcnt(6)
v_mfma_f32_16x16x32_bf16 v[88:91], a[4:7], v[64:67], v[88:91]
v_mfma_f32_16x16x32_bf16 v[92:95], a[132:135], v[64:67], v[92:95]
ds_read_b128 v[64:67], v15 offset:256
v_mfma_f32_16x16x32_bf16 v[96:99], a[4:7], v[68:71], v[96:99]
buffer_load_dwordx4 v12, s[16:19], s29 offen offset:2048 lds
v_mfma_f32_16x16x32_bf16 v[100:103], a[132:135], v[68:71], v[100:103]
ds_read_b128 v[68:71], v15 offset:4352
s_waitcnt lgkmcnt(6)
v_mfma_f32_16x16x32_bf16 v[88:91], a[8:11], v[72:75], v[88:91]
v_mfma_f32_16x16x32_bf16 v[92:95], a[136:139], v[72:75], v[92:95]
ds_read_b128 v[72:75], v16 offset:256
v_mfma_f32_16x16x32_bf16 v[96:99], a[8:11], v[76:79], v[96:99]
v_mfma_f32_16x16x32_bf16 v[100:103], a[136:139], v[76:79], v[100:103]
ds_read_b128 v[76:79], v16 offset:4352
s_waitcnt lgkmcnt(6)
v_mfma_f32_16x16x32_bf16 v[88:91], a[12:15], v[80:83], v[88:91]
v_mfma_f32_16x16x32_bf16 v[92:95], a[140:143], v[80:83], v[92:95]
ds_read_b128 v[80:83], v17 offset:256
v_mfma_f32_16x16x32_bf16 v[96:99], a[12:15], v[84:87], v[96:99]
buffer_load_dwordx4 v13, s[16:19], s29 offen offset:3072 lds
v_mfma_f32_16x16x32_bf16 v[100:103], a[140:143], v[84:87], v[100:103]
ds_read_b128 v[84:87], v17 offset:4352
s_waitcnt lgkmcnt(6)
v_mfma_f32_16x16x32_bf16 v[88:91], a[16:19], v[56:59], v[88:91]
v_cvt_pk_bf16_f32 v120, v104, v105
v_cvt_pk_bf16_f32 v121, v106, v107
v_mfma_f32_16x16x32_bf16 v[92:95], a[144:147], v[56:59], v[92:95]
v_cvt_pk_bf16_f32 v122, v108, v109
ds_read_b128 v[56:59], v14 offset:512
v_mfma_f32_16x16x32_bf16 v[96:99], a[16:19], v[60:63], v[96:99]
v_cvt_pk_bf16_f32 v123, v110, v111
buffer_store_dwordx4 v[120:123], v22, s[4:7], s40 offen offset:0 sc1
v_mfma_f32_16x16x32_bf16 v[100:103], a[144:147], v[60:63], v[100:103]
ds_read_b128 v[60:63], v14 offset:4608
s_waitcnt lgkmcnt(6)
v_mfma_f32_16x16x32_bf16 v[88:91], a[20:23], v[64:67], v[88:91]
v_cvt_pk_bf16_f32 v124, v112, v113
v_cvt_pk_bf16_f32 v125, v114, v115
v_mfma_f32_16x16x32_bf16 v[92:95], a[148:151], v[64:67], v[92:95]
v_cvt_pk_bf16_f32 v126, v116, v117
ds_read_b128 v[64:67], v15 offset:512
s_add_u32 m0, s44, 69632
s_add_u32 s29, s39, 73728
v_mfma_f32_16x16x32_bf16 v[96:99], a[20:23], v[68:71], v[96:99]
buffer_load_dwordx4 v10, s[16:19], s29 offen offset:0 lds
v_mfma_f32_16x16x32_bf16 v[100:103], a[148:151], v[68:71], v[100:103]
ds_read_b128 v[68:71], v15 offset:4608
s_waitcnt lgkmcnt(6)
v_mfma_f32_16x16x32_bf16 v[88:91], a[24:27], v[72:75], v[88:91]
v_cvt_pk_bf16_f32 v127, v118, v119
buffer_store_dwordx4 v[36:39], v30, s[4:7], s40 offen sc1
v_mfma_f32_16x16x32_bf16 v[92:95], a[152:155], v[72:75], v[92:95]
buffer_store_dwordx4 v[124:127], v22, s[4:7], s40 offen offset:1024 sc1
ds_read_b128 v[72:75], v16 offset:512
v_mfma_f32_16x16x32_bf16 v[96:99], a[24:27], v[76:79], v[96:99]
s_lshr_b32 s40, s47, 8
s_xor_b32 s40, s40, s56
v_mfma_f32_16x16x32_bf16 v[100:103], a[152:155], v[76:79], v[100:103]
ds_read_b128 v[76:79], v16 offset:4608
s_waitcnt lgkmcnt(6)
v_mfma_f32_16x16x32_bf16 v[88:91], a[28:31], v[80:83], v[88:91]
s_and_b32 s40, s40, s55
s_or_b32 s40, s40, s47
v_mfma_f32_16x16x32_bf16 v[92:95], a[156:159], v[80:83], v[92:95]
s_add_u32 s47, s47, s36
ds_read_b128 v[80:83], v17 offset:512
v_mfma_f32_16x16x32_bf16 v[96:99], a[28:31], v[84:87], v[96:99]
buffer_load_dwordx4 v11, s[16:19], s29 offen offset:1024 lds
v_mfma_f32_16x16x32_bf16 v[100:103], a[156:159], v[84:87], v[100:103]
ds_read_b128 v[84:87], v17 offset:4608
s_waitcnt lgkmcnt(6)
v_mfma_f32_16x16x32_bf16 v[88:91], a[32:35], v[56:59], v[88:91]
v_mfma_f32_16x16x32_bf16 v[92:95], a[160:163], v[56:59], v[92:95]
ds_read_b128 v[56:59], v14 offset:768
v_mfma_f32_16x16x32_bf16 v[96:99], a[32:35], v[60:63], v[96:99]
v_mfma_f32_16x16x32_bf16 v[100:103], a[160:163], v[60:63], v[100:103]
ds_read_b128 v[60:63], v14 offset:4864
s_waitcnt lgkmcnt(6)
v_mfma_f32_16x16x32_bf16 v[88:91], a[36:39], v[64:67], v[88:91]
v_mfma_f32_16x16x32_bf16 v[92:95], a[164:167], v[64:67], v[92:95]
ds_read_b128 v[64:67], v15 offset:768
v_mfma_f32_16x16x32_bf16 v[96:99], a[36:39], v[68:71], v[96:99]
buffer_load_dwordx4 v12, s[16:19], s29 offen offset:2048 lds
v_mfma_f32_16x16x32_bf16 v[100:103], a[164:167], v[68:71], v[100:103]
ds_read_b128 v[68:71], v15 offset:4864
s_waitcnt lgkmcnt(6)
v_mfma_f32_16x16x32_bf16 v[88:91], a[40:43], v[72:75], v[88:91]
v_mfma_f32_16x16x32_bf16 v[92:95], a[168:171], v[72:75], v[92:95]
ds_read_b128 v[72:75], v16 offset:768
v_mfma_f32_16x16x32_bf16 v[96:99], a[40:43], v[76:79], v[96:99]
v_mfma_f32_16x16x32_bf16 v[100:103], a[168:171], v[76:79], v[100:103]
ds_read_b128 v[76:79], v16 offset:4864
s_waitcnt lgkmcnt(6)
v_mfma_f32_16x16x32_bf16 v[88:91], a[44:47], v[80:83], v[88:91]
v_mfma_f32_16x16x32_bf16 v[92:95], a[172:175], v[80:83], v[92:95]
ds_read_b128 v[80:83], v17 offset:768
v_mfma_f32_16x16x32_bf16 v[96:99], a[44:47], v[84:87], v[96:99]
buffer_load_dwordx4 v13, s[16:19], s29 offen offset:3072 lds
v_mfma_f32_16x16x32_bf16 v[100:103], a[172:175], v[84:87], v[100:103]
ds_read_b128 v[84:87], v17 offset:4864
s_waitcnt vmcnt(11)
s_barrier
s_waitcnt lgkmcnt(6)
v_mfma_f32_16x16x32_bf16 v[88:91], a[48:51], v[56:59], v[88:91]
v_mfma_f32_16x16x32_bf16 v[92:95], a[176:179], v[56:59], v[92:95]
ds_read_b128 v[56:59], v14 offset:32768
v_mfma_f32_16x16x32_bf16 v[96:99], a[48:51], v[60:63], v[96:99]
v_mfma_f32_16x16x32_bf16 v[100:103], a[176:179], v[60:63], v[100:103]
ds_read_b128 v[60:63], v14 offset:36864
s_waitcnt lgkmcnt(6)
v_mfma_f32_16x16x32_bf16 v[88:91], a[52:55], v[64:67], v[88:91]
v_mfma_f32_16x16x32_bf16 v[92:95], a[180:183], v[64:67], v[92:95]
ds_read_b128 v[64:67], v15 offset:32768
s_add_u32 m0, s44, 98304
s_add_u32 s29, s39, 66560
v_mfma_f32_16x16x32_bf16 v[96:99], a[52:55], v[68:71], v[96:99]
buffer_load_dwordx4 v10, s[16:19], s29 offen offset:0 lds
v_mfma_f32_16x16x32_bf16 v[100:103], a[180:183], v[68:71], v[100:103]
ds_read_b128 v[68:71], v15 offset:36864
s_waitcnt lgkmcnt(6)
v_mfma_f32_16x16x32_bf16 v[88:91], a[56:59], v[72:75], v[88:91]
v_mfma_f32_16x16x32_bf16 v[92:95], a[184:187], v[72:75], v[92:95]
ds_read_b128 v[72:75], v16 offset:32768
v_mfma_f32_16x16x32_bf16 v[96:99], a[56:59], v[76:79], v[96:99]
v_mfma_f32_16x16x32_bf16 v[100:103], a[184:187], v[76:79], v[100:103]
ds_read_b128 v[76:79], v16 offset:36864
s_waitcnt lgkmcnt(6)
v_mfma_f32_16x16x32_bf16 v[88:91], a[60:63], v[80:83], v[88:91]
v_mfma_f32_16x16x32_bf16 v[92:95], a[188:191], v[80:83], v[92:95]
ds_read_b128 v[80:83], v17 offset:32768
v_mfma_f32_16x16x32_bf16 v[96:99], a[60:63], v[84:87], v[96:99]
buffer_load_dwordx4 v11, s[16:19], s29 offen offset:1024 lds
v_mfma_f32_16x16x32_bf16 v[100:103], a[188:191], v[84:87], v[100:103]
ds_read_b128 v[84:87], v17 offset:36864
s_waitcnt lgkmcnt(6)
v_mfma_f32_16x16x32_bf16 v[88:91], a[64:67], v[56:59], v[88:91]
v_mfma_f32_16x16x32_bf16 v[92:95], a[192:195], v[56:59], v[92:95]
ds_read_b128 v[56:59], v14 offset:33024
v_mfma_f32_16x16x32_bf16 v[96:99], a[64:67], v[60:63], v[96:99]
v_mfma_f32_16x16x32_bf16 v[100:103], a[192:195], v[60:63], v[100:103]
ds_read_b128 v[60:63], v14 offset:37120
s_waitcnt lgkmcnt(6)
v_mfma_f32_16x16x32_bf16 v[88:91], a[68:71], v[64:67], v[88:91]
v_mfma_f32_16x16x32_bf16 v[92:95], a[196:199], v[64:67], v[92:95]
ds_read_b128 v[64:67], v15 offset:33024
v_mfma_f32_16x16x32_bf16 v[96:99], a[68:71], v[68:71], v[96:99]
buffer_load_dwordx4 v12, s[16:19], s29 offen offset:2048 lds
v_mfma_f32_16x16x32_bf16 v[100:103], a[196:199], v[68:71], v[100:103]
ds_read_b128 v[68:71], v15 offset:37120
s_waitcnt lgkmcnt(6)
v_mfma_f32_16x16x32_bf16 v[88:91], a[72:75], v[72:75], v[88:91]
v_mfma_f32_16x16x32_bf16 v[92:95], a[200:203], v[72:75], v[92:95]
ds_read_b128 v[72:75], v16 offset:33024
v_mfma_f32_16x16x32_bf16 v[96:99], a[72:75], v[76:79], v[96:99]
v_mfma_f32_16x16x32_bf16 v[100:103], a[200:203], v[76:79], v[100:103]
ds_read_b128 v[76:79], v16 offset:37120
s_waitcnt lgkmcnt(6)
v_mfma_f32_16x16x32_bf16 v[88:91], a[76:79], v[80:83], v[88:91]
v_mfma_f32_16x16x32_bf16 v[92:95], a[204:207], v[80:83], v[92:95]
ds_read_b128 v[80:83], v17 offset:33024
v_mfma_f32_16x16x32_bf16 v[96:99], a[76:79], v[84:87], v[96:99]
buffer_load_dwordx4 v13, s[16:19], s29 offen offset:3072 lds
v_mfma_f32_16x16x32_bf16 v[100:103], a[204:207], v[84:87], v[100:103]
ds_read_b128 v[84:87], v17 offset:37120
s_waitcnt lgkmcnt(6)
v_mfma_f32_16x16x32_bf16 v[88:91], a[80:83], v[56:59], v[88:91]
s_cmp_lt_u32 s38, 64
s_cbranch_scc1 L_wpT13
s_sub_u32 s46, s38, 64
s_lshl_b32 s46, s46, 17
buffer_load_dword v26, v31, s[12:15], s46 offen
L_wpT13:
v_mfma_f32_16x16x32_bf16 v[92:95], a[208:211], v[56:59], v[92:95]
ds_read_b128 v[56:59], v14 offset:33280
v_mfma_f32_16x16x32_bf16 v[96:99], a[80:83], v[60:63], v[96:99]
v_mfma_f32_16x16x32_bf16 v[100:103], a[208:211], v[60:63], v[100:103]
ds_read_b128 v[60:63], v14 offset:37376
s_waitcnt lgkmcnt(6)
v_mfma_f32_16x16x32_bf16 v[88:91], a[84:87], v[64:67], v[88:91]
v_mfma_f32_16x16x32_bf16 v[92:95], a[212:215], v[64:67], v[92:95]
ds_read_b128 v[64:67], v15 offset:33280
s_add_u32 m0, s44, 102400
s_add_u32 s29, s39, 74752
v_mfma_f32_16x16x32_bf16 v[96:99], a[84:87], v[68:71], v[96:99]
buffer_load_dwordx4 v10, s[16:19], s29 offen offset:0 lds
v_mfma_f32_16x16x32_bf16 v[100:103], a[212:215], v[68:71], v[100:103]
ds_read_b128 v[68:71], v15 offset:37376
s_waitcnt lgkmcnt(6)
v_mfma_f32_16x16x32_bf16 v[88:91], a[88:91], v[72:75], v[88:91]
v_mfma_f32_16x16x32_bf16 v[92:95], a[216:219], v[72:75], v[92:95]
ds_read_b128 v[72:75], v16 offset:33280
v_mfma_f32_16x16x32_bf16 v[96:99], a[88:91], v[76:79], v[96:99]
v_mfma_f32_16x16x32_bf16 v[100:103], a[216:219], v[76:79], v[100:103]
ds_read_b128 v[76:79], v16 offset:37376
s_waitcnt lgkmcnt(6)
v_mfma_f32_16x16x32_bf16 v[88:91], a[92:95], v[80:83], v[88:91]
v_mfma_f32_16x16x32_bf16 v[92:95], a[220:223], v[80:83], v[92:95]
ds_read_b128 v[80:83], v17 offset:33280
v_mfma_f32_16x16x32_bf16 v[96:99], a[92:95], v[84:87], v[96:99]
buffer_load_dwordx4 v11, s[16:19], s29 offen offset:1024 lds
v_mfma_f32_16x16x32_bf16 v[100:103], a[220:223], v[84:87], v[100:103]
ds_read_b128 v[84:87], v17 offset:37376
s_waitcnt lgkmcnt(6)
v_mfma_f32_16x16x32_bf16 v[88:91], a[96:99], v[56:59], v[88:91]
v_mfma_f32_16x16x32_bf16 v[92:95], a[224:227], v[56:59], v[92:95]
ds_read_b128 v[56:59], v14 offset:33536
v_mfma_f32_16x16x32_bf16 v[96:99], a[96:99], v[60:63], v[96:99]
v_mfma_f32_16x16x32_bf16 v[100:103], a[224:227], v[60:63], v[100:103]
ds_read_b128 v[60:63], v14 offset:37632
s_waitcnt lgkmcnt(6)
v_mfma_f32_16x16x32_bf16 v[88:91], a[100:103], v[64:67], v[88:91]
v_mfma_f32_16x16x32_bf16 v[92:95], a[228:231], v[64:67], v[92:95]
ds_read_b128 v[64:67], v15 offset:33536
v_mfma_f32_16x16x32_bf16 v[96:99], a[100:103], v[68:71], v[96:99]
buffer_load_dwordx4 v12, s[16:19], s29 offen offset:2048 lds
v_mfma_f32_16x16x32_bf16 v[100:103], a[228:231], v[68:71], v[100:103]
ds_read_b128 v[68:71], v15 offset:37632
s_waitcnt lgkmcnt(6)
v_mfma_f32_16x16x32_bf16 v[88:91], a[104:107], v[72:75], v[88:91]
v_mfma_f32_16x16x32_bf16 v[92:95], a[232:235], v[72:75], v[92:95]
ds_read_b128 v[72:75], v16 offset:33536
v_mfma_f32_16x16x32_bf16 v[96:99], a[104:107], v[76:79], v[96:99]
v_mfma_f32_16x16x32_bf16 v[100:103], a[232:235], v[76:79], v[100:103]
ds_read_b128 v[76:79], v16 offset:37632
s_waitcnt lgkmcnt(6)
v_mfma_f32_16x16x32_bf16 v[88:91], a[108:111], v[80:83], v[88:91]
v_mfma_f32_16x16x32_bf16 v[92:95], a[236:239], v[80:83], v[92:95]
ds_read_b128 v[80:83], v17 offset:33536
v_mfma_f32_16x16x32_bf16 v[96:99], a[108:111], v[84:87], v[96:99]
buffer_load_dwordx4 v13, s[16:19], s29 offen offset:3072 lds
v_mfma_f32_16x16x32_bf16 v[100:103], a[236:239], v[84:87], v[100:103]
ds_read_b128 v[84:87], v17 offset:37632
s_waitcnt vmcnt(8)
s_barrier
s_waitcnt lgkmcnt(6)
v_mfma_f32_16x16x32_bf16 v[88:91], a[112:115], v[56:59], v[88:91]
s_add_u32 s38, s38, 1
v_mfma_f32_16x16x32_bf16 v[92:95], a[240:243], v[56:59], v[92:95]
ds_read_b128 v[56:59], v18 offset:0
v_mfma_f32_16x16x32_bf16 v[96:99], a[112:115], v[60:63], v[96:99]
v_mfma_f32_16x16x32_bf16 v[100:103], a[240:243], v[60:63], v[100:103]
ds_read_b128 v[60:63], v18 offset:4096
s_waitcnt lgkmcnt(6)
v_mfma_f32_16x16x32_bf16 v[88:91], a[116:119], v[64:67], v[88:91]
v_mfma_f32_16x16x32_bf16 v[92:95], a[244:247], v[64:67], v[92:95]
ds_read_b128 v[64:67], v19 offset:0
s_add_u32 m0, s44, 0
s_add_u32 s29, s39, 131072
v_mfma_f32_16x16x32_bf16 v[96:99], a[116:119], v[68:71], v[96:99]
buffer_load_dwordx4 v10, s[16:19], s29 offen offset:0 lds
v_mfma_f32_16x16x32_bf16 v[100:103], a[244:247], v[68:71], v[100:103]
ds_read_b128 v[68:71], v19 offset:4096
s_waitcnt lgkmcnt(6)
v_mfma_f32_16x16x32_bf16 v[88:91], a[120:123], v[72:75], v[88:91]
v_mfma_f32_16x16x32_bf16 v[92:95], a[248:251], v[72:75], v[92:95]
ds_read_b128 v[72:75], v20 offset:0
v_mfma_f32_16x16x32_bf16 v[96:99], a[120:123], v[76:79], v[96:99]
v_mfma_f32_16x16x32_bf16 v[100:103], a[248:251], v[76:79], v[100:103]
ds_read_b128 v[76:79], v20 offset:4096
s_waitcnt lgkmcnt(6)
v_mfma_f32_16x16x32_bf16 v[88:91], a[124:127], v[80:83], v[88:91]
v_mfma_f32_16x16x32_bf16 v[92:95], a[252:255], v[80:83], v[92:95]
ds_read_b128 v[80:83], v21 offset:0
v_mfma_f32_16x16x32_bf16 v[96:99], a[124:127], v[84:87], v[96:99]
buffer_load_dwordx4 v11, s[16:19], s29 offen offset:1024 lds
v_mfma_f32_16x16x32_bf16 v[100:103], a[252:255], v[84:87], v[100:103]
ds_read_b128 v[84:87], v21 offset:4096
s_cmp_eq_u32 s38, 64
s_cbranch_scc1 L_gx_T
s_waitcnt lgkmcnt(6)
v_mfma_f32_16x16x32_bf16 v[104:107], a[0:3], v[56:59], 0
v_mfma_f32_16x16x32_bf16 v[108:111], a[128:131], v[56:59], 0
ds_read_b128 v[56:59], v18 offset:256
v_mfma_f32_16x16x32_bf16 v[112:115], a[0:3], v[60:63], 0
v_mfma_f32_16x16x32_bf16 v[116:119], a[128:131], v[60:63], 0
ds_read_b128 v[60:63], v18 offset:4352
s_waitcnt lgkmcnt(6)
v_mfma_f32_16x16x32_bf16 v[104:107], a[4:7], v[64:67], v[104:107]
v_mfma_f32_16x16x32_bf16 v[108:111], a[132:135], v[64:67], v[108:111]
ds_read_b128 v[64:67], v19 offset:256
v_mfma_f32_16x16x32_bf16 v[112:115], a[4:7], v[68:71], v[112:115]
buffer_load_dwordx4 v12, s[16:19], s29 offen offset:2048 lds
v_mfma_f32_16x16x32_bf16 v[116:119], a[132:135], v[68:71], v[116:119]
ds_read_b128 v[68:71], v19 offset:4352
s_waitcnt lgkmcnt(6)
v_mfma_f32_16x16x32_bf16 v[104:107], a[8:11], v[72:75], v[104:107]
v_mfma_f32_16x16x32_bf16 v[108:111], a[136:139], v[72:75], v[108:111]
ds_read_b128 v[72:75], v20 offset:256
v_mfma_f32_16x16x32_bf16 v[112:115], a[8:11], v[76:79], v[112:115]
v_mfma_f32_16x16x32_bf16 v[116:119], a[136:139], v[76:79], v[116:119]
ds_read_b128 v[76:79], v20 offset:4352
s_waitcnt lgkmcnt(6)
v_mfma_f32_16x16x32_bf16 v[104:107], a[12:15], v[80:83], v[104:107]
v_mfma_f32_16x16x32_bf16 v[108:111], a[140:143], v[80:83], v[108:111]
ds_read_b128 v[80:83], v21 offset:256
v_mfma_f32_16x16x32_bf16 v[112:115], a[12:15], v[84:87], v[112:115]
buffer_load_dwordx4 v13, s[16:19], s29 offen offset:3072 lds
v_mfma_f32_16x16x32_bf16 v[116:119], a[140:143], v[84:87], v[116:119]
ds_read_b128 v[84:87], v21 offset:4352
s_waitcnt lgkmcnt(6)
v_mfma_f32_16x16x32_bf16 v[104:107], a[16:19], v[56:59], v[104:107]
v_cvt_pk_bf16_f32 v120, v88, v89
v_cvt_pk_bf16_f32 v121, v90, v91
v_mfma_f32_16x16x32_bf16 v[108:111], a[144:147], v[56:59], v[108:111]
v_cvt_pk_bf16_f32 v122, v92, v93
ds_read_b128 v[56:59], v18 offset:512
v_mfma_f32_16x16x32_bf16 v[112:115], a[16:19], v[60:63], v[112:115]
v_cvt_pk_bf16_f32 v123, v94, v95
buffer_store_dwordx4 v[120:123], v22, s[4:7], s40 offen offset:0 sc1
v_mfma_f32_16x16x32_bf16 v[116:119], a[144:147], v[60:63], v[116:119]
ds_read_b128 v[60:63], v18 offset:4608
s_waitcnt lgkmcnt(6)
v_mfma_f32_16x16x32_bf16 v[104:107], a[20:23], v[64:67], v[104:107]
v_cvt_pk_bf16_f32 v124, v96, v97
v_cvt_pk_bf16_f32 v125, v98, v99
v_mfma_f32_16x16x32_bf16 v[108:111], a[148:151], v[64:67], v[108:111]
v_cvt_pk_bf16_f32 v126, v100, v101
ds_read_b128 v[64:67], v19 offset:512
s_add_u32 m0, s44, 4096
s_add_u32 s29, s39, 139264
v_mfma_f32_16x16x32_bf16 v[112:115], a[20:23], v[68:71], v[112:115]
buffer_load_dwordx4 v10, s[16:19], s29 offen offset:0 lds
v_mfma_f32_16x16x32_bf16 v[116:119], a[148:151], v[68:71], v[116:119]
ds_read_b128 v[68:71], v19 offset:4608
s_waitcnt lgkmcnt(6)
v_mfma_f32_16x16x32_bf16 v[104:107], a[24:27], v[72:75], v[104:107]
v_cvt_pk_bf16_f32 v127, v102, v103
buffer_store_dwordx4 v[36:39], v30, s[4:7], s40 offen sc1
v_mfma_f32_16x16x32_bf16 v[108:111], a[152:155], v[72:75], v[108:111]
buffer_store_dwordx4 v[124:127], v22, s[4:7], s40 offen offset:1024 sc1
ds_read_b128 v[72:75], v20 offset:512
v_mfma_f32_16x16x32_bf16 v[112:115], a[24:27], v[76:79], v[112:115]
s_lshr_b32 s40, s47, 8
s_xor_b32 s40, s40, s56
v_mfma_f32_16x16x32_bf16 v[116:119], a[152:155], v[76:79], v[116:119]
ds_read_b128 v[76:79], v20 offset:4608
s_waitcnt lgkmcnt(6)
v_mfma_f32_16x16x32_bf16 v[104:107], a[28:31], v[80:83], v[104:107]
s_and_b32 s40, s40, s55
s_or_b32 s40, s40, s47
v_mfma_f32_16x16x32_bf16 v[108:111], a[156:159], v[80:83], v[108:111]
s_add_u32 s47, s47, s36
ds_read_b128 v[80:83], v21 offset:512
v_mfma_f32_16x16x32_bf16 v[112:115], a[28:31], v[84:87], v[112:115]
buffer_load_dwordx4 v11, s[16:19], s29 offen offset:1024 lds
v_mfma_f32_16x16x32_bf16 v[116:119], a[156:159], v[84:87], v[116:119]
ds_read_b128 v[84:87], v21 offset:4608
s_waitcnt lgkmcnt(6)
v_mfma_f32_16x16x32_bf16 v[104:107], a[32:35], v[56:59], v[104:107]
v_mfma_f32_16x16x32_bf16 v[108:111], a[160:163], v[56:59], v[108:111]
ds_read_b128 v[56:59], v18 offset:768
v_mfma_f32_16x16x32_bf16 v[112:115], a[32:35], v[60:63], v[112:115]
v_mfma_f32_16x16x32_bf16 v[116:119], a[160:163], v[60:63], v[116:119]
ds_read_b128 v[60:63], v18 offset:4864
s_waitcnt lgkmcnt(6)
v_mfma_f32_16x16x32_bf16 v[104:107], a[36:39], v[64:67], v[104:107]
v_mfma_f32_16x16x32_bf16 v[108:111], a[164:167], v[64:67], v[108:111]
ds_read_b128 v[64:67], v19 offset:768
v_mfma_f32_16x16x32_bf16 v[112:115], a[36:39], v[68:71], v[112:115]
buffer_load_dwordx4 v12, s[16:19], s29 offen offset:2048 lds
v_mfma_f32_16x16x32_bf16 v[116:119], a[164:167], v[68:71], v[116:119]
ds_read_b128 v[68:71], v19 offset:4864
s_waitcnt lgkmcnt(6)
v_mfma_f32_16x16x32_bf16 v[104:107], a[40:43], v[72:75], v[104:107]
v_mfma_f32_16x16x32_bf16 v[108:111], a[168:171], v[72:75], v[108:111]
ds_read_b128 v[72:75], v20 offset:768
v_mfma_f32_16x16x32_bf16 v[112:115], a[40:43], v[76:79], v[112:115]
v_mfma_f32_16x16x32_bf16 v[116:119], a[168:171], v[76:79], v[116:119]
ds_read_b128 v[76:79], v20 offset:4864
s_waitcnt lgkmcnt(6)
v_mfma_f32_16x16x32_bf16 v[104:107], a[44:47], v[80:83], v[104:107]
v_mfma_f32_16x16x32_bf16 v[108:111], a[172:175], v[80:83], v[108:111]
ds_read_b128 v[80:83], v21 offset:768
v_mfma_f32_16x16x32_bf16 v[112:115], a[44:47], v[84:87], v[112:115]
buffer_load_dwordx4 v13, s[16:19], s29 offen offset:3072 lds
v_mfma_f32_16x16x32_bf16 v[116:119], a[172:175], v[84:87], v[116:119]
ds_read_b128 v[84:87], v21 offset:4864
s_waitcnt vmcnt(11)
s_barrier
s_waitcnt lgkmcnt(6)
v_mfma_f32_16x16x32_bf16 v[104:107], a[48:51], v[56:59], v[104:107]
v_mfma_f32_16x16x32_bf16 v[108:111], a[176:179], v[56:59], v[108:111]
ds_read_b128 v[56:59], v18 offset:32768
v_mfma_f32_16x16x32_bf16 v[112:115], a[48:51], v[60:63], v[112:115]
v_mfma_f32_16x16x32_bf16 v[116:119], a[176:179], v[60:63], v[116:119]
ds_read_b128 v[60:63], v18 offset:36864
s_waitcnt lgkmcnt(6)
v_mfma_f32_16x16x32_bf16 v[104:107], a[52:55], v[64:67], v[104:107]
v_mfma_f32_16x16x32_bf16 v[108:111], a[180:183], v[64:67], v[108:111]
ds_read_b128 v[64:67], v19 offset:32768
s_add_u32 m0, s44, 32768
s_add_u32 s29, s39, 132096
v_mfma_f32_16x16x32_bf16 v[112:115], a[52:55], v[68:71], v[112:115]
buffer_load_dwordx4 v10, s[16:19], s29 offen offset:0 lds
v_mfma_f32_16x16x32_bf16 v[116:119], a[180:183], v[68:71], v[116:119]
ds_read_b128 v[68:71], v19 offset:36864
s_waitcnt lgkmcnt(6)
v_mfma_f32_16x16x32_bf16 v[104:107], a[56:59], v[72:75], v[104:107]
v_mfma_f32_16x16x32_bf16 v[108:111], a[184:187], v[72:75], v[108:111]
ds_read_b128 v[72:75], v20 offset:32768
v_mfma_f32_16x16x32_bf16 v[112:115], a[56:59], v[76:79], v[112:115]
v_mfma_f32_16x16x32_bf16 v[116:119], a[184:187], v[76:79], v[116:119]
ds_read_b128 v[76:79], v20 offset:36864
s_waitcnt lgkmcnt(6)
v_mfma_f32_16x16x32_bf16 v[104:107], a[60:63], v[80:83], v[104:107]
v_mfma_f32_16x16x32_bf16 v[108:111], a[188:191], v[80:83], v[108:111]
ds_read_b128 v[80:83], v21 offset:32768
v_mfma_f32_16x16x32_bf16 v[112:115], a[60:63], v[84:87], v[112:115]
buffer_load_dwordx4 v11, s[16:19], s29 offen offset:1024 lds
v_mfma_f32_16x16x32_bf16 v[116:119], a[188:191], v[84:87], v[116:119]
ds_read_b128 v[84:87], v21 offset:36864
s_waitcnt lgkmcnt(6)
v_mfma_f32_16x16x32_bf16 v[104:107], a[64:67], v[56:59], v[104:107]
v_mfma_f32_16x16x32_bf16 v[108:111], a[192:195], v[56:59], v[108:111]
ds_read_b128 v[56:59], v18 offset:33024
v_mfma_f32_16x16x32_bf16 v[112:115], a[64:67], v[60:63], v[112:115]
v_mfma_f32_16x16x32_bf16 v[116:119], a[192:195], v[60:63], v[116:119]
ds_read_b128 v[60:63], v18 offset:37120
s_waitcnt lgkmcnt(6)
v_mfma_f32_16x16x32_bf16 v[104:107], a[68:71], v[64:67], v[104:107]
v_mfma_f32_16x16x32_bf16 v[108:111], a[196:199], v[64:67], v[108:111]
ds_read_b128 v[64:67], v19 offset:33024
v_mfma_f32_16x16x32_bf16 v[112:115], a[68:71], v[68:71], v[112:115]
buffer_load_dwordx4 v12, s[16:19], s29 offen offset:2048 lds
v_mfma_f32_16x16x32_bf16 v[116:119], a[196:199], v[68:71], v[116:119]
ds_read_b128 v[68:71], v19 offset:37120
s_waitcnt lgkmcnt(6)
v_mfma_f32_16x16x32_bf16 v[104:107], a[72:75], v[72:75], v[104:107]
v_mfma_f32_16x16x32_bf16 v[108:111], a[200:203], v[72:75], v[108:111]
ds_read_b128 v[72:75], v20 offset:33024
v_mfma_f32_16x16x32_bf16 v[112:115], a[72:75], v[76:79], v[112:115]
v_mfma_f32_16x16x32_bf16 v[116:119], a[200:203], v[76:79], v[116:119]
ds_read_b128 v[76:79], v20 offset:37120
s_waitcnt lgkmcnt(6)
v_mfma_f32_16x16x32_bf16 v[104:107], a[76:79], v[80:83], v[104:107]
v_mfma_f32_16x16x32_bf16 v[108:111], a[204:207], v[80:83], v[108:111]
ds_read_b128 v[80:83], v21 offset:33024
v_mfma_f32_16x16x32_bf16 v[112:115], a[76:79], v[84:87], v[112:115]
buffer_load_dwordx4 v13, s[16:19], s29 offen offset:3072 lds
v_mfma_f32_16x16x32_bf16 v[116:119], a[204:207], v[84:87], v[116:119]
ds_read_b128 v[84:87], v21 offset:37120
s_waitcnt lgkmcnt(6)
v_mfma_f32_16x16x32_bf16 v[104:107], a[80:83], v[56:59], v[104:107]
s_cmp_lt_u32 s38, 64
s_cbranch_scc1 L_wpT33
s_sub_u32 s46, s38, 64
s_lshl_b32 s46, s46, 17
buffer_load_dword v26, v31, s[12:15], s46 offen
L_wpT33:
v_mfma_f32_16x16x32_bf16 v[108:111], a[208:211], v[56:59], v[108:111]
ds_read_b128 v[56:59], v18 offset:33280
v_mfma_f32_16x16x32_bf16 v[112:115], a[80:83], v[60:63], v[112:115]
v_mfma_f32_16x16x32_bf16 v[116:119], a[208:211], v[60:63], v[116:119]
ds_read_b128 v[60:63], v18 offset:37376
s_waitcnt lgkmcnt(6)
v_mfma_f32_16x16x32_bf16 v[104:107], a[84:87], v[64:67], v[104:107]
v_mfma_f32_16x16x32_bf16 v[108:111], a[212:215], v[64:67], v[108:111]
ds_read_b128 v[64:67], v19 offset:33280
s_add_u32 m0, s44, 36864
s_add_u32 s29, s39, 140288
v_mfma_f32_16x16x32_bf16 v[112:115], a[84:87], v[68:71], v[112:115]
buffer_load_dwordx4 v10, s[16:19], s29 offen offset:0 lds
v_mfma_f32_16x16x32_bf16 v[116:119], a[212:215], v[68:71], v[116:119]
ds_read_b128 v[68:71], v19 offset:37376
s_waitcnt lgkmcnt(6)
v_mfma_f32_16x16x32_bf16 v[104:107], a[88:91], v[72:75], v[104:107]
v_mfma_f32_16x16x32_bf16 v[108:111], a[216:219], v[72:75], v[108:111]
ds_read_b128 v[72:75], v20 offset:33280
v_mfma_f32_16x16x32_bf16 v[112:115], a[88:91], v[76:79], v[112:115]
v_mfma_f32_16x16x32_bf16 v[116:119], a[216:219], v[76:79], v[116:119]
ds_read_b128 v[76:79], v20 offset:37376
s_waitcnt lgkmcnt(6)
v_mfma_f32_16x16x32_bf16 v[104:107], a[92:95], v[80:83], v[104:107]
v_mfma_f32_16x16x32_bf16 v[108:111], a[220:223], v[80:83], v[108:111]
ds_read_b128 v[80:83], v21 offset:33280
v_mfma_f32_16x16x32_bf16 v[112:115], a[92:95], v[84:87], v[112:115]
buffer_load_dwordx4 v11, s[16:19], s29 offen offset:1024 lds
v_mfma_f32_16x16x32_bf16 v[116:119], a[220:223], v[84:87], v[116:119]
ds_read_b128 v[84:87], v21 offset:37376
s_waitcnt lgkmcnt(6)
v_mfma_f32_16x16x32_bf16 v[104:107], a[96:99], v[56:59], v[104:107]
v_mfma_f32_16x16x32_bf16 v[108:111], a[224:227], v[56:59], v[108:111]
ds_read_b128 v[56:59], v18 offset:33536
v_mfma_f32_16x16x32_bf16 v[112:115], a[96:99], v[60:63], v[112:115]
v_mfma_f32_16x16x32_bf16 v[116:119], a[224:227], v[60:63], v[116:119]
ds_read_b128 v[60:63], v18 offset:37632
s_waitcnt lgkmcnt(6)
v_mfma_f32_16x16x32_bf16 v[104:107], a[100:103], v[64:67], v[104:107]
v_mfma_f32_16x16x32_bf16 v[108:111], a[228:231], v[64:67], v[108:111]
ds_read_b128 v[64:67], v19 offset:33536
v_mfma_f32_16x16x32_bf16 v[112:115], a[100:103], v[68:71], v[112:115]
buffer_load_dwordx4 v12, s[16:19], s29 offen offset:2048 lds
v_mfma_f32_16x16x32_bf16 v[116:119], a[228:231], v[68:71], v[116:119]
ds_read_b128 v[68:71], v19 offset:37632
s_waitcnt lgkmcnt(6)
v_mfma_f32_16x16x32_bf16 v[104:107], a[104:107], v[72:75], v[104:107]
v_mfma_f32_16x16x32_bf16 v[108:111], a[232:235], v[72:75], v[108:111]
ds_read_b128 v[72:75], v20 offset:33536
v_mfma_f32_16x16x32_bf16 v[112:115], a[104:107], v[76:79], v[112:115]
v_mfma_f32_16x16x32_bf16 v[116:119], a[232:235], v[76:79], v[116:119]
ds_read_b128 v[76:79], v20 offset:37632
s_waitcnt lgkmcnt(6)
v_mfma_f32_16x16x32_bf16 v[104:107], a[108:111], v[80:83], v[104:107]
v_mfma_f32_16x16x32_bf16 v[108:111], a[236:239], v[80:83], v[108:111]
ds_read_b128 v[80:83], v21 offset:33536
v_mfma_f32_16x16x32_bf16 v[112:115], a[108:111], v[84:87], v[112:115]
buffer_load_dwordx4 v13, s[16:19], s29 offen offset:3072 lds
v_mfma_f32_16x16x32_bf16 v[116:119], a[236:239], v[84:87], v[116:119]
ds_read_b128 v[84:87], v21 offset:37632
s_waitcnt vmcnt(8)
s_barrier
s_waitcnt lgkmcnt(6)
v_mfma_f32_16x16x32_bf16 v[104:107], a[112:115], v[56:59], v[104:107]
s_add_u32 s38, s38, 1
v_mfma_f32_16x16x32_bf16 v[108:111], a[240:243], v[56:59], v[108:111]
ds_read_b128 v[56:59], v14 offset:0
v_mfma_f32_16x16x32_bf16 v[112:115], a[112:115], v[60:63], v[112:115]
v_mfma_f32_16x16x32_bf16 v[116:119], a[240:243], v[60:63], v[116:119]
ds_read_b128 v[60:63], v14 offset:4096
s_waitcnt lgkmcnt(6)
v_mfma_f32_16x16x32_bf16 v[104:107], a[116:119], v[64:67], v[104:107]
v_mfma_f32_16x16x32_bf16 v[108:111], a[244:247], v[64:67], v[108:111]
ds_read_b128 v[64:67], v15 offset:0
s_add_u32 m0, s44, 65536
s_add_u32 s29, s39, 196608
v_mfma_f32_16x16x32_bf16 v[112:115], a[116:119], v[68:71], v[112:115]
buffer_load_dwordx4 v10, s[16:19], s29 offen offset:0 lds
v_mfma_f32_16x16x32_bf16 v[116:119], a[244:247], v[68:71], v[116:119]
ds_read_b128 v[68:71], v15 offset:4096
s_waitcnt lgkmcnt(6)
v_mfma_f32_16x16x32_bf16 v[104:107], a[120:123], v[72:75], v[104:107]
v_mfma_f32_16x16x32_bf16 v[108:111], a[248:251], v[72:75], v[108:111]
ds_read_b128 v[72:75], v16 offset:0
v_mfma_f32_16x16x32_bf16 v[112:115], a[120:123], v[76:79], v[112:115]
v_mfma_f32_16x16x32_bf16 v[116:119], a[248:251], v[76:79], v[116:119]
ds_read_b128 v[76:79], v16 offset:4096
s_waitcnt lgkmcnt(6)
v_mfma_f32_16x16x32_bf16 v[104:107], a[124:127], v[80:83], v[104:107]
v_mfma_f32_16x16x32_bf16 v[108:111], a[252:255], v[80:83], v[108:111]
ds_read_b128 v[80:83], v17 offset:0
v_mfma_f32_16x16x32_bf16 v[112:115], a[124:127], v[84:87], v[112:115]
buffer_load_dwordx4 v11, s[16:19], s29 offen offset:1024 lds
v_mfma_f32_16x16x32_bf16 v[116:119], a[252:255], v[84:87], v[116:119]
ds_read_b128 v[84:87], v17 offset:4096
s_add_u32 s39, s39, 131072
s_cmp_eq_u32 s45, 1
s_cbranch_scc1 L_qhook
s_branch L_gl_T3
L_gx_T:
s_cmp_eq_u32 s45, 1
s_cbranch_scc1 L_qend
s_nop 7
v_cvt_pk_bf16_f32 v120, v88, v89
v_cvt_pk_bf16_f32 v121, v90, v91
v_cvt_pk_bf16_f32 v122, v92, v93
v_cvt_pk_bf16_f32 v123, v94, v95
buffer_store_dwordx4 v[120:123], v22, s[4:7], s40 offen offset:0 sc1
v_cvt_pk_bf16_f32 v124, v96, v97
v_cvt_pk_bf16_f32 v125, v98, v99
v_cvt_pk_bf16_f32 v126, v100, v101
v_cvt_pk_bf16_f32 v127, v102, v103
buffer_store_dwordx4 v[36:39], v30, s[4:7], s40 offen sc1
buffer_store_dwordx4 v[124:127], v22, s[4:7], s40 offen offset:1024 sc1
s_lshr_b32 s40, s47, 8
s_xor_b32 s40, s40, s56
s_and_b32 s40, s40, s55
s_or_b32 s40, s40, s47
s_add_u32 s47, s47, s36
s_waitcnt vmcnt(0) lgkmcnt(0)
s_barrier
v_mov_b32 v24, s38
buffer_store_dword v24, v32, s[4:7], 0 offen sc1
s_cmp_ge_u32 s32, 96
s_cbranch_scc1 L_b2go
s_branch L_fg
L_qhook:
s_and_b32 s24, s38, 3
s_cmp_eq_u32 s24, 1
s_cbranch_scc1 L_qcomp
s_cmp_eq_u32 s53, 0
s_cbranch_scc1 L_qnp
s_sub_u32 s24, s49, 1
v_mov_b32 v5, s24
s_mov_b32 s53, 0
s_waitcnt vmcnt(24)
buffer_store_dword v5, v28, s[4:7], 0 offen sc1
L_qnp:
s_waitcnt vmcnt(24)
v_min_i32 v40, v40, v41
v_min3_i32 v40, v40, v42, v43
s_nop 0
v_readfirstlane_b32 s50, v40
s_nop 0
s_cmp_ge_i32 s50, s49
s_cbranch_scc0 L_gl_T
s_cmp_gt_u32 s38, s49
s_cbranch_scc0 L_gl_T
s_lshr_b32 s25, s48, 5
s_lshl_b32 s25, s25, 19
s_lshr_b32 s26, s25, 8
s_and_b32 s26, s26, 0x2000
s_xor_b32 s26, s26, s54
s_or_b32 s26, s26, s25
s_and_b32 s25, s48, 31
s_lshl_b32 s25, s25, 14
s_add_u32 s26, s26, s25
s_xor_b32 s24, s26, 0x2000
s_add_u32 s25, s24, 75497472
buffer_load_dwordx4 v[128:131], v2, s[4:7], s25 offen offset:0
buffer_load_dwordx4 v[132:135], v2, s[4:7], s25 offen offset:1024
buffer_load_dwordx4 v[136:139], v2, s[4:7], s25 offen offset:2048
buffer_load_dwordx4 v[140:143], v2, s[4:7], s25 offen offset:3072
s_add_u32 s25, s24, 75501568
buffer_load_dwordx4 v[144:147], v2, s[4:7], s25 offen offset:0
buffer_load_dwordx4 v[148:151], v2, s[4:7], s25 offen offset:1024
buffer_load_dwordx4 v[152:155], v2, s[4:7], s25 offen offset:2048
buffer_load_dwordx4 v[156:159], v2, s[4:7], s25 offen offset:3072
s_add_u32 s25, s26, 75497472
buffer_load_dwordx4 v[160:163], v2, s[4:7], s25 offen offset:0
buffer_load_dwordx4 v[164:167], v2, s[4:7], s25 offen offset:1024
buffer_load_dwordx4 v[168:171], v2, s[4:7], s25 offen offset:2048
buffer_load_dwordx4 v[172:175], v2, s[4:7], s25 offen offset:3072
s_add_u32 s25, s26, 75501568
buffer_load_dwordx4 v[176:179], v2, s[4:7], s25 offen offset:0
buffer_load_dwordx4 v[180:183], v2, s[4:7], s25 offen offset:1024
buffer_load_dwordx4 v[184:187], v2, s[4:7], s25 offen offset:2048
buffer_load_dwordx4 v[188:191], v2, s[4:7], s25 offen offset:3072
s_add_u32 s25, s26, 109051904
buffer_load_dwordx4 v[192:195], v2, s[4:7], s25 offen offset:0
buffer_load_dwordx4 v[196:199], v2, s[4:7], s25 offen offset:1024
buffer_load_dwordx4 v[200:203], v2, s[4:7], s25 offen offset:2048
buffer_load_dwordx4 v[204:207], v2, s[4:7], s25 offen offset:3072
s_add_u32 s25, s26, 109056000
buffer_load_dwordx4 v[208:211], v2, s[4:7], s25 offen offset:0
buffer_load_dwordx4 v[212:215], v2, s[4:7], s25 offen offset:1024
buffer_load_dwordx4 v[216:219], v2, s[4:7], s25 offen offset:2048
buffer_load_dwordx4 v[220:223], v2, s[4:7], s25 offen offset:3072
s_lshr_b32 s25, s48, 5
s_lshl_b32 s25, s25, 19
s_lshr_b32 s26, s25, 8
s_and_b32 s26, s26, 0x2000
s_xor_b32 s26, s26, s54
s_or_b32 s26, s26, s25
s_bfe_u32 s25, s48, 0x40001
s_lshl_b32 s25, s25, 14
s_add_u32 s26, s26, s25
s_and_b32 s25, s48, 1
s_lshl_b32 s25, s25, 12
s_add_u32 s26, s26, s25
s_add_u32 s26, s26, 8650752
buffer_load_dwordx4 v[224:227], v8, s[4:7], s26 offen offset:0 sc1
buffer_load_dwordx4 v[228:231], v8, s[4:7], s26 offen offset:1024 sc1
buffer_load_dwordx4 v[232:235], v8, s[4:7], s26 offen offset:2048 sc1
buffer_load_dwordx4 v[236:239], v8, s[4:7], s26 offen offset:3072 sc1
buffer_load_dword v240, v9, s[4:7], s26 offen offset:2560 sc1
buffer_load_dword v242, v9, s[4:7], s26 offen offset:2816 sc1
buffer_load_dword v244, v9, s[4:7], s26 offen offset:3584 sc1
buffer_load_dword v246, v9, s[4:7], s26 offen offset:3840 sc1
buffer_load_dword v248, v9, s[4:7], s26 offen offset:512 sc1
buffer_load_dword v250, v9, s[4:7], s26 offen offset:768 sc1
buffer_load_dword v252, v9, s[4:7], s26 offen offset:1536 sc1
buffer_load_dword v254, v9, s[4:7], s26 offen offset:1792 sc1
s_mov_b32 s52, 1
s_branch L_gl_T
L_qcomp:
buffer_load_dwordx4 v[40:43], v27, s[4:7], 0 offen sc1
s_cmp_eq_u32 s52, 0
s_cbranch_scc1 L_gl_T
s_waitcnt lgkmcnt(0)
s_branch L_t6c
L_qend:
s_nop 7
v_cvt_pk_bf16_f32 v120, v88, v89
v_cvt_pk_bf16_f32 v121, v90, v91
v_cvt_pk_bf16_f32 v122, v92, v93
v_cvt_pk_bf16_f32 v123, v94, v95
buffer_store_dwordx4 v[120:123], v22, s[4:7], s40 offen offset:0 sc1
v_cvt_pk_bf16_f32 v124, v96, v97
v_cvt_pk_bf16_f32 v125, v98, v99
v_cvt_pk_bf16_f32 v126, v100, v101
v_cvt_pk_bf16_f32 v127, v102, v103
buffer_store_dwordx4 v[36:39], v30, s[4:7], s40 offen sc1
buffer_store_dwordx4 v[124:127], v22, s[4:7], s40 offen offset:1024 sc1
s_waitcnt vmcnt(0) lgkmcnt(0)
s_barrier
s_cmp_eq_u32 s52, 1
s_cbranch_scc1 L_t6c
L_t6r:
s_cmp_eq_u32 s51, 1
s_cbranch_scc1 L_wk_done
s_branch L_wk_go
L_wk:
s_sleep 16
L_wk_go:
buffer_load_dword v40, v29, s[4:7], 0 offen sc1
s_sub_u32 s28, s28, 1
s_cbranch_scc1 L_end
s_waitcnt vmcnt(0)
v_cmp_gt_i32 vcc, s49, v40
s_cbranch_vccnz L_wk
v_cmp_gt_i32 vcc, 64, v40
s_cbranch_vccnz L_wk_done
s_mov_b32 s51, 1
L_wk_done:
s_lshr_b32 s25, s48, 5
s_lshl_b32 s25, s25, 19
s_lshr_b32 s26, s25, 8
s_and_b32 s26, s26, 0x2000
s_xor_b32 s26, s26, s54
s_or_b32 s26, s26, s25
s_and_b32 s25, s48, 31
s_lshl_b32 s25, s25, 14
s_add_u32 s26, s26, s25
s_xor_b32 s24, s26, 0x2000
s_add_u32 s25, s24, 75497472
buffer_load_dwordx4 v[128:131], v2, s[4:7], s25 offen offset:0
buffer_load_dwordx4 v[132:135], v2, s[4:7], s25 offen offset:1024
buffer_load_dwordx4 v[136:139], v2, s[4:7], s25 offen offset:2048
buffer_load_dwordx4 v[140:143], v2, s[4:7], s25 offen offset:3072
s_add_u32 s25, s24, 75501568
buffer_load_dwordx4 v[144:147], v2, s[4:7], s25 offen offset:0
buffer_load_dwordx4 v[148:151], v2, s[4:7], s25 offen offset:1024
buffer_load_dwordx4 v[152:155], v2, s[4:7], s25 offen offset:2048
buffer_load_dwordx4 v[156:159], v2, s[4:7], s25 offen offset:3072
s_add_u32 s25, s26, 75497472
buffer_load_dwordx4 v[160:163], v2, s[4:7], s25 offen offset:0
buffer_load_dwordx4 v[164:167], v2, s[4:7], s25 offen offset:1024
buffer_load_dwordx4 v[168:171], v2, s[4:7], s25 offen offset:2048
buffer_load_dwordx4 v[172:175], v2, s[4:7], s25 offen offset:3072
s_add_u32 s25, s26, 75501568
buffer_load_dwordx4 v[176:179], v2, s[4:7], s25 offen offset:0
buffer_load_dwordx4 v[180:183], v2, s[4:7], s25 offen offset:1024
buffer_load_dwordx4 v[184:187], v2, s[4:7], s25 offen offset:2048
buffer_load_dwordx4 v[188:191], v2, s[4:7], s25 offen offset:3072
s_add_u32 s25, s26, 109051904
buffer_load_dwordx4 v[192:195], v2, s[4:7], s25 offen offset:0
buffer_load_dwordx4 v[196:199], v2, s[4:7], s25 offen offset:1024
buffer_load_dwordx4 v[200:203], v2, s[4:7], s25 offen offset:2048
buffer_load_dwordx4 v[204:207], v2, s[4:7], s25 offen offset:3072
s_add_u32 s25, s26, 109056000
buffer_load_dwordx4 v[208:211], v2, s[4:7], s25 offen offset:0
buffer_load_dwordx4 v[212:215], v2, s[4:7], s25 offen offset:1024
buffer_load_dwordx4 v[216:219], v2, s[4:7], s25 offen offset:2048
buffer_load_dwordx4 v[220:223], v2, s[4:7], s25 offen offset:3072
s_branch L_wr_chk
L_wr:
s_sleep 24
buffer_load_dwordx4 v[40:43], v27, s[4:7], 0 offen sc1
s_sub_u32 s28, s28, 1
s_cbranch_scc1 L_end
s_waitcnt vmcnt(0)
v_min_i32 v40, v40, v41
v_min3_i32 v40, v40, v42, v43
s_nop 0
v_readfirstlane_b32 s50, v40
L_wr_chk:
s_nop 0
s_add_u32 s24, s50, 2
s_cmp_ge_i32 s24, s49
s_cbranch_scc0 L_wr
s_lshr_b32 s25, s48, 5
s_lshl_b32 s25, s25, 19
s_lshr_b32 s26, s25, 8
s_and_b32 s26, s26, 0x2000
s_xor_b32 s26, s26, s54
s_or_b32 s26, s26, s25
s_bfe_u32 s25, s48, 0x40001
s_lshl_b32 s25, s25, 14
s_add_u32 s26, s26, s25
s_and_b32 s25, s48, 1
s_lshl_b32 s25, s25, 12
s_add_u32 s26, s26, s25
s_add_u32 s26, s26, 8650752
buffer_load_dwordx4 v[224:227], v8, s[4:7], s26 offen offset:0 sc1
buffer_load_dwordx4 v[228:231], v8, s[4:7], s26 offen offset:1024 sc1
buffer_load_dwordx4 v[232:235], v8, s[4:7], s26 offen offset:2048 sc1
buffer_load_dwordx4 v[236:239], v8, s[4:7], s26 offen offset:3072 sc1
buffer_load_dword v240, v9, s[4:7], s26 offen offset:2560 sc1
buffer_load_dword v242, v9, s[4:7], s26 offen offset:2816 sc1
buffer_load_dword v244, v9, s[4:7], s26 offen offset:3584 sc1
buffer_load_dword v246, v9, s[4:7], s26 offen offset:3840 sc1
buffer_load_dword v248, v9, s[4:7], s26 offen offset:512 sc1
buffer_load_dword v250, v9, s[4:7], s26 offen offset:768 sc1
buffer_load_dword v252, v9, s[4:7], s26 offen offset:1536 sc1
buffer_load_dword v254, v9, s[4:7], s26 offen offset:1792 sc1
L_t6c:
s_mov_b32 s27, 0x3e0293ee
v_mov_b32 v121, 0
v_mov_b32 v123, 0
s_waitcnt vmcnt(20)
v_mfma_f32_16x16x32_bf16 v[56:59], v[160:163], v[128:131], 0
v_mfma_f32_16x16x32_bf16 v[60:63], v[164:167], v[128:131], 0
v_mfma_f32_16x16x32_bf16 v[68:71], v[160:163], v[132:135], 0
v_mfma_f32_16x16x32_bf16 v[72:75], v[164:167], v[132:135], 0
v_mfma_f32_16x16x32_bf16 v[56:59], v[168:171], v[136:139], v[56:59]
v_mfma_f32_16x16x32_bf16 v[60:63], v[172:175], v[136:139], v[60:63]
v_mfma_f32_16x16x32_bf16 v[68:71], v[168:171], v[140:143], v[68:71]
v_mfma_f32_16x16x32_bf16 v[72:75], v[172:175], v[140:143], v[72:75]
v_mfma_f32_16x16x32_bf16 v[56:59], v[176:179], v[144:147], v[56:59]
v_mfma_f32_16x16x32_bf16 v[60:63], v[180:183], v[144:147], v[60:63]
v_mfma_f32_16x16x32_bf16 v[68:71], v[176:179], v[148:151], v[68:71]
v_mfma_f32_16x16x32_bf16 v[72:75], v[180:183], v[148:151], v[72:75]
v_mfma_f32_16x16x32_bf16 v[56:59], v[184:187], v[152:155], v[56:59]
v_mfma_f32_16x16x32_bf16 v[60:63], v[188:191], v[152:155], v[60:63]
v_mfma_f32_16x16x32_bf16 v[68:71], v[184:187], v[156:159], v[68:71]
v_mfma_f32_16x16x32_bf16 v[72:75], v[188:191], v[156:159], v[72:75]
v_cndmask_b32 v56, v46, v56, s[64:65]
v_cndmask_b32 v57, v46, v57, s[66:67]
v_cndmask_b32 v58, v46, v58, s[68:69]
v_cndmask_b32 v59, v46, v59, s[70:71]
v_cndmask_b32 v60, v46, v60, s[72:73]
v_cndmask_b32 v61, v46, v61, s[74:75]
v_cndmask_b32 v62, v46, v62, s[76:77]
v_cndmask_b32 v63, v46, v63, s[78:79]
v_cndmask_b32 v68, v46, v68, s[80:81]
v_cndmask_b32 v69, v46, v69, s[82:83]
v_cndmask_b32 v70, v46, v70, s[84:85]
v_cndmask_b32 v71, v46, v71, s[86:87]
v_cndmask_b32 v72, v46, v72, s[88:89]
v_cndmask_b32 v73, v46, v73, s[90:91]
v_cndmask_b32 v74, v46, v74, s[92:93]
v_cndmask_b32 v75, v46, v75, s[94:95]
s_branch L_km_chk
L_km_again:
s_sleep 2
s_lshr_b32 s25, s48, 5
s_lshl_b32 s25, s25, 19
s_lshr_b32 s26, s25, 8
s_and_b32 s26, s26, 0x2000
s_xor_b32 s26, s26, s54
s_or_b32 s26, s26, s25
s_bfe_u32 s25, s48, 0x40001
s_lshl_b32 s25, s25, 14
s_add_u32 s26, s26, s25
s_and_b32 s25, s48, 1
s_lshl_b32 s25, s25, 12
s_add_u32 s26, s26, s25
s_add_u32 s26, s26, 8650752
buffer_load_dwordx4 v[224:227], v8, s[4:7], s26 offen offset:0 sc1
buffer_load_dwordx4 v[228:231], v8, s[4:7], s26 offen offset:1024 sc1
buffer_load_dwordx4 v[232:235], v8, s[4:7], s26 offen offset:2048 sc1
buffer_load_dwordx4 v[236:239], v8, s[4:7], s26 offen offset:3072 sc1
buffer_load_dword v240, v9, s[4:7], s26 offen offset:2560 sc1
buffer_load_dword v242, v9, s[4:7], s26 offen offset:2816 sc1
buffer_load_dword v244, v9, s[4:7], s26 offen offset:3584 sc1
buffer_load_dword v246, v9, s[4:7], s26 offen offset:3840 sc1
buffer_load_dword v248, v9, s[4:7], s26 offen offset:512 sc1
buffer_load_dword v250, v9, s[4:7], s26 offen offset:768 sc1
buffer_load_dword v252, v9, s[4:7], s26 offen offset:1536 sc1
buffer_load_dword v254, v9, s[4:7], s26 offen offset:1792 sc1
s_sub_u32 s28, s28, 1
s_cbranch_scc1 L_end
L_km_chk:
s_waitcnt vmcnt(0)
v_max3_u32 v5, v224, v225, v226
v_max3_u32 v5, v5, v227, v228
v_max3_u32 v5, v5, v229, v230
v_max3_u32 v5, v5, v231, v232
v_max3_u32 v5, v5, v233, v234
v_max3_u32 v5, v5, v235, v236
v_max3_u32 v5, v5, v237, v238
v_max3_u32 v5, v5, v239, v240
v_max3_u32 v5, v5, v242, v244
v_max3_u32 v5, v5, v246, v248
v_max3_u32 v5, v5, v250, v252
v_max_u32 v5, v5, v254
v_cmp_eq_u32 vcc, -1, v5
s_cbranch_vccnz L_km_again
v_mfma_f32_16x16x32_bf16 v[64:67], v[224:227], v[128:131], 0
v_mfma_f32_16x16x32_bf16 v[76:79], v[224:227], v[132:135], 0
v_mfma_f32_16x16x32_bf16 v[64:67], v[228:231], v[136:139], v[64:67]
v_mfma_f32_16x16x32_bf16 v[76:79], v[228:231], v[140:143], v[76:79]
v_mfma_f32_16x16x32_bf16 v[64:67], v[232:235], v[144:147], v[64:67]
v_mfma_f32_16x16x32_bf16 v[76:79], v[232:235], v[148:151], v[76:79]
v_mfma_f32_16x16x32_bf16 v[64:67], v[236:239], v[152:155], v[64:67]
v_mfma_f32_16x16x32_bf16 v[76:79], v[236:239], v[156:159], v[76:79]
s_lshr_b32 s25, s48, 5
s_lshl_b32 s25, s25, 19
s_lshr_b32 s24, s25, 8
s_and_b32 s24, s24, 0x2000
s_xor_b32 s24, s24, s54
s_or_b32 s24, s24, s25
s_xor_b32 s24, s24, 0x2000
s_bfe_u32 s25, s48, 0x40001
s_lshl_b32 s25, s25, 14
s_add_u32 s24, s24, s25
s_and_b32 s25, s48, 1
s_lshl_b32 s25, s25, 12
s_add_u32 s24, s24, s25
s_add_u32 s24, s24, 109051904
s_add_u32 s25, s24, 0x40000
v_max3_f32 v47, v56, v57, v58
v_max3_f32 v47, v47, v59, v60
v_max3_f32 v47, v47, v61, v62
v_max3_f32 v47, v47, v63, v64
v_max_f32 v47, v47, v65
v_mov_b32 v49, v47
s_nop 1
v_permlane16_swap_b32 v47, v49
v_max_f32 v47, v47, v49
v_mov_b32 v49, v47
s_nop 1
v_permlane32_swap_b32 v47, v49
v_max_f32 v47, v47, v49
v_mul_f32 v47, s27, v47
v_fma_f32 v56, v56, s27, -v47
v_fma_f32 v57, v57, s27, -v47
v_fma_f32 v58, v58, s27, -v47
v_fma_f32 v59, v59, s27, -v47
v_fma_f32 v60, v60, s27, -v47
v_fma_f32 v61, v61, s27, -v47
v_fma_f32 v62, v62, s27, -v47
v_fma_f32 v63, v63, s27, -v47
v_fma_f32 v64, v64, s27, -v47
v_fma_f32 v65, v65, s27, -v47
v_exp_f32 v56, v56
v_exp_f32 v57, v57
v_exp_f32 v58, v58
v_exp_f32 v59, v59
v_exp_f32 v60, v60
v_exp_f32 v61, v61
v_exp_f32 v62, v62
v_exp_f32 v63, v63
v_exp_f32 v64, v64
v_exp_f32 v65, v65
v_cvt_pk_bf16_f32 v56, v56, v57
v_cvt_pk_bf16_f32 v57, v58, v59
v_cvt_pk_bf16_f32 v58, v60, v61
v_cvt_pk_bf16_f32 v59, v62, v63
v_cvt_pk_bf16_f32 v120, v64, v65
s_nop 1
v_mfma_f32_16x16x16_bf16 v[80:83], v[52:53], v[120:121], 0
v_max3_f32 v48, v68, v69, v70
v_max3_f32 v48, v48, v71, v72
v_mfma_f32_16x16x16_bf16 v[128:131], v[240:241], v[120:121], 0
v_max3_f32 v48, v48, v73, v74
v_max3_f32 v48, v48, v75, v76
v_mfma_f32_16x16x16_bf16 v[132:135], v[242:243], v[120:121], 0
v_max_f32 v48, v48, v77
v_mov_b32 v49, v48
v_mfma_f32_16x16x16_bf16 v[136:139], v[244:245], v[120:121], 0
s_nop 0
v_permlane16_swap_b32 v48, v49
v_max_f32 v48, v48, v49
v_mfma_f32_16x16x16_bf16 v[140:143], v[246:247], v[120:121], 0
v_mov_b32 v49, v48
s_nop 1
v_permlane32_swap_b32 v48, v49
v_mfma_f32_16x16x16_bf16 v[144:147], v[248:249], v[120:121], 0
v_max_f32 v48, v48, v49
v_mul_f32 v48, s27, v48
v_mfma_f32_16x16x16_bf16 v[148:151], v[250:251], v[120:121], 0
v_fma_f32 v68, v68, s27, -v48
v_fma_f32 v69, v69, s27, -v48
v_mfma_f32_16x16x16_bf16 v[152:155], v[252:253], v[120:121], 0
v_fma_f32 v70, v70, s27, -v48
v_fma_f32 v71, v71, s27, -v48
v_mfma_f32_16x16x16_bf16 v[156:159], v[254:255], v[120:121], 0
v_fma_f32 v72, v72, s27, -v48
v_fma_f32 v73, v73, s27, -v48
v_mfma_f32_16x16x32_bf16 v[80:83], v[52:55], v[56:59], v[80:83]
v_fma_f32 v74, v74, s27, -v48
v_fma_f32 v75, v75, s27, -v48
v_mfma_f32_16x16x32_bf16 v[128:131], v[192:195], v[56:59], v[128:131]
v_fma_f32 v76, v76, s27, -v48
v_fma_f32 v77, v77, s27, -v48
v_mfma_f32_16x16x32_bf16 v[132:135], v[196:199], v[56:59], v[132:135]
v_exp_f32 v68, v68
v_exp_f32 v69, v69
v_mfma_f32_16x16x32_bf16 v[136:139], v[200:203], v[56:59], v[136:139]
v_exp_f32 v70, v70
v_exp_f32 v71, v71
v_mfma_f32_16x16x32_bf16 v[140:143], v[204:207], v[56:59], v[140:143]
v_exp_f32 v72, v72
v_exp_f32 v73, v73
v_mfma_f32_16x16x32_bf16 v[144:147], v[208:211], v[56:59], v[144:147]
v_exp_f32 v74, v74
v_exp_f32 v75, v75
v_mfma_f32_16x16x32_bf16 v[148:151], v[212:215], v[56:59], v[148:151]
v_exp_f32 v76, v76
v_exp_f32 v77, v77
v_mfma_f32_16x16x32_bf16 v[152:155], v[216:219], v[56:59], v[152:155]
v_cvt_pk_bf16_f32 v68, v68, v69
v_cvt_pk_bf16_f32 v69, v70, v71
v_mfma_f32_16x16x32_bf16 v[156:159], v[220:223], v[56:59], v[156:159]
v_cvt_pk_bf16_f32 v70, v72, v73
v_cvt_pk_bf16_f32 v71, v74, v75
v_cvt_pk_bf16_f32 v122, v76, v77
s_nop 1
v_mfma_f32_16x16x16_bf16 v[84:87], v[52:53], v[122:123], 0
v_rcp_f32 v47, v80
s_nop 0
v_mul_f32 v128, v128, v47
v_mfma_f32_16x16x16_bf16 v[160:163], v[240:241], v[122:123], 0
v_mul_f32 v129, v129, v47
v_mul_f32 v130, v130, v47
v_mfma_f32_16x16x16_bf16 v[164:167], v[242:243], v[122:123], 0
v_mul_f32 v131, v131, v47
v_cvt_pk_bf16_f32 v224, v128, v129
v_mfma_f32_16x16x16_bf16 v[168:171], v[244:245], v[122:123], 0
v_cvt_pk_bf16_f32 v225, v130, v131
v_mul_f32 v132, v132, v47
v_mfma_f32_16x16x16_bf16 v[172:175], v[246:247], v[122:123], 0
v_mul_f32 v133, v133, v47
v_mul_f32 v134, v134, v47
v_mfma_f32_16x16x16_bf16 v[176:179], v[248:249], v[122:123], 0
v_mul_f32 v135, v135, v47
v_cvt_pk_bf16_f32 v226, v132, v133
v_mfma_f32_16x16x16_bf16 v[180:183], v[250:251], v[122:123], 0
v_cvt_pk_bf16_f32 v227, v134, v135
buffer_store_dwordx4 v[224:227], v2, s[4:7], s24 offen offset:0 sc1
v_mfma_f32_16x16x16_bf16 v[184:187], v[252:253], v[122:123], 0
v_mul_f32 v136, v136, v47
v_mul_f32 v137, v137, v47
v_mfma_f32_16x16x16_bf16 v[188:191], v[254:255], v[122:123], 0
v_mul_f32 v138, v138, v47
v_mul_f32 v139, v139, v47
v_mfma_f32_16x16x32_bf16 v[84:87], v[52:55], v[68:71], v[84:87]
v_cvt_pk_bf16_f32 v228, v136, v137
v_cvt_pk_bf16_f32 v229, v138, v139
v_mfma_f32_16x16x32_bf16 v[160:163], v[192:195], v[68:71], v[160:163]
v_mul_f32 v140, v140, v47
v_mul_f32 v141, v141, v47
v_mfma_f32_16x16x32_bf16 v[164:167], v[196:199], v[68:71], v[164:167]
v_mul_f32 v142, v142, v47
v_mul_f32 v143, v143, v47
v_mfma_f32_16x16x32_bf16 v[168:171], v[200:203], v[68:71], v[168:171]
v_cvt_pk_bf16_f32 v230, v140, v141
v_cvt_pk_bf16_f32 v231, v142, v143
v_mfma_f32_16x16x32_bf16 v[172:175], v[204:207], v[68:71], v[172:175]
buffer_store_dwordx4 v[228:231], v2, s[4:7], s24 offen offset:1024 sc1
v_mul_f32 v144, v144, v47
v_mfma_f32_16x16x32_bf16 v[176:179], v[208:211], v[68:71], v[176:179]
v_mul_f32 v145, v145, v47
v_mul_f32 v146, v146, v47
v_mfma_f32_16x16x32_bf16 v[180:183], v[212:215], v[68:71], v[180:183]
v_mul_f32 v147, v147, v47
v_cvt_pk_bf16_f32 v232, v144, v145
v_mfma_f32_16x16x32_bf16 v[184:187], v[216:219], v[68:71], v[184:187]
v_cvt_pk_bf16_f32 v233, v146, v147
v_mul_f32 v148, v148, v47
v_mfma_f32_16x16x32_bf16 v[188:191], v[220:223], v[68:71], v[188:191]
v_mul_f32 v149, v149, v47
v_mul_f32 v150, v150, v47
v_mul_f32 v151, v151, v47
v_cvt_pk_bf16_f32 v234, v148, v149
v_cvt_pk_bf16_f32 v235, v150, v151
buffer_store_dwordx4 v[232:235], v2, s[4:7], s24 offen offset:2048 sc1
v_mul_f32 v152, v152, v47
v_mul_f32 v153, v153, v47
v_mul_f32 v154, v154, v47
v_mul_f32 v155, v155, v47
v_cvt_pk_bf16_f32 v236, v152, v153
v_cvt_pk_bf16_f32 v237, v154, v155
v_mul_f32 v156, v156, v47
v_mul_f32 v157, v157, v47
v_mul_f32 v158, v158, v47
v_mul_f32 v159, v159, v47
v_cvt_pk_bf16_f32 v238, v156, v157
v_cvt_pk_bf16_f32 v239, v158, v159
buffer_store_dwordx4 v[236:239], v2, s[4:7], s24 offen offset:3072 sc1
v_rcp_f32 v48, v84
s_nop 0
v_mul_f32 v160, v160, v48
v_mul_f32 v161, v161, v48
v_mul_f32 v162, v162, v48
v_mul_f32 v163, v163, v48
v_cvt_pk_bf16_f32 v192, v160, v161
v_cvt_pk_bf16_f32 v193, v162, v163
v_mul_f32 v164, v164, v48
v_mul_f32 v165, v165, v48
v_mul_f32 v166, v166, v48
v_mul_f32 v167, v167, v48
v_cvt_pk_bf16_f32 v194, v164, v165
v_cvt_pk_bf16_f32 v195, v166, v167
buffer_store_dwordx4 v[192:195], v2, s[4:7], s25 offen offset:0 sc1
v_mul_f32 v168, v168, v48
v_mul_f32 v169, v169, v48
v_mul_f32 v170, v170, v48
v_mul_f32 v171, v171, v48
v_cvt_pk_bf16_f32 v200, v168, v169
v_cvt_pk_bf16_f32 v201, v170, v171
v_mul_f32 v172, v172, v48
v_mul_f32 v173, v173, v48
v_mul_f32 v174, v174, v48
v_mul_f32 v175, v175, v48
v_cvt_pk_bf16_f32 v202, v172, v173
v_cvt_pk_bf16_f32 v203, v174, v175
buffer_store_dwordx4 v[200:203], v2, s[4:7], s25 offen offset:1024 sc1
v_mul_f32 v176, v176, v48
v_mul_f32 v177, v177, v48
v_mul_f32 v178, v178, v48
v_mul_f32 v179, v179, v48
v_cvt_pk_bf16_f32 v208, v176, v177
v_cvt_pk_bf16_f32 v209, v178, v179
v_mul_f32 v180, v180, v48
v_mul_f32 v181, v181, v48
v_mul_f32 v182, v182, v48
v_mul_f32 v183, v183, v48
v_cvt_pk_bf16_f32 v210, v180, v181
v_cvt_pk_bf16_f32 v211, v182, v183
buffer_store_dwordx4 v[208:211], v2, s[4:7], s25 offen offset:2048 sc1
v_mul_f32 v184, v184, v48
v_mul_f32 v185, v185, v48
v_mul_f32 v186, v186, v48
v_mul_f32 v187, v187, v48
v_cvt_pk_bf16_f32 v216, v184, v185
v_cvt_pk_bf16_f32 v217, v186, v187
v_mul_f32 v188, v188, v48
v_mul_f32 v189, v189, v48
v_mul_f32 v190, v190, v48
v_mul_f32 v191, v191, v48
v_cvt_pk_bf16_f32 v218, v188, v189
v_cvt_pk_bf16_f32 v219, v190, v191
buffer_store_dwordx4 v[216:219], v2, s[4:7], s25 offen offset:3072 sc1
s_add_u32 s48, s48, 128
s_add_u32 s49, s49, 4
s_mov_b32 s52, 0
s_mov_b32 s53, 1
s_cmp_lg_u32 s38, 64
s_cbranch_scc1 L_grd
s_sub_u32 s24, s49, 1
v_mov_b32 v24, s24
s_waitcnt vmcnt(0)
buffer_store_dword v24, v28, s[4:7], 0 offen sc1
s_cmp_le_u32 s49, 64
s_cbranch_scc1 L_t6r
s_branch L_end
L_gl_N:
s_cmp_eq_u32 s20, 1
s_cbranch_scc1 L_gl_N1
s_cmp_eq_u32 s20, 2
s_cbranch_scc1 L_gl_N2
s_cmp_eq_u32 s20, 3
s_cbranch_scc1 L_gl_N3
.p2align 6
L_gl_N0:
s_waitcnt lgkmcnt(6)
v_mfma_f32_16x16x32_bf16 v[88:91], v[56:59], a[0:3], 0
buffer_load_dwordx4 v12, s[16:19], s29 offen offset:2048 lds
v_mfma_f32_16x16x32_bf16 v[92:95], v[56:59], a[128:131], 0
ds_read_b128 v[56:59], v14 offset:256
v_mfma_f32_16x16x32_bf16 v[96:99], v[60:63], a[0:3], 0
v_mfma_f32_16x16x32_bf16 v[100:103], v[60:63], a[128:131], 0
ds_read_b128 v[60:63], v14 offset:4352
s_waitcnt lgkmcnt(6)
v_mfma_f32_16x16x32_bf16 v[88:91], v[64:67], a[4:7], v[88:91]
v_cvt_pk_bf16_f32 v120, v104, v105
v_cvt_pk_bf16_f32 v121, v106, v107
v_mfma_f32_16x16x32_bf16 v[92:95], v[64:67], a[132:135], v[92:95]
v_cvt_pk_bf16_f32 v122, v112, v113
ds_read_b128 v[64:67], v15 offset:256
v_mfma_f32_16x16x32_bf16 v[96:99], v[68:71], a[4:7], v[96:99]
v_cvt_pk_bf16_f32 v123, v114, v115
buffer_store_dwordx4 v[120:123], v22, s[4:7], s40 offen offset:0 sc1
v_mfma_f32_16x16x32_bf16 v[100:103], v[68:71], a[132:135], v[100:103]
ds_read_b128 v[68:71], v15 offset:4352
s_waitcnt lgkmcnt(6)
v_mfma_f32_16x16x32_bf16 v[88:91], v[72:75], a[8:11], v[88:91]
buffer_load_dwordx4 v13, s[16:19], s29 offen offset:3072 lds
v_mfma_f32_16x16x32_bf16 v[92:95], v[72:75], a[136:139], v[92:95]
v_cvt_pk_bf16_f32 v124, v108, v109
ds_read_b128 v[72:75], v16 offset:256
v_mfma_f32_16x16x32_bf16 v[96:99], v[76:79], a[8:11], v[96:99]
v_cvt_pk_bf16_f32 v125, v110, v111
v_cvt_pk_bf16_f32 v126, v116, v117
v_mfma_f32_16x16x32_bf16 v[100:103], v[76:79], a[136:139], v[100:103]
ds_read_b128 v[76:79], v16 offset:4352
s_waitcnt lgkmcnt(6)
v_mfma_f32_16x16x32_bf16 v[88:91], v[80:83], a[12:15], v[88:91]
v_cvt_pk_bf16_f32 v127, v118, v119
buffer_store_dwordx4 v[36:39], v30, s[4:7], s40 offen sc1
v_mfma_f32_16x16x32_bf16 v[92:95], v[80:83], a[140:143], v[92:95]
buffer_store_dwordx4 v[124:127], v22, s[4:7], s40 offen offset:1024 sc1
ds_read_b128 v[80:83], v17 offset:256
v_mfma_f32_16x16x32_bf16 v[96:99], v[84:87], a[12:15], v[96:99]
s_lshr_b32 s40, s47, 8
s_xor_b32 s40, s40, s56
v_mfma_f32_16x16x32_bf16 v[100:103], v[84:87], a[140:143], v[100:103]
ds_read_b128 v[84:87], v17 offset:4352
s_waitcnt lgkmcnt(6)
s_add_u32 m0, s44, 69632
s_add_u32 s29, s39, 73728
v_mfma_f32_16x16x32_bf16 v[88:91], v[56:59], a[16:19], v[88:91]
buffer_load_dwordx4 v10, s[16:19], s29 offen offset:0 lds
v_mfma_f32_16x16x32_bf16 v[92:95], v[56:59], a[144:147], v[92:95]
s_and_b32 s40, s40, s55
ds_read_b128 v[56:59], v14 offset:512
v_mfma_f32_16x16x32_bf16 v[96:99], v[60:63], a[16:19], v[96:99]
s_or_b32 s40, s40, s47
s_add_u32 s47, s47, s36
v_mfma_f32_16x16x32_bf16 v[100:103], v[60:63], a[144:147], v[100:103]
ds_read_b128 v[60:63], v14 offset:4608
s_waitcnt lgkmcnt(6)
v_mfma_f32_16x16x32_bf16 v[88:91], v[64:67], a[20:23], v[88:91]
v_mfma_f32_16x16x32_bf16 v[92:95], v[64:67], a[148:151], v[92:95]
ds_read_b128 v[64:67], v15 offset:512
v_mfma_f32_16x16x32_bf16 v[96:99], v[68:71], a[20:23], v[96:99]
v_mfma_f32_16x16x32_bf16 v[100:103], v[68:71], a[148:151], v[100:103]
ds_read_b128 v[68:71], v15 offset:4608
s_waitcnt lgkmcnt(6)
v_mfma_f32_16x16x32_bf16 v[88:91], v[72:75], a[24:27], v[88:91]
buffer_load_dwordx4 v11, s[16:19], s29 offen offset:1024 lds
v_mfma_f32_16x16x32_bf16 v[92:95], v[72:75], a[152:155], v[92:95]
ds_read_b128 v[72:75], v16 offset:512
v_mfma_f32_16x16x32_bf16 v[96:99], v[76:79], a[24:27], v[96:99]
v_mfma_f32_16x16x32_bf16 v[100:103], v[76:79], a[152:155], v[100:103]
ds_read_b128 v[76:79], v16 offset:4608
s_waitcnt lgkmcnt(6)
v_mfma_f32_16x16x32_bf16 v[88:91], v[80:83], a[28:31], v[88:91]
v_mfma_f32_16x16x32_bf16 v[92:95], v[80:83], a[156:159], v[92:95]
ds_read_b128 v[80:83], v17 offset:512
v_mfma_f32_16x16x32_bf16 v[96:99], v[84:87], a[28:31], v[96:99]
v_mfma_f32_16x16x32_bf16 v[100:103], v[84:87], a[156:159], v[100:103]
ds_read_b128 v[84:87], v17 offset:4608
s_waitcnt lgkmcnt(6)
v_mfma_f32_16x16x32_bf16 v[88:91], v[56:59], a[32:35], v[88:91]
buffer_load_dwordx4 v12, s[16:19], s29 offen offset:2048 lds
v_mfma_f32_16x16x32_bf16 v[92:95], v[56:59], a[160:163], v[92:95]
ds_read_b128 v[56:59], v14 offset:768
v_mfma_f32_16x16x32_bf16 v[96:99], v[60:63], a[32:35], v[96:99]
v_mfma_f32_16x16x32_bf16 v[100:103], v[60:63], a[160:163], v[100:103]
ds_read_b128 v[60:63], v14 offset:4864
s_waitcnt lgkmcnt(6)
v_mfma_f32_16x16x32_bf16 v[88:91], v[64:67], a[36:39], v[88:91]
v_mfma_f32_16x16x32_bf16 v[92:95], v[64:67], a[164:167], v[92:95]
ds_read_b128 v[64:67], v15 offset:768
v_mfma_f32_16x16x32_bf16 v[96:99], v[68:71], a[36:39], v[96:99]
v_mfma_f32_16x16x32_bf16 v[100:103], v[68:71], a[164:167], v[100:103]
ds_read_b128 v[68:71], v15 offset:4864
s_waitcnt lgkmcnt(6)
v_mfma_f32_16x16x32_bf16 v[88:91], v[72:75], a[40:43], v[88:91]
buffer_load_dwordx4 v13, s[16:19], s29 offen offset:3072 lds
v_mfma_f32_16x16x32_bf16 v[92:95], v[72:75], a[168:171], v[92:95]
ds_read_b128 v[72:75], v16 offset:768
v_mfma_f32_16x16x32_bf16 v[96:99], v[76:79], a[40:43], v[96:99]
v_mfma_f32_16x16x32_bf16 v[100:103], v[76:79], a[168:171], v[100:103]
ds_read_b128 v[76:79], v16 offset:4864
s_waitcnt lgkmcnt(6)
v_mfma_f32_16x16x32_bf16 v[88:91], v[80:83], a[44:47], v[88:91]
v_mfma_f32_16x16x32_bf16 v[92:95], v[80:83], a[172:175], v[92:95]
ds_read_b128 v[80:83], v17 offset:768
v_mfma_f32_16x16x32_bf16 v[96:99], v[84:87], a[44:47], v[96:99]
v_mfma_f32_16x16x32_bf16 v[100:103], v[84:87], a[172:175], v[100:103]
ds_read_b128 v[84:87], v17 offset:4864
s_waitcnt vmcnt(12)
s_barrier
s_waitcnt lgkmcnt(6)
s_add_u32 m0, s44, 98304
s_add_u32 s29, s39, 66560
v_mfma_f32_16x16x32_bf16 v[88:91], v[56:59], a[48:51], v[88:91]
s_add_u32 s43, s39, 0
buffer_load_dword v26, v25, s[16:19], s43 offen
buffer_load_dwordx4 v10, s[16:19], s29 offen offset:0 lds
v_mfma_f32_16x16x32_bf16 v[92:95], v[56:59], a[176:179], v[92:95]
ds_read_b128 v[56:59], v14 offset:32768
v_mfma_f32_16x16x32_bf16 v[96:99], v[60:63], a[48:51], v[96:99]
v_mfma_f32_16x16x32_bf16 v[100:103], v[60:63], a[176:179], v[100:103]
ds_read_b128 v[60:63], v14 offset:36864
s_waitcnt lgkmcnt(6)
v_mfma_f32_16x16x32_bf16 v[88:91], v[64:67], a[52:55], v[88:91]
v_mfma_f32_16x16x32_bf16 v[92:95], v[64:67], a[180:183], v[92:95]
ds_read_b128 v[64:67], v15 offset:32768
v_mfma_f32_16x16x32_bf16 v[96:99], v[68:71], a[52:55], v[96:99]
v_mfma_f32_16x16x32_bf16 v[100:103], v[68:71], a[180:183], v[100:103]
ds_read_b128 v[68:71], v15 offset:36864
s_waitcnt lgkmcnt(6)
v_mfma_f32_16x16x32_bf16 v[88:91], v[72:75], a[56:59], v[88:91]
buffer_load_dwordx4 v11, s[16:19], s29 offen offset:1024 lds
v_mfma_f32_16x16x32_bf16 v[92:95], v[72:75], a[184:187], v[92:95]
ds_read_b128 v[72:75], v16 offset:32768
v_mfma_f32_16x16x32_bf16 v[96:99], v[76:79], a[56:59], v[96:99]
v_mfma_f32_16x16x32_bf16 v[100:103], v[76:79], a[184:187], v[100:103]
ds_read_b128 v[76:79], v16 offset:36864
s_waitcnt lgkmcnt(6)
v_mfma_f32_16x16x32_bf16 v[88:91], v[80:83], a[60:63], v[88:91]
v_mfma_f32_16x16x32_bf16 v[92:95], v[80:83], a[188:191], v[92:95]
ds_read_b128 v[80:83], v17 offset:32768
v_mfma_f32_16x16x32_bf16 v[96:99], v[84:87], a[60:63], v[96:99]
v_mfma_f32_16x16x32_bf16 v[100:103], v[84:87], a[188:191], v[100:103]
ds_read_b128 v[84:87], v17 offset:36864
s_waitcnt lgkmcnt(6)
v_mfma_f32_16x16x32_bf16 v[88:91], v[56:59], a[64:67], v[88:91]
buffer_load_dwordx4 v12, s[16:19], s29 offen offset:2048 lds
v_mfma_f32_16x16x32_bf16 v[92:95], v[56:59], a[192:195], v[92:95]
ds_read_b128 v[56:59], v14 offset:33024
v_mfma_f32_16x16x32_bf16 v[96:99], v[60:63], a[64:67], v[96:99]
v_mfma_f32_16x16x32_bf16 v[100:103], v[60:63], a[192:195], v[100:103]
ds_read_b128 v[60:63], v14 offset:37120
s_waitcnt lgkmcnt(6)
v_mfma_f32_16x16x32_bf16 v[88:91], v[64:67], a[68:71], v[88:91]
v_mfma_f32_16x16x32_bf16 v[92:95], v[64:67], a[196:199], v[92:95]
ds_read_b128 v[64:67], v15 offset:33024
v_mfma_f32_16x16x32_bf16 v[96:99], v[68:71], a[68:71], v[96:99]
v_mfma_f32_16x16x32_bf16 v[100:103], v[68:71], a[196:199], v[100:103]
ds_read_b128 v[68:71], v15 offset:37120
s_waitcnt lgkmcnt(6)
v_mfma_f32_16x16x32_bf16 v[88:91], v[72:75], a[72:75], v[88:91]
buffer_load_dwordx4 v13, s[16:19], s29 offen offset:3072 lds
v_mfma_f32_16x16x32_bf16 v[92:95], v[72:75], a[200:203], v[92:95]
ds_read_b128 v[72:75], v16 offset:33024
v_mfma_f32_16x16x32_bf16 v[96:99], v[76:79], a[72:75], v[96:99]
v_mfma_f32_16x16x32_bf16 v[100:103], v[76:79], a[200:203], v[100:103]
ds_read_b128 v[76:79], v16 offset:37120
s_waitcnt lgkmcnt(6)
v_mfma_f32_16x16x32_bf16 v[88:91], v[80:83], a[76:79], v[88:91]
v_mfma_f32_16x16x32_bf16 v[92:95], v[80:83], a[204:207], v[92:95]
ds_read_b128 v[80:83], v17 offset:33024
v_mfma_f32_16x16x32_bf16 v[96:99], v[84:87], a[76:79], v[96:99]
v_mfma_f32_16x16x32_bf16 v[100:103], v[84:87], a[204:207], v[100:103]
ds_read_b128 v[84:87], v17 offset:37120
s_waitcnt lgkmcnt(6)
s_add_u32 m0, s44, 102400
s_add_u32 s29, s39, 74752
v_mfma_f32_16x16x32_bf16 v[88:91], v[56:59], a[80:83], v[88:91]
s_cmp_lt_u32 s38, 64
s_cbranch_scc1 L_wpN10
s_sub_u32 s46, s38, 64
s_lshl_b32 s46, s46, 17
buffer_load_dword v26, v31, s[12:15], s46 offen
L_wpN10:
buffer_load_dwordx4 v10, s[16:19], s29 offen offset:0 lds
v_mfma_f32_16x16x32_bf16 v[92:95], v[56:59], a[208:211], v[92:95]
ds_read_b128 v[56:59], v14 offset:33280
v_mfma_f32_16x16x32_bf16 v[96:99], v[60:63], a[80:83], v[96:99]
v_mfma_f32_16x16x32_bf16 v[100:103], v[60:63], a[208:211], v[100:103]
ds_read_b128 v[60:63], v14 offset:37376
s_waitcnt lgkmcnt(6)
v_mfma_f32_16x16x32_bf16 v[88:91], v[64:67], a[84:87], v[88:91]
v_mfma_f32_16x16x32_bf16 v[92:95], v[64:67], a[212:215], v[92:95]
ds_read_b128 v[64:67], v15 offset:33280
v_mfma_f32_16x16x32_bf16 v[96:99], v[68:71], a[84:87], v[96:99]
v_mfma_f32_16x16x32_bf16 v[100:103], v[68:71], a[212:215], v[100:103]
ds_read_b128 v[68:71], v15 offset:37376
s_waitcnt lgkmcnt(6)
v_mfma_f32_16x16x32_bf16 v[88:91], v[72:75], a[88:91], v[88:91]
buffer_load_dwordx4 v11, s[16:19], s29 offen offset:1024 lds
v_mfma_f32_16x16x32_bf16 v[92:95], v[72:75], a[216:219], v[92:95]
ds_read_b128 v[72:75], v16 offset:33280
v_mfma_f32_16x16x32_bf16 v[96:99], v[76:79], a[88:91], v[96:99]
v_mfma_f32_16x16x32_bf16 v[100:103], v[76:79], a[216:219], v[100:103]
ds_read_b128 v[76:79], v16 offset:37376
s_waitcnt lgkmcnt(6)
v_mfma_f32_16x16x32_bf16 v[88:91], v[80:83], a[92:95], v[88:91]
v_mfma_f32_16x16x32_bf16 v[92:95], v[80:83], a[220:223], v[92:95]
ds_read_b128 v[80:83], v17 offset:33280
v_mfma_f32_16x16x32_bf16 v[96:99], v[84:87], a[92:95], v[96:99]
v_mfma_f32_16x16x32_bf16 v[100:103], v[84:87], a[220:223], v[100:103]
ds_read_b128 v[84:87], v17 offset:37376
s_waitcnt lgkmcnt(6)
v_mfma_f32_16x16x32_bf16 v[88:91], v[56:59], a[96:99], v[88:91]
buffer_load_dwordx4 v12, s[16:19], s29 offen offset:2048 lds
v_mfma_f32_16x16x32_bf16 v[92:95], v[56:59], a[224:227], v[92:95]
ds_read_b128 v[56:59], v14 offset:33536
v_mfma_f32_16x16x32_bf16 v[96:99], v[60:63], a[96:99], v[96:99]
v_mfma_f32_16x16x32_bf16 v[100:103], v[60:63], a[224:227], v[100:103]
ds_read_b128 v[60:63], v14 offset:37632
s_waitcnt lgkmcnt(6)
v_mfma_f32_16x16x32_bf16 v[88:91], v[64:67], a[100:103], v[88:91]
v_mfma_f32_16x16x32_bf16 v[92:95], v[64:67], a[228:231], v[92:95]
ds_read_b128 v[64:67], v15 offset:33536
v_mfma_f32_16x16x32_bf16 v[96:99], v[68:71], a[100:103], v[96:99]
v_mfma_f32_16x16x32_bf16 v[100:103], v[68:71], a[228:231], v[100:103]
ds_read_b128 v[68:71], v15 offset:37632
s_waitcnt lgkmcnt(6)
v_mfma_f32_16x16x32_bf16 v[88:91], v[72:75], a[104:107], v[88:91]
buffer_load_dwordx4 v13, s[16:19], s29 offen offset:3072 lds
v_mfma_f32_16x16x32_bf16 v[92:95], v[72:75], a[232:235], v[92:95]
ds_read_b128 v[72:75], v16 offset:33536
v_mfma_f32_16x16x32_bf16 v[96:99], v[76:79], a[104:107], v[96:99]
v_mfma_f32_16x16x32_bf16 v[100:103], v[76:79], a[232:235], v[100:103]
ds_read_b128 v[76:79], v16 offset:37632
s_waitcnt lgkmcnt(6)
v_mfma_f32_16x16x32_bf16 v[88:91], v[80:83], a[108:111], v[88:91]
v_mfma_f32_16x16x32_bf16 v[92:95], v[80:83], a[236:239], v[92:95]
ds_read_b128 v[80:83], v17 offset:33536
v_mfma_f32_16x16x32_bf16 v[96:99], v[84:87], a[108:111], v[96:99]
v_mfma_f32_16x16x32_bf16 v[100:103], v[84:87], a[236:239], v[100:103]
ds_read_b128 v[84:87], v17 offset:37632
s_waitcnt vmcnt(9)
s_barrier
s_waitcnt lgkmcnt(6)
s_add_u32 m0, s44, 0
s_add_u32 s29, s39, 131072
v_mfma_f32_16x16x32_bf16 v[88:91], v[56:59], a[112:115], v[88:91]
v_mov_b32 v24, s38
buffer_store_dword v24, v32, s[4:7], 0 offen sc1
s_add_u32 s38, s38, 1
buffer_load_dwordx4 v10, s[16:19], s29 offen offset:0 lds
v_mfma_f32_16x16x32_bf16 v[92:95], v[56:59], a[240:243], v[92:95]
ds_read_b128 v[56:59], v18 offset:0
v_mfma_f32_16x16x32_bf16 v[96:99], v[60:63], a[112:115], v[96:99]
v_mfma_f32_16x16x32_bf16 v[100:103], v[60:63], a[240:243], v[100:103]
ds_read_b128 v[60:63], v18 offset:4096
s_waitcnt lgkmcnt(6)
v_mfma_f32_16x16x32_bf16 v[88:91], v[64:67], a[116:119], v[88:91]
v_mfma_f32_16x16x32_bf16 v[92:95], v[64:67], a[244:247], v[92:95]
ds_read_b128 v[64:67], v19 offset:0
v_mfma_f32_16x16x32_bf16 v[96:99], v[68:71], a[116:119], v[96:99]
v_mfma_f32_16x16x32_bf16 v[100:103], v[68:71], a[244:247], v[100:103]
ds_read_b128 v[68:71], v19 offset:4096
s_waitcnt lgkmcnt(6)
v_mfma_f32_16x16x32_bf16 v[88:91], v[72:75], a[120:123], v[88:91]
buffer_load_dwordx4 v11, s[16:19], s29 offen offset:1024 lds
v_mfma_f32_16x16x32_bf16 v[92:95], v[72:75], a[248:251], v[92:95]
ds_read_b128 v[72:75], v20 offset:0
v_mfma_f32_16x16x32_bf16 v[96:99], v[76:79], a[120:123], v[96:99]
v_mfma_f32_16x16x32_bf16 v[100:103], v[76:79], a[248:251], v[100:103]
ds_read_b128 v[76:79], v20 offset:4096
s_waitcnt lgkmcnt(6)
v_mfma_f32_16x16x32_bf16 v[88:91], v[80:83], a[124:127], v[88:91]
v_mfma_f32_16x16x32_bf16 v[92:95], v[80:83], a[252:255], v[92:95]
ds_read_b128 v[80:83], v21 offset:0
v_mfma_f32_16x16x32_bf16 v[96:99], v[84:87], a[124:127], v[96:99]
v_mfma_f32_16x16x32_bf16 v[100:103], v[84:87], a[252:255], v[100:103]
ds_read_b128 v[84:87], v21 offset:4096
s_cmp_eq_u32 s38, 64
s_cbranch_scc1 L_gx_N
s_waitcnt lgkmcnt(6)
v_mfma_f32_16x16x32_bf16 v[104:107], v[56:59], a[0:3], 0
buffer_load_dwordx4 v12, s[16:19], s29 offen offset:2048 lds
v_mfma_f32_16x16x32_bf16 v[108:111], v[56:59], a[128:131], 0
ds_read_b128 v[56:59], v18 offset:256
v_mfma_f32_16x16x32_bf16 v[112:115], v[60:63], a[0:3], 0
v_mfma_f32_16x16x32_bf16 v[116:119], v[60:63], a[128:131], 0
ds_read_b128 v[60:63], v18 offset:4352
s_waitcnt lgkmcnt(6)
v_mfma_f32_16x16x32_bf16 v[104:107], v[64:67], a[4:7], v[104:107]
v_cvt_pk_bf16_f32 v120, v88, v89
v_cvt_pk_bf16_f32 v121, v90, v91
v_mfma_f32_16x16x32_bf16 v[108:111], v[64:67], a[132:135], v[108:111]
v_cvt_pk_bf16_f32 v122, v96, v97
ds_read_b128 v[64:67], v19 offset:256
v_mfma_f32_16x16x32_bf16 v[112:115], v[68:71], a[4:7], v[112:115]
v_cvt_pk_bf16_f32 v123, v98, v99
buffer_store_dwordx4 v[120:123], v22, s[4:7], s40 offen offset:0 sc1
v_mfma_f32_16x16x32_bf16 v[116:119], v[68:71], a[132:135], v[116:119]
ds_read_b128 v[68:71], v19 offset:4352
s_waitcnt lgkmcnt(6)
v_mfma_f32_16x16x32_bf16 v[104:107], v[72:75], a[8:11], v[104:107]
buffer_load_dwordx4 v13, s[16:19], s29 offen offset:3072 lds
v_mfma_f32_16x16x32_bf16 v[108:111], v[72:75], a[136:139], v[108:111]
v_cvt_pk_bf16_f32 v124, v92, v93
ds_read_b128 v[72:75], v20 offset:256
v_mfma_f32_16x16x32_bf16 v[112:115], v[76:79], a[8:11], v[112:115]
v_cvt_pk_bf16_f32 v125, v94, v95
v_cvt_pk_bf16_f32 v126, v100, v101
v_mfma_f32_16x16x32_bf16 v[116:119], v[76:79], a[136:139], v[116:119]
ds_read_b128 v[76:79], v20 offset:4352
s_waitcnt lgkmcnt(6)
v_mfma_f32_16x16x32_bf16 v[104:107], v[80:83], a[12:15], v[104:107]
v_cvt_pk_bf16_f32 v127, v102, v103
buffer_store_dwordx4 v[36:39], v30, s[4:7], s40 offen sc1
v_mfma_f32_16x16x32_bf16 v[108:111], v[80:83], a[140:143], v[108:111]
buffer_store_dwordx4 v[124:127], v22, s[4:7], s40 offen offset:1024 sc1
ds_read_b128 v[80:83], v21 offset:256
v_mfma_f32_16x16x32_bf16 v[112:115], v[84:87], a[12:15], v[112:115]
s_lshr_b32 s40, s47, 8
s_xor_b32 s40, s40, s56
v_mfma_f32_16x16x32_bf16 v[116:119], v[84:87], a[140:143], v[116:119]
ds_read_b128 v[84:87], v21 offset:4352
s_waitcnt lgkmcnt(6)
s_add_u32 m0, s44, 4096
s_add_u32 s29, s39, 139264
v_mfma_f32_16x16x32_bf16 v[104:107], v[56:59], a[16:19], v[104:107]
buffer_load_dwordx4 v10, s[16:19], s29 offen offset:0 lds
v_mfma_f32_16x16x32_bf16 v[108:111], v[56:59], a[144:147], v[108:111]
s_and_b32 s40, s40, s55
ds_read_b128 v[56:59], v18 offset:512
v_mfma_f32_16x16x32_bf16 v[112:115], v[60:63], a[16:19], v[112:115]
s_or_b32 s40, s40, s47
s_add_u32 s47, s47, s36
v_mfma_f32_16x16x32_bf16 v[116:119], v[60:63], a[144:147], v[116:119]
ds_read_b128 v[60:63], v18 offset:4608
s_waitcnt lgkmcnt(6)
v_mfma_f32_16x16x32_bf16 v[104:107], v[64:67], a[20:23], v[104:107]
v_mfma_f32_16x16x32_bf16 v[108:111], v[64:67], a[148:151], v[108:111]
ds_read_b128 v[64:67], v19 offset:512
v_mfma_f32_16x16x32_bf16 v[112:115], v[68:71], a[20:23], v[112:115]
v_mfma_f32_16x16x32_bf16 v[116:119], v[68:71], a[148:151], v[116:119]
ds_read_b128 v[68:71], v19 offset:4608
s_waitcnt lgkmcnt(6)
v_mfma_f32_16x16x32_bf16 v[104:107], v[72:75], a[24:27], v[104:107]
buffer_load_dwordx4 v11, s[16:19], s29 offen offset:1024 lds
v_mfma_f32_16x16x32_bf16 v[108:111], v[72:75], a[152:155], v[108:111]
ds_read_b128 v[72:75], v20 offset:512
v_mfma_f32_16x16x32_bf16 v[112:115], v[76:79], a[24:27], v[112:115]
v_mfma_f32_16x16x32_bf16 v[116:119], v[76:79], a[152:155], v[116:119]
ds_read_b128 v[76:79], v20 offset:4608
s_waitcnt lgkmcnt(6)
v_mfma_f32_16x16x32_bf16 v[104:107], v[80:83], a[28:31], v[104:107]
v_mfma_f32_16x16x32_bf16 v[108:111], v[80:83], a[156:159], v[108:111]
ds_read_b128 v[80:83], v21 offset:512
v_mfma_f32_16x16x32_bf16 v[112:115], v[84:87], a[28:31], v[112:115]
v_mfma_f32_16x16x32_bf16 v[116:119], v[84:87], a[156:159], v[116:119]
ds_read_b128 v[84:87], v21 offset:4608
s_waitcnt lgkmcnt(6)
v_mfma_f32_16x16x32_bf16 v[104:107], v[56:59], a[32:35], v[104:107]
buffer_load_dwordx4 v12, s[16:19], s29 offen offset:2048 lds
v_mfma_f32_16x16x32_bf16 v[108:111], v[56:59], a[160:163], v[108:111]
ds_read_b128 v[56:59], v18 offset:768
v_mfma_f32_16x16x32_bf16 v[112:115], v[60:63], a[32:35], v[112:115]
v_mfma_f32_16x16x32_bf16 v[116:119], v[60:63], a[160:163], v[116:119]
ds_read_b128 v[60:63], v18 offset:4864
s_waitcnt lgkmcnt(6)
v_mfma_f32_16x16x32_bf16 v[104:107], v[64:67], a[36:39], v[104:107]
v_mfma_f32_16x16x32_bf16 v[108:111], v[64:67], a[164:167], v[108:111]
ds_read_b128 v[64:67], v19 offset:768
v_mfma_f32_16x16x32_bf16 v[112:115], v[68:71], a[36:39], v[112:115]
v_mfma_f32_16x16x32_bf16 v[116:119], v[68:71], a[164:167], v[116:119]
ds_read_b128 v[68:71], v19 offset:4864
s_waitcnt lgkmcnt(6)
v_mfma_f32_16x16x32_bf16 v[104:107], v[72:75], a[40:43], v[104:107]
buffer_load_dwordx4 v13, s[16:19], s29 offen offset:3072 lds
v_mfma_f32_16x16x32_bf16 v[108:111], v[72:75], a[168:171], v[108:111]
ds_read_b128 v[72:75], v20 offset:768
v_mfma_f32_16x16x32_bf16 v[112:115], v[76:79], a[40:43], v[112:115]
v_mfma_f32_16x16x32_bf16 v[116:119], v[76:79], a[168:171], v[116:119]
ds_read_b128 v[76:79], v20 offset:4864
s_waitcnt lgkmcnt(6)
v_mfma_f32_16x16x32_bf16 v[104:107], v[80:83], a[44:47], v[104:107]
v_mfma_f32_16x16x32_bf16 v[108:111], v[80:83], a[172:175], v[108:111]
ds_read_b128 v[80:83], v21 offset:768
v_mfma_f32_16x16x32_bf16 v[112:115], v[84:87], a[44:47], v[112:115]
v_mfma_f32_16x16x32_bf16 v[116:119], v[84:87], a[172:175], v[116:119]
ds_read_b128 v[84:87], v21 offset:4864
s_waitcnt vmcnt(12)
s_barrier
s_waitcnt lgkmcnt(6)
s_add_u32 m0, s44, 32768
s_add_u32 s29, s39, 132096
v_mfma_f32_16x16x32_bf16 v[104:107], v[56:59], a[48:51], v[104:107]
s_add_u32 s43, s39, 65536
buffer_load_dword v26, v25, s[16:19], s43 offen
buffer_load_dwordx4 v10, s[16:19], s29 offen offset:0 lds
v_mfma_f32_16x16x32_bf16 v[108:111], v[56:59], a[176:179], v[108:111]
ds_read_b128 v[56:59], v18 offset:32768
v_mfma_f32_16x16x32_bf16 v[112:115], v[60:63], a[48:51], v[112:115]
v_mfma_f32_16x16x32_bf16 v[116:119], v[60:63], a[176:179], v[116:119]
ds_read_b128 v[60:63], v18 offset:36864
s_waitcnt lgkmcnt(6)
v_mfma_f32_16x16x32_bf16 v[104:107], v[64:67], a[52:55], v[104:107]
v_mfma_f32_16x16x32_bf16 v[108:111], v[64:67], a[180:183], v[108:111]
ds_read_b128 v[64:67], v19 offset:32768
v_mfma_f32_16x16x32_bf16 v[112:115], v[68:71], a[52:55], v[112:115]
v_mfma_f32_16x16x32_bf16 v[116:119], v[68:71], a[180:183], v[116:119]
ds_read_b128 v[68:71], v19 offset:36864
s_waitcnt lgkmcnt(6)
v_mfma_f32_16x16x32_bf16 v[104:107], v[72:75], a[56:59], v[104:107]
buffer_load_dwordx4 v11, s[16:19], s29 offen offset:1024 lds
v_mfma_f32_16x16x32_bf16 v[108:111], v[72:75], a[184:187], v[108:111]
ds_read_b128 v[72:75], v20 offset:32768
v_mfma_f32_16x16x32_bf16 v[112:115], v[76:79], a[56:59], v[112:115]
v_mfma_f32_16x16x32_bf16 v[116:119], v[76:79], a[184:187], v[116:119]
ds_read_b128 v[76:79], v20 offset:36864
s_waitcnt lgkmcnt(6)
v_mfma_f32_16x16x32_bf16 v[104:107], v[80:83], a[60:63], v[104:107]
v_mfma_f32_16x16x32_bf16 v[108:111], v[80:83], a[188:191], v[108:111]
ds_read_b128 v[80:83], v21 offset:32768
v_mfma_f32_16x16x32_bf16 v[112:115], v[84:87], a[60:63], v[112:115]
v_mfma_f32_16x16x32_bf16 v[116:119], v[84:87], a[188:191], v[116:119]
ds_read_b128 v[84:87], v21 offset:36864
s_waitcnt lgkmcnt(6)
v_mfma_f32_16x16x32_bf16 v[104:107], v[56:59], a[64:67], v[104:107]
buffer_load_dwordx4 v12, s[16:19], s29 offen offset:2048 lds
v_mfma_f32_16x16x32_bf16 v[108:111], v[56:59], a[192:195], v[108:111]
ds_read_b128 v[56:59], v18 offset:33024
v_mfma_f32_16x16x32_bf16 v[112:115], v[60:63], a[64:67], v[112:115]
v_mfma_f32_16x16x32_bf16 v[116:119], v[60:63], a[192:195], v[116:119]
ds_read_b128 v[60:63], v18 offset:37120
s_waitcnt lgkmcnt(6)
v_mfma_f32_16x16x32_bf16 v[104:107], v[64:67], a[68:71], v[104:107]
v_mfma_f32_16x16x32_bf16 v[108:111], v[64:67], a[196:199], v[108:111]
ds_read_b128 v[64:67], v19 offset:33024
v_mfma_f32_16x16x32_bf16 v[112:115], v[68:71], a[68:71], v[112:115]
v_mfma_f32_16x16x32_bf16 v[116:119], v[68:71], a[196:199], v[116:119]
ds_read_b128 v[68:71], v19 offset:37120
s_waitcnt lgkmcnt(6)
v_mfma_f32_16x16x32_bf16 v[104:107], v[72:75], a[72:75], v[104:107]
buffer_load_dwordx4 v13, s[16:19], s29 offen offset:3072 lds
v_mfma_f32_16x16x32_bf16 v[108:111], v[72:75], a[200:203], v[108:111]
ds_read_b128 v[72:75], v20 offset:33024
v_mfma_f32_16x16x32_bf16 v[112:115], v[76:79], a[72:75], v[112:115]
v_mfma_f32_16x16x32_bf16 v[116:119], v[76:79], a[200:203], v[116:119]
ds_read_b128 v[76:79], v20 offset:37120
s_waitcnt lgkmcnt(6)
v_mfma_f32_16x16x32_bf16 v[104:107], v[80:83], a[76:79], v[104:107]
v_mfma_f32_16x16x32_bf16 v[108:111], v[80:83], a[204:207], v[108:111]
ds_read_b128 v[80:83], v21 offset:33024
v_mfma_f32_16x16x32_bf16 v[112:115], v[84:87], a[76:79], v[112:115]
v_mfma_f32_16x16x32_bf16 v[116:119], v[84:87], a[204:207], v[116:119]
ds_read_b128 v[84:87], v21 offset:37120
s_waitcnt lgkmcnt(6)
s_add_u32 m0, s44, 36864
s_add_u32 s29, s39, 140288
v_mfma_f32_16x16x32_bf16 v[104:107], v[56:59], a[80:83], v[104:107]
s_cmp_lt_u32 s38, 64
s_cbranch_scc1 L_wpN30
s_sub_u32 s46, s38, 64
s_lshl_b32 s46, s46, 17
buffer_load_dword v26, v31, s[12:15], s46 offen
L_wpN30:
buffer_load_dwordx4 v10, s[16:19], s29 offen offset:0 lds
v_mfma_f32_16x16x32_bf16 v[108:111], v[56:59], a[208:211], v[108:111]
ds_read_b128 v[56:59], v18 offset:33280
v_mfma_f32_16x16x32_bf16 v[112:115], v[60:63], a[80:83], v[112:115]
v_mfma_f32_16x16x32_bf16 v[116:119], v[60:63], a[208:211], v[116:119]
ds_read_b128 v[60:63], v18 offset:37376
s_waitcnt lgkmcnt(6)
v_mfma_f32_16x16x32_bf16 v[104:107], v[64:67], a[84:87], v[104:107]
v_mfma_f32_16x16x32_bf16 v[108:111], v[64:67], a[212:215], v[108:111]
ds_read_b128 v[64:67], v19 offset:33280
v_mfma_f32_16x16x32_bf16 v[112:115], v[68:71], a[84:87], v[112:115]
v_mfma_f32_16x16x32_bf16 v[116:119], v[68:71], a[212:215], v[116:119]
ds_read_b128 v[68:71], v19 offset:37376
s_waitcnt lgkmcnt(6)
v_mfma_f32_16x16x32_bf16 v[104:107], v[72:75], a[88:91], v[104:107]
buffer_load_dwordx4 v11, s[16:19], s29 offen offset:1024 lds
v_mfma_f32_16x16x32_bf16 v[108:111], v[72:75], a[216:219], v[108:111]
ds_read_b128 v[72:75], v20 offset:33280
v_mfma_f32_16x16x32_bf16 v[112:115], v[76:79], a[88:91], v[112:115]
v_mfma_f32_16x16x32_bf16 v[116:119], v[76:79], a[216:219], v[116:119]
ds_read_b128 v[76:79], v20 offset:37376
s_waitcnt lgkmcnt(6)
v_mfma_f32_16x16x32_bf16 v[104:107], v[80:83], a[92:95], v[104:107]
v_mfma_f32_16x16x32_bf16 v[108:111], v[80:83], a[220:223], v[108:111]
ds_read_b128 v[80:83], v21 offset:33280
v_mfma_f32_16x16x32_bf16 v[112:115], v[84:87], a[92:95], v[112:115]
v_mfma_f32_16x16x32_bf16 v[116:119], v[84:87], a[220:223], v[116:119]
ds_read_b128 v[84:87], v21 offset:37376
s_waitcnt lgkmcnt(6)
v_mfma_f32_16x16x32_bf16 v[104:107], v[56:59], a[96:99], v[104:107]
buffer_load_dwordx4 v12, s[16:19], s29 offen offset:2048 lds
v_mfma_f32_16x16x32_bf16 v[108:111], v[56:59], a[224:227], v[108:111]
ds_read_b128 v[56:59], v18 offset:33536
v_mfma_f32_16x16x32_bf16 v[112:115], v[60:63], a[96:99], v[112:115]
v_mfma_f32_16x16x32_bf16 v[116:119], v[60:63], a[224:227], v[116:119]
ds_read_b128 v[60:63], v18 offset:37632
s_waitcnt lgkmcnt(6)
v_mfma_f32_16x16x32_bf16 v[104:107], v[64:67], a[100:103], v[104:107]
v_mfma_f32_16x16x32_bf16 v[108:111], v[64:67], a[228:231], v[108:111]
ds_read_b128 v[64:67], v19 offset:33536
v_mfma_f32_16x16x32_bf16 v[112:115], v[68:71], a[100:103], v[112:115]
v_mfma_f32_16x16x32_bf16 v[116:119], v[68:71], a[228:231], v[116:119]
ds_read_b128 v[68:71], v19 offset:37632
s_waitcnt lgkmcnt(6)
v_mfma_f32_16x16x32_bf16 v[104:107], v[72:75], a[104:107], v[104:107]
buffer_load_dwordx4 v13, s[16:19], s29 offen offset:3072 lds
v_mfma_f32_16x16x32_bf16 v[108:111], v[72:75], a[232:235], v[108:111]
ds_read_b128 v[72:75], v20 offset:33536
v_mfma_f32_16x16x32_bf16 v[112:115], v[76:79], a[104:107], v[112:115]
v_mfma_f32_16x16x32_bf16 v[116:119], v[76:79], a[232:235], v[116:119]
ds_read_b128 v[76:79], v20 offset:37632
s_waitcnt lgkmcnt(6)
v_mfma_f32_16x16x32_bf16 v[104:107], v[80:83], a[108:111], v[104:107]
v_mfma_f32_16x16x32_bf16 v[108:111], v[80:83], a[236:239], v[108:111]
ds_read_b128 v[80:83], v21 offset:33536
v_mfma_f32_16x16x32_bf16 v[112:115], v[84:87], a[108:111], v[112:115]
v_mfma_f32_16x16x32_bf16 v[116:119], v[84:87], a[236:239], v[116:119]
ds_read_b128 v[84:87], v21 offset:37632
s_waitcnt vmcnt(9)
s_barrier
s_waitcnt lgkmcnt(6)
s_add_u32 m0, s44, 65536
s_add_u32 s29, s39, 196608
v_mfma_f32_16x16x32_bf16 v[104:107], v[56:59], a[112:115], v[104:107]
v_mov_b32 v24, s38
buffer_store_dword v24, v32, s[4:7], 0 offen sc1
s_add_u32 s38, s38, 1
buffer_load_dwordx4 v10, s[16:19], s29 offen offset:0 lds
v_mfma_f32_16x16x32_bf16 v[108:111], v[56:59], a[240:243], v[108:111]
ds_read_b128 v[56:59], v14 offset:0
v_mfma_f32_16x16x32_bf16 v[112:115], v[60:63], a[112:115], v[112:115]
v_mfma_f32_16x16x32_bf16 v[116:119], v[60:63], a[240:243], v[116:119]
ds_read_b128 v[60:63], v14 offset:4096
s_waitcnt lgkmcnt(6)
v_mfma_f32_16x16x32_bf16 v[104:107], v[64:67], a[116:119], v[104:107]
v_mfma_f32_16x16x32_bf16 v[108:111], v[64:67], a[244:247], v[108:111]
ds_read_b128 v[64:67], v15 offset:0
v_mfma_f32_16x16x32_bf16 v[112:115], v[68:71], a[116:119], v[112:115]
v_mfma_f32_16x16x32_bf16 v[116:119], v[68:71], a[244:247], v[116:119]
ds_read_b128 v[68:71], v15 offset:4096
s_waitcnt lgkmcnt(6)
v_mfma_f32_16x16x32_bf16 v[104:107], v[72:75], a[120:123], v[104:107]
buffer_load_dwordx4 v11, s[16:19], s29 offen offset:1024 lds
v_mfma_f32_16x16x32_bf16 v[108:111], v[72:75], a[248:251], v[108:111]
ds_read_b128 v[72:75], v16 offset:0
v_mfma_f32_16x16x32_bf16 v[112:115], v[76:79], a[120:123], v[112:115]
v_mfma_f32_16x16x32_bf16 v[116:119], v[76:79], a[248:251], v[116:119]
ds_read_b128 v[76:79], v16 offset:4096
s_waitcnt lgkmcnt(6)
v_mfma_f32_16x16x32_bf16 v[104:107], v[80:83], a[124:127], v[104:107]
v_mfma_f32_16x16x32_bf16 v[108:111], v[80:83], a[252:255], v[108:111]
ds_read_b128 v[80:83], v17 offset:0
v_mfma_f32_16x16x32_bf16 v[112:115], v[84:87], a[124:127], v[112:115]
v_mfma_f32_16x16x32_bf16 v[116:119], v[84:87], a[252:255], v[116:119]
ds_read_b128 v[84:87], v17 offset:4096
s_add_u32 s39, s39, 131072
s_branch L_gl_N0
.p2align 6
L_gl_N1:
s_waitcnt lgkmcnt(6)
v_mfma_f32_16x16x32_bf16 v[88:91], v[56:59], a[0:3], 0
v_mfma_f32_16x16x32_bf16 v[92:95], v[56:59], a[128:131], 0
ds_read_b128 v[56:59], v14 offset:256
v_mfma_f32_16x16x32_bf16 v[96:99], v[60:63], a[0:3], 0
buffer_load_dwordx4 v12, s[16:19], s29 offen offset:2048 lds
v_mfma_f32_16x16x32_bf16 v[100:103], v[60:63], a[128:131], 0
ds_read_b128 v[60:63], v14 offset:4352
s_waitcnt lgkmcnt(6)
v_mfma_f32_16x16x32_bf16 v[88:91], v[64:67], a[4:7], v[88:91]
v_mfma_f32_16x16x32_bf16 v[92:95], v[64:67], a[132:135], v[92:95]
ds_read_b128 v[64:67], v15 offset:256
v_mfma_f32_16x16x32_bf16 v[96:99], v[68:71], a[4:7], v[96:99]
v_mfma_f32_16x16x32_bf16 v[100:103], v[68:71], a[132:135], v[100:103]
ds_read_b128 v[68:71], v15 offset:4352
s_waitcnt lgkmcnt(6)
v_mfma_f32_16x16x32_bf16 v[88:91], v[72:75], a[8:11], v[88:91]
v_cvt_pk_bf16_f32 v120, v104, v105
v_cvt_pk_bf16_f32 v121, v106, v107
v_mfma_f32_16x16x32_bf16 v[92:95], v[72:75], a[136:139], v[92:95]
v_cvt_pk_bf16_f32 v122, v112, v113
ds_read_b128 v[72:75], v16 offset:256
v_mfma_f32_16x16x32_bf16 v[96:99], v[76:79], a[8:11], v[96:99]
buffer_load_dwordx4 v13, s[16:19], s29 offen offset:3072 lds
v_mfma_f32_16x16x32_bf16 v[100:103], v[76:79], a[136:139], v[100:103]
ds_read_b128 v[76:79], v16 offset:4352
s_waitcnt lgkmcnt(6)
v_mfma_f32_16x16x32_bf16 v[88:91], v[80:83], a[12:15], v[88:91]
v_cvt_pk_bf16_f32 v123, v114, v115
buffer_store_dwordx4 v[120:123], v22, s[4:7], s40 offen offset:0 sc1
v_mfma_f32_16x16x32_bf16 v[92:95], v[80:83], a[140:143], v[92:95]
v_cvt_pk_bf16_f32 v124, v108, v109
ds_read_b128 v[80:83], v17 offset:256
v_mfma_f32_16x16x32_bf16 v[96:99], v[84:87], a[12:15], v[96:99]
v_cvt_pk_bf16_f32 v125, v110, v111
v_cvt_pk_bf16_f32 v126, v116, v117
v_mfma_f32_16x16x32_bf16 v[100:103], v[84:87], a[140:143], v[100:103]
ds_read_b128 v[84:87], v17 offset:4352
s_waitcnt lgkmcnt(6)
v_mfma_f32_16x16x32_bf16 v[88:91], v[56:59], a[16:19], v[88:91]
v_cvt_pk_bf16_f32 v127, v118, v119
buffer_store_dwordx4 v[36:39], v30, s[4:7], s40 offen sc1
v_mfma_f32_16x16x32_bf16 v[92:95], v[56:59], a[144:147], v[92:95]
buffer_store_dwordx4 v[124:127], v22, s[4:7], s40 offen offset:1024 sc1
ds_read_b128 v[56:59], v14 offset:512
s_add_u32 m0, s44, 69632
s_add_u32 s29, s39, 73728
v_mfma_f32_16x16x32_bf16 v[96:99], v[60:63], a[16:19], v[96:99]
buffer_load_dwordx4 v10, s[16:19], s29 offen offset:0 lds
v_mfma_f32_16x16x32_bf16 v[100:103], v[60:63], a[144:147], v[100:103]
ds_read_b128 v[60:63], v14 offset:4608
s_waitcnt lgkmcnt(6)
v_mfma_f32_16x16x32_bf16 v[88:91], v[64:67], a[20:23], v[88:91]
s_lshr_b32 s40, s47, 8
s_xor_b32 s40, s40, s56
v_mfma_f32_16x16x32_bf16 v[92:95], v[64:67], a[148:151], v[92:95]
s_and_b32 s40, s40, s55
ds_read_b128 v[64:67], v15 offset:512
v_mfma_f32_16x16x32_bf16 v[96:99], v[68:71], a[20:23], v[96:99]
s_or_b32 s40, s40, s47
s_add_u32 s47, s47, s36
v_mfma_f32_16x16x32_bf16 v[100:103], v[68:71], a[148:151], v[100:103]
ds_read_b128 v[68:71], v15 offset:4608
s_waitcnt lgkmcnt(6)
v_mfma_f32_16x16x32_bf16 v[88:91], v[72:75], a[24:27], v[88:91]
v_mfma_f32_16x16x32_bf16 v[92:95], v[72:75], a[152:155], v[92:95]
ds_read_b128 v[72:75], v16 offset:512
v_mfma_f32_16x16x32_bf16 v[96:99], v[76:79], a[24:27], v[96:99]
buffer_load_dwordx4 v11, s[16:19], s29 offen offset:1024 lds
v_mfma_f32_16x16x32_bf16 v[100:103], v[76:79], a[152:155], v[100:103]
ds_read_b128 v[76:79], v16 offset:4608
s_waitcnt lgkmcnt(6)
v_mfma_f32_16x16x32_bf16 v[88:91], v[80:83], a[28:31], v[88:91]
v_mfma_f32_16x16x32_bf16 v[92:95], v[80:83], a[156:159], v[92:95]
ds_read_b128 v[80:83], v17 offset:512
v_mfma_f32_16x16x32_bf16 v[96:99], v[84:87], a[28:31], v[96:99]
v_mfma_f32_16x16x32_bf16 v[100:103], v[84:87], a[156:159], v[100:103]
ds_read_b128 v[84:87], v17 offset:4608
s_waitcnt lgkmcnt(6)
v_mfma_f32_16x16x32_bf16 v[88:91], v[56:59], a[32:35], v[88:91]
v_mfma_f32_16x16x32_bf16 v[92:95], v[56:59], a[160:163], v[92:95]
ds_read_b128 v[56:59], v14 offset:768
v_mfma_f32_16x16x32_bf16 v[96:99], v[60:63], a[32:35], v[96:99]
buffer_load_dwordx4 v12, s[16:19], s29 offen offset:2048 lds
v_mfma_f32_16x16x32_bf16 v[100:103], v[60:63], a[160:163], v[100:103]
ds_read_b128 v[60:63], v14 offset:4864
s_waitcnt lgkmcnt(6)
v_mfma_f32_16x16x32_bf16 v[88:91], v[64:67], a[36:39], v[88:91]
v_mfma_f32_16x16x32_bf16 v[92:95], v[64:67], a[164:167], v[92:95]
ds_read_b128 v[64:67], v15 offset:768
v_mfma_f32_16x16x32_bf16 v[96:99], v[68:71], a[36:39], v[96:99]
v_mfma_f32_16x16x32_bf16 v[100:103], v[68:71], a[164:167], v[100:103]
ds_read_b128 v[68:71], v15 offset:4864
s_waitcnt lgkmcnt(6)
v_mfma_f32_16x16x32_bf16 v[88:91], v[72:75], a[40:43], v[88:91]
v_mfma_f32_16x16x32_bf16 v[92:95], v[72:75], a[168:171], v[92:95]
ds_read_b128 v[72:75], v16 offset:768
v_mfma_f32_16x16x32_bf16 v[96:99], v[76:79], a[40:43], v[96:99]
buffer_load_dwordx4 v13, s[16:19], s29 offen offset:3072 lds
v_mfma_f32_16x16x32_bf16 v[100:103], v[76:79], a[168:171], v[100:103]
ds_read_b128 v[76:79], v16 offset:4864
s_waitcnt lgkmcnt(6)
v_mfma_f32_16x16x32_bf16 v[88:91], v[80:83], a[44:47], v[88:91]
v_mfma_f32_16x16x32_bf16 v[92:95], v[80:83], a[172:175], v[92:95]
ds_read_b128 v[80:83], v17 offset:768
v_mfma_f32_16x16x32_bf16 v[96:99], v[84:87], a[44:47], v[96:99]
v_mfma_f32_16x16x32_bf16 v[100:103], v[84:87], a[172:175], v[100:103]
ds_read_b128 v[84:87], v17 offset:4864
s_waitcnt vmcnt(11)
s_barrier
s_waitcnt lgkmcnt(6)
v_mfma_f32_16x16x32_bf16 v[88:91], v[56:59], a[48:51], v[88:91]
v_mfma_f32_16x16x32_bf16 v[92:95], v[56:59], a[176:179], v[92:95]
ds_read_b128 v[56:59], v14 offset:32768
s_add_u32 m0, s44, 98304
s_add_u32 s29, s39, 66560
v_mfma_f32_16x16x32_bf16 v[96:99], v[60:63], a[48:51], v[96:99]
buffer_load_dwordx4 v10, s[16:19], s29 offen offset:0 lds
v_mfma_f32_16x16x32_bf16 v[100:103], v[60:63], a[176:179], v[100:103]
ds_read_b128 v[60:63], v14 offset:36864
s_waitcnt lgkmcnt(6)
v_mfma_f32_16x16x32_bf16 v[88:91], v[64:67], a[52:55], v[88:91]
v_mfma_f32_16x16x32_bf16 v[92:95], v[64:67], a[180:183], v[92:95]
ds_read_b128 v[64:67], v15 offset:32768
v_mfma_f32_16x16x32_bf16 v[96:99], v[68:71], a[52:55], v[96:99]
v_mfma_f32_16x16x32_bf16 v[100:103], v[68:71], a[180:183], v[100:103]
ds_read_b128 v[68:71], v15 offset:36864
s_waitcnt lgkmcnt(6)
v_mfma_f32_16x16x32_bf16 v[88:91], v[72:75], a[56:59], v[88:91]
v_mfma_f32_16x16x32_bf16 v[92:95], v[72:75], a[184:187], v[92:95]
ds_read_b128 v[72:75], v16 offset:32768
v_mfma_f32_16x16x32_bf16 v[96:99], v[76:79], a[56:59], v[96:99]
buffer_load_dwordx4 v11, s[16:19], s29 offen offset:1024 lds
v_mfma_f32_16x16x32_bf16 v[100:103], v[76:79], a[184:187], v[100:103]
ds_read_b128 v[76:79], v16 offset:36864
s_waitcnt lgkmcnt(6)
v_mfma_f32_16x16x32_bf16 v[88:91], v[80:83], a[60:63], v[88:91]
v_mfma_f32_16x16x32_bf16 v[92:95], v[80:83], a[188:191], v[92:95]
ds_read_b128 v[80:83], v17 offset:32768
v_mfma_f32_16x16x32_bf16 v[96:99], v[84:87], a[60:63], v[96:99]
v_mfma_f32_16x16x32_bf16 v[100:103], v[84:87], a[188:191], v[100:103]
ds_read_b128 v[84:87], v17 offset:36864
s_waitcnt lgkmcnt(6)
v_mfma_f32_16x16x32_bf16 v[88:91], v[56:59], a[64:67], v[88:91]
v_mfma_f32_16x16x32_bf16 v[92:95], v[56:59], a[192:195], v[92:95]
ds_read_b128 v[56:59], v14 offset:33024
v_mfma_f32_16x16x32_bf16 v[96:99], v[60:63], a[64:67], v[96:99]
buffer_load_dwordx4 v12, s[16:19], s29 offen offset:2048 lds
v_mfma_f32_16x16x32_bf16 v[100:103], v[60:63], a[192:195], v[100:103]
ds_read_b128 v[60:63], v14 offset:37120
s_waitcnt lgkmcnt(6)
v_mfma_f32_16x16x32_bf16 v[88:91], v[64:67], a[68:71], v[88:91]
v_mfma_f32_16x16x32_bf16 v[92:95], v[64:67], a[196:199], v[92:95]
ds_read_b128 v[64:67], v15 offset:33024
v_mfma_f32_16x16x32_bf16 v[96:99], v[68:71], a[68:71], v[96:99]
v_mfma_f32_16x16x32_bf16 v[100:103], v[68:71], a[196:199], v[100:103]
ds_read_b128 v[68:71], v15 offset:37120
s_waitcnt lgkmcnt(6)
v_mfma_f32_16x16x32_bf16 v[88:91], v[72:75], a[72:75], v[88:91]
v_mfma_f32_16x16x32_bf16 v[92:95], v[72:75], a[200:203], v[92:95]
ds_read_b128 v[72:75], v16 offset:33024
v_mfma_f32_16x16x32_bf16 v[96:99], v[76:79], a[72:75], v[96:99]
buffer_load_dwordx4 v13, s[16:19], s29 offen offset:3072 lds
v_mfma_f32_16x16x32_bf16 v[100:103], v[76:79], a[200:203], v[100:103]
ds_read_b128 v[76:79], v16 offset:37120
s_waitcnt lgkmcnt(6)
v_mfma_f32_16x16x32_bf16 v[88:91], v[80:83], a[76:79], v[88:91]
v_mfma_f32_16x16x32_bf16 v[92:95], v[80:83], a[204:207], v[92:95]
ds_read_b128 v[80:83], v17 offset:33024
v_mfma_f32_16x16x32_bf16 v[96:99], v[84:87], a[76:79], v[96:99]
v_mfma_f32_16x16x32_bf16 v[100:103], v[84:87], a[204:207], v[100:103]
ds_read_b128 v[84:87], v17 offset:37120
s_waitcnt lgkmcnt(6)
v_mfma_f32_16x16x32_bf16 v[88:91], v[56:59], a[80:83], v[88:91]
s_cmp_lt_u32 s38, 64
s_cbranch_scc1 L_wpN11
s_sub_u32 s46, s38, 64
s_lshl_b32 s46, s46, 17
buffer_load_dword v26, v31, s[12:15], s46 offen
L_wpN11:
v_mfma_f32_16x16x32_bf16 v[92:95], v[56:59], a[208:211], v[92:95]
ds_read_b128 v[56:59], v14 offset:33280
s_add_u32 m0, s44, 102400
s_add_u32 s29, s39, 74752
v_mfma_f32_16x16x32_bf16 v[96:99], v[60:63], a[80:83], v[96:99]
buffer_load_dwordx4 v10, s[16:19], s29 offen offset:0 lds
v_mfma_f32_16x16x32_bf16 v[100:103], v[60:63], a[208:211], v[100:103]
ds_read_b128 v[60:63], v14 offset:37376
s_waitcnt lgkmcnt(6)
v_mfma_f32_16x16x32_bf16 v[88:91], v[64:67], a[84:87], v[88:91]
v_mfma_f32_16x16x32_bf16 v[92:95], v[64:67], a[212:215], v[92:95]
ds_read_b128 v[64:67], v15 offset:33280
v_mfma_f32_16x16x32_bf16 v[96:99], v[68:71], a[84:87], v[96:99]
v_mfma_f32_16x16x32_bf16 v[100:103], v[68:71], a[212:215], v[100:103]
ds_read_b128 v[68:71], v15 offset:37376
s_waitcnt lgkmcnt(6)
v_mfma_f32_16x16x32_bf16 v[88:91], v[72:75], a[88:91], v[88:91]
v_mfma_f32_16x16x32_bf16 v[92:95], v[72:75], a[216:219], v[92:95]
ds_read_b128 v[72:75], v16 offset:33280
v_mfma_f32_16x16x32_bf16 v[96:99], v[76:79], a[88:91], v[96:99]
buffer_load_dwordx4 v11, s[16:19], s29 offen offset:1024 lds
v_mfma_f32_16x16x32_bf16 v[100:103], v[76:79], a[216:219], v[100:103]
ds_read_b128 v[76:79], v16 offset:37376
s_waitcnt lgkmcnt(6)
v_mfma_f32_16x16x32_bf16 v[88:91], v[80:83], a[92:95], v[88:91]
v_mfma_f32_16x16x32_bf16 v[92:95], v[80:83], a[220:223], v[92:95]
ds_read_b128 v[80:83], v17 offset:33280
v_mfma_f32_16x16x32_bf16 v[96:99], v[84:87], a[92:95], v[96:99]
v_mfma_f32_16x16x32_bf16 v[100:103], v[84:87], a[220:223], v[100:103]
ds_read_b128 v[84:87], v17 offset:37376
s_waitcnt lgkmcnt(6)
v_mfma_f32_16x16x32_bf16 v[88:91], v[56:59], a[96:99], v[88:91]
v_mfma_f32_16x16x32_bf16 v[92:95], v[56:59], a[224:227], v[92:95]
ds_read_b128 v[56:59], v14 offset:33536
v_mfma_f32_16x16x32_bf16 v[96:99], v[60:63], a[96:99], v[96:99]
buffer_load_dwordx4 v12, s[16:19], s29 offen offset:2048 lds
v_mfma_f32_16x16x32_bf16 v[100:103], v[60:63], a[224:227], v[100:103]
ds_read_b128 v[60:63], v14 offset:37632
s_waitcnt lgkmcnt(6)
v_mfma_f32_16x16x32_bf16 v[88:91], v[64:67], a[100:103], v[88:91]
v_mfma_f32_16x16x32_bf16 v[92:95], v[64:67], a[228:231], v[92:95]
ds_read_b128 v[64:67], v15 offset:33536
v_mfma_f32_16x16x32_bf16 v[96:99], v[68:71], a[100:103], v[96:99]
v_mfma_f32_16x16x32_bf16 v[100:103], v[68:71], a[228:231], v[100:103]
ds_read_b128 v[68:71], v15 offset:37632
s_waitcnt lgkmcnt(6)
v_mfma_f32_16x16x32_bf16 v[88:91], v[72:75], a[104:107], v[88:91]
v_mfma_f32_16x16x32_bf16 v[92:95], v[72:75], a[232:235], v[92:95]
ds_read_b128 v[72:75], v16 offset:33536
v_mfma_f32_16x16x32_bf16 v[96:99], v[76:79], a[104:107], v[96:99]
buffer_load_dwordx4 v13, s[16:19], s29 offen offset:3072 lds
v_mfma_f32_16x16x32_bf16 v[100:103], v[76:79], a[232:235], v[100:103]
ds_read_b128 v[76:79], v16 offset:37632
s_waitcnt lgkmcnt(6)
v_mfma_f32_16x16x32_bf16 v[88:91], v[80:83], a[108:111], v[88:91]
v_mfma_f32_16x16x32_bf16 v[92:95], v[80:83], a[236:239], v[92:95]
ds_read_b128 v[80:83], v17 offset:33536
v_mfma_f32_16x16x32_bf16 v[96:99], v[84:87], a[108:111], v[96:99]
v_mfma_f32_16x16x32_bf16 v[100:103], v[84:87], a[236:239], v[100:103]
ds_read_b128 v[84:87], v17 offset:37632
s_waitcnt vmcnt(8)
s_barrier
s_waitcnt lgkmcnt(6)
v_mfma_f32_16x16x32_bf16 v[88:91], v[56:59], a[112:115], v[88:91]
s_add_u32 s38, s38, 1
v_mfma_f32_16x16x32_bf16 v[92:95], v[56:59], a[240:243], v[92:95]
ds_read_b128 v[56:59], v18 offset:0
s_add_u32 m0, s44, 0
s_add_u32 s29, s39, 131072
v_mfma_f32_16x16x32_bf16 v[96:99], v[60:63], a[112:115], v[96:99]
buffer_load_dwordx4 v10, s[16:19], s29 offen offset:0 lds
v_mfma_f32_16x16x32_bf16 v[100:103], v[60:63], a[240:243], v[100:103]
ds_read_b128 v[60:63], v18 offset:4096
s_waitcnt lgkmcnt(6)
v_mfma_f32_16x16x32_bf16 v[88:91], v[64:67], a[116:119], v[88:91]
v_mfma_f32_16x16x32_bf16 v[92:95], v[64:67], a[244:247], v[92:95]
ds_read_b128 v[64:67], v19 offset:0
v_mfma_f32_16x16x32_bf16 v[96:99], v[68:71], a[116:119], v[96:99]
v_mfma_f32_16x16x32_bf16 v[100:103], v[68:71], a[244:247], v[100:103]
ds_read_b128 v[68:71], v19 offset:4096
s_waitcnt lgkmcnt(6)
v_mfma_f32_16x16x32_bf16 v[88:91], v[72:75], a[120:123], v[88:91]
v_mfma_f32_16x16x32_bf16 v[92:95], v[72:75], a[248:251], v[92:95]
ds_read_b128 v[72:75], v20 offset:0
v_mfma_f32_16x16x32_bf16 v[96:99], v[76:79], a[120:123], v[96:99]
buffer_load_dwordx4 v11, s[16:19], s29 offen offset:1024 lds
v_mfma_f32_16x16x32_bf16 v[100:103], v[76:79], a[248:251], v[100:103]
ds_read_b128 v[76:79], v20 offset:4096
s_waitcnt lgkmcnt(6)
v_mfma_f32_16x16x32_bf16 v[88:91], v[80:83], a[124:127], v[88:91]
v_mfma_f32_16x16x32_bf16 v[92:95], v[80:83], a[252:255], v[92:95]
ds_read_b128 v[80:83], v21 offset:0
v_mfma_f32_16x16x32_bf16 v[96:99], v[84:87], a[124:127], v[96:99]
v_mfma_f32_16x16x32_bf16 v[100:103], v[84:87], a[252:255], v[100:103]
ds_read_b128 v[84:87], v21 offset:4096
s_cmp_eq_u32 s38, 64
s_cbranch_scc1 L_gx_N
s_waitcnt lgkmcnt(6)
v_mfma_f32_16x16x32_bf16 v[104:107], v[56:59], a[0:3], 0
v_mfma_f32_16x16x32_bf16 v[108:111], v[56:59], a[128:131], 0
ds_read_b128 v[56:59], v18 offset:256
v_mfma_f32_16x16x32_bf16 v[112:115], v[60:63], a[0:3], 0
buffer_load_dwordx4 v12, s[16:19], s29 offen offset:2048 lds
v_mfma_f32_16x16x32_bf16 v[116:119], v[60:63], a[128:131], 0
ds_read_b128 v[60:63], v18 offset:4352
s_waitcnt lgkmcnt(6)
v_mfma_f32_16x16x32_bf16 v[104:107], v[64:67], a[4:7], v[104:107]
v_mfma_f32_16x16x32_bf16 v[108:111], v[64:67], a[132:135], v[108:111]
ds_read_b128 v[64:67], v19 offset:256
v_mfma_f32_16x16x32_bf16 v[112:115], v[68:71], a[4:7], v[112:115]
v_mfma_f32_16x16x32_bf16 v[116:119], v[68:71], a[132:135], v[116:119]
ds_read_b128 v[68:71], v19 offset:4352
s_waitcnt lgkmcnt(6)
v_mfma_f32_16x16x32_bf16 v[104:107], v[72:75], a[8:11], v[104:107]
v_cvt_pk_bf16_f32 v120, v88, v89
v_cvt_pk_bf16_f32 v121, v90, v91
v_mfma_f32_16x16x32_bf16 v[108:111], v[72:75], a[136:139], v[108:111]
v_cvt_pk_bf16_f32 v122, v96, v97
ds_read_b128 v[72:75], v20 offset:256
v_mfma_f32_16x16x32_bf16 v[112:115], v[76:79], a[8:11], v[112:115]
buffer_load_dwordx4 v13, s[16:19], s29 offen offset:3072 lds
v_mfma_f32_16x16x32_bf16 v[116:119], v[76:79], a[136:139], v[116:119]
ds_read_b128 v[76:79], v20 offset:4352
s_waitcnt lgkmcnt(6)
v_mfma_f32_16x16x32_bf16 v[104:107], v[80:83], a[12:15], v[104:107]
v_cvt_pk_bf16_f32 v123, v98, v99
buffer_store_dwordx4 v[120:123], v22, s[4:7], s40 offen offset:0 sc1
v_mfma_f32_16x16x32_bf16 v[108:111], v[80:83], a[140:143], v[108:111]
v_cvt_pk_bf16_f32 v124, v92, v93
ds_read_b128 v[80:83], v21 offset:256
v_mfma_f32_16x16x32_bf16 v[112:115], v[84:87], a[12:15], v[112:115]
v_cvt_pk_bf16_f32 v125, v94, v95
v_cvt_pk_bf16_f32 v126, v100, v101
v_mfma_f32_16x16x32_bf16 v[116:119], v[84:87], a[140:143], v[116:119]
ds_read_b128 v[84:87], v21 offset:4352
s_waitcnt lgkmcnt(6)
v_mfma_f32_16x16x32_bf16 v[104:107], v[56:59], a[16:19], v[104:107]
v_cvt_pk_bf16_f32 v127, v102, v103
buffer_store_dwordx4 v[36:39], v30, s[4:7], s40 offen sc1
v_mfma_f32_16x16x32_bf16 v[108:111], v[56:59], a[144:147], v[108:111]
buffer_store_dwordx4 v[124:127], v22, s[4:7], s40 offen offset:1024 sc1
ds_read_b128 v[56:59], v18 offset:512
s_add_u32 m0, s44, 4096
s_add_u32 s29, s39, 139264
v_mfma_f32_16x16x32_bf16 v[112:115], v[60:63], a[16:19], v[112:115]
buffer_load_dwordx4 v10, s[16:19], s29 offen offset:0 lds
v_mfma_f32_16x16x32_bf16 v[116:119], v[60:63], a[144:147], v[116:119]
ds_read_b128 v[60:63], v18 offset:4608
s_waitcnt lgkmcnt(6)
v_mfma_f32_16x16x32_bf16 v[104:107], v[64:67], a[20:23], v[104:107]
s_lshr_b32 s40, s47, 8
s_xor_b32 s40, s40, s56
v_mfma_f32_16x16x32_bf16 v[108:111], v[64:67], a[148:151], v[108:111]
s_and_b32 s40, s40, s55
ds_read_b128 v[64:67], v19 offset:512
v_mfma_f32_16x16x32_bf16 v[112:115], v[68:71], a[20:23], v[112:115]
s_or_b32 s40, s40, s47
s_add_u32 s47, s47, s36
v_mfma_f32_16x16x32_bf16 v[116:119], v[68:71], a[148:151], v[116:119]
ds_read_b128 v[68:71], v19 offset:4608
s_waitcnt lgkmcnt(6)
v_mfma_f32_16x16x32_bf16 v[104:107], v[72:75], a[24:27], v[104:107]
v_mfma_f32_16x16x32_bf16 v[108:111], v[72:75], a[152:155], v[108:111]
ds_read_b128 v[72:75], v20 offset:512
v_mfma_f32_16x16x32_bf16 v[112:115], v[76:79], a[24:27], v[112:115]
buffer_load_dwordx4 v11, s[16:19], s29 offen offset:1024 lds
v_mfma_f32_16x16x32_bf16 v[116:119], v[76:79], a[152:155], v[116:119]
ds_read_b128 v[76:79], v20 offset:4608
s_waitcnt lgkmcnt(6)
v_mfma_f32_16x16x32_bf16 v[104:107], v[80:83], a[28:31], v[104:107]
v_mfma_f32_16x16x32_bf16 v[108:111], v[80:83], a[156:159], v[108:111]
ds_read_b128 v[80:83], v21 offset:512
v_mfma_f32_16x16x32_bf16 v[112:115], v[84:87], a[28:31], v[112:115]
v_mfma_f32_16x16x32_bf16 v[116:119], v[84:87], a[156:159], v[116:119]
ds_read_b128 v[84:87], v21 offset:4608
s_waitcnt lgkmcnt(6)
v_mfma_f32_16x16x32_bf16 v[104:107], v[56:59], a[32:35], v[104:107]
v_mfma_f32_16x16x32_bf16 v[108:111], v[56:59], a[160:163], v[108:111]
ds_read_b128 v[56:59], v18 offset:768
v_mfma_f32_16x16x32_bf16 v[112:115], v[60:63], a[32:35], v[112:115]
buffer_load_dwordx4 v12, s[16:19], s29 offen offset:2048 lds
v_mfma_f32_16x16x32_bf16 v[116:119], v[60:63], a[160:163], v[116:119]
ds_read_b128 v[60:63], v18 offset:4864
s_waitcnt lgkmcnt(6)
v_mfma_f32_16x16x32_bf16 v[104:107], v[64:67], a[36:39], v[104:107]
v_mfma_f32_16x16x32_bf16 v[108:111], v[64:67], a[164:167], v[108:111]
ds_read_b128 v[64:67], v19 offset:768
v_mfma_f32_16x16x32_bf16 v[112:115], v[68:71], a[36:39], v[112:115]
v_mfma_f32_16x16x32_bf16 v[116:119], v[68:71], a[164:167], v[116:119]
ds_read_b128 v[68:71], v19 offset:4864
s_waitcnt lgkmcnt(6)
v_mfma_f32_16x16x32_bf16 v[104:107], v[72:75], a[40:43], v[104:107]
v_mfma_f32_16x16x32_bf16 v[108:111], v[72:75], a[168:171], v[108:111]
ds_read_b128 v[72:75], v20 offset:768
v_mfma_f32_16x16x32_bf16 v[112:115], v[76:79], a[40:43], v[112:115]
buffer_load_dwordx4 v13, s[16:19], s29 offen offset:3072 lds
v_mfma_f32_16x16x32_bf16 v[116:119], v[76:79], a[168:171], v[116:119]
ds_read_b128 v[76:79], v20 offset:4864
s_waitcnt lgkmcnt(6)
v_mfma_f32_16x16x32_bf16 v[104:107], v[80:83], a[44:47], v[104:107]
v_mfma_f32_16x16x32_bf16 v[108:111], v[80:83], a[172:175], v[108:111]
ds_read_b128 v[80:83], v21 offset:768
v_mfma_f32_16x16x32_bf16 v[112:115], v[84:87], a[44:47], v[112:115]
v_mfma_f32_16x16x32_bf16 v[116:119], v[84:87], a[172:175], v[116:119]
ds_read_b128 v[84:87], v21 offset:4864
s_waitcnt vmcnt(11)
s_barrier
s_waitcnt lgkmcnt(6)
v_mfma_f32_16x16x32_bf16 v[104:107], v[56:59], a[48:51], v[104:107]
v_mfma_f32_16x16x32_bf16 v[108:111], v[56:59], a[176:179], v[108:111]
ds_read_b128 v[56:59], v18 offset:32768
s_add_u32 m0, s44, 32768
s_add_u32 s29, s39, 132096
v_mfma_f32_16x16x32_bf16 v[112:115], v[60:63], a[48:51], v[112:115]
buffer_load_dwordx4 v10, s[16:19], s29 offen offset:0 lds
v_mfma_f32_16x16x32_bf16 v[116:119], v[60:63], a[176:179], v[116:119]
ds_read_b128 v[60:63], v18 offset:36864
s_waitcnt lgkmcnt(6)
v_mfma_f32_16x16x32_bf16 v[104:107], v[64:67], a[52:55], v[104:107]
v_mfma_f32_16x16x32_bf16 v[108:111], v[64:67], a[180:183], v[108:111]
ds_read_b128 v[64:67], v19 offset:32768
v_mfma_f32_16x16x32_bf16 v[112:115], v[68:71], a[52:55], v[112:115]
v_mfma_f32_16x16x32_bf16 v[116:119], v[68:71], a[180:183], v[116:119]
ds_read_b128 v[68:71], v19 offset:36864
s_waitcnt lgkmcnt(6)
v_mfma_f32_16x16x32_bf16 v[104:107], v[72:75], a[56:59], v[104:107]
v_mfma_f32_16x16x32_bf16 v[108:111], v[72:75], a[184:187], v[108:111]
ds_read_b128 v[72:75], v20 offset:32768
v_mfma_f32_16x16x32_bf16 v[112:115], v[76:79], a[56:59], v[112:115]
buffer_load_dwordx4 v11, s[16:19], s29 offen offset:1024 lds
v_mfma_f32_16x16x32_bf16 v[116:119], v[76:79], a[184:187], v[116:119]
ds_read_b128 v[76:79], v20 offset:36864
s_waitcnt lgkmcnt(6)
v_mfma_f32_16x16x32_bf16 v[104:107], v[80:83], a[60:63], v[104:107]
v_mfma_f32_16x16x32_bf16 v[108:111], v[80:83], a[188:191], v[108:111]
ds_read_b128 v[80:83], v21 offset:32768
v_mfma_f32_16x16x32_bf16 v[112:115], v[84:87], a[60:63], v[112:115]
v_mfma_f32_16x16x32_bf16 v[116:119], v[84:87], a[188:191], v[116:119]
ds_read_b128 v[84:87], v21 offset:36864
s_waitcnt lgkmcnt(6)
v_mfma_f32_16x16x32_bf16 v[104:107], v[56:59], a[64:67], v[104:107]
v_mfma_f32_16x16x32_bf16 v[108:111], v[56:59], a[192:195], v[108:111]
ds_read_b128 v[56:59], v18 offset:33024
v_mfma_f32_16x16x32_bf16 v[112:115], v[60:63], a[64:67], v[112:115]
buffer_load_dwordx4 v12, s[16:19], s29 offen offset:2048 lds
v_mfma_f32_16x16x32_bf16 v[116:119], v[60:63], a[192:195], v[116:119]
ds_read_b128 v[60:63], v18 offset:37120
s_waitcnt lgkmcnt(6)
v_mfma_f32_16x16x32_bf16 v[104:107], v[64:67], a[68:71], v[104:107]
v_mfma_f32_16x16x32_bf16 v[108:111], v[64:67], a[196:199], v[108:111]
ds_read_b128 v[64:67], v19 offset:33024
v_mfma_f32_16x16x32_bf16 v[112:115], v[68:71], a[68:71], v[112:115]
v_mfma_f32_16x16x32_bf16 v[116:119], v[68:71], a[196:199], v[116:119]
ds_read_b128 v[68:71], v19 offset:37120
s_waitcnt lgkmcnt(6)
v_mfma_f32_16x16x32_bf16 v[104:107], v[72:75], a[72:75], v[104:107]
v_mfma_f32_16x16x32_bf16 v[108:111], v[72:75], a[200:203], v[108:111]
ds_read_b128 v[72:75], v20 offset:33024
v_mfma_f32_16x16x32_bf16 v[112:115], v[76:79], a[72:75], v[112:115]
buffer_load_dwordx4 v13, s[16:19], s29 offen offset:3072 lds
v_mfma_f32_16x16x32_bf16 v[116:119], v[76:79], a[200:203], v[116:119]
ds_read_b128 v[76:79], v20 offset:37120
s_waitcnt lgkmcnt(6)
v_mfma_f32_16x16x32_bf16 v[104:107], v[80:83], a[76:79], v[104:107]
v_mfma_f32_16x16x32_bf16 v[108:111], v[80:83], a[204:207], v[108:111]
ds_read_b128 v[80:83], v21 offset:33024
v_mfma_f32_16x16x32_bf16 v[112:115], v[84:87], a[76:79], v[112:115]
v_mfma_f32_16x16x32_bf16 v[116:119], v[84:87], a[204:207], v[116:119]
ds_read_b128 v[84:87], v21 offset:37120
s_waitcnt lgkmcnt(6)
v_mfma_f32_16x16x32_bf16 v[104:107], v[56:59], a[80:83], v[104:107]
s_cmp_lt_u32 s38, 64
s_cbranch_scc1 L_wpN31
s_sub_u32 s46, s38, 64
s_lshl_b32 s46, s46, 17
buffer_load_dword v26, v31, s[12:15], s46 offen
L_wpN31:
v_mfma_f32_16x16x32_bf16 v[108:111], v[56:59], a[208:211], v[108:111]
ds_read_b128 v[56:59], v18 offset:33280
s_add_u32 m0, s44, 36864
s_add_u32 s29, s39, 140288
v_mfma_f32_16x16x32_bf16 v[112:115], v[60:63], a[80:83], v[112:115]
buffer_load_dwordx4 v10, s[16:19], s29 offen offset:0 lds
v_mfma_f32_16x16x32_bf16 v[116:119], v[60:63], a[208:211], v[116:119]
ds_read_b128 v[60:63], v18 offset:37376
s_waitcnt lgkmcnt(6)
v_mfma_f32_16x16x32_bf16 v[104:107], v[64:67], a[84:87], v[104:107]
v_mfma_f32_16x16x32_bf16 v[108:111], v[64:67], a[212:215], v[108:111]
ds_read_b128 v[64:67], v19 offset:33280
v_mfma_f32_16x16x32_bf16 v[112:115], v[68:71], a[84:87], v[112:115]
v_mfma_f32_16x16x32_bf16 v[116:119], v[68:71], a[212:215], v[116:119]
ds_read_b128 v[68:71], v19 offset:37376
s_waitcnt lgkmcnt(6)
v_mfma_f32_16x16x32_bf16 v[104:107], v[72:75], a[88:91], v[104:107]
v_mfma_f32_16x16x32_bf16 v[108:111], v[72:75], a[216:219], v[108:111]
ds_read_b128 v[72:75], v20 offset:33280
v_mfma_f32_16x16x32_bf16 v[112:115], v[76:79], a[88:91], v[112:115]
buffer_load_dwordx4 v11, s[16:19], s29 offen offset:1024 lds
v_mfma_f32_16x16x32_bf16 v[116:119], v[76:79], a[216:219], v[116:119]
ds_read_b128 v[76:79], v20 offset:37376
s_waitcnt lgkmcnt(6)
v_mfma_f32_16x16x32_bf16 v[104:107], v[80:83], a[92:95], v[104:107]
v_mfma_f32_16x16x32_bf16 v[108:111], v[80:83], a[220:223], v[108:111]
ds_read_b128 v[80:83], v21 offset:33280
v_mfma_f32_16x16x32_bf16 v[112:115], v[84:87], a[92:95], v[112:115]
v_mfma_f32_16x16x32_bf16 v[116:119], v[84:87], a[220:223], v[116:119]
ds_read_b128 v[84:87], v21 offset:37376
s_waitcnt lgkmcnt(6)
v_mfma_f32_16x16x32_bf16 v[104:107], v[56:59], a[96:99], v[104:107]
v_mfma_f32_16x16x32_bf16 v[108:111], v[56:59], a[224:227], v[108:111]
ds_read_b128 v[56:59], v18 offset:33536
v_mfma_f32_16x16x32_bf16 v[112:115], v[60:63], a[96:99], v[112:115]
buffer_load_dwordx4 v12, s[16:19], s29 offen offset:2048 lds
v_mfma_f32_16x16x32_bf16 v[116:119], v[60:63], a[224:227], v[116:119]
ds_read_b128 v[60:63], v18 offset:37632
s_waitcnt lgkmcnt(6)
v_mfma_f32_16x16x32_bf16 v[104:107], v[64:67], a[100:103], v[104:107]
v_mfma_f32_16x16x32_bf16 v[108:111], v[64:67], a[228:231], v[108:111]
ds_read_b128 v[64:67], v19 offset:33536
v_mfma_f32_16x16x32_bf16 v[112:115], v[68:71], a[100:103], v[112:115]
v_mfma_f32_16x16x32_bf16 v[116:119], v[68:71], a[228:231], v[116:119]
ds_read_b128 v[68:71], v19 offset:37632
s_waitcnt lgkmcnt(6)
v_mfma_f32_16x16x32_bf16 v[104:107], v[72:75], a[104:107], v[104:107]
v_mfma_f32_16x16x32_bf16 v[108:111], v[72:75], a[232:235], v[108:111]
ds_read_b128 v[72:75], v20 offset:33536
v_mfma_f32_16x16x32_bf16 v[112:115], v[76:79], a[104:107], v[112:115]
buffer_load_dwordx4 v13, s[16:19], s29 offen offset:3072 lds
v_mfma_f32_16x16x32_bf16 v[116:119], v[76:79], a[232:235], v[116:119]
ds_read_b128 v[76:79], v20 offset:37632
s_waitcnt lgkmcnt(6)
v_mfma_f32_16x16x32_bf16 v[104:107], v[80:83], a[108:111], v[104:107]
v_mfma_f32_16x16x32_bf16 v[108:111], v[80:83], a[236:239], v[108:111]
ds_read_b128 v[80:83], v21 offset:33536
v_mfma_f32_16x16x32_bf16 v[112:115], v[84:87], a[108:111], v[112:115]
v_mfma_f32_16x16x32_bf16 v[116:119], v[84:87], a[236:239], v[116:119]
ds_read_b128 v[84:87], v21 offset:37632
s_waitcnt vmcnt(8)
s_barrier
s_waitcnt lgkmcnt(6)
v_mfma_f32_16x16x32_bf16 v[104:107], v[56:59], a[112:115], v[104:107]
s_add_u32 s38, s38, 1
v_mfma_f32_16x16x32_bf16 v[108:111], v[56:59], a[240:243], v[108:111]
ds_read_b128 v[56:59], v14 offset:0
s_add_u32 m0, s44, 65536
s_add_u32 s29, s39, 196608
v_mfma_f32_16x16x32_bf16 v[112:115], v[60:63], a[112:115], v[112:115]
buffer_load_dwordx4 v10, s[16:19], s29 offen offset:0 lds
v_mfma_f32_16x16x32_bf16 v[116:119], v[60:63], a[240:243], v[116:119]
ds_read_b128 v[60:63], v14 offset:4096
s_waitcnt lgkmcnt(6)
v_mfma_f32_16x16x32_bf16 v[104:107], v[64:67], a[116:119], v[104:107]
v_mfma_f32_16x16x32_bf16 v[108:111], v[64:67], a[244:247], v[108:111]
ds_read_b128 v[64:67], v15 offset:0
v_mfma_f32_16x16x32_bf16 v[112:115], v[68:71], a[116:119], v[112:115]
v_mfma_f32_16x16x32_bf16 v[116:119], v[68:71], a[244:247], v[116:119]
ds_read_b128 v[68:71], v15 offset:4096
s_waitcnt lgkmcnt(6)
v_mfma_f32_16x16x32_bf16 v[104:107], v[72:75], a[120:123], v[104:107]
v_mfma_f32_16x16x32_bf16 v[108:111], v[72:75], a[248:251], v[108:111]
ds_read_b128 v[72:75], v16 offset:0
v_mfma_f32_16x16x32_bf16 v[112:115], v[76:79], a[120:123], v[112:115]
buffer_load_dwordx4 v11, s[16:19], s29 offen offset:1024 lds
v_mfma_f32_16x16x32_bf16 v[116:119], v[76:79], a[248:251], v[116:119]
ds_read_b128 v[76:79], v16 offset:4096
s_waitcnt lgkmcnt(6)
v_mfma_f32_16x16x32_bf16 v[104:107], v[80:83], a[124:127], v[104:107]
v_mfma_f32_16x16x32_bf16 v[108:111], v[80:83], a[252:255], v[108:111]
ds_read_b128 v[80:83], v17 offset:0
v_mfma_f32_16x16x32_bf16 v[112:115], v[84:87], a[124:127], v[112:115]
v_mfma_f32_16x16x32_bf16 v[116:119], v[84:87], a[252:255], v[116:119]
ds_read_b128 v[84:87], v17 offset:4096
s_add_u32 s39, s39, 131072
s_branch L_gl_N1
.p2align 6
L_gl_N2:
s_waitcnt lgkmcnt(6)
v_mfma_f32_16x16x32_bf16 v[88:91], v[56:59], a[0:3], 0
v_mfma_f32_16x16x32_bf16 v[92:95], v[56:59], a[128:131], 0
ds_read_b128 v[56:59], v14 offset:256
v_mfma_f32_16x16x32_bf16 v[96:99], v[60:63], a[0:3], 0
v_mfma_f32_16x16x32_bf16 v[100:103], v[60:63], a[128:131], 0
ds_read_b128 v[60:63], v14 offset:4352
s_waitcnt lgkmcnt(6)
v_mfma_f32_16x16x32_bf16 v[88:91], v[64:67], a[4:7], v[88:91]
buffer_load_dwordx4 v12, s[16:19], s29 offen offset:2048 lds
v_mfma_f32_16x16x32_bf16 v[92:95], v[64:67], a[132:135], v[92:95]
ds_read_b128 v[64:67], v15 offset:256
v_mfma_f32_16x16x32_bf16 v[96:99], v[68:71], a[4:7], v[96:99]
v_mfma_f32_16x16x32_bf16 v[100:103], v[68:71], a[132:135], v[100:103]
ds_read_b128 v[68:71], v15 offset:4352
s_waitcnt lgkmcnt(6)
v_mfma_f32_16x16x32_bf16 v[88:91], v[72:75], a[8:11], v[88:91]
v_mfma_f32_16x16x32_bf16 v[92:95], v[72:75], a[136:139], v[92:95]
ds_read_b128 v[72:75], v16 offset:256
v_mfma_f32_16x16x32_bf16 v[96:99], v[76:79], a[8:11], v[96:99]
v_mfma_f32_16x16x32_bf16 v[100:103], v[76:79], a[136:139], v[100:103]
ds_read_b128 v[76:79], v16 offset:4352
s_waitcnt lgkmcnt(6)
v_mfma_f32_16x16x32_bf16 v[88:91], v[80:83], a[12:15], v[88:91]
buffer_load_dwordx4 v13, s[16:19], s29 offen offset:3072 lds
v_mfma_f32_16x16x32_bf16 v[92:95], v[80:83], a[140:143], v[92:95]
v_cvt_pk_bf16_f32 v120, v104, v105
ds_read_b128 v[80:83], v17 offset:256
v_mfma_f32_16x16x32_bf16 v[96:99], v[84:87], a[12:15], v[96:99]
v_cvt_pk_bf16_f32 v121, v106, v107
v_cvt_pk_bf16_f32 v122, v112, v113
v_mfma_f32_16x16x32_bf16 v[100:103], v[84:87], a[140:143], v[100:103]
ds_read_b128 v[84:87], v17 offset:4352
s_waitcnt lgkmcnt(6)
v_mfma_f32_16x16x32_bf16 v[88:91], v[56:59], a[16:19], v[88:91]
v_cvt_pk_bf16_f32 v123, v114, v115
buffer_store_dwordx4 v[120:123], v22, s[4:7], s40 offen offset:0 sc1
v_mfma_f32_16x16x32_bf16 v[92:95], v[56:59], a[144:147], v[92:95]
v_cvt_pk_bf16_f32 v124, v108, v109
ds_read_b128 v[56:59], v14 offset:512
v_mfma_f32_16x16x32_bf16 v[96:99], v[60:63], a[16:19], v[96:99]
v_cvt_pk_bf16_f32 v125, v110, v111
v_cvt_pk_bf16_f32 v126, v116, v117
v_mfma_f32_16x16x32_bf16 v[100:103], v[60:63], a[144:147], v[100:103]
ds_read_b128 v[60:63], v14 offset:4608
s_waitcnt lgkmcnt(6)
s_add_u32 m0, s44, 69632
s_add_u32 s29, s39, 73728
v_mfma_f32_16x16x32_bf16 v[88:91], v[64:67], a[20:23], v[88:91]
buffer_load_dwordx4 v10, s[16:19], s29 offen offset:0 lds
v_mfma_f32_16x16x32_bf16 v[92:95], v[64:67], a[148:151], v[92:95]
v_cvt_pk_bf16_f32 v127, v118, v119
ds_read_b128 v[64:67], v15 offset:512
v_mfma_f32_16x16x32_bf16 v[96:99], v[68:71], a[20:23], v[96:99]
buffer_store_dwordx4 v[36:39], v30, s[4:7], s40 offen sc1
buffer_store_dwordx4 v[124:127], v22, s[4:7], s40 offen offset:1024 sc1
v_mfma_f32_16x16x32_bf16 v[100:103], v[68:71], a[148:151], v[100:103]
ds_read_b128 v[68:71], v15 offset:4608
s_waitcnt lgkmcnt(6)
v_mfma_f32_16x16x32_bf16 v[88:91], v[72:75], a[24:27], v[88:91]
s_lshr_b32 s40, s47, 8
s_xor_b32 s40, s40, s56
v_mfma_f32_16x16x32_bf16 v[92:95], v[72:75], a[152:155], v[92:95]
s_and_b32 s40, s40, s55
ds_read_b128 v[72:75], v16 offset:512
v_mfma_f32_16x16x32_bf16 v[96:99], v[76:79], a[24:27], v[96:99]
s_or_b32 s40, s40, s47
s_add_u32 s47, s47, s36
v_mfma_f32_16x16x32_bf16 v[100:103], v[76:79], a[152:155], v[100:103]
ds_read_b128 v[76:79], v16 offset:4608
s_waitcnt lgkmcnt(6)
v_mfma_f32_16x16x32_bf16 v[88:91], v[80:83], a[28:31], v[88:91]
buffer_load_dwordx4 v11, s[16:19], s29 offen offset:1024 lds
v_mfma_f32_16x16x32_bf16 v[92:95], v[80:83], a[156:159], v[92:95]
ds_read_b128 v[80:83], v17 offset:512
v_mfma_f32_16x16x32_bf16 v[96:99], v[84:87], a[28:31], v[96:99]
v_mfma_f32_16x16x32_bf16 v[100:103], v[84:87], a[156:159], v[100:103]
ds_read_b128 v[84:87], v17 offset:4608
s_waitcnt lgkmcnt(6)
v_mfma_f32_16x16x32_bf16 v[88:91], v[56:59], a[32:35], v[88:91]
v_mfma_f32_16x16x32_bf16 v[92:95], v[56:59], a[160:163], v[92:95]
ds_read_b128 v[56:59], v14 offset:768
v_mfma_f32_16x16x32_bf16 v[96:99], v[60:63], a[32:35], v[96:99]
v_mfma_f32_16x16x32_bf16 v[100:103], v[60:63], a[160:163], v[100:103]
ds_read_b128 v[60:63], v14 offset:4864
s_waitcnt lgkmcnt(6)
v_mfma_f32_16x16x32_bf16 v[88:91], v[64:67], a[36:39], v[88:91]
buffer_load_dwordx4 v12, s[16:19], s29 offen offset:2048 lds
v_mfma_f32_16x16x32_bf16 v[92:95], v[64:67], a[164:167], v[92:95]
ds_read_b128 v[64:67], v15 offset:768
v_mfma_f32_16x16x32_bf16 v[96:99], v[68:71], a[36:39], v[96:99]
v_mfma_f32_16x16x32_bf16 v[100:103], v[68:71], a[164:167], v[100:103]
ds_read_b128 v[68:71], v15 offset:4864
s_waitcnt lgkmcnt(6)
v_mfma_f32_16x16x32_bf16 v[88:91], v[72:75], a[40:43], v[88:91]
v_mfma_f32_16x16x32_bf16 v[92:95], v[72:75], a[168:171], v[92:95]
ds_read_b128 v[72:75], v16 offset:768
v_mfma_f32_16x16x32_bf16 v[96:99], v[76:79], a[40:43], v[96:99]
v_mfma_f32_16x16x32_bf16 v[100:103], v[76:79], a[168:171], v[100:103]
ds_read_b128 v[76:79], v16 offset:4864
s_waitcnt lgkmcnt(6)
v_mfma_f32_16x16x32_bf16 v[88:91], v[80:83], a[44:47], v[88:91]
buffer_load_dwordx4 v13, s[16:19], s29 offen offset:3072 lds
v_mfma_f32_16x16x32_bf16 v[92:95], v[80:83], a[172:175], v[92:95]
ds_read_b128 v[80:83], v17 offset:768
v_mfma_f32_16x16x32_bf16 v[96:99], v[84:87], a[44:47], v[96:99]
v_mfma_f32_16x16x32_bf16 v[100:103], v[84:87], a[172:175], v[100:103]
ds_read_b128 v[84:87], v17 offset:4864
s_waitcnt vmcnt(11)
s_barrier
s_waitcnt lgkmcnt(6)
v_mfma_f32_16x16x32_bf16 v[88:91], v[56:59], a[48:51], v[88:91]
v_mfma_f32_16x16x32_bf16 v[92:95], v[56:59], a[176:179], v[92:95]
ds_read_b128 v[56:59], v14 offset:32768
v_mfma_f32_16x16x32_bf16 v[96:99], v[60:63], a[48:51], v[96:99]
v_mfma_f32_16x16x32_bf16 v[100:103], v[60:63], a[176:179], v[100:103]
ds_read_b128 v[60:63], v14 offset:36864
s_waitcnt lgkmcnt(6)
s_add_u32 m0, s44, 98304
s_add_u32 s29, s39, 66560
v_mfma_f32_16x16x32_bf16 v[88:91], v[64:67], a[52:55], v[88:91]
buffer_load_dwordx4 v10, s[16:19], s29 offen offset:0 lds
v_mfma_f32_16x16x32_bf16 v[92:95], v[64:67], a[180:183], v[92:95]
ds_read_b128 v[64:67], v15 offset:32768
v_mfma_f32_16x16x32_bf16 v[96:99], v[68:71], a[52:55], v[96:99]
v_mfma_f32_16x16x32_bf16 v[100:103], v[68:71], a[180:183], v[100:103]
ds_read_b128 v[68:71], v15 offset:36864
s_waitcnt lgkmcnt(6)
v_mfma_f32_16x16x32_bf16 v[88:91], v[72:75], a[56:59], v[88:91]
v_mfma_f32_16x16x32_bf16 v[92:95], v[72:75], a[184:187], v[92:95]
ds_read_b128 v[72:75], v16 offset:32768
v_mfma_f32_16x16x32_bf16 v[96:99], v[76:79], a[56:59], v[96:99]
v_mfma_f32_16x16x32_bf16 v[100:103], v[76:79], a[184:187], v[100:103]
ds_read_b128 v[76:79], v16 offset:36864
s_waitcnt lgkmcnt(6)
v_mfma_f32_16x16x32_bf16 v[88:91], v[80:83], a[60:63], v[88:91]
buffer_load_dwordx4 v11, s[16:19], s29 offen offset:1024 lds
v_mfma_f32_16x16x32_bf16 v[92:95], v[80:83], a[188:191], v[92:95]
ds_read_b128 v[80:83], v17 offset:32768
v_mfma_f32_16x16x32_bf16 v[96:99], v[84:87], a[60:63], v[96:99]
v_mfma_f32_16x16x32_bf16 v[100:103], v[84:87], a[188:191], v[100:103]
ds_read_b128 v[84:87], v17 offset:36864
s_waitcnt lgkmcnt(6)
v_mfma_f32_16x16x32_bf16 v[88:91], v[56:59], a[64:67], v[88:91]
v_mfma_f32_16x16x32_bf16 v[92:95], v[56:59], a[192:195], v[92:95]
ds_read_b128 v[56:59], v14 offset:33024
v_mfma_f32_16x16x32_bf16 v[96:99], v[60:63], a[64:67], v[96:99]
v_mfma_f32_16x16x32_bf16 v[100:103], v[60:63], a[192:195], v[100:103]
ds_read_b128 v[60:63], v14 offset:37120
s_waitcnt lgkmcnt(6)
v_mfma_f32_16x16x32_bf16 v[88:91], v[64:67], a[68:71], v[88:91]
buffer_load_dwordx4 v12, s[16:19], s29 offen offset:2048 lds
v_mfma_f32_16x16x32_bf16 v[92:95], v[64:67], a[196:199], v[92:95]
ds_read_b128 v[64:67], v15 offset:33024
v_mfma_f32_16x16x32_bf16 v[96:99], v[68:71], a[68:71], v[96:99]
v_mfma_f32_16x16x32_bf16 v[100:103], v[68:71], a[196:199], v[100:103]
ds_read_b128 v[68:71], v15 offset:37120
s_waitcnt lgkmcnt(6)
v_mfma_f32_16x16x32_bf16 v[88:91], v[72:75], a[72:75], v[88:91]
v_mfma_f32_16x16x32_bf16 v[92:95], v[72:75], a[200:203], v[92:95]
ds_read_b128 v[72:75], v16 offset:33024
v_mfma_f32_16x16x32_bf16 v[96:99], v[76:79], a[72:75], v[96:99]
v_mfma_f32_16x16x32_bf16 v[100:103], v[76:79], a[200:203], v[100:103]
ds_read_b128 v[76:79], v16 offset:37120
s_waitcnt lgkmcnt(6)
v_mfma_f32_16x16x32_bf16 v[88:91], v[80:83], a[76:79], v[88:91]
buffer_load_dwordx4 v13, s[16:19], s29 offen offset:3072 lds
v_mfma_f32_16x16x32_bf16 v[92:95], v[80:83], a[204:207], v[92:95]
ds_read_b128 v[80:83], v17 offset:33024
v_mfma_f32_16x16x32_bf16 v[96:99], v[84:87], a[76:79], v[96:99]
v_mfma_f32_16x16x32_bf16 v[100:103], v[84:87], a[204:207], v[100:103]
ds_read_b128 v[84:87], v17 offset:37120
s_waitcnt lgkmcnt(6)
v_mfma_f32_16x16x32_bf16 v[88:91], v[56:59], a[80:83], v[88:91]
s_cmp_lt_u32 s38, 64
s_cbranch_scc1 L_wpN12
s_sub_u32 s46, s38, 64
s_lshl_b32 s46, s46, 17
buffer_load_dword v26, v31, s[12:15], s46 offen
L_wpN12:
v_mfma_f32_16x16x32_bf16 v[92:95], v[56:59], a[208:211], v[92:95]
ds_read_b128 v[56:59], v14 offset:33280
v_mfma_f32_16x16x32_bf16 v[96:99], v[60:63], a[80:83], v[96:99]
v_mfma_f32_16x16x32_bf16 v[100:103], v[60:63], a[208:211], v[100:103]
ds_read_b128 v[60:63], v14 offset:37376
s_waitcnt lgkmcnt(6)
s_add_u32 m0, s44, 102400
s_add_u32 s29, s39, 74752
v_mfma_f32_16x16x32_bf16 v[88:91], v[64:67], a[84:87], v[88:91]
buffer_load_dwordx4 v10, s[16:19], s29 offen offset:0 lds
v_mfma_f32_16x16x32_bf16 v[92:95], v[64:67], a[212:215], v[92:95]
ds_read_b128 v[64:67], v15 offset:33280
v_mfma_f32_16x16x32_bf16 v[96:99], v[68:71], a[84:87], v[96:99]
v_mfma_f32_16x16x32_bf16 v[100:103], v[68:71], a[212:215], v[100:103]
ds_read_b128 v[68:71], v15 offset:37376
s_waitcnt lgkmcnt(6)
v_mfma_f32_16x16x32_bf16 v[88:91], v[72:75], a[88:91], v[88:91]
v_mfma_f32_16x16x32_bf16 v[92:95], v[72:75], a[216:219], v[92:95]
ds_read_b128 v[72:75], v16 offset:33280
v_mfma_f32_16x16x32_bf16 v[96:99], v[76:79], a[88:91], v[96:99]
v_mfma_f32_16x16x32_bf16 v[100:103], v[76:79], a[216:219], v[100:103]
ds_read_b128 v[76:79], v16 offset:37376
s_waitcnt lgkmcnt(6)
v_mfma_f32_16x16x32_bf16 v[88:91], v[80:83], a[92:95], v[88:91]
buffer_load_dwordx4 v11, s[16:19], s29 offen offset:1024 lds
v_mfma_f32_16x16x32_bf16 v[92:95], v[80:83], a[220:223], v[92:95]
ds_read_b128 v[80:83], v17 offset:33280
v_mfma_f32_16x16x32_bf16 v[96:99], v[84:87], a[92:95], v[96:99]
v_mfma_f32_16x16x32_bf16 v[100:103], v[84:87], a[220:223], v[100:103]
ds_read_b128 v[84:87], v17 offset:37376
s_waitcnt lgkmcnt(6)
v_mfma_f32_16x16x32_bf16 v[88:91], v[56:59], a[96:99], v[88:91]
v_mfma_f32_16x16x32_bf16 v[92:95], v[56:59], a[224:227], v[92:95]
ds_read_b128 v[56:59], v14 offset:33536
v_mfma_f32_16x16x32_bf16 v[96:99], v[60:63], a[96:99], v[96:99]
v_mfma_f32_16x16x32_bf16 v[100:103], v[60:63], a[224:227], v[100:103]
ds_read_b128 v[60:63], v14 offset:37632
s_waitcnt lgkmcnt(6)
v_mfma_f32_16x16x32_bf16 v[88:91], v[64:67], a[100:103], v[88:91]
buffer_load_dwordx4 v12, s[16:19], s29 offen offset:2048 lds
v_mfma_f32_16x16x32_bf16 v[92:95], v[64:67], a[228:231], v[92:95]
ds_read_b128 v[64:67], v15 offset:33536
v_mfma_f32_16x16x32_bf16 v[96:99], v[68:71], a[100:103], v[96:99]
v_mfma_f32_16x16x32_bf16 v[100:103], v[68:71], a[228:231], v[100:103]
ds_read_b128 v[68:71], v15 offset:37632
s_waitcnt lgkmcnt(6)
v_mfma_f32_16x16x32_bf16 v[88:91], v[72:75], a[104:107], v[88:91]
v_mfma_f32_16x16x32_bf16 v[92:95], v[72:75], a[232:235], v[92:95]
ds_read_b128 v[72:75], v16 offset:33536
v_mfma_f32_16x16x32_bf16 v[96:99], v[76:79], a[104:107], v[96:99]
v_mfma_f32_16x16x32_bf16 v[100:103], v[76:79], a[232:235], v[100:103]
ds_read_b128 v[76:79], v16 offset:37632
s_waitcnt lgkmcnt(6)
v_mfma_f32_16x16x32_bf16 v[88:91], v[80:83], a[108:111], v[88:91]
buffer_load_dwordx4 v13, s[16:19], s29 offen offset:3072 lds
v_mfma_f32_16x16x32_bf16 v[92:95], v[80:83], a[236:239], v[92:95]
ds_read_b128 v[80:83], v17 offset:33536
v_mfma_f32_16x16x32_bf16 v[96:99], v[84:87], a[108:111], v[96:99]
v_mfma_f32_16x16x32_bf16 v[100:103], v[84:87], a[236:239], v[100:103]
ds_read_b128 v[84:87], v17 offset:37632
s_waitcnt vmcnt(8)
s_barrier
s_waitcnt lgkmcnt(6)
v_mfma_f32_16x16x32_bf16 v[88:91], v[56:59], a[112:115], v[88:91]
s_add_u32 s38, s38, 1
v_mfma_f32_16x16x32_bf16 v[92:95], v[56:59], a[240:243], v[92:95]
ds_read_b128 v[56:59], v18 offset:0
v_mfma_f32_16x16x32_bf16 v[96:99], v[60:63], a[112:115], v[96:99]
v_mfma_f32_16x16x32_bf16 v[100:103], v[60:63], a[240:243], v[100:103]
ds_read_b128 v[60:63], v18 offset:4096
s_waitcnt lgkmcnt(6)
s_add_u32 m0, s44, 0
s_add_u32 s29, s39, 131072
v_mfma_f32_16x16x32_bf16 v[88:91], v[64:67], a[116:119], v[88:91]
buffer_load_dwordx4 v10, s[16:19], s29 offen offset:0 lds
v_mfma_f32_16x16x32_bf16 v[92:95], v[64:67], a[244:247], v[92:95]
ds_read_b128 v[64:67], v19 offset:0
v_mfma_f32_16x16x32_bf16 v[96:99], v[68:71], a[116:119], v[96:99]
v_mfma_f32_16x16x32_bf16 v[100:103], v[68:71], a[244:247], v[100:103]
ds_read_b128 v[68:71], v19 offset:4096
s_waitcnt lgkmcnt(6)
v_mfma_f32_16x16x32_bf16 v[88:91], v[72:75], a[120:123], v[88:91]
v_mfma_f32_16x16x32_bf16 v[92:95], v[72:75], a[248:251], v[92:95]
ds_read_b128 v[72:75], v20 offset:0
v_mfma_f32_16x16x32_bf16 v[96:99], v[76:79], a[120:123], v[96:99]
v_mfma_f32_16x16x32_bf16 v[100:103], v[76:79], a[248:251], v[100:103]
ds_read_b128 v[76:79], v20 offset:4096
s_waitcnt lgkmcnt(6)
v_mfma_f32_16x16x32_bf16 v[88:91], v[80:83], a[124:127], v[88:91]
buffer_load_dwordx4 v11, s[16:19], s29 offen offset:1024 lds
v_mfma_f32_16x16x32_bf16 v[92:95], v[80:83], a[252:255], v[92:95]
ds_read_b128 v[80:83], v21 offset:0
v_mfma_f32_16x16x32_bf16 v[96:99], v[84:87], a[124:127], v[96:99]
v_mfma_f32_16x16x32_bf16 v[100:103], v[84:87], a[252:255], v[100:103]
ds_read_b128 v[84:87], v21 offset:4096
s_cmp_eq_u32 s38, 64
s_cbranch_scc1 L_gx_N
s_waitcnt lgkmcnt(6)
v_mfma_f32_16x16x32_bf16 v[104:107], v[56:59], a[0:3], 0
v_mfma_f32_16x16x32_bf16 v[108:111], v[56:59], a[128:131], 0
ds_read_b128 v[56:59], v18 offset:256
v_mfma_f32_16x16x32_bf16 v[112:115], v[60:63], a[0:3], 0
v_mfma_f32_16x16x32_bf16 v[116:119], v[60:63], a[128:131], 0
ds_read_b128 v[60:63], v18 offset:4352
s_waitcnt lgkmcnt(6)
v_mfma_f32_16x16x32_bf16 v[104:107], v[64:67], a[4:7], v[104:107]
buffer_load_dwordx4 v12, s[16:19], s29 offen offset:2048 lds
v_mfma_f32_16x16x32_bf16 v[108:111], v[64:67], a[132:135], v[108:111]
ds_read_b128 v[64:67], v19 offset:256
v_mfma_f32_16x16x32_bf16 v[112:115], v[68:71], a[4:7], v[112:115]
v_mfma_f32_16x16x32_bf16 v[116:119], v[68:71], a[132:135], v[116:119]
ds_read_b128 v[68:71], v19 offset:4352
s_waitcnt lgkmcnt(6)
v_mfma_f32_16x16x32_bf16 v[104:107], v[72:75], a[8:11], v[104:107]
v_mfma_f32_16x16x32_bf16 v[108:111], v[72:75], a[136:139], v[108:111]
ds_read_b128 v[72:75], v20 offset:256
v_mfma_f32_16x16x32_bf16 v[112:115], v[76:79], a[8:11], v[112:115]
v_mfma_f32_16x16x32_bf16 v[116:119], v[76:79], a[136:139], v[116:119]
ds_read_b128 v[76:79], v20 offset:4352
s_waitcnt lgkmcnt(6)
v_mfma_f32_16x16x32_bf16 v[104:107], v[80:83], a[12:15], v[104:107]
buffer_load_dwordx4 v13, s[16:19], s29 offen offset:3072 lds
v_mfma_f32_16x16x32_bf16 v[108:111], v[80:83], a[140:143], v[108:111]
v_cvt_pk_bf16_f32 v120, v88, v89
ds_read_b128 v[80:83], v21 offset:256
v_mfma_f32_16x16x32_bf16 v[112:115], v[84:87], a[12:15], v[112:115]
v_cvt_pk_bf16_f32 v121, v90, v91
v_cvt_pk_bf16_f32 v122, v96, v97
v_mfma_f32_16x16x32_bf16 v[116:119], v[84:87], a[140:143], v[116:119]
ds_read_b128 v[84:87], v21 offset:4352
s_waitcnt lgkmcnt(6)
v_mfma_f32_16x16x32_bf16 v[104:107], v[56:59], a[16:19], v[104:107]
v_cvt_pk_bf16_f32 v123, v98, v99
buffer_store_dwordx4 v[120:123], v22, s[4:7], s40 offen offset:0 sc1
v_mfma_f32_16x16x32_bf16 v[108:111], v[56:59], a[144:147], v[108:111]
v_cvt_pk_bf16_f32 v124, v92, v93
ds_read_b128 v[56:59], v18 offset:512
v_mfma_f32_16x16x32_bf16 v[112:115], v[60:63], a[16:19], v[112:115]
v_cvt_pk_bf16_f32 v125, v94, v95
v_cvt_pk_bf16_f32 v126, v100, v101
v_mfma_f32_16x16x32_bf16 v[116:119], v[60:63], a[144:147], v[116:119]
ds_read_b128 v[60:63], v18 offset:4608
s_waitcnt lgkmcnt(6)
s_add_u32 m0, s44, 4096
s_add_u32 s29, s39, 139264
v_mfma_f32_16x16x32_bf16 v[104:107], v[64:67], a[20:23], v[104:107]
buffer_load_dwordx4 v10, s[16:19], s29 offen offset:0 lds
v_mfma_f32_16x16x32_bf16 v[108:111], v[64:67], a[148:151], v[108:111]
v_cvt_pk_bf16_f32 v127, v102, v103
ds_read_b128 v[64:67], v19 offset:512
v_mfma_f32_16x16x32_bf16 v[112:115], v[68:71], a[20:23], v[112:115]
buffer_store_dwordx4 v[36:39], v30, s[4:7], s40 offen sc1
buffer_store_dwordx4 v[124:127], v22, s[4:7], s40 offen offset:1024 sc1
v_mfma_f32_16x16x32_bf16 v[116:119], v[68:71], a[148:151], v[116:119]
ds_read_b128 v[68:71], v19 offset:4608
s_waitcnt lgkmcnt(6)
v_mfma_f32_16x16x32_bf16 v[104:107], v[72:75], a[24:27], v[104:107]
s_lshr_b32 s40, s47, 8
s_xor_b32 s40, s40, s56
v_mfma_f32_16x16x32_bf16 v[108:111], v[72:75], a[152:155], v[108:111]
s_and_b32 s40, s40, s55
ds_read_b128 v[72:75], v20 offset:512
v_mfma_f32_16x16x32_bf16 v[112:115], v[76:79], a[24:27], v[112:115]
s_or_b32 s40, s40, s47
s_add_u32 s47, s47, s36
v_mfma_f32_16x16x32_bf16 v[116:119], v[76:79], a[152:155], v[116:119]
ds_read_b128 v[76:79], v20 offset:4608
s_waitcnt lgkmcnt(6)
v_mfma_f32_16x16x32_bf16 v[104:107], v[80:83], a[28:31], v[104:107]
buffer_load_dwordx4 v11, s[16:19], s29 offen offset:1024 lds
v_mfma_f32_16x16x32_bf16 v[108:111], v[80:83], a[156:159], v[108:111]
ds_read_b128 v[80:83], v21 offset:512
v_mfma_f32_16x16x32_bf16 v[112:115], v[84:87], a[28:31], v[112:115]
v_mfma_f32_16x16x32_bf16 v[116:119], v[84:87], a[156:159], v[116:119]
ds_read_b128 v[84:87], v21 offset:4608
s_waitcnt lgkmcnt(6)
v_mfma_f32_16x16x32_bf16 v[104:107], v[56:59], a[32:35], v[104:107]
v_mfma_f32_16x16x32_bf16 v[108:111], v[56:59], a[160:163], v[108:111]
ds_read_b128 v[56:59], v18 offset:768
v_mfma_f32_16x16x32_bf16 v[112:115], v[60:63], a[32:35], v[112:115]
v_mfma_f32_16x16x32_bf16 v[116:119], v[60:63], a[160:163], v[116:119]
ds_read_b128 v[60:63], v18 offset:4864
s_waitcnt lgkmcnt(6)
v_mfma_f32_16x16x32_bf16 v[104:107], v[64:67], a[36:39], v[104:107]
buffer_load_dwordx4 v12, s[16:19], s29 offen offset:2048 lds
v_mfma_f32_16x16x32_bf16 v[108:111], v[64:67], a[164:167], v[108:111]
ds_read_b128 v[64:67], v19 offset:768
v_mfma_f32_16x16x32_bf16 v[112:115], v[68:71], a[36:39], v[112:115]
v_mfma_f32_16x16x32_bf16 v[116:119], v[68:71], a[164:167], v[116:119]
ds_read_b128 v[68:71], v19 offset:4864
s_waitcnt lgkmcnt(6)
v_mfma_f32_16x16x32_bf16 v[104:107], v[72:75], a[40:43], v[104:107]
v_mfma_f32_16x16x32_bf16 v[108:111], v[72:75], a[168:171], v[108:111]
ds_read_b128 v[72:75], v20 offset:768
v_mfma_f32_16x16x32_bf16 v[112:115], v[76:79], a[40:43], v[112:115]
v_mfma_f32_16x16x32_bf16 v[116:119], v[76:79], a[168:171], v[116:119]
ds_read_b128 v[76:79], v20 offset:4864
s_waitcnt lgkmcnt(6)
v_mfma_f32_16x16x32_bf16 v[104:107], v[80:83], a[44:47], v[104:107]
buffer_load_dwordx4 v13, s[16:19], s29 offen offset:3072 lds
v_mfma_f32_16x16x32_bf16 v[108:111], v[80:83], a[172:175], v[108:111]
ds_read_b128 v[80:83], v21 offset:768
v_mfma_f32_16x16x32_bf16 v[112:115], v[84:87], a[44:47], v[112:115]
v_mfma_f32_16x16x32_bf16 v[116:119], v[84:87], a[172:175], v[116:119]
ds_read_b128 v[84:87], v21 offset:4864
s_waitcnt vmcnt(11)
s_barrier
s_waitcnt lgkmcnt(6)
v_mfma_f32_16x16x32_bf16 v[104:107], v[56:59], a[48:51], v[104:107]
v_mfma_f32_16x16x32_bf16 v[108:111], v[56:59], a[176:179], v[108:111]
ds_read_b128 v[56:59], v18 offset:32768
v_mfma_f32_16x16x32_bf16 v[112:115], v[60:63], a[48:51], v[112:115]
v_mfma_f32_16x16x32_bf16 v[116:119], v[60:63], a[176:179], v[116:119]
ds_read_b128 v[60:63], v18 offset:36864
s_waitcnt lgkmcnt(6)
s_add_u32 m0, s44, 32768
s_add_u32 s29, s39, 132096
v_mfma_f32_16x16x32_bf16 v[104:107], v[64:67], a[52:55], v[104:107]
buffer_load_dwordx4 v10, s[16:19], s29 offen offset:0 lds
v_mfma_f32_16x16x32_bf16 v[108:111], v[64:67], a[180:183], v[108:111]
ds_read_b128 v[64:67], v19 offset:32768
v_mfma_f32_16x16x32_bf16 v[112:115], v[68:71], a[52:55], v[112:115]
v_mfma_f32_16x16x32_bf16 v[116:119], v[68:71], a[180:183], v[116:119]
ds_read_b128 v[68:71], v19 offset:36864
s_waitcnt lgkmcnt(6)
v_mfma_f32_16x16x32_bf16 v[104:107], v[72:75], a[56:59], v[104:107]
v_mfma_f32_16x16x32_bf16 v[108:111], v[72:75], a[184:187], v[108:111]
ds_read_b128 v[72:75], v20 offset:32768
v_mfma_f32_16x16x32_bf16 v[112:115], v[76:79], a[56:59], v[112:115]
v_mfma_f32_16x16x32_bf16 v[116:119], v[76:79], a[184:187], v[116:119]
ds_read_b128 v[76:79], v20 offset:36864
s_waitcnt lgkmcnt(6)
v_mfma_f32_16x16x32_bf16 v[104:107], v[80:83], a[60:63], v[104:107]
buffer_load_dwordx4 v11, s[16:19], s29 offen offset:1024 lds
v_mfma_f32_16x16x32_bf16 v[108:111], v[80:83], a[188:191], v[108:111]
ds_read_b128 v[80:83], v21 offset:32768
v_mfma_f32_16x16x32_bf16 v[112:115], v[84:87], a[60:63], v[112:115]
v_mfma_f32_16x16x32_bf16 v[116:119], v[84:87], a[188:191], v[116:119]
ds_read_b128 v[84:87], v21 offset:36864
s_waitcnt lgkmcnt(6)
v_mfma_f32_16x16x32_bf16 v[104:107], v[56:59], a[64:67], v[104:107]
v_mfma_f32_16x16x32_bf16 v[108:111], v[56:59], a[192:195], v[108:111]
ds_read_b128 v[56:59], v18 offset:33024
v_mfma_f32_16x16x32_bf16 v[112:115], v[60:63], a[64:67], v[112:115]
v_mfma_f32_16x16x32_bf16 v[116:119], v[60:63], a[192:195], v[116:119]
ds_read_b128 v[60:63], v18 offset:37120
s_waitcnt lgkmcnt(6)
v_mfma_f32_16x16x32_bf16 v[104:107], v[64:67], a[68:71], v[104:107]
buffer_load_dwordx4 v12, s[16:19], s29 offen offset:2048 lds
v_mfma_f32_16x16x32_bf16 v[108:111], v[64:67], a[196:199], v[108:111]
ds_read_b128 v[64:67], v19 offset:33024
v_mfma_f32_16x16x32_bf16 v[112:115], v[68:71], a[68:71], v[112:115]
v_mfma_f32_16x16x32_bf16 v[116:119], v[68:71], a[196:199], v[116:119]
ds_read_b128 v[68:71], v19 offset:37120
s_waitcnt lgkmcnt(6)
v_mfma_f32_16x16x32_bf16 v[104:107], v[72:75], a[72:75], v[104:107]
v_mfma_f32_16x16x32_bf16 v[108:111], v[72:75], a[200:203], v[108:111]
ds_read_b128 v[72:75], v20 offset:33024
v_mfma_f32_16x16x32_bf16 v[112:115], v[76:79], a[72:75], v[112:115]
v_mfma_f32_16x16x32_bf16 v[116:119], v[76:79], a[200:203], v[116:119]
ds_read_b128 v[76:79], v20 offset:37120
s_waitcnt lgkmcnt(6)
v_mfma_f32_16x16x32_bf16 v[104:107], v[80:83], a[76:79], v[104:107]
buffer_load_dwordx4 v13, s[16:19], s29 offen offset:3072 lds
v_mfma_f32_16x16x32_bf16 v[108:111], v[80:83], a[204:207], v[108:111]
ds_read_b128 v[80:83], v21 offset:33024
v_mfma_f32_16x16x32_bf16 v[112:115], v[84:87], a[76:79], v[112:115]
v_mfma_f32_16x16x32_bf16 v[116:119], v[84:87], a[204:207], v[116:119]
ds_read_b128 v[84:87], v21 offset:37120
s_waitcnt lgkmcnt(6)
v_mfma_f32_16x16x32_bf16 v[104:107], v[56:59], a[80:83], v[104:107]
s_cmp_lt_u32 s38, 64
s_cbranch_scc1 L_wpN32
s_sub_u32 s46, s38, 64
s_lshl_b32 s46, s46, 17
buffer_load_dword v26, v31, s[12:15], s46 offen
L_wpN32:
v_mfma_f32_16x16x32_bf16 v[108:111], v[56:59], a[208:211], v[108:111]
ds_read_b128 v[56:59], v18 offset:33280
v_mfma_f32_16x16x32_bf16 v[112:115], v[60:63], a[80:83], v[112:115]
v_mfma_f32_16x16x32_bf16 v[116:119], v[60:63], a[208:211], v[116:119]
ds_read_b128 v[60:63], v18 offset:37376
s_waitcnt lgkmcnt(6)
s_add_u32 m0, s44, 36864
s_add_u32 s29, s39, 140288
v_mfma_f32_16x16x32_bf16 v[104:107], v[64:67], a[84:87], v[104:107]
buffer_load_dwordx4 v10, s[16:19], s29 offen offset:0 lds
v_mfma_f32_16x16x32_bf16 v[108:111], v[64:67], a[212:215], v[108:111]
ds_read_b128 v[64:67], v19 offset:33280
v_mfma_f32_16x16x32_bf16 v[112:115], v[68:71], a[84:87], v[112:115]
v_mfma_f32_16x16x32_bf16 v[116:119], v[68:71], a[212:215], v[116:119]
ds_read_b128 v[68:71], v19 offset:37376
s_waitcnt lgkmcnt(6)
v_mfma_f32_16x16x32_bf16 v[104:107], v[72:75], a[88:91], v[104:107]
v_mfma_f32_16x16x32_bf16 v[108:111], v[72:75], a[216:219], v[108:111]
ds_read_b128 v[72:75], v20 offset:33280
v_mfma_f32_16x16x32_bf16 v[112:115], v[76:79], a[88:91], v[112:115]
v_mfma_f32_16x16x32_bf16 v[116:119], v[76:79], a[216:219], v[116:119]
ds_read_b128 v[76:79], v20 offset:37376
s_waitcnt lgkmcnt(6)
v_mfma_f32_16x16x32_bf16 v[104:107], v[80:83], a[92:95], v[104:107]
buffer_load_dwordx4 v11, s[16:19], s29 offen offset:1024 lds
v_mfma_f32_16x16x32_bf16 v[108:111], v[80:83], a[220:223], v[108:111]
ds_read_b128 v[80:83], v21 offset:33280
v_mfma_f32_16x16x32_bf16 v[112:115], v[84:87], a[92:95], v[112:115]
v_mfma_f32_16x16x32_bf16 v[116:119], v[84:87], a[220:223], v[116:119]
ds_read_b128 v[84:87], v21 offset:37376
s_waitcnt lgkmcnt(6)
v_mfma_f32_16x16x32_bf16 v[104:107], v[56:59], a[96:99], v[104:107]
v_mfma_f32_16x16x32_bf16 v[108:111], v[56:59], a[224:227], v[108:111]
ds_read_b128 v[56:59], v18 offset:33536
v_mfma_f32_16x16x32_bf16 v[112:115], v[60:63], a[96:99], v[112:115]
v_mfma_f32_16x16x32_bf16 v[116:119], v[60:63], a[224:227], v[116:119]
ds_read_b128 v[60:63], v18 offset:37632
s_waitcnt lgkmcnt(6)
v_mfma_f32_16x16x32_bf16 v[104:107], v[64:67], a[100:103], v[104:107]
buffer_load_dwordx4 v12, s[16:19], s29 offen offset:2048 lds
v_mfma_f32_16x16x32_bf16 v[108:111], v[64:67], a[228:231], v[108:111]
ds_read_b128 v[64:67], v19 offset:33536
v_mfma_f32_16x16x32_bf16 v[112:115], v[68:71], a[100:103], v[112:115]
v_mfma_f32_16x16x32_bf16 v[116:119], v[68:71], a[228:231], v[116:119]
ds_read_b128 v[68:71], v19 offset:37632
s_waitcnt lgkmcnt(6)
v_mfma_f32_16x16x32_bf16 v[104:107], v[72:75], a[104:107], v[104:107]
v_mfma_f32_16x16x32_bf16 v[108:111], v[72:75], a[232:235], v[108:111]
ds_read_b128 v[72:75], v20 offset:33536
v_mfma_f32_16x16x32_bf16 v[112:115], v[76:79], a[104:107], v[112:115]
v_mfma_f32_16x16x32_bf16 v[116:119], v[76:79], a[232:235], v[116:119]
ds_read_b128 v[76:79], v20 offset:37632
s_waitcnt lgkmcnt(6)
v_mfma_f32_16x16x32_bf16 v[104:107], v[80:83], a[108:111], v[104:107]
buffer_load_dwordx4 v13, s[16:19], s29 offen offset:3072 lds
v_mfma_f32_16x16x32_bf16 v[108:111], v[80:83], a[236:239], v[108:111]
ds_read_b128 v[80:83], v21 offset:33536
v_mfma_f32_16x16x32_bf16 v[112:115], v[84:87], a[108:111], v[112:115]
v_mfma_f32_16x16x32_bf16 v[116:119], v[84:87], a[236:239], v[116:119]
ds_read_b128 v[84:87], v21 offset:37632
s_waitcnt vmcnt(8)
s_barrier
s_waitcnt lgkmcnt(6)
v_mfma_f32_16x16x32_bf16 v[104:107], v[56:59], a[112:115], v[104:107]
s_add_u32 s38, s38, 1
v_mfma_f32_16x16x32_bf16 v[108:111], v[56:59], a[240:243], v[108:111]
ds_read_b128 v[56:59], v14 offset:0
v_mfma_f32_16x16x32_bf16 v[112:115], v[60:63], a[112:115], v[112:115]
v_mfma_f32_16x16x32_bf16 v[116:119], v[60:63], a[240:243], v[116:119]
ds_read_b128 v[60:63], v14 offset:4096
s_waitcnt lgkmcnt(6)
s_add_u32 m0, s44, 65536
s_add_u32 s29, s39, 196608
v_mfma_f32_16x16x32_bf16 v[104:107], v[64:67], a[116:119], v[104:107]
buffer_load_dwordx4 v10, s[16:19], s29 offen offset:0 lds
v_mfma_f32_16x16x32_bf16 v[108:111], v[64:67], a[244:247], v[108:111]
ds_read_b128 v[64:67], v15 offset:0
v_mfma_f32_16x16x32_bf16 v[112:115], v[68:71], a[116:119], v[112:115]
v_mfma_f32_16x16x32_bf16 v[116:119], v[68:71], a[244:247], v[116:119]
ds_read_b128 v[68:71], v15 offset:4096
s_waitcnt lgkmcnt(6)
v_mfma_f32_16x16x32_bf16 v[104:107], v[72:75], a[120:123], v[104:107]
v_mfma_f32_16x16x32_bf16 v[108:111], v[72:75], a[248:251], v[108:111]
ds_read_b128 v[72:75], v16 offset:0
v_mfma_f32_16x16x32_bf16 v[112:115], v[76:79], a[120:123], v[112:115]
v_mfma_f32_16x16x32_bf16 v[116:119], v[76:79], a[248:251], v[116:119]
ds_read_b128 v[76:79], v16 offset:4096
s_waitcnt lgkmcnt(6)
v_mfma_f32_16x16x32_bf16 v[104:107], v[80:83], a[124:127], v[104:107]
buffer_load_dwordx4 v11, s[16:19], s29 offen offset:1024 lds
v_mfma_f32_16x16x32_bf16 v[108:111], v[80:83], a[252:255], v[108:111]
ds_read_b128 v[80:83], v17 offset:0
v_mfma_f32_16x16x32_bf16 v[112:115], v[84:87], a[124:127], v[112:115]
v_mfma_f32_16x16x32_bf16 v[116:119], v[84:87], a[252:255], v[116:119]
ds_read_b128 v[84:87], v17 offset:4096
s_add_u32 s39, s39, 131072
s_branch L_gl_N2
.p2align 6
L_gl_N3:
s_waitcnt lgkmcnt(6)
v_mfma_f32_16x16x32_bf16 v[88:91], v[56:59], a[0:3], 0
v_mfma_f32_16x16x32_bf16 v[92:95], v[56:59], a[128:131], 0
ds_read_b128 v[56:59], v14 offset:256
v_mfma_f32_16x16x32_bf16 v[96:99], v[60:63], a[0:3], 0
v_mfma_f32_16x16x32_bf16 v[100:103], v[60:63], a[128:131], 0
ds_read_b128 v[60:63], v14 offset:4352
s_waitcnt lgkmcnt(6)
v_mfma_f32_16x16x32_bf16 v[88:91], v[64:67], a[4:7], v[88:91]
v_mfma_f32_16x16x32_bf16 v[92:95], v[64:67], a[132:135], v[92:95]
ds_read_b128 v[64:67], v15 offset:256
v_mfma_f32_16x16x32_bf16 v[96:99], v[68:71], a[4:7], v[96:99]
buffer_load_dwordx4 v12, s[16:19], s29 offen offset:2048 lds
v_mfma_f32_16x16x32_bf16 v[100:103], v[68:71], a[132:135], v[100:103]
ds_read_b128 v[68:71], v15 offset:4352
s_waitcnt lgkmcnt(6)
v_mfma_f32_16x16x32_bf16 v[88:91], v[72:75], a[8:11], v[88:91]
v_mfma_f32_16x16x32_bf16 v[92:95], v[72:75], a[136:139], v[92:95]
ds_read_b128 v[72:75], v16 offset:256
v_mfma_f32_16x16x32_bf16 v[96:99], v[76:79], a[8:11], v[96:99]
v_mfma_f32_16x16x32_bf16 v[100:103], v[76:79], a[136:139], v[100:103]
ds_read_b128 v[76:79], v16 offset:4352
s_waitcnt lgkmcnt(6)
v_mfma_f32_16x16x32_bf16 v[88:91], v[80:83], a[12:15], v[88:91]
v_mfma_f32_16x16x32_bf16 v[92:95], v[80:83], a[140:143], v[92:95]
ds_read_b128 v[80:83], v17 offset:256
v_mfma_f32_16x16x32_bf16 v[96:99], v[84:87], a[12:15], v[96:99]
buffer_load_dwordx4 v13, s[16:19], s29 offen offset:3072 lds
v_mfma_f32_16x16x32_bf16 v[100:103], v[84:87], a[140:143], v[100:103]
ds_read_b128 v[84:87], v17 offset:4352
s_waitcnt lgkmcnt(6)
v_mfma_f32_16x16x32_bf16 v[88:91], v[56:59], a[16:19], v[88:91]
v_cvt_pk_bf16_f32 v120, v104, v105
v_cvt_pk_bf16_f32 v121, v106, v107
v_mfma_f32_16x16x32_bf16 v[92:95], v[56:59], a[144:147], v[92:95]
v_cvt_pk_bf16_f32 v122, v112, v113
ds_read_b128 v[56:59], v14 offset:512
v_mfma_f32_16x16x32_bf16 v[96:99], v[60:63], a[16:19], v[96:99]
v_cvt_pk_bf16_f32 v123, v114, v115
buffer_store_dwordx4 v[120:123], v22, s[4:7], s40 offen offset:0 sc1
v_mfma_f32_16x16x32_bf16 v[100:103], v[60:63], a[144:147], v[100:103]
ds_read_b128 v[60:63], v14 offset:4608
s_waitcnt lgkmcnt(6)
v_mfma_f32_16x16x32_bf16 v[88:91], v[64:67], a[20:23], v[88:91]
v_cvt_pk_bf16_f32 v124, v108, v109
v_cvt_pk_bf16_f32 v125, v110, v111
v_mfma_f32_16x16x32_bf16 v[92:95], v[64:67], a[148:151], v[92:95]
v_cvt_pk_bf16_f32 v126, v116, v117
ds_read_b128 v[64:67], v15 offset:512
s_add_u32 m0, s44, 69632
s_add_u32 s29, s39, 73728
v_mfma_f32_16x16x32_bf16 v[96:99], v[68:71], a[20:23], v[96:99]
buffer_load_dwordx4 v10, s[16:19], s29 offen offset:0 lds
v_mfma_f32_16x16x32_bf16 v[100:103], v[68:71], a[148:151], v[100:103]
ds_read_b128 v[68:71], v15 offset:4608
s_waitcnt lgkmcnt(6)
v_mfma_f32_16x16x32_bf16 v[88:91], v[72:75], a[24:27], v[88:91]
v_cvt_pk_bf16_f32 v127, v118, v119
buffer_store_dwordx4 v[36:39], v30, s[4:7], s40 offen sc1
v_mfma_f32_16x16x32_bf16 v[92:95], v[72:75], a[152:155], v[92:95]
buffer_store_dwordx4 v[124:127], v22, s[4:7], s40 offen offset:1024 sc1
ds_read_b128 v[72:75], v16 offset:512
v_mfma_f32_16x16x32_bf16 v[96:99], v[76:79], a[24:27], v[96:99]
s_lshr_b32 s40, s47, 8
s_xor_b32 s40, s40, s56
v_mfma_f32_16x16x32_bf16 v[100:103], v[76:79], a[152:155], v[100:103]
ds_read_b128 v[76:79], v16 offset:4608
s_waitcnt lgkmcnt(6)
v_mfma_f32_16x16x32_bf16 v[88:91], v[80:83], a[28:31], v[88:91]
s_and_b32 s40, s40, s55
s_or_b32 s40, s40, s47
v_mfma_f32_16x16x32_bf16 v[92:95], v[80:83], a[156:159], v[92:95]
s_add_u32 s47, s47, s36
ds_read_b128 v[80:83], v17 offset:512
v_mfma_f32_16x16x32_bf16 v[96:99], v[84:87], a[28:31], v[96:99]
buffer_load_dwordx4 v11, s[16:19], s29 offen offset:1024 lds
v_mfma_f32_16x16x32_bf16 v[100:103], v[84:87], a[156:159], v[100:103]
ds_read_b128 v[84:87], v17 offset:4608
s_waitcnt lgkmcnt(6)
v_mfma_f32_16x16x32_bf16 v[88:91], v[56:59], a[32:35], v[88:91]
v_mfma_f32_16x16x32_bf16 v[92:95], v[56:59], a[160:163], v[92:95]
ds_read_b128 v[56:59], v14 offset:768
v_mfma_f32_16x16x32_bf16 v[96:99], v[60:63], a[32:35], v[96:99]
v_mfma_f32_16x16x32_bf16 v[100:103], v[60:63], a[160:163], v[100:103]
ds_read_b128 v[60:63], v14 offset:4864
s_waitcnt lgkmcnt(6)
v_mfma_f32_16x16x32_bf16 v[88:91], v[64:67], a[36:39], v[88:91]
v_mfma_f32_16x16x32_bf16 v[92:95], v[64:67], a[164:167], v[92:95]
ds_read_b128 v[64:67], v15 offset:768
v_mfma_f32_16x16x32_bf16 v[96:99], v[68:71], a[36:39], v[96:99]
buffer_load_dwordx4 v12, s[16:19], s29 offen offset:2048 lds
v_mfma_f32_16x16x32_bf16 v[100:103], v[68:71], a[164:167], v[100:103]
ds_read_b128 v[68:71], v15 offset:4864
s_waitcnt lgkmcnt(6)
v_mfma_f32_16x16x32_bf16 v[88:91], v[72:75], a[40:43], v[88:91]
v_mfma_f32_16x16x32_bf16 v[92:95], v[72:75], a[168:171], v[92:95]
ds_read_b128 v[72:75], v16 offset:768
v_mfma_f32_16x16x32_bf16 v[96:99], v[76:79], a[40:43], v[96:99]
v_mfma_f32_16x16x32_bf16 v[100:103], v[76:79], a[168:171], v[100:103]
ds_read_b128 v[76:79], v16 offset:4864
s_waitcnt lgkmcnt(6)
v_mfma_f32_16x16x32_bf16 v[88:91], v[80:83], a[44:47], v[88:91]
v_mfma_f32_16x16x32_bf16 v[92:95], v[80:83], a[172:175], v[92:95]
ds_read_b128 v[80:83], v17 offset:768
v_mfma_f32_16x16x32_bf16 v[96:99], v[84:87], a[44:47], v[96:99]
buffer_load_dwordx4 v13, s[16:19], s29 offen offset:3072 lds
v_mfma_f32_16x16x32_bf16 v[100:103], v[84:87], a[172:175], v[100:103]
ds_read_b128 v[84:87], v17 offset:4864
s_waitcnt vmcnt(11)
s_barrier
s_waitcnt lgkmcnt(6)
v_mfma_f32_16x16x32_bf16 v[88:91], v[56:59], a[48:51], v[88:91]
v_mfma_f32_16x16x32_bf16 v[92:95], v[56:59], a[176:179], v[92:95]
ds_read_b128 v[56:59], v14 offset:32768
v_mfma_f32_16x16x32_bf16 v[96:99], v[60:63], a[48:51], v[96:99]
v_mfma_f32_16x16x32_bf16 v[100:103], v[60:63], a[176:179], v[100:103]
ds_read_b128 v[60:63], v14 offset:36864
s_waitcnt lgkmcnt(6)
v_mfma_f32_16x16x32_bf16 v[88:91], v[64:67], a[52:55], v[88:91]
v_mfma_f32_16x16x32_bf16 v[92:95], v[64:67], a[180:183], v[92:95]
ds_read_b128 v[64:67], v15 offset:32768
s_add_u32 m0, s44, 98304
s_add_u32 s29, s39, 66560
v_mfma_f32_16x16x32_bf16 v[96:99], v[68:71], a[52:55], v[96:99]
buffer_load_dwordx4 v10, s[16:19], s29 offen offset:0 lds
v_mfma_f32_16x16x32_bf16 v[100:103], v[68:71], a[180:183], v[100:103]
ds_read_b128 v[68:71], v15 offset:36864
s_waitcnt lgkmcnt(6)
v_mfma_f32_16x16x32_bf16 v[88:91], v[72:75], a[56:59], v[88:91]
v_mfma_f32_16x16x32_bf16 v[92:95], v[72:75], a[184:187], v[92:95]
ds_read_b128 v[72:75], v16 offset:32768
v_mfma_f32_16x16x32_bf16 v[96:99], v[76:79], a[56:59], v[96:99]
v_mfma_f32_16x16x32_bf16 v[100:103], v[76:79], a[184:187], v[100:103]
ds_read_b128 v[76:79], v16 offset:36864
s_waitcnt lgkmcnt(6)
v_mfma_f32_16x16x32_bf16 v[88:91], v[80:83], a[60:63], v[88:91]
v_mfma_f32_16x16x32_bf16 v[92:95], v[80:83], a[188:191], v[92:95]
ds_read_b128 v[80:83], v17 offset:32768
v_mfma_f32_16x16x32_bf16 v[96:99], v[84:87], a[60:63], v[96:99]
buffer_load_dwordx4 v11, s[16:19], s29 offen offset:1024 lds
v_mfma_f32_16x16x32_bf16 v[100:103], v[84:87], a[188:191], v[100:103]
ds_read_b128 v[84:87], v17 offset:36864
s_waitcnt lgkmcnt(6)
v_mfma_f32_16x16x32_bf16 v[88:91], v[56:59], a[64:67], v[88:91]
v_mfma_f32_16x16x32_bf16 v[92:95], v[56:59], a[192:195], v[92:95]
ds_read_b128 v[56:59], v14 offset:33024
v_mfma_f32_16x16x32_bf16 v[96:99], v[60:63], a[64:67], v[96:99]
v_mfma_f32_16x16x32_bf16 v[100:103], v[60:63], a[192:195], v[100:103]
ds_read_b128 v[60:63], v14 offset:37120
s_waitcnt lgkmcnt(6)
v_mfma_f32_16x16x32_bf16 v[88:91], v[64:67], a[68:71], v[88:91]
v_mfma_f32_16x16x32_bf16 v[92:95], v[64:67], a[196:199], v[92:95]
ds_read_b128 v[64:67], v15 offset:33024
v_mfma_f32_16x16x32_bf16 v[96:99], v[68:71], a[68:71], v[96:99]
buffer_load_dwordx4 v12, s[16:19], s29 offen offset:2048 lds
v_mfma_f32_16x16x32_bf16 v[100:103], v[68:71], a[196:199], v[100:103]
ds_read_b128 v[68:71], v15 offset:37120
s_waitcnt lgkmcnt(6)
v_mfma_f32_16x16x32_bf16 v[88:91], v[72:75], a[72:75], v[88:91]
v_mfma_f32_16x16x32_bf16 v[92:95], v[72:75], a[200:203], v[92:95]
ds_read_b128 v[72:75], v16 offset:33024
v_mfma_f32_16x16x32_bf16 v[96:99], v[76:79], a[72:75], v[96:99]
v_mfma_f32_16x16x32_bf16 v[100:103], v[76:79], a[200:203], v[100:103]
ds_read_b128 v[76:79], v16 offset:37120
s_waitcnt lgkmcnt(6)
v_mfma_f32_16x16x32_bf16 v[88:91], v[80:83], a[76:79], v[88:91]
v_mfma_f32_16x16x32_bf16 v[92:95], v[80:83], a[204:207], v[92:95]
ds_read_b128 v[80:83], v17 offset:33024
v_mfma_f32_16x16x32_bf16 v[96:99], v[84:87], a[76:79], v[96:99]
buffer_load_dwordx4 v13, s[16:19], s29 offen offset:3072 lds
v_mfma_f32_16x16x32_bf16 v[100:103], v[84:87], a[204:207], v[100:103]
ds_read_b128 v[84:87], v17 offset:37120
s_waitcnt lgkmcnt(6)
v_mfma_f32_16x16x32_bf16 v[88:91], v[56:59], a[80:83], v[88:91]
s_cmp_lt_u32 s38, 64
s_cbranch_scc1 L_wpN13
s_sub_u32 s46, s38, 64
s_lshl_b32 s46, s46, 17
buffer_load_dword v26, v31, s[12:15], s46 offen
L_wpN13:
v_mfma_f32_16x16x32_bf16 v[92:95], v[56:59], a[208:211], v[92:95]
ds_read_b128 v[56:59], v14 offset:33280
v_mfma_f32_16x16x32_bf16 v[96:99], v[60:63], a[80:83], v[96:99]
v_mfma_f32_16x16x32_bf16 v[100:103], v[60:63], a[208:211], v[100:103]
ds_read_b128 v[60:63], v14 offset:37376
s_waitcnt lgkmcnt(6)
v_mfma_f32_16x16x32_bf16 v[88:91], v[64:67], a[84:87], v[88:91]
v_mfma_f32_16x16x32_bf16 v[92:95], v[64:67], a[212:215], v[92:95]
ds_read_b128 v[64:67], v15 offset:33280
s_add_u32 m0, s44, 102400
s_add_u32 s29, s39, 74752
v_mfma_f32_16x16x32_bf16 v[96:99], v[68:71], a[84:87], v[96:99]
buffer_load_dwordx4 v10, s[16:19], s29 offen offset:0 lds
v_mfma_f32_16x16x32_bf16 v[100:103], v[68:71], a[212:215], v[100:103]
ds_read_b128 v[68:71], v15 offset:37376
s_waitcnt lgkmcnt(6)
v_mfma_f32_16x16x32_bf16 v[88:91], v[72:75], a[88:91], v[88:91]
v_mfma_f32_16x16x32_bf16 v[92:95], v[72:75], a[216:219], v[92:95]
ds_read_b128 v[72:75], v16 offset:33280
v_mfma_f32_16x16x32_bf16 v[96:99], v[76:79], a[88:91], v[96:99]
v_mfma_f32_16x16x32_bf16 v[100:103], v[76:79], a[216:219], v[100:103]
ds_read_b128 v[76:79], v16 offset:37376
s_waitcnt lgkmcnt(6)
v_mfma_f32_16x16x32_bf16 v[88:91], v[80:83], a[92:95], v[88:91]
v_mfma_f32_16x16x32_bf16 v[92:95], v[80:83], a[220:223], v[92:95]
ds_read_b128 v[80:83], v17 offset:33280
v_mfma_f32_16x16x32_bf16 v[96:99], v[84:87], a[92:95], v[96:99]
buffer_load_dwordx4 v11, s[16:19], s29 offen offset:1024 lds
v_mfma_f32_16x16x32_bf16 v[100:103], v[84:87], a[220:223], v[100:103]
ds_read_b128 v[84:87], v17 offset:37376
s_waitcnt lgkmcnt(6)
v_mfma_f32_16x16x32_bf16 v[88:91], v[56:59], a[96:99], v[88:91]
v_mfma_f32_16x16x32_bf16 v[92:95], v[56:59], a[224:227], v[92:95]
ds_read_b128 v[56:59], v14 offset:33536
v_mfma_f32_16x16x32_bf16 v[96:99], v[60:63], a[96:99], v[96:99]
v_mfma_f32_16x16x32_bf16 v[100:103], v[60:63], a[224:227], v[100:103]
ds_read_b128 v[60:63], v14 offset:37632
s_waitcnt lgkmcnt(6)
v_mfma_f32_16x16x32_bf16 v[88:91], v[64:67], a[100:103], v[88:91]
v_mfma_f32_16x16x32_bf16 v[92:95], v[64:67], a[228:231], v[92:95]
ds_read_b128 v[64:67], v15 offset:33536
v_mfma_f32_16x16x32_bf16 v[96:99], v[68:71], a[100:103], v[96:99]
buffer_load_dwordx4 v12, s[16:19], s29 offen offset:2048 lds
v_mfma_f32_16x16x32_bf16 v[100:103], v[68:71], a[228:231], v[100:103]
ds_read_b128 v[68:71], v15 offset:37632
s_waitcnt lgkmcnt(6)
v_mfma_f32_16x16x32_bf16 v[88:91], v[72:75], a[104:107], v[88:91]
v_mfma_f32_16x16x32_bf16 v[92:95], v[72:75], a[232:235], v[92:95]
ds_read_b128 v[72:75], v16 offset:33536
v_mfma_f32_16x16x32_bf16 v[96:99], v[76:79], a[104:107], v[96:99]
v_mfma_f32_16x16x32_bf16 v[100:103], v[76:79], a[232:235], v[100:103]
ds_read_b128 v[76:79], v16 offset:37632
s_waitcnt lgkmcnt(6)
v_mfma_f32_16x16x32_bf16 v[88:91], v[80:83], a[108:111], v[88:91]
v_mfma_f32_16x16x32_bf16 v[92:95], v[80:83], a[236:239], v[92:95]
ds_read_b128 v[80:83], v17 offset:33536
v_mfma_f32_16x16x32_bf16 v[96:99], v[84:87], a[108:111], v[96:99]
buffer_load_dwordx4 v13, s[16:19], s29 offen offset:3072 lds
v_mfma_f32_16x16x32_bf16 v[100:103], v[84:87], a[236:239], v[100:103]
ds_read_b128 v[84:87], v17 offset:37632
s_waitcnt vmcnt(8)
s_barrier
s_waitcnt lgkmcnt(6)
v_mfma_f32_16x16x32_bf16 v[88:91], v[56:59], a[112:115], v[88:91]
s_add_u32 s38, s38, 1
v_mfma_f32_16x16x32_bf16 v[92:95], v[56:59], a[240:243], v[92:95]
ds_read_b128 v[56:59], v18 offset:0
v_mfma_f32_16x16x32_bf16 v[96:99], v[60:63], a[112:115], v[96:99]
v_mfma_f32_16x16x32_bf16 v[100:103], v[60:63], a[240:243], v[100:103]
ds_read_b128 v[60:63], v18 offset:4096
s_waitcnt lgkmcnt(6)
v_mfma_f32_16x16x32_bf16 v[88:91], v[64:67], a[116:119], v[88:91]
v_mfma_f32_16x16x32_bf16 v[92:95], v[64:67], a[244:247], v[92:95]
ds_read_b128 v[64:67], v19 offset:0
s_add_u32 m0, s44, 0
s_add_u32 s29, s39, 131072
v_mfma_f32_16x16x32_bf16 v[96:99], v[68:71], a[116:119], v[96:99]
buffer_load_dwordx4 v10, s[16:19], s29 offen offset:0 lds
v_mfma_f32_16x16x32_bf16 v[100:103], v[68:71], a[244:247], v[100:103]
ds_read_b128 v[68:71], v19 offset:4096
s_waitcnt lgkmcnt(6)
v_mfma_f32_16x16x32_bf16 v[88:91], v[72:75], a[120:123], v[88:91]
v_mfma_f32_16x16x32_bf16 v[92:95], v[72:75], a[248:251], v[92:95]
ds_read_b128 v[72:75], v20 offset:0
v_mfma_f32_16x16x32_bf16 v[96:99], v[76:79], a[120:123], v[96:99]
v_mfma_f32_16x16x32_bf16 v[100:103], v[76:79], a[248:251], v[100:103]
ds_read_b128 v[76:79], v20 offset:4096
s_waitcnt lgkmcnt(6)
v_mfma_f32_16x16x32_bf16 v[88:91], v[80:83], a[124:127], v[88:91]
v_mfma_f32_16x16x32_bf16 v[92:95], v[80:83], a[252:255], v[92:95]
ds_read_b128 v[80:83], v21 offset:0
v_mfma_f32_16x16x32_bf16 v[96:99], v[84:87], a[124:127], v[96:99]
buffer_load_dwordx4 v11, s[16:19], s29 offen offset:1024 lds
v_mfma_f32_16x16x32_bf16 v[100:103], v[84:87], a[252:255], v[100:103]
ds_read_b128 v[84:87], v21 offset:4096
s_cmp_eq_u32 s38, 64
s_cbranch_scc1 L_gx_N
s_waitcnt lgkmcnt(6)
v_mfma_f32_16x16x32_bf16 v[104:107], v[56:59], a[0:3], 0
v_mfma_f32_16x16x32_bf16 v[108:111], v[56:59], a[128:131], 0
ds_read_b128 v[56:59], v18 offset:256
v_mfma_f32_16x16x32_bf16 v[112:115], v[60:63], a[0:3], 0
v_mfma_f32_16x16x32_bf16 v[116:119], v[60:63], a[128:131], 0
ds_read_b128 v[60:63], v18 offset:4352
s_waitcnt lgkmcnt(6)
v_mfma_f32_16x16x32_bf16 v[104:107], v[64:67], a[4:7], v[104:107]
v_mfma_f32_16x16x32_bf16 v[108:111], v[64:67], a[132:135], v[108:111]
ds_read_b128 v[64:67], v19 offset:256
v_mfma_f32_16x16x32_bf16 v[112:115], v[68:71], a[4:7], v[112:115]
buffer_load_dwordx4 v12, s[16:19], s29 offen offset:2048 lds
v_mfma_f32_16x16x32_bf16 v[116:119], v[68:71], a[132:135], v[116:119]
ds_read_b128 v[68:71], v19 offset:4352
s_waitcnt lgkmcnt(6)
v_mfma_f32_16x16x32_bf16 v[104:107], v[72:75], a[8:11], v[104:107]
v_mfma_f32_16x16x32_bf16 v[108:111], v[72:75], a[136:139], v[108:111]
ds_read_b128 v[72:75], v20 offset:256
v_mfma_f32_16x16x32_bf16 v[112:115], v[76:79], a[8:11], v[112:115]
v_mfma_f32_16x16x32_bf16 v[116:119], v[76:79], a[136:139], v[116:119]
ds_read_b128 v[76:79], v20 offset:4352
s_waitcnt lgkmcnt(6)
v_mfma_f32_16x16x32_bf16 v[104:107], v[80:83], a[12:15], v[104:107]
v_mfma_f32_16x16x32_bf16 v[108:111], v[80:83], a[140:143], v[108:111]
ds_read_b128 v[80:83], v21 offset:256
v_mfma_f32_16x16x32_bf16 v[112:115], v[84:87], a[12:15], v[112:115]
buffer_load_dwordx4 v13, s[16:19], s29 offen offset:3072 lds
v_mfma_f32_16x16x32_bf16 v[116:119], v[84:87], a[140:143], v[116:119]
ds_read_b128 v[84:87], v21 offset:4352
s_waitcnt lgkmcnt(6)
v_mfma_f32_16x16x32_bf16 v[104:107], v[56:59], a[16:19], v[104:107]
v_cvt_pk_bf16_f32 v120, v88, v89
v_cvt_pk_bf16_f32 v121, v90, v91
v_mfma_f32_16x16x32_bf16 v[108:111], v[56:59], a[144:147], v[108:111]
v_cvt_pk_bf16_f32 v122, v96, v97
ds_read_b128 v[56:59], v18 offset:512
v_mfma_f32_16x16x32_bf16 v[112:115], v[60:63], a[16:19], v[112:115]
v_cvt_pk_bf16_f32 v123, v98, v99
buffer_store_dwordx4 v[120:123], v22, s[4:7], s40 offen offset:0 sc1
v_mfma_f32_16x16x32_bf16 v[116:119], v[60:63], a[144:147], v[116:119]
ds_read_b128 v[60:63], v18 offset:4608
s_waitcnt lgkmcnt(6)
v_mfma_f32_16x16x32_bf16 v[104:107], v[64:67], a[20:23], v[104:107]
v_cvt_pk_bf16_f32 v124, v92, v93
v_cvt_pk_bf16_f32 v125, v94, v95
v_mfma_f32_16x16x32_bf16 v[108:111], v[64:67], a[148:151], v[108:111]
v_cvt_pk_bf16_f32 v126, v100, v101
ds_read_b128 v[64:67], v19 offset:512
s_add_u32 m0, s44, 4096
s_add_u32 s29, s39, 139264
v_mfma_f32_16x16x32_bf16 v[112:115], v[68:71], a[20:23], v[112:115]
buffer_load_dwordx4 v10, s[16:19], s29 offen offset:0 lds
v_mfma_f32_16x16x32_bf16 v[116:119], v[68:71], a[148:151], v[116:119]
ds_read_b128 v[68:71], v19 offset:4608
s_waitcnt lgkmcnt(6)
v_mfma_f32_16x16x32_bf16 v[104:107], v[72:75], a[24:27], v[104:107]
v_cvt_pk_bf16_f32 v127, v102, v103
buffer_store_dwordx4 v[36:39], v30, s[4:7], s40 offen sc1
v_mfma_f32_16x16x32_bf16 v[108:111], v[72:75], a[152:155], v[108:111]
buffer_store_dwordx4 v[124:127], v22, s[4:7], s40 offen offset:1024 sc1
ds_read_b128 v[72:75], v20 offset:512
v_mfma_f32_16x16x32_bf16 v[112:115], v[76:79], a[24:27], v[112:115]
s_lshr_b32 s40, s47, 8
s_xor_b32 s40, s40, s56
v_mfma_f32_16x16x32_bf16 v[116:119], v[76:79], a[152:155], v[116:119]
ds_read_b128 v[76:79], v20 offset:4608
s_waitcnt lgkmcnt(6)
v_mfma_f32_16x16x32_bf16 v[104:107], v[80:83], a[28:31], v[104:107]
s_and_b32 s40, s40, s55
s_or_b32 s40, s40, s47
v_mfma_f32_16x16x32_bf16 v[108:111], v[80:83], a[156:159], v[108:111]
s_add_u32 s47, s47, s36
ds_read_b128 v[80:83], v21 offset:512
v_mfma_f32_16x16x32_bf16 v[112:115], v[84:87], a[28:31], v[112:115]
buffer_load_dwordx4 v11, s[16:19], s29 offen offset:1024 lds
v_mfma_f32_16x16x32_bf16 v[116:119], v[84:87], a[156:159], v[116:119]
ds_read_b128 v[84:87], v21 offset:4608
s_waitcnt lgkmcnt(6)
v_mfma_f32_16x16x32_bf16 v[104:107], v[56:59], a[32:35], v[104:107]
v_mfma_f32_16x16x32_bf16 v[108:111], v[56:59], a[160:163], v[108:111]
ds_read_b128 v[56:59], v18 offset:768
v_mfma_f32_16x16x32_bf16 v[112:115], v[60:63], a[32:35], v[112:115]
v_mfma_f32_16x16x32_bf16 v[116:119], v[60:63], a[160:163], v[116:119]
ds_read_b128 v[60:63], v18 offset:4864
s_waitcnt lgkmcnt(6)
v_mfma_f32_16x16x32_bf16 v[104:107], v[64:67], a[36:39], v[104:107]
v_mfma_f32_16x16x32_bf16 v[108:111], v[64:67], a[164:167], v[108:111]
ds_read_b128 v[64:67], v19 offset:768
v_mfma_f32_16x16x32_bf16 v[112:115], v[68:71], a[36:39], v[112:115]
buffer_load_dwordx4 v12, s[16:19], s29 offen offset:2048 lds
v_mfma_f32_16x16x32_bf16 v[116:119], v[68:71], a[164:167], v[116:119]
ds_read_b128 v[68:71], v19 offset:4864
s_waitcnt lgkmcnt(6)
v_mfma_f32_16x16x32_bf16 v[104:107], v[72:75], a[40:43], v[104:107]
v_mfma_f32_16x16x32_bf16 v[108:111], v[72:75], a[168:171], v[108:111]
ds_read_b128 v[72:75], v20 offset:768
v_mfma_f32_16x16x32_bf16 v[112:115], v[76:79], a[40:43], v[112:115]
v_mfma_f32_16x16x32_bf16 v[116:119], v[76:79], a[168:171], v[116:119]
ds_read_b128 v[76:79], v20 offset:4864
s_waitcnt lgkmcnt(6)
v_mfma_f32_16x16x32_bf16 v[104:107], v[80:83], a[44:47], v[104:107]
v_mfma_f32_16x16x32_bf16 v[108:111], v[80:83], a[172:175], v[108:111]
ds_read_b128 v[80:83], v21 offset:768
v_mfma_f32_16x16x32_bf16 v[112:115], v[84:87], a[44:47], v[112:115]
buffer_load_dwordx4 v13, s[16:19], s29 offen offset:3072 lds
v_mfma_f32_16x16x32_bf16 v[116:119], v[84:87], a[172:175], v[116:119]
ds_read_b128 v[84:87], v21 offset:4864
s_waitcnt vmcnt(11)
s_barrier
s_waitcnt lgkmcnt(6)
v_mfma_f32_16x16x32_bf16 v[104:107], v[56:59], a[48:51], v[104:107]
v_mfma_f32_16x16x32_bf16 v[108:111], v[56:59], a[176:179], v[108:111]
ds_read_b128 v[56:59], v18 offset:32768
v_mfma_f32_16x16x32_bf16 v[112:115], v[60:63], a[48:51], v[112:115]
v_mfma_f32_16x16x32_bf16 v[116:119], v[60:63], a[176:179], v[116:119]
ds_read_b128 v[60:63], v18 offset:36864
s_waitcnt lgkmcnt(6)
v_mfma_f32_16x16x32_bf16 v[104:107], v[64:67], a[52:55], v[104:107]
v_mfma_f32_16x16x32_bf16 v[108:111], v[64:67], a[180:183], v[108:111]
ds_read_b128 v[64:67], v19 offset:32768
s_add_u32 m0, s44, 32768
s_add_u32 s29, s39, 132096
v_mfma_f32_16x16x32_bf16 v[112:115], v[68:71], a[52:55], v[112:115]
buffer_load_dwordx4 v10, s[16:19], s29 offen offset:0 lds
v_mfma_f32_16x16x32_bf16 v[116:119], v[68:71], a[180:183], v[116:119]
ds_read_b128 v[68:71], v19 offset:36864
s_waitcnt lgkmcnt(6)
v_mfma_f32_16x16x32_bf16 v[104:107], v[72:75], a[56:59], v[104:107]
v_mfma_f32_16x16x32_bf16 v[108:111], v[72:75], a[184:187], v[108:111]
ds_read_b128 v[72:75], v20 offset:32768
v_mfma_f32_16x16x32_bf16 v[112:115], v[76:79], a[56:59], v[112:115]
v_mfma_f32_16x16x32_bf16 v[116:119], v[76:79], a[184:187], v[116:119]
ds_read_b128 v[76:79], v20 offset:36864
s_waitcnt lgkmcnt(6)
v_mfma_f32_16x16x32_bf16 v[104:107], v[80:83], a[60:63], v[104:107]
v_mfma_f32_16x16x32_bf16 v[108:111], v[80:83], a[188:191], v[108:111]
ds_read_b128 v[80:83], v21 offset:32768
v_mfma_f32_16x16x32_bf16 v[112:115], v[84:87], a[60:63], v[112:115]
buffer_load_dwordx4 v11, s[16:19], s29 offen offset:1024 lds
v_mfma_f32_16x16x32_bf16 v[116:119], v[84:87], a[188:191], v[116:119]
ds_read_b128 v[84:87], v21 offset:36864
s_waitcnt lgkmcnt(6)
v_mfma_f32_16x16x32_bf16 v[104:107], v[56:59], a[64:67], v[104:107]
v_mfma_f32_16x16x32_bf16 v[108:111], v[56:59], a[192:195], v[108:111]
ds_read_b128 v[56:59], v18 offset:33024
v_mfma_f32_16x16x32_bf16 v[112:115], v[60:63], a[64:67], v[112:115]
v_mfma_f32_16x16x32_bf16 v[116:119], v[60:63], a[192:195], v[116:119]
ds_read_b128 v[60:63], v18 offset:37120
s_waitcnt lgkmcnt(6)
v_mfma_f32_16x16x32_bf16 v[104:107], v[64:67], a[68:71], v[104:107]
v_mfma_f32_16x16x32_bf16 v[108:111], v[64:67], a[196:199], v[108:111]
ds_read_b128 v[64:67], v19 offset:33024
v_mfma_f32_16x16x32_bf16 v[112:115], v[68:71], a[68:71], v[112:115]
buffer_load_dwordx4 v12, s[16:19], s29 offen offset:2048 lds
v_mfma_f32_16x16x32_bf16 v[116:119], v[68:71], a[196:199], v[116:119]
ds_read_b128 v[68:71], v19 offset:37120
s_waitcnt lgkmcnt(6)
v_mfma_f32_16x16x32_bf16 v[104:107], v[72:75], a[72:75], v[104:107]
v_mfma_f32_16x16x32_bf16 v[108:111], v[72:75], a[200:203], v[108:111]
ds_read_b128 v[72:75], v20 offset:33024
v_mfma_f32_16x16x32_bf16 v[112:115], v[76:79], a[72:75], v[112:115]
v_mfma_f32_16x16x32_bf16 v[116:119], v[76:79], a[200:203], v[116:119]
ds_read_b128 v[76:79], v20 offset:37120
s_waitcnt lgkmcnt(6)
v_mfma_f32_16x16x32_bf16 v[104:107], v[80:83], a[76:79], v[104:107]
v_mfma_f32_16x16x32_bf16 v[108:111], v[80:83], a[204:207], v[108:111]
ds_read_b128 v[80:83], v21 offset:33024
v_mfma_f32_16x16x32_bf16 v[112:115], v[84:87], a[76:79], v[112:115]
buffer_load_dwordx4 v13, s[16:19], s29 offen offset:3072 lds
v_mfma_f32_16x16x32_bf16 v[116:119], v[84:87], a[204:207], v[116:119]
ds_read_b128 v[84:87], v21 offset:37120
s_waitcnt lgkmcnt(6)
v_mfma_f32_16x16x32_bf16 v[104:107], v[56:59], a[80:83], v[104:107]
s_cmp_lt_u32 s38, 64
s_cbranch_scc1 L_wpN33
s_sub_u32 s46, s38, 64
s_lshl_b32 s46, s46, 17
buffer_load_dword v26, v31, s[12:15], s46 offen
L_wpN33:
v_mfma_f32_16x16x32_bf16 v[108:111], v[56:59], a[208:211], v[108:111]
ds_read_b128 v[56:59], v18 offset:33280
v_mfma_f32_16x16x32_bf16 v[112:115], v[60:63], a[80:83], v[112:115]
v_mfma_f32_16x16x32_bf16 v[116:119], v[60:63], a[208:211], v[116:119]
ds_read_b128 v[60:63], v18 offset:37376
s_waitcnt lgkmcnt(6)
v_mfma_f32_16x16x32_bf16 v[104:107], v[64:67], a[84:87], v[104:107]
v_mfma_f32_16x16x32_bf16 v[108:111], v[64:67], a[212:215], v[108:111]
ds_read_b128 v[64:67], v19 offset:33280
s_add_u32 m0, s44, 36864
s_add_u32 s29, s39, 140288
v_mfma_f32_16x16x32_bf16 v[112:115], v[68:71], a[84:87], v[112:115]
buffer_load_dwordx4 v10, s[16:19], s29 offen offset:0 lds
v_mfma_f32_16x16x32_bf16 v[116:119], v[68:71], a[212:215], v[116:119]
ds_read_b128 v[68:71], v19 offset:37376
s_waitcnt lgkmcnt(6)
v_mfma_f32_16x16x32_bf16 v[104:107], v[72:75], a[88:91], v[104:107]
v_mfma_f32_16x16x32_bf16 v[108:111], v[72:75], a[216:219], v[108:111]
ds_read_b128 v[72:75], v20 offset:33280
v_mfma_f32_16x16x32_bf16 v[112:115], v[76:79], a[88:91], v[112:115]
v_mfma_f32_16x16x32_bf16 v[116:119], v[76:79], a[216:219], v[116:119]
ds_read_b128 v[76:79], v20 offset:37376
s_waitcnt lgkmcnt(6)
v_mfma_f32_16x16x32_bf16 v[104:107], v[80:83], a[92:95], v[104:107]
v_mfma_f32_16x16x32_bf16 v[108:111], v[80:83], a[220:223], v[108:111]
ds_read_b128 v[80:83], v21 offset:33280
v_mfma_f32_16x16x32_bf16 v[112:115], v[84:87], a[92:95], v[112:115]
buffer_load_dwordx4 v11, s[16:19], s29 offen offset:1024 lds
v_mfma_f32_16x16x32_bf16 v[116:119], v[84:87], a[220:223], v[116:119]
ds_read_b128 v[84:87], v21 offset:37376
s_waitcnt lgkmcnt(6)
v_mfma_f32_16x16x32_bf16 v[104:107], v[56:59], a[96:99], v[104:107]
v_mfma_f32_16x16x32_bf16 v[108:111], v[56:59], a[224:227], v[108:111]
ds_read_b128 v[56:59], v18 offset:33536
v_mfma_f32_16x16x32_bf16 v[112:115], v[60:63], a[96:99], v[112:115]
v_mfma_f32_16x16x32_bf16 v[116:119], v[60:63], a[224:227], v[116:119]
ds_read_b128 v[60:63], v18 offset:37632
s_waitcnt lgkmcnt(6)
v_mfma_f32_16x16x32_bf16 v[104:107], v[64:67], a[100:103], v[104:107]
v_mfma_f32_16x16x32_bf16 v[108:111], v[64:67], a[228:231], v[108:111]
ds_read_b128 v[64:67], v19 offset:33536
v_mfma_f32_16x16x32_bf16 v[112:115], v[68:71], a[100:103], v[112:115]
buffer_load_dwordx4 v12, s[16:19], s29 offen offset:2048 lds
v_mfma_f32_16x16x32_bf16 v[116:119], v[68:71], a[228:231], v[116:119]
ds_read_b128 v[68:71], v19 offset:37632
s_waitcnt lgkmcnt(6)
v_mfma_f32_16x16x32_bf16 v[104:107], v[72:75], a[104:107], v[104:107]
v_mfma_f32_16x16x32_bf16 v[108:111], v[72:75], a[232:235], v[108:111]
ds_read_b128 v[72:75], v20 offset:33536
v_mfma_f32_16x16x32_bf16 v[112:115], v[76:79], a[104:107], v[112:115]
v_mfma_f32_16x16x32_bf16 v[116:119], v[76:79], a[232:235], v[116:119]
ds_read_b128 v[76:79], v20 offset:37632
s_waitcnt lgkmcnt(6)
v_mfma_f32_16x16x32_bf16 v[104:107], v[80:83], a[108:111], v[104:107]
v_mfma_f32_16x16x32_bf16 v[108:111], v[80:83], a[236:239], v[108:111]
ds_read_b128 v[80:83], v21 offset:33536
v_mfma_f32_16x16x32_bf16 v[112:115], v[84:87], a[108:111], v[112:115]
buffer_load_dwordx4 v13, s[16:19], s29 offen offset:3072 lds
v_mfma_f32_16x16x32_bf16 v[116:119], v[84:87], a[236:239], v[116:119]
ds_read_b128 v[84:87], v21 offset:37632
s_waitcnt vmcnt(8)
s_barrier
s_waitcnt lgkmcnt(6)
v_mfma_f32_16x16x32_bf16 v[104:107], v[56:59], a[112:115], v[104:107]
s_add_u32 s38, s38, 1
v_mfma_f32_16x16x32_bf16 v[108:111], v[56:59], a[240:243], v[108:111]
ds_read_b128 v[56:59], v14 offset:0
v_mfma_f32_16x16x32_bf16 v[112:115], v[60:63], a[112:115], v[112:115]
v_mfma_f32_16x16x32_bf16 v[116:119], v[60:63], a[240:243], v[116:119]
ds_read_b128 v[60:63], v14 offset:4096
s_waitcnt lgkmcnt(6)
v_mfma_f32_16x16x32_bf16 v[104:107], v[64:67], a[116:119], v[104:107]
v_mfma_f32_16x16x32_bf16 v[108:111], v[64:67], a[244:247], v[108:111]
ds_read_b128 v[64:67], v15 offset:0
s_add_u32 m0, s44, 65536
s_add_u32 s29, s39, 196608
v_mfma_f32_16x16x32_bf16 v[112:115], v[68:71], a[116:119], v[112:115]
buffer_load_dwordx4 v10, s[16:19], s29 offen offset:0 lds
v_mfma_f32_16x16x32_bf16 v[116:119], v[68:71], a[244:247], v[116:119]
ds_read_b128 v[68:71], v15 offset:4096
s_waitcnt lgkmcnt(6)
v_mfma_f32_16x16x32_bf16 v[104:107], v[72:75], a[120:123], v[104:107]
v_mfma_f32_16x16x32_bf16 v[108:111], v[72:75], a[248:251], v[108:111]
ds_read_b128 v[72:75], v16 offset:0
v_mfma_f32_16x16x32_bf16 v[112:115], v[76:79], a[120:123], v[112:115]
v_mfma_f32_16x16x32_bf16 v[116:119], v[76:79], a[248:251], v[116:119]
ds_read_b128 v[76:79], v16 offset:4096
s_waitcnt lgkmcnt(6)
v_mfma_f32_16x16x32_bf16 v[104:107], v[80:83], a[124:127], v[104:107]
v_mfma_f32_16x16x32_bf16 v[108:111], v[80:83], a[252:255], v[108:111]
ds_read_b128 v[80:83], v17 offset:0
v_mfma_f32_16x16x32_bf16 v[112:115], v[84:87], a[124:127], v[112:115]
buffer_load_dwordx4 v11, s[16:19], s29 offen offset:1024 lds
v_mfma_f32_16x16x32_bf16 v[116:119], v[84:87], a[252:255], v[116:119]
ds_read_b128 v[84:87], v17 offset:4096
s_add_u32 s39, s39, 131072
s_branch L_gl_N3
L_gx_N:
s_nop 7
v_cvt_pk_bf16_f32 v120, v88, v89
v_cvt_pk_bf16_f32 v121, v90, v91
v_cvt_pk_bf16_f32 v122, v96, v97
v_cvt_pk_bf16_f32 v123, v98, v99
buffer_store_dwordx4 v[120:123], v22, s[4:7], s40 offen offset:0 sc1
v_cvt_pk_bf16_f32 v124, v92, v93
v_cvt_pk_bf16_f32 v125, v94, v95
v_cvt_pk_bf16_f32 v126, v100, v101
v_cvt_pk_bf16_f32 v127, v102, v103
buffer_store_dwordx4 v[36:39], v30, s[4:7], s40 offen sc1
buffer_store_dwordx4 v[124:127], v22, s[4:7], s40 offen offset:1024 sc1
s_lshr_b32 s40, s47, 8
s_xor_b32 s40, s40, s56
s_and_b32 s40, s40, s55
s_or_b32 s40, s40, s47
s_add_u32 s47, s47, s36
s_waitcnt vmcnt(0) lgkmcnt(0)
s_barrier
v_mov_b32 v24, s38
buffer_store_dword v24, v32, s[4:7], 0 offen sc1
s_cmp_ge_u32 s32, 96
s_cbranch_scc1 L_b2go
s_branch L_fg
L_fg:
s_load_dwordx16 s[64:79], s[0:1], 0
s_load_dwordx8 s[80:87], s[0:1], 64
s_load_dwordx2 s[88:89], s[0:1], 96
s_waitcnt lgkmcnt(0)
s_xor_b32 s30, s54, 0x2000
s_cmp_lt_u32 s32, 64
s_cselect_b32 s23, 0x2000, 0
s_and_b32 s30, s30, s23
s_and_b32 s50, s32, 7
s_xor_b32 s50, s50, 1
s_mov_b32 s33, 2048
s_mov_b32 s16, s84
s_mov_b32 s17, s85
s_mov_b32 s18, 8388608
v_and_b32 v7, 31, v1
v_lshlrev_b32 v7, 2, v7
s_lshr_b32 s26, s20, 1
s_and_b32 s27, s20, 1
s_lshl_b32 s27, s27, 14
s_cmp_ge_u32 s32, 96
s_cbranch_scc1 L_fgB
s_lshr_b32 s48, s32, 5
s_bfe_u32 s49, s32, 0x20003
s_add_u32 s46, s48, 61
s_add_u32 s48, s48, 2
s_cmp_ge_u32 s32, 64
s_cselect_b32 s48, 1, s48
s_cselect_b32 s46, 0, s46
s_cselect_b32 s51, 1, 30
s_add_u32 s57, s49, 1
s_and_b32 s57, s57, 3
s_mov_b32 s58, s49
s_mov_b32 s12, s74
s_mov_b32 s13, s75
s_mov_b32 s14, 8388608
s_lshl_b32 s24, s48, 19
s_lshl_b32 s25, s26, 18
s_add_u32 s24, s24, s25
s_lshl_b32 s25, s49, 16
s_add_u32 s24, s24, s25
s_add_u32 s24, s24, s27
s_add_u32 s52, s24, 109051904
s_cmp_ge_u32 s32, 64
s_cselect_b32 s25, 1, 2
s_lshl_b32 s24, s25, 19
s_mov_b32 s34, 0
s_lshl_b32 s26, s49, 7
s_add_u32 s26, s26, 32768
s_add_u32 s26, s26, s30
s_branch L_fgP
L_fgB:
s_and_b32 s50, s21, 7
s_bfe_u32 s48, s21, 0x20005
s_mov_b32 s49, 4
s_mov_b32 s51, 15
s_mov_b32 s46, 127
s_add_u32 s48, s48, 4
s_mov_b32 s12, s82
s_mov_b32 s13, s83
s_mov_b32 s14, 2097152
s_lshl_b32 s24, s48, 17
s_lshl_b32 s25, s26, 16
s_add_u32 s24, s24, s25
s_add_u32 s24, s24, s27
s_add_u32 s52, s24, 171966464
s_mov_b32 s24, 524288
s_mov_b32 s25, 4
s_mov_b32 s34, 2048
s_mov_b32 s26, 49152
v_mov_b32 v7, 0
L_fgP:
s_add_u32 s53, s52, s24
s_add_u32 s54, s53, s24
s_add_u32 s55, s54, s24
s_cmp_le_u32 s51, 3
s_cselect_b32 s55, 2147483648, s55
s_lshl_b32 s56, s24, 1
s_lshl_b32 s63, s25, 17
v_add_u32 v7, s26, v7
s_and_b32 s26, s32, 0x67
s_lshl_b32 s26, s26, 6
s_add_u32 s26, s26, 33792
s_add_u32 s26, s26, s30
s_add_u32 s43, s48, 3
s_cmp_eq_u32 s49, 4
s_cselect_b32 s26, 49408, s26
s_cselect_b32 s29, 0, 3
v_and_b32 v5, s29, v1
v_lshlrev_b32 v5, 9, v5
v_add_u32 v5, s26, v5
v_cmp_gt_u32 vcc, 32, v1
s_nop 1
v_cndmask_b32 v27, v5, v7, vcc
s_cselect_b32 s26, 0, 1
s_cselect_b32 s29, 1000, 2
v_mov_b32 v5, s26
v_mov_b32 v6, s29
v_cndmask_b32 v11, v5, v6, vcc
s_cselect_b32 s26, 31, -3
s_cselect_b32 s29, -5873, s43
v_mov_b32 v5, s26
v_mov_b32 v6, s29
v_cndmask_b32 v10, v5, v6, vcc
s_lshl_b32 s26, s32, 6
s_add_u32 s26, s26, 33792
s_add_u32 s26, s26, s30
s_cmp_lt_u32 s49, 4
s_cselect_b32 s26, s26, 2147483648
s_cmp_eq_u32 s20, 0
s_cselect_b32 s26, s26, 2147483648
s_cmp_eq_u32 s20, 0
s_cbranch_scc1 L_fgw0p
v_mov_b32 v27, 2147483648
v_mov_b32 v11, 0
v_mov_b32 v10, -2
L_fgw0p:
v_mov_b32 v5, s26
v_mov_b32 v6, 2147483648
v_cmp_eq_u32 vcc, 0, v1
s_nop 1
v_cndmask_b32 v23, v6, v5, vcc
s_lshl_b32 s26, s50, 2
s_add_u32 s26, s26, s20
s_lshl_b32 s27, s50, 14
s_lshl_b32 s24, s20, 11
s_add_u32 s27, s27, s24
v_add_u32 v13, s27, v2
s_lshl_b32 s60, s48, 19
s_add_u32 s60, s60, 41943040
s_lshl_b32 s62, s48, 17
s_lshl_b32 s37, s49, 17
s_xor_b32 s39, s37, 131072
s_xor_b32 s40, s37, 262144
s_xor_b32 s47, s37, 393216
s_lshl_b32 s24, s63, 2
s_sub_u32 s59, s60, s24
s_sub_u32 s61, s62, s63
s_lshr_b32 s24, s56, 1
s_sub_u32 s25, s52, s24
s_lshr_b32 s45, s25, 8
s_xor_b32 s45, s45, s30
s_and_b32 s45, s45, s23
s_or_b32 s45, s45, s25
s_mov_b32 s25, s52
s_lshr_b32 s52, s25, 8
s_xor_b32 s52, s52, s30
s_and_b32 s52, s52, s23
s_or_b32 s52, s52, s25
s_mov_b32 s25, s53
s_lshr_b32 s53, s25, 8
s_xor_b32 s53, s53, s30
s_and_b32 s53, s53, s23
s_or_b32 s53, s53, s25
s_mov_b32 s25, s54
s_lshr_b32 s54, s25, 8
s_xor_b32 s54, s54, s30
s_and_b32 s54, s54, s23
s_or_b32 s54, s54, s25
s_mov_b32 s25, s55
s_lshr_b32 s55, s25, 8
s_xor_b32 s55, s55, s30
s_and_b32 s55, s55, s23
s_or_b32 s55, s55, s25
v_lshrrev_b32 v5, 2, v4
v_lshlrev_b32 v5, 3, v5
v_and_b32 v6, 3, v4
v_add_u32 v5, v5, v6
v_lshlrev_b32 v5, 12, v5
v_lshl_add_u32 v5, v3, 4, v5
s_lshl_b32 s26, s26, 6
s_add_u32 s27, s26, s34
v_add_u32 v25, s27, v5
v_add_u32 v26, 16384, v25
v_mov_b32 v14, v2
v_add_u32 v18, 65536, v2
s_cmp_eq_u32 s49, 4
s_cselect_b32 s24, 15, 17
s_lshr_b32 s25, s50, 2
s_lshl_b32 s24, s25, s24
s_and_b32 s25, s50, 3
s_lshl_b32 s25, s25, 13
s_add_u32 s24, s24, s25
s_lshr_b32 s25, s56, 1
s_mul_i32 s25, s25, 0
s_add_u32 s24, s24, s25
s_cmp_eq_u32 s20, 0
s_cselect_b32 s24, s24, 1073741824
v_lshlrev_b32 v15, 7, v1
v_add_u32 v15, s24, v15
s_and_b32 s25, s49, 3
s_lshl_b32 s42, s25, 21
s_lshl_b32 s25, s50, 8
s_add_u32 s42, s42, s25
v_mul_lo_u32 v5, v3, s33
v_lshlrev_b32 v6, 2, v3
v_xor_b32 v6, v6, v4
v_lshl_add_u32 v8, v6, 4, v5
s_lshl_b32 s24, s20, 5
s_mul_i32 s24, s24, s33
s_add_u32 s42, s42, s24
s_lshl_b32 s33, s33, 2
s_lshl_b32 s41, s20, 13
s_add_u32 s41, s41, 65536
v_bfe_u32 v5, v1, 2, 2
v_lshl_add_u32 v5, v3, 3, v5
v_lshlrev_b32 v5, 8, v5
v_and_b32 v6, 3, v1
v_lshl_add_u32 v5, v6, 4, v5
v_bfe_u32 v6, v1, 2, 2
v_xor_b32 v6, s20, v6
v_lshl_add_u32 v5, v6, 6, v5
v_add_u32 v9, 65536, v5
s_branch L_fgw0_go
L_fgw0:
s_sleep 8
L_fgw0_go:
buffer_load_dword v12, v27, s[4:7], 0 offen sc1
s_sub_u32 s28, s28, 1
s_cbranch_scc1 L_end
s_waitcnt vmcnt(0)
v_cmp_gt_i32 vcc, v10, v12
s_cbranch_vccnz L_fgw0
s_waitcnt vmcnt(0)
s_barrier
s_add_u32 m0, s44, 0
s_add_u32 s29, s45, 0
buffer_load_dwordx4 v2, s[4:7], s29 offen lds
s_add_u32 m0, s44, 1024
s_add_u32 s29, s45, 1024
buffer_load_dwordx4 v2, s[4:7], s29 offen lds
s_add_u32 m0, s44, 2048
s_add_u32 s29, s45, 2048
buffer_load_dwordx4 v2, s[4:7], s29 offen lds
s_add_u32 m0, s44, 3072
s_add_u32 s29, s45, 3072
buffer_load_dwordx4 v2, s[4:7], s29 offen lds
s_add_u32 m0, s44, 4096
s_add_u32 s29, s45, 4096
buffer_load_dwordx4 v2, s[4:7], s29 offen lds
s_add_u32 m0, s44, 5120
s_add_u32 s29, s45, 5120
buffer_load_dwordx4 v2, s[4:7], s29 offen lds
s_add_u32 m0, s44, 6144
s_add_u32 s29, s45, 6144
buffer_load_dwordx4 v2, s[4:7], s29 offen lds
s_add_u32 m0, s44, 7168
s_add_u32 s29, s45, 7168
buffer_load_dwordx4 v2, s[4:7], s29 offen lds
s_add_u32 m0, s44, 32768
s_add_u32 s29, s45, 32768
buffer_load_dwordx4 v2, s[4:7], s29 offen lds
s_add_u32 m0, s44, 33792
s_add_u32 s29, s45, 33792
buffer_load_dwordx4 v2, s[4:7], s29 offen lds
s_add_u32 m0, s44, 34816
s_add_u32 s29, s45, 34816
buffer_load_dwordx4 v2, s[4:7], s29 offen lds
s_add_u32 m0, s44, 35840
s_add_u32 s29, s45, 35840
buffer_load_dwordx4 v2, s[4:7], s29 offen lds
s_add_u32 m0, s44, 36864
s_add_u32 s29, s45, 36864
buffer_load_dwordx4 v2, s[4:7], s29 offen lds
s_add_u32 m0, s44, 37888
s_add_u32 s29, s45, 37888
buffer_load_dwordx4 v2, s[4:7], s29 offen lds
s_add_u32 m0, s44, 38912
s_add_u32 s29, s45, 38912
buffer_load_dwordx4 v2, s[4:7], s29 offen lds
s_add_u32 m0, s44, 39936
s_add_u32 s29, s45, 39936
buffer_load_dwordx4 v2, s[4:7], s29 offen lds
s_add_u32 m0, s41, 0
s_nop 0
buffer_load_dwordx4 v8, s[12:15], s42 offen lds
s_add_u32 s42, s42, s33
s_add_u32 m0, s41, 1024
s_nop 0
buffer_load_dwordx4 v8, s[12:15], s42 offen lds
s_add_u32 s42, s42, s33
s_add_u32 m0, s41, 2048
s_nop 0
buffer_load_dwordx4 v8, s[12:15], s42 offen lds
s_add_u32 s42, s42, s33
s_add_u32 m0, s41, 3072
s_nop 0
buffer_load_dwordx4 v8, s[12:15], s42 offen lds
s_add_u32 s42, s42, s33
s_add_u32 m0, s41, 4096
s_nop 0
buffer_load_dwordx4 v8, s[12:15], s42 offen lds
s_add_u32 s42, s42, s33
s_add_u32 m0, s41, 5120
s_nop 0
buffer_load_dwordx4 v8, s[12:15], s42 offen lds
s_add_u32 s42, s42, s33
s_add_u32 m0, s41, 6144
s_nop 0
buffer_load_dwordx4 v8, s[12:15], s42 offen lds
s_add_u32 s42, s42, s33
s_add_u32 m0, s41, 7168
s_nop 0
buffer_load_dwordx4 v8, s[12:15], s42 offen lds
s_add_u32 s42, s42, s33
s_mul_i32 s24, s33, 24
s_add_u32 s42, s42, s24
s_add_u32 m0, s41, 32768
s_nop 0
buffer_load_dwordx4 v8, s[12:15], s42 offen lds
s_add_u32 s42, s42, s33
s_add_u32 m0, s41, 33792
s_nop 0
buffer_load_dwordx4 v8, s[12:15], s42 offen lds
s_add_u32 s42, s42, s33
s_add_u32 m0, s41, 34816
s_nop 0
buffer_load_dwordx4 v8, s[12:15], s42 offen lds
s_add_u32 s42, s42, s33
s_add_u32 m0, s41, 35840
s_nop 0
buffer_load_dwordx4 v8, s[12:15], s42 offen lds
s_add_u32 s42, s42, s33
s_add_u32 m0, s41, 36864
s_nop 0
buffer_load_dwordx4 v8, s[12:15], s42 offen lds
s_add_u32 s42, s42, s33
s_add_u32 m0, s41, 37888
s_nop 0
buffer_load_dwordx4 v8, s[12:15], s42 offen lds
s_add_u32 s42, s42, s33
s_add_u32 m0, s41, 38912
s_nop 0
buffer_load_dwordx4 v8, s[12:15], s42 offen lds
s_add_u32 s42, s42, s33
s_add_u32 m0, s41, 39936
s_nop 0
buffer_load_dwordx4 v8, s[12:15], s42 offen lds
s_add_u32 s42, s42, s33
s_mul_i32 s24, s33, 24
s_add_u32 s42, s42, s24
s_add_u32 m0, s41, 65536
s_nop 0
buffer_load_dwordx4 v8, s[12:15], s42 offen lds
s_add_u32 s42, s42, s33
s_add_u32 m0, s41, 66560
s_nop 0
buffer_load_dwordx4 v8, s[12:15], s42 offen lds
s_add_u32 s42, s42, s33
s_add_u32 m0, s41, 67584
s_nop 0
buffer_load_dwordx4 v8, s[12:15], s42 offen lds
s_add_u32 s42, s42, s33
s_add_u32 m0, s41, 68608
s_nop 0
buffer_load_dwordx4 v8, s[12:15], s42 offen lds
s_add_u32 s42, s42, s33
s_add_u32 m0, s41, 69632
s_nop 0
buffer_load_dwordx4 v8, s[12:15], s42 offen lds
s_add_u32 s42, s42, s33
s_add_u32 m0, s41, 70656
s_nop 0
buffer_load_dwordx4 v8, s[12:15], s42 offen lds
s_add_u32 s42, s42, s33
s_add_u32 m0, s41, 71680
s_nop 0
buffer_load_dwordx4 v8, s[12:15], s42 offen lds
s_add_u32 s42, s42, s33
s_add_u32 m0, s41, 72704
s_nop 0
buffer_load_dwordx4 v8, s[12:15], s42 offen lds
s_add_u32 s42, s42, s33
s_mul_i32 s24, s33, 24
s_add_u32 s42, s42, s24
s_waitcnt vmcnt(16)
s_barrier
ds_read_b64_tr_b16 a[0:1], v9 offset:0
ds_read_b64_tr_b16 a[2:3], v9 offset:1024
ds_read_b64_tr_b16 a[128:129], v9 offset:8
ds_read_b64_tr_b16 a[130:131], v9 offset:1032
ds_read_b64_tr_b16 a[4:5], v9 offset:8192
ds_read_b64_tr_b16 a[6:7], v9 offset:9216
ds_read_b64_tr_b16 a[132:133], v9 offset:8200
ds_read_b64_tr_b16 a[134:135], v9 offset:9224
ds_read_b64_tr_b16 a[8:9], v9 offset:16384
ds_read_b64_tr_b16 a[10:11], v9 offset:17408
ds_read_b64_tr_b16 a[136:137], v9 offset:16392
ds_read_b64_tr_b16 a[138:139], v9 offset:17416
ds_read_b64_tr_b16 a[12:13], v9 offset:24576
ds_read_b64_tr_b16 a[14:15], v9 offset:25600
ds_read_b64_tr_b16 a[140:141], v9 offset:24584
ds_read_b64_tr_b16 a[142:143], v9 offset:25608
s_waitcnt lgkmcnt(0)
ds_read_b128 v[56:59], v14 offset:0
ds_read_b128 v[60:63], v14 offset:16384
ds_read_b128 v[64:67], v14 offset:1024
ds_read_b128 v[68:71], v14 offset:17408
ds_read_b128 v[72:75], v14 offset:2048
ds_read_b128 v[76:79], v14 offset:18432
ds_read_b128 v[80:83], v14 offset:3072
ds_read_b128 v[84:87], v14 offset:19456
s_waitcnt lgkmcnt(0)
v_mfma_f32_16x16x32_bf16 v[104:107], a[0:3], v[56:59], 0
v_mfma_f32_16x16x32_bf16 v[108:111], a[128:131], v[56:59], 0
v_mfma_f32_16x16x32_bf16 v[112:115], a[0:3], v[60:63], 0
v_mfma_f32_16x16x32_bf16 v[116:119], a[128:131], v[60:63], 0
v_mfma_f32_16x16x32_bf16 v[104:107], a[4:7], v[64:67], v[104:107]
v_mfma_f32_16x16x32_bf16 v[108:111], a[132:135], v[64:67], v[108:111]
v_mfma_f32_16x16x32_bf16 v[112:115], a[4:7], v[68:71], v[112:115]
v_mfma_f32_16x16x32_bf16 v[116:119], a[132:135], v[68:71], v[116:119]
v_mfma_f32_16x16x32_bf16 v[104:107], a[8:11], v[72:75], v[104:107]
v_mfma_f32_16x16x32_bf16 v[108:111], a[136:139], v[72:75], v[108:111]
v_mfma_f32_16x16x32_bf16 v[112:115], a[8:11], v[76:79], v[112:115]
v_mfma_f32_16x16x32_bf16 v[116:119], a[136:139], v[76:79], v[116:119]
v_mfma_f32_16x16x32_bf16 v[104:107], a[12:15], v[80:83], v[104:107]
v_mfma_f32_16x16x32_bf16 v[108:111], a[140:143], v[80:83], v[108:111]
v_mfma_f32_16x16x32_bf16 v[112:115], a[12:15], v[84:87], v[112:115]
v_mfma_f32_16x16x32_bf16 v[116:119], a[140:143], v[84:87], v[116:119]
s_waitcnt vmcnt(8)
s_barrier
s_add_u32 m0, s41, 0
s_nop 0
buffer_load_dwordx4 v8, s[12:15], s42 offen lds
s_add_u32 s42, s42, s33
s_add_u32 m0, s41, 1024
s_nop 0
buffer_load_dwordx4 v8, s[12:15], s42 offen lds
s_add_u32 s42, s42, s33
s_add_u32 m0, s41, 2048
s_nop 0
buffer_load_dwordx4 v8, s[12:15], s42 offen lds
s_add_u32 s42, s42, s33
s_add_u32 m0, s41, 3072
s_nop 0
buffer_load_dwordx4 v8, s[12:15], s42 offen lds
s_add_u32 s42, s42, s33
s_add_u32 m0, s41, 4096
s_nop 0
buffer_load_dwordx4 v8, s[12:15], s42 offen lds
s_add_u32 s42, s42, s33
s_add_u32 m0, s41, 5120
s_nop 0
buffer_load_dwordx4 v8, s[12:15], s42 offen lds
s_add_u32 s42, s42, s33
s_add_u32 m0, s41, 6144
s_nop 0
buffer_load_dwordx4 v8, s[12:15], s42 offen lds
s_add_u32 s42, s42, s33
s_add_u32 m0, s41, 7168
s_nop 0
buffer_load_dwordx4 v8, s[12:15], s42 offen lds
s_add_u32 s42, s42, s33
s_mul_i32 s24, s33, 24
s_add_u32 s42, s42, s24
ds_read_b64_tr_b16 a[16:17], v9 offset:32768
ds_read_b64_tr_b16 a[18:19], v9 offset:33792
ds_read_b64_tr_b16 a[144:145], v9 offset:32776
ds_read_b64_tr_b16 a[146:147], v9 offset:33800
ds_read_b64_tr_b16 a[20:21], v9 offset:40960
ds_read_b64_tr_b16 a[22:23], v9 offset:41984
ds_read_b64_tr_b16 a[148:149], v9 offset:40968
ds_read_b64_tr_b16 a[150:151], v9 offset:41992
ds_read_b64_tr_b16 a[24:25], v9 offset:49152
ds_read_b64_tr_b16 a[26:27], v9 offset:50176
ds_read_b64_tr_b16 a[152:153], v9 offset:49160
ds_read_b64_tr_b16 a[154:155], v9 offset:50184
ds_read_b64_tr_b16 a[28:29], v9 offset:57344
ds_read_b64_tr_b16 a[30:31], v9 offset:58368
ds_read_b64_tr_b16 a[156:157], v9 offset:57352
ds_read_b64_tr_b16 a[158:159], v9 offset:58376
s_waitcnt lgkmcnt(0)
ds_read_b128 v[56:59], v14 offset:4096
ds_read_b128 v[60:63], v14 offset:20480
ds_read_b128 v[64:67], v14 offset:5120
ds_read_b128 v[68:71], v14 offset:21504
ds_read_b128 v[72:75], v14 offset:6144
ds_read_b128 v[76:79], v14 offset:22528
ds_read_b128 v[80:83], v14 offset:7168
ds_read_b128 v[84:87], v14 offset:23552
s_waitcnt lgkmcnt(0)
v_mfma_f32_16x16x32_bf16 v[104:107], a[16:19], v[56:59], v[104:107]
v_mfma_f32_16x16x32_bf16 v[108:111], a[144:147], v[56:59], v[108:111]
v_mfma_f32_16x16x32_bf16 v[112:115], a[16:19], v[60:63], v[112:115]
v_mfma_f32_16x16x32_bf16 v[116:119], a[144:147], v[60:63], v[116:119]
v_mfma_f32_16x16x32_bf16 v[104:107], a[20:23], v[64:67], v[104:107]
v_mfma_f32_16x16x32_bf16 v[108:111], a[148:151], v[64:67], v[108:111]
v_mfma_f32_16x16x32_bf16 v[112:115], a[20:23], v[68:71], v[112:115]
v_mfma_f32_16x16x32_bf16 v[116:119], a[148:151], v[68:71], v[116:119]
v_mfma_f32_16x16x32_bf16 v[104:107], a[24:27], v[72:75], v[104:107]
v_mfma_f32_16x16x32_bf16 v[108:111], a[152:155], v[72:75], v[108:111]
v_mfma_f32_16x16x32_bf16 v[112:115], a[24:27], v[76:79], v[112:115]
v_mfma_f32_16x16x32_bf16 v[116:119], a[152:155], v[76:79], v[116:119]
v_mfma_f32_16x16x32_bf16 v[104:107], a[28:31], v[80:83], v[104:107]
v_mfma_f32_16x16x32_bf16 v[108:111], a[156:159], v[80:83], v[108:111]
v_mfma_f32_16x16x32_bf16 v[112:115], a[28:31], v[84:87], v[112:115]
v_mfma_f32_16x16x32_bf16 v[116:119], a[156:159], v[84:87], v[116:119]
s_waitcnt vmcnt(8)
s_barrier
s_add_u32 m0, s41, 32768
s_nop 0
buffer_load_dwordx4 v8, s[12:15], s42 offen lds
s_add_u32 s42, s42, s33
s_add_u32 m0, s41, 33792
s_nop 0
buffer_load_dwordx4 v8, s[12:15], s42 offen lds
s_add_u32 s42, s42, s33
s_add_u32 m0, s41, 34816
s_nop 0
buffer_load_dwordx4 v8, s[12:15], s42 offen lds
s_add_u32 s42, s42, s33
s_add_u32 m0, s41, 35840
s_nop 0
buffer_load_dwordx4 v8, s[12:15], s42 offen lds
s_add_u32 s42, s42, s33
s_add_u32 m0, s41, 36864
s_nop 0
buffer_load_dwordx4 v8, s[12:15], s42 offen lds
s_add_u32 s42, s42, s33
s_add_u32 m0, s41, 37888
s_nop 0
buffer_load_dwordx4 v8, s[12:15], s42 offen lds
s_add_u32 s42, s42, s33
s_add_u32 m0, s41, 38912
s_nop 0
buffer_load_dwordx4 v8, s[12:15], s42 offen lds
s_add_u32 s42, s42, s33
s_add_u32 m0, s41, 39936
s_nop 0
buffer_load_dwordx4 v8, s[12:15], s42 offen lds
s_add_u32 s42, s42, s33
s_mul_i32 s24, s33, 24
s_add_u32 s42, s42, s24
v_add_u32 v9, 65536, v9
ds_read_b64_tr_b16 a[32:33], v9 offset:0
ds_read_b64_tr_b16 a[34:35], v9 offset:1024
ds_read_b64_tr_b16 a[160:161], v9 offset:8
ds_read_b64_tr_b16 a[162:163], v9 offset:1032
ds_read_b64_tr_b16 a[36:37], v9 offset:8192
ds_read_b64_tr_b16 a[38:39], v9 offset:9216
ds_read_b64_tr_b16 a[164:165], v9 offset:8200
ds_read_b64_tr_b16 a[166:167], v9 offset:9224
ds_read_b64_tr_b16 a[40:41], v9 offset:16384
ds_read_b64_tr_b16 a[42:43], v9 offset:17408
ds_read_b64_tr_b16 a[168:169], v9 offset:16392
ds_read_b64_tr_b16 a[170:171], v9 offset:17416
ds_read_b64_tr_b16 a[44:45], v9 offset:24576
ds_read_b64_tr_b16 a[46:47], v9 offset:25600
ds_read_b64_tr_b16 a[172:173], v9 offset:24584
ds_read_b64_tr_b16 a[174:175], v9 offset:25608
s_waitcnt lgkmcnt(0)
ds_read_b128 v[56:59], v14 offset:8192
ds_read_b128 v[60:63], v14 offset:24576
ds_read_b128 v[64:67], v14 offset:9216
ds_read_b128 v[68:71], v14 offset:25600
ds_read_b128 v[72:75], v14 offset:10240
ds_read_b128 v[76:79], v14 offset:26624
ds_read_b128 v[80:83], v14 offset:11264
ds_read_b128 v[84:87], v14 offset:27648
s_waitcnt lgkmcnt(0)
v_mfma_f32_16x16x32_bf16 v[104:107], a[32:35], v[56:59], v[104:107]
v_mfma_f32_16x16x32_bf16 v[108:111], a[160:163], v[56:59], v[108:111]
v_mfma_f32_16x16x32_bf16 v[112:115], a[32:35], v[60:63], v[112:115]
v_mfma_f32_16x16x32_bf16 v[116:119], a[160:163], v[60:63], v[116:119]
v_mfma_f32_16x16x32_bf16 v[104:107], a[36:39], v[64:67], v[104:107]
v_mfma_f32_16x16x32_bf16 v[108:111], a[164:167], v[64:67], v[108:111]
v_mfma_f32_16x16x32_bf16 v[112:115], a[36:39], v[68:71], v[112:115]
v_mfma_f32_16x16x32_bf16 v[116:119], a[164:167], v[68:71], v[116:119]
v_mfma_f32_16x16x32_bf16 v[104:107], a[40:43], v[72:75], v[104:107]
v_mfma_f32_16x16x32_bf16 v[108:111], a[168:171], v[72:75], v[108:111]
v_mfma_f32_16x16x32_bf16 v[112:115], a[40:43], v[76:79], v[112:115]
v_mfma_f32_16x16x32_bf16 v[116:119], a[168:171], v[76:79], v[116:119]
v_mfma_f32_16x16x32_bf16 v[104:107], a[44:47], v[80:83], v[104:107]
v_mfma_f32_16x16x32_bf16 v[108:111], a[172:175], v[80:83], v[108:111]
v_mfma_f32_16x16x32_bf16 v[112:115], a[44:47], v[84:87], v[112:115]
v_mfma_f32_16x16x32_bf16 v[116:119], a[172:175], v[84:87], v[116:119]
s_waitcnt vmcnt(8)
s_barrier
s_add_u32 m0, s41, 65536
s_nop 0
buffer_load_dwordx4 v8, s[12:15], s42 offen lds
s_add_u32 s42, s42, s33
s_add_u32 m0, s41, 66560
s_nop 0
buffer_load_dwordx4 v8, s[12:15], s42 offen lds
s_add_u32 s42, s42, s33
s_add_u32 m0, s41, 67584
s_nop 0
buffer_load_dwordx4 v8, s[12:15], s42 offen lds
s_add_u32 s42, s42, s33
s_add_u32 m0, s41, 68608
s_nop 0
buffer_load_dwordx4 v8, s[12:15], s42 offen lds
s_add_u32 s42, s42, s33
s_add_u32 m0, s41, 69632
s_nop 0
buffer_load_dwordx4 v8, s[12:15], s42 offen lds
s_add_u32 s42, s42, s33
s_add_u32 m0, s41, 70656
s_nop 0
buffer_load_dwordx4 v8, s[12:15], s42 offen lds
s_add_u32 s42, s42, s33
s_add_u32 m0, s41, 71680
s_nop 0
buffer_load_dwordx4 v8, s[12:15], s42 offen lds
s_add_u32 s42, s42, s33
s_add_u32 m0, s41, 72704
s_nop 0
buffer_load_dwordx4 v8, s[12:15], s42 offen lds
s_add_u32 s42, s42, s33
s_mul_i32 s24, s33, 24
s_add_u32 s42, s42, s24
v_subrev_u32 v9, 65536, v9
ds_read_b64_tr_b16 a[48:49], v9 offset:0
ds_read_b64_tr_b16 a[50:51], v9 offset:1024
ds_read_b64_tr_b16 a[176:177], v9 offset:8
ds_read_b64_tr_b16 a[178:179], v9 offset:1032
ds_read_b64_tr_b16 a[52:53], v9 offset:8192
ds_read_b64_tr_b16 a[54:55], v9 offset:9216
ds_read_b64_tr_b16 a[180:181], v9 offset:8200
ds_read_b64_tr_b16 a[182:183], v9 offset:9224
ds_read_b64_tr_b16 a[56:57], v9 offset:16384
ds_read_b64_tr_b16 a[58:59], v9 offset:17408
ds_read_b64_tr_b16 a[184:185], v9 offset:16392
ds_read_b64_tr_b16 a[186:187], v9 offset:17416
ds_read_b64_tr_b16 a[60:61], v9 offset:24576
ds_read_b64_tr_b16 a[62:63], v9 offset:25600
ds_read_b64_tr_b16 a[188:189], v9 offset:24584
ds_read_b64_tr_b16 a[190:191], v9 offset:25608
s_waitcnt lgkmcnt(0)
ds_read_b128 v[56:59], v14 offset:12288
ds_read_b128 v[60:63], v14 offset:28672
ds_read_b128 v[64:67], v14 offset:13312
ds_read_b128 v[68:71], v14 offset:29696
ds_read_b128 v[72:75], v14 offset:14336
ds_read_b128 v[76:79], v14 offset:30720
ds_read_b128 v[80:83], v14 offset:15360
ds_read_b128 v[84:87], v14 offset:31744
s_waitcnt lgkmcnt(0)
v_mfma_f32_16x16x32_bf16 v[104:107], a[48:51], v[56:59], v[104:107]
v_mfma_f32_16x16x32_bf16 v[108:111], a[176:179], v[56:59], v[108:111]
v_mfma_f32_16x16x32_bf16 v[112:115], a[48:51], v[60:63], v[112:115]
v_mfma_f32_16x16x32_bf16 v[116:119], a[176:179], v[60:63], v[116:119]
v_mfma_f32_16x16x32_bf16 v[104:107], a[52:55], v[64:67], v[104:107]
v_mfma_f32_16x16x32_bf16 v[108:111], a[180:183], v[64:67], v[108:111]
v_mfma_f32_16x16x32_bf16 v[112:115], a[52:55], v[68:71], v[112:115]
v_mfma_f32_16x16x32_bf16 v[116:119], a[180:183], v[68:71], v[116:119]
v_mfma_f32_16x16x32_bf16 v[104:107], a[56:59], v[72:75], v[104:107]
v_mfma_f32_16x16x32_bf16 v[108:111], a[184:187], v[72:75], v[108:111]
v_mfma_f32_16x16x32_bf16 v[112:115], a[56:59], v[76:79], v[112:115]
v_mfma_f32_16x16x32_bf16 v[116:119], a[184:187], v[76:79], v[116:119]
v_mfma_f32_16x16x32_bf16 v[104:107], a[60:63], v[80:83], v[104:107]
v_mfma_f32_16x16x32_bf16 v[108:111], a[188:191], v[80:83], v[108:111]
v_mfma_f32_16x16x32_bf16 v[112:115], a[60:63], v[84:87], v[112:115]
v_mfma_f32_16x16x32_bf16 v[116:119], a[188:191], v[84:87], v[116:119]
s_waitcnt vmcnt(8)
s_barrier
s_add_u32 m0, s41, 0
s_nop 0
buffer_load_dwordx4 v8, s[12:15], s42 offen lds
s_add_u32 s42, s42, s33
s_add_u32 m0, s41, 1024
s_nop 0
buffer_load_dwordx4 v8, s[12:15], s42 offen lds
s_add_u32 s42, s42, s33
s_add_u32 m0, s41, 2048
s_nop 0
buffer_load_dwordx4 v8, s[12:15], s42 offen lds
s_add_u32 s42, s42, s33
s_add_u32 m0, s41, 3072
s_nop 0
buffer_load_dwordx4 v8, s[12:15], s42 offen lds
s_add_u32 s42, s42, s33
s_add_u32 m0, s41, 4096
s_nop 0
buffer_load_dwordx4 v8, s[12:15], s42 offen lds
s_add_u32 s42, s42, s33
s_add_u32 m0, s41, 5120
s_nop 0
buffer_load_dwordx4 v8, s[12:15], s42 offen lds
s_add_u32 s42, s42, s33
s_add_u32 m0, s41, 6144
s_nop 0
buffer_load_dwordx4 v8, s[12:15], s42 offen lds
s_add_u32 s42, s42, s33
s_add_u32 m0, s41, 7168
s_nop 0
buffer_load_dwordx4 v8, s[12:15], s42 offen lds
s_add_u32 s42, s42, s33
s_mul_i32 s24, s33, 24
s_add_u32 s42, s42, s24
ds_read_b64_tr_b16 a[64:65], v9 offset:32768
ds_read_b64_tr_b16 a[66:67], v9 offset:33792
ds_read_b64_tr_b16 a[192:193], v9 offset:32776
ds_read_b64_tr_b16 a[194:195], v9 offset:33800
ds_read_b64_tr_b16 a[68:69], v9 offset:40960
ds_read_b64_tr_b16 a[70:71], v9 offset:41984
ds_read_b64_tr_b16 a[196:197], v9 offset:40968
ds_read_b64_tr_b16 a[198:199], v9 offset:41992
ds_read_b64_tr_b16 a[72:73], v9 offset:49152
ds_read_b64_tr_b16 a[74:75], v9 offset:50176
ds_read_b64_tr_b16 a[200:201], v9 offset:49160
ds_read_b64_tr_b16 a[202:203], v9 offset:50184
ds_read_b64_tr_b16 a[76:77], v9 offset:57344
ds_read_b64_tr_b16 a[78:79], v9 offset:58368
ds_read_b64_tr_b16 a[204:205], v9 offset:57352
ds_read_b64_tr_b16 a[206:207], v9 offset:58376
s_waitcnt lgkmcnt(0)
s_add_u32 m0, s44, 0
s_add_u32 s29, s52, 0
buffer_load_dwordx4 v2, s[4:7], s29 offen lds
s_add_u32 m0, s44, 1024
s_add_u32 s29, s52, 1024
buffer_load_dwordx4 v2, s[4:7], s29 offen lds
s_add_u32 m0, s44, 2048
s_add_u32 s29, s52, 2048
buffer_load_dwordx4 v2, s[4:7], s29 offen lds
s_add_u32 m0, s44, 3072
s_add_u32 s29, s52, 3072
buffer_load_dwordx4 v2, s[4:7], s29 offen lds
s_add_u32 m0, s44, 4096
s_add_u32 s29, s52, 4096
buffer_load_dwordx4 v2, s[4:7], s29 offen lds
s_add_u32 m0, s44, 5120
s_add_u32 s29, s52, 5120
buffer_load_dwordx4 v2, s[4:7], s29 offen lds
s_add_u32 m0, s44, 6144
s_add_u32 s29, s52, 6144
buffer_load_dwordx4 v2, s[4:7], s29 offen lds
s_add_u32 m0, s44, 7168
s_add_u32 s29, s52, 7168
buffer_load_dwordx4 v2, s[4:7], s29 offen lds
ds_read_b128 v[56:59], v14 offset:32768
ds_read_b128 v[60:63], v14 offset:49152
ds_read_b128 v[64:67], v14 offset:33792
ds_read_b128 v[68:71], v14 offset:50176
ds_read_b128 v[72:75], v14 offset:34816
ds_read_b128 v[76:79], v14 offset:51200
ds_read_b128 v[80:83], v14 offset:35840
ds_read_b128 v[84:87], v14 offset:52224
s_waitcnt lgkmcnt(0)
v_mfma_f32_16x16x32_bf16 v[104:107], a[64:67], v[56:59], v[104:107]
v_mfma_f32_16x16x32_bf16 v[108:111], a[192:195], v[56:59], v[108:111]
v_mfma_f32_16x16x32_bf16 v[112:115], a[64:67], v[60:63], v[112:115]
v_mfma_f32_16x16x32_bf16 v[116:119], a[192:195], v[60:63], v[116:119]
v_mfma_f32_16x16x32_bf16 v[104:107], a[68:71], v[64:67], v[104:107]
v_mfma_f32_16x16x32_bf16 v[108:111], a[196:199], v[64:67], v[108:111]
v_mfma_f32_16x16x32_bf16 v[112:115], a[68:71], v[68:71], v[112:115]
v_mfma_f32_16x16x32_bf16 v[116:119], a[196:199], v[68:71], v[116:119]
v_mfma_f32_16x16x32_bf16 v[104:107], a[72:75], v[72:75], v[104:107]
v_mfma_f32_16x16x32_bf16 v[108:111], a[200:203], v[72:75], v[108:111]
v_mfma_f32_16x16x32_bf16 v[112:115], a[72:75], v[76:79], v[112:115]
v_mfma_f32_16x16x32_bf16 v[116:119], a[200:203], v[76:79], v[116:119]
v_mfma_f32_16x16x32_bf16 v[104:107], a[76:79], v[80:83], v[104:107]
v_mfma_f32_16x16x32_bf16 v[108:111], a[204:207], v[80:83], v[108:111]
v_mfma_f32_16x16x32_bf16 v[112:115], a[76:79], v[84:87], v[112:115]
v_mfma_f32_16x16x32_bf16 v[116:119], a[204:207], v[84:87], v[116:119]
s_waitcnt vmcnt(16)
s_barrier
s_add_u32 m0, s41, 32768
s_nop 0
buffer_load_dwordx4 v8, s[12:15], s42 offen lds
s_add_u32 s42, s42, s33
s_add_u32 m0, s41, 33792
s_nop 0
buffer_load_dwordx4 v8, s[12:15], s42 offen lds
s_add_u32 s42, s42, s33
s_add_u32 m0, s41, 34816
s_nop 0
buffer_load_dwordx4 v8, s[12:15], s42 offen lds
s_add_u32 s42, s42, s33
s_add_u32 m0, s41, 35840
s_nop 0
buffer_load_dwordx4 v8, s[12:15], s42 offen lds
s_add_u32 s42, s42, s33
s_add_u32 m0, s41, 36864
s_nop 0
buffer_load_dwordx4 v8, s[12:15], s42 offen lds
s_add_u32 s42, s42, s33
s_add_u32 m0, s41, 37888
s_nop 0
buffer_load_dwordx4 v8, s[12:15], s42 offen lds
s_add_u32 s42, s42, s33
s_add_u32 m0, s41, 38912
s_nop 0
buffer_load_dwordx4 v8, s[12:15], s42 offen lds
s_add_u32 s42, s42, s33
s_add_u32 m0, s41, 39936
s_nop 0
buffer_load_dwordx4 v8, s[12:15], s42 offen lds
s_add_u32 s42, s42, s33
s_mul_i32 s24, s33, 24
s_add_u32 s42, s42, s24
v_add_u32 v9, 65536, v9
ds_read_b64_tr_b16 a[80:81], v9 offset:0
ds_read_b64_tr_b16 a[82:83], v9 offset:1024
ds_read_b64_tr_b16 a[208:209], v9 offset:8
ds_read_b64_tr_b16 a[210:211], v9 offset:1032
ds_read_b64_tr_b16 a[84:85], v9 offset:8192
ds_read_b64_tr_b16 a[86:87], v9 offset:9216
ds_read_b64_tr_b16 a[212:213], v9 offset:8200
ds_read_b64_tr_b16 a[214:215], v9 offset:9224
ds_read_b64_tr_b16 a[88:89], v9 offset:16384
ds_read_b64_tr_b16 a[90:91], v9 offset:17408
ds_read_b64_tr_b16 a[216:217], v9 offset:16392
ds_read_b64_tr_b16 a[218:219], v9 offset:17416
ds_read_b64_tr_b16 a[92:93], v9 offset:24576
ds_read_b64_tr_b16 a[94:95], v9 offset:25600
ds_read_b64_tr_b16 a[220:221], v9 offset:24584
ds_read_b64_tr_b16 a[222:223], v9 offset:25608
s_waitcnt lgkmcnt(0)
ds_read_b128 v[56:59], v14 offset:36864
ds_read_b128 v[60:63], v14 offset:53248
ds_read_b128 v[64:67], v14 offset:37888
ds_read_b128 v[68:71], v14 offset:54272
ds_read_b128 v[72:75], v14 offset:38912
ds_read_b128 v[76:79], v14 offset:55296
ds_read_b128 v[80:83], v14 offset:39936
ds_read_b128 v[84:87], v14 offset:56320
s_waitcnt lgkmcnt(0)
v_mfma_f32_16x16x32_bf16 v[104:107], a[80:83], v[56:59], v[104:107]
v_mfma_f32_16x16x32_bf16 v[108:111], a[208:211], v[56:59], v[108:111]
v_mfma_f32_16x16x32_bf16 v[112:115], a[80:83], v[60:63], v[112:115]
v_mfma_f32_16x16x32_bf16 v[116:119], a[208:211], v[60:63], v[116:119]
v_mfma_f32_16x16x32_bf16 v[104:107], a[84:87], v[64:67], v[104:107]
v_mfma_f32_16x16x32_bf16 v[108:111], a[212:215], v[64:67], v[108:111]
v_mfma_f32_16x16x32_bf16 v[112:115], a[84:87], v[68:71], v[112:115]
v_mfma_f32_16x16x32_bf16 v[116:119], a[212:215], v[68:71], v[116:119]
v_mfma_f32_16x16x32_bf16 v[104:107], a[88:91], v[72:75], v[104:107]
v_mfma_f32_16x16x32_bf16 v[108:111], a[216:219], v[72:75], v[108:111]
v_mfma_f32_16x16x32_bf16 v[112:115], a[88:91], v[76:79], v[112:115]
v_mfma_f32_16x16x32_bf16 v[116:119], a[216:219], v[76:79], v[116:119]
v_mfma_f32_16x16x32_bf16 v[104:107], a[92:95], v[80:83], v[104:107]
v_mfma_f32_16x16x32_bf16 v[108:111], a[220:223], v[80:83], v[108:111]
v_mfma_f32_16x16x32_bf16 v[112:115], a[92:95], v[84:87], v[112:115]
v_mfma_f32_16x16x32_bf16 v[116:119], a[220:223], v[84:87], v[116:119]
s_waitcnt vmcnt(16)
s_barrier
v_subrev_u32 v9, 65536, v9
ds_read_b64_tr_b16 a[96:97], v9 offset:0
ds_read_b64_tr_b16 a[98:99], v9 offset:1024
ds_read_b64_tr_b16 a[224:225], v9 offset:8
ds_read_b64_tr_b16 a[226:227], v9 offset:1032
ds_read_b64_tr_b16 a[100:101], v9 offset:8192
ds_read_b64_tr_b16 a[102:103], v9 offset:9216
ds_read_b64_tr_b16 a[228:229], v9 offset:8200
ds_read_b64_tr_b16 a[230:231], v9 offset:9224
ds_read_b64_tr_b16 a[104:105], v9 offset:16384
ds_read_b64_tr_b16 a[106:107], v9 offset:17408
ds_read_b64_tr_b16 a[232:233], v9 offset:16392
ds_read_b64_tr_b16 a[234:235], v9 offset:17416
ds_read_b64_tr_b16 a[108:109], v9 offset:24576
ds_read_b64_tr_b16 a[110:111], v9 offset:25600
ds_read_b64_tr_b16 a[236:237], v9 offset:24584
ds_read_b64_tr_b16 a[238:239], v9 offset:25608
s_waitcnt lgkmcnt(0)
ds_read_b128 v[56:59], v14 offset:40960
ds_read_b128 v[60:63], v14 offset:57344
ds_read_b128 v[64:67], v14 offset:41984
ds_read_b128 v[68:71], v14 offset:58368
ds_read_b128 v[72:75], v14 offset:43008
ds_read_b128 v[76:79], v14 offset:59392
ds_read_b128 v[80:83], v14 offset:44032
ds_read_b128 v[84:87], v14 offset:60416
s_waitcnt lgkmcnt(0)
v_mfma_f32_16x16x32_bf16 v[104:107], a[96:99], v[56:59], v[104:107]
v_mfma_f32_16x16x32_bf16 v[108:111], a[224:227], v[56:59], v[108:111]
v_mfma_f32_16x16x32_bf16 v[112:115], a[96:99], v[60:63], v[112:115]
v_mfma_f32_16x16x32_bf16 v[116:119], a[224:227], v[60:63], v[116:119]
v_mfma_f32_16x16x32_bf16 v[104:107], a[100:103], v[64:67], v[104:107]
v_mfma_f32_16x16x32_bf16 v[108:111], a[228:231], v[64:67], v[108:111]
v_mfma_f32_16x16x32_bf16 v[112:115], a[100:103], v[68:71], v[112:115]
v_mfma_f32_16x16x32_bf16 v[116:119], a[228:231], v[68:71], v[116:119]
v_mfma_f32_16x16x32_bf16 v[104:107], a[104:107], v[72:75], v[104:107]
v_mfma_f32_16x16x32_bf16 v[108:111], a[232:235], v[72:75], v[108:111]
v_mfma_f32_16x16x32_bf16 v[112:115], a[104:107], v[76:79], v[112:115]
v_mfma_f32_16x16x32_bf16 v[116:119], a[232:235], v[76:79], v[116:119]
v_mfma_f32_16x16x32_bf16 v[104:107], a[108:111], v[80:83], v[104:107]
v_mfma_f32_16x16x32_bf16 v[108:111], a[236:239], v[80:83], v[108:111]
v_mfma_f32_16x16x32_bf16 v[112:115], a[108:111], v[84:87], v[112:115]
v_mfma_f32_16x16x32_bf16 v[116:119], a[236:239], v[84:87], v[116:119]
s_waitcnt vmcnt(0)
s_barrier
ds_read_b64_tr_b16 a[112:113], v9 offset:32768
ds_read_b64_tr_b16 a[114:115], v9 offset:33792
ds_read_b64_tr_b16 a[240:241], v9 offset:32776
ds_read_b64_tr_b16 a[242:243], v9 offset:33800
ds_read_b64_tr_b16 a[116:117], v9 offset:40960
ds_read_b64_tr_b16 a[118:119], v9 offset:41984
ds_read_b64_tr_b16 a[244:245], v9 offset:40968
ds_read_b64_tr_b16 a[246:247], v9 offset:41992
ds_read_b64_tr_b16 a[120:121], v9 offset:49152
ds_read_b64_tr_b16 a[122:123], v9 offset:50176
ds_read_b64_tr_b16 a[248:249], v9 offset:49160
ds_read_b64_tr_b16 a[250:251], v9 offset:50184
ds_read_b64_tr_b16 a[124:125], v9 offset:57344
ds_read_b64_tr_b16 a[126:127], v9 offset:58368
ds_read_b64_tr_b16 a[252:253], v9 offset:57352
ds_read_b64_tr_b16 a[254:255], v9 offset:58376
s_waitcnt lgkmcnt(0)
ds_read_b128 v[56:59], v14 offset:45056
ds_read_b128 v[60:63], v14 offset:61440
ds_read_b128 v[64:67], v14 offset:46080
ds_read_b128 v[68:71], v14 offset:62464
ds_read_b128 v[72:75], v14 offset:47104
ds_read_b128 v[76:79], v14 offset:63488
ds_read_b128 v[80:83], v14 offset:48128
ds_read_b128 v[84:87], v14 offset:64512
s_waitcnt lgkmcnt(0)
v_mfma_f32_16x16x32_bf16 v[104:107], a[112:115], v[56:59], v[104:107]
v_mfma_f32_16x16x32_bf16 v[108:111], a[240:243], v[56:59], v[108:111]
v_mfma_f32_16x16x32_bf16 v[112:115], a[112:115], v[60:63], v[112:115]
v_mfma_f32_16x16x32_bf16 v[116:119], a[240:243], v[60:63], v[116:119]
v_mfma_f32_16x16x32_bf16 v[104:107], a[116:119], v[64:67], v[104:107]
v_mfma_f32_16x16x32_bf16 v[108:111], a[244:247], v[64:67], v[108:111]
v_mfma_f32_16x16x32_bf16 v[112:115], a[116:119], v[68:71], v[112:115]
v_mfma_f32_16x16x32_bf16 v[116:119], a[244:247], v[68:71], v[116:119]
v_mfma_f32_16x16x32_bf16 v[104:107], a[120:123], v[72:75], v[104:107]
v_mfma_f32_16x16x32_bf16 v[108:111], a[248:251], v[72:75], v[108:111]
v_mfma_f32_16x16x32_bf16 v[112:115], a[120:123], v[76:79], v[112:115]
v_mfma_f32_16x16x32_bf16 v[116:119], a[248:251], v[76:79], v[116:119]
v_mfma_f32_16x16x32_bf16 v[104:107], a[124:127], v[80:83], v[104:107]
v_mfma_f32_16x16x32_bf16 v[108:111], a[252:255], v[80:83], v[108:111]
v_mfma_f32_16x16x32_bf16 v[112:115], a[124:127], v[84:87], v[112:115]
v_mfma_f32_16x16x32_bf16 v[116:119], a[252:255], v[84:87], v[116:119]
s_add_u32 s24, s59, s37
s_lshr_b32 s59, s24, 8
s_xor_b32 s59, s59, s30
s_and_b32 s59, s59, s23
s_or_b32 s59, s59, s24
s_add_u32 s60, s60, s37
v_add_u32 v5, 1024, v13
s_lshl_b32 s45, s63, 2
s_cmp_eq_u32 s49, 4
s_cselect_b32 s8, s16, s4
s_cselect_b32 s9, s17, s5
s_cselect_b32 s10, s18, s6
s_mov_b32 s11, 0x20000
s_cselect_b32 s59, s61, s59
s_cselect_b32 s60, s62, s60
s_cselect_b32 s45, s63, s45
s_cselect_b64 vcc, -1, 0
v_cndmask_b32 v8, v13, v25, vcc
v_cndmask_b32 v9, v5, v26, vcc
s_lshl_b32 s24, s49, 2
s_add_u32 s24, s24, s20
s_and_b32 s25, s24, 7
s_lshl_b32 s26, s25, 10
s_lshl_b32 s27, s50, 14
s_add_u32 s26, s26, s27
s_add_u32 s27, s26, 0
v_add_u32 v208, s27, v2
s_add_u32 s27, s26, 131072
v_add_u32 v209, s27, v2
s_add_u32 s27, s26, 262144
v_add_u32 v210, s27, v2
s_add_u32 s27, s26, 393216
v_add_u32 v211, s27, v2
s_lshr_b32 s26, s25, 1
s_sub_u32 s26, s26, s20
s_lshl_b32 s26, s26, 6
s_and_b32 s27, s25, 1
s_lshl_b32 s27, s27, 14
s_add_u32 s26, s26, s27
v_add_u32 v212, s26, v25
s_lshr_b32 s24, s24, 3
s_lshl_b32 s24, s24, 1
s_add_u32 s24, s24, s48
s_sub_u32 s24, s24, 2
s_lshl_b32 s58, s24, 17
s_lshl_b32 s25, s24, 19
s_add_u32 s25, s25, 41943040
s_lshr_b32 s57, s25, 8
s_xor_b32 s57, s57, s30
s_and_b32 s57, s57, s23
s_or_b32 s57, s57, s25
s_cmp_eq_u32 s49, 4
s_cselect_b32 s57, 2147483648, s57
s_cselect_b32 s58, 2147483648, s58
s_mov_b32 s35, 2147483648
s_mov_b32 s36, 2147483648
s_mov_b32 s39, 2147483648
s_mov_b32 s38, 0
s_waitcnt vmcnt(0)
s_barrier
s_add_u32 m0, s44, 32768
s_add_u32 s29, s52, 32768
buffer_load_dwordx4 v2, s[4:7], s29 offen lds
s_add_u32 m0, s44, 33792
s_add_u32 s29, s52, 33792
buffer_load_dwordx4 v2, s[4:7], s29 offen lds
s_add_u32 m0, s44, 34816
s_add_u32 s29, s52, 34816
buffer_load_dwordx4 v2, s[4:7], s29 offen lds
s_add_u32 m0, s44, 35840
s_add_u32 s29, s52, 35840
buffer_load_dwordx4 v2, s[4:7], s29 offen lds
s_add_u32 m0, s44, 36864
s_add_u32 s29, s52, 36864
buffer_load_dwordx4 v2, s[4:7], s29 offen lds
s_add_u32 m0, s44, 37888
s_add_u32 s29, s52, 37888
buffer_load_dwordx4 v2, s[4:7], s29 offen lds
s_add_u32 m0, s44, 38912
s_add_u32 s29, s52, 38912
buffer_load_dwordx4 v2, s[4:7], s29 offen lds
s_add_u32 m0, s44, 39936
s_add_u32 s29, s52, 39936
buffer_load_dwordx4 v2, s[4:7], s29 offen lds
s_mov_b32 s24, 2147483648
buffer_load_dword v17, v2, s[4:7], s24 offen
buffer_load_dword v17, v2, s[4:7], s24 offen
buffer_load_dword v17, v2, s[4:7], s24 offen
buffer_load_dword v17, v2, s[4:7], s24 offen
buffer_load_dword v17, v2, s[4:7], s24 offen
s_add_u32 m0, s44, 65536
s_add_u32 s29, s53, 0
buffer_load_dwordx4 v2, s[4:7], s29 offen offset:0 lds
buffer_load_dwordx4 v2, s[4:7], s29 offen offset:1024 lds
ds_read_b128 v[56:59], v14 offset:0
ds_read_b128 v[60:63], v14 offset:16384
ds_read_b128 v[64:67], v14 offset:1024
ds_read_b128 v[68:71], v14 offset:17408
ds_read_b128 v[72:75], v14 offset:2048
ds_read_b128 v[76:79], v14 offset:18432
ds_read_b128 v[80:83], v14 offset:3072
ds_read_b128 v[84:87], v14 offset:19456
s_cmp_eq_u32 s20, 1
s_cbranch_scc1 L_fgl1
s_cmp_eq_u32 s20, 2
s_cbranch_scc1 L_fgl2
s_cmp_eq_u32 s20, 3
s_cbranch_scc1 L_fgl3
.p2align 6
L_fgl0:
s_waitcnt lgkmcnt(6)
v_mfma_f32_16x16x32_bf16 v[88:91], a[0:3], v[56:59], 0
buffer_load_dwordx4 v2, s[4:7], s29 offen offset:2048 lds
v_mfma_f32_16x16x32_bf16 v[92:95], a[128:131], v[56:59], 0
ds_read_b128 v[56:59], v14 offset:4096
v_mfma_f32_16x16x32_bf16 v[96:99], a[0:3], v[60:63], 0
v_mfma_f32_16x16x32_bf16 v[100:103], a[128:131], v[60:63], 0
ds_read_b128 v[60:63], v14 offset:20480
s_waitcnt lgkmcnt(6)
v_mfma_f32_16x16x32_bf16 v[88:91], a[4:7], v[64:67], v[88:91]
v_cvt_pk_bf16_f32 v120, v104, v105
v_cvt_pk_bf16_f32 v121, v106, v107
v_mfma_f32_16x16x32_bf16 v[92:95], a[132:135], v[64:67], v[92:95]
v_cvt_pk_bf16_f32 v122, v108, v109
ds_read_b128 v[64:67], v14 offset:5120
v_mfma_f32_16x16x32_bf16 v[96:99], a[4:7], v[68:71], v[96:99]
v_cvt_pk_bf16_f32 v123, v110, v111
buffer_store_dwordx4 v[120:123], v8, s[8:11], s59 offen sc1
v_mfma_f32_16x16x32_bf16 v[100:103], a[132:135], v[68:71], v[100:103]
ds_read_b128 v[68:71], v14 offset:21504
s_waitcnt lgkmcnt(6)
v_mfma_f32_16x16x32_bf16 v[88:91], a[8:11], v[72:75], v[88:91]
buffer_load_dwordx4 v2, s[4:7], s29 offen offset:3072 lds
v_mfma_f32_16x16x32_bf16 v[92:95], a[136:139], v[72:75], v[92:95]
v_cvt_pk_bf16_f32 v124, v112, v113
ds_read_b128 v[72:75], v14 offset:6144
v_mfma_f32_16x16x32_bf16 v[96:99], a[8:11], v[76:79], v[96:99]
v_cvt_pk_bf16_f32 v125, v114, v115
v_cvt_pk_bf16_f32 v126, v116, v117
v_mfma_f32_16x16x32_bf16 v[100:103], a[136:139], v[76:79], v[100:103]
ds_read_b128 v[76:79], v14 offset:22528
s_waitcnt lgkmcnt(6)
v_mfma_f32_16x16x32_bf16 v[88:91], a[12:15], v[80:83], v[88:91]
v_cvt_pk_bf16_f32 v127, v118, v119
buffer_store_dwordx4 v[124:127], v9, s[8:11], s59 offen sc1
v_mfma_f32_16x16x32_bf16 v[92:95], a[140:143], v[80:83], v[92:95]
s_lshr_b32 s59, s60, 8
ds_read_b128 v[80:83], v14 offset:7168
v_mfma_f32_16x16x32_bf16 v[96:99], a[12:15], v[84:87], v[96:99]
s_xor_b32 s59, s59, s30
s_and_b32 s59, s59, s23
v_mfma_f32_16x16x32_bf16 v[100:103], a[140:143], v[84:87], v[100:103]
ds_read_b128 v[84:87], v14 offset:23552
s_waitcnt lgkmcnt(6)
s_add_u32 m0, s44, 69632
s_add_u32 s29, s53, 4096
v_mfma_f32_16x16x32_bf16 v[88:91], a[16:19], v[56:59], v[88:91]
buffer_load_dwordx4 v2, s[4:7], s29 offen offset:0 lds
v_mfma_f32_16x16x32_bf16 v[92:95], a[144:147], v[56:59], v[92:95]
s_or_b32 s59, s59, s60
ds_read_b128 v[56:59], v14 offset:8192
v_mfma_f32_16x16x32_bf16 v[96:99], a[16:19], v[60:63], v[96:99]
s_add_u32 s60, s60, s45
v_mfma_f32_16x16x32_bf16 v[100:103], a[144:147], v[60:63], v[100:103]
ds_read_b128 v[60:63], v14 offset:24576
s_waitcnt lgkmcnt(6)
v_mfma_f32_16x16x32_bf16 v[88:91], a[20:23], v[64:67], v[88:91]
v_mfma_f32_16x16x32_bf16 v[92:95], a[148:151], v[64:67], v[92:95]
ds_read_b128 v[64:67], v14 offset:9216
v_mfma_f32_16x16x32_bf16 v[96:99], a[20:23], v[68:71], v[96:99]
v_mfma_f32_16x16x32_bf16 v[100:103], a[148:151], v[68:71], v[100:103]
ds_read_b128 v[68:71], v14 offset:25600
s_waitcnt lgkmcnt(6)
v_mfma_f32_16x16x32_bf16 v[88:91], a[24:27], v[72:75], v[88:91]
buffer_load_dwordx4 v2, s[4:7], s29 offen offset:1024 lds
v_mfma_f32_16x16x32_bf16 v[92:95], a[152:155], v[72:75], v[92:95]
ds_read_b128 v[72:75], v14 offset:10240
v_mfma_f32_16x16x32_bf16 v[96:99], a[24:27], v[76:79], v[96:99]
v_mfma_f32_16x16x32_bf16 v[100:103], a[152:155], v[76:79], v[100:103]
ds_read_b128 v[76:79], v14 offset:26624
s_waitcnt lgkmcnt(6)
v_mfma_f32_16x16x32_bf16 v[88:91], a[28:31], v[80:83], v[88:91]
v_mfma_f32_16x16x32_bf16 v[92:95], a[156:159], v[80:83], v[92:95]
ds_read_b128 v[80:83], v14 offset:11264
v_mfma_f32_16x16x32_bf16 v[96:99], a[28:31], v[84:87], v[96:99]
v_mfma_f32_16x16x32_bf16 v[100:103], a[156:159], v[84:87], v[100:103]
ds_read_b128 v[84:87], v14 offset:27648
s_waitcnt lgkmcnt(6)
v_mfma_f32_16x16x32_bf16 v[88:91], a[32:35], v[56:59], v[88:91]
buffer_load_dwordx4 v2, s[4:7], s29 offen offset:2048 lds
v_mfma_f32_16x16x32_bf16 v[92:95], a[160:163], v[56:59], v[92:95]
ds_read_b128 v[56:59], v14 offset:12288
v_mfma_f32_16x16x32_bf16 v[96:99], a[32:35], v[60:63], v[96:99]
v_mfma_f32_16x16x32_bf16 v[100:103], a[160:163], v[60:63], v[100:103]
ds_read_b128 v[60:63], v14 offset:28672
s_waitcnt lgkmcnt(6)
v_mfma_f32_16x16x32_bf16 v[88:91], a[36:39], v[64:67], v[88:91]
v_add_u32 v10, v10, v11
v_min_i32 v10, s46, v10
v_mfma_f32_16x16x32_bf16 v[92:95], a[164:167], v[64:67], v[92:95]
buffer_load_dword v12, v27, s[4:7], 0 offen sc1
ds_read_b128 v[64:67], v14 offset:13312
v_mfma_f32_16x16x32_bf16 v[96:99], a[36:39], v[68:71], v[96:99]
v_mfma_f32_16x16x32_bf16 v[100:103], a[164:167], v[68:71], v[100:103]
ds_read_b128 v[68:71], v14 offset:29696
s_waitcnt lgkmcnt(6)
v_mfma_f32_16x16x32_bf16 v[88:91], a[40:43], v[72:75], v[88:91]
buffer_load_dwordx4 v2, s[4:7], s29 offen offset:3072 lds
v_mfma_f32_16x16x32_bf16 v[92:95], a[168:171], v[72:75], v[92:95]
ds_read_b128 v[72:75], v14 offset:14336
v_mfma_f32_16x16x32_bf16 v[96:99], a[40:43], v[76:79], v[96:99]
v_mfma_f32_16x16x32_bf16 v[100:103], a[168:171], v[76:79], v[100:103]
ds_read_b128 v[76:79], v14 offset:30720
s_waitcnt lgkmcnt(6)
v_mfma_f32_16x16x32_bf16 v[88:91], a[44:47], v[80:83], v[88:91]
v_mfma_f32_16x16x32_bf16 v[92:95], a[172:175], v[80:83], v[92:95]
ds_read_b128 v[80:83], v14 offset:15360
v_mfma_f32_16x16x32_bf16 v[96:99], a[44:47], v[84:87], v[96:99]
v_mfma_f32_16x16x32_bf16 v[100:103], a[172:175], v[84:87], v[100:103]
ds_read_b128 v[84:87], v14 offset:31744
s_waitcnt vmcnt(16)
s_barrier
s_waitcnt lgkmcnt(6)
s_add_u32 m0, s44, 98304
s_add_u32 s29, s53, 32768
v_mfma_f32_16x16x32_bf16 v[88:91], a[48:51], v[56:59], v[88:91]
buffer_load_dwordx4 v2, s[4:7], s29 offen offset:0 lds
v_mfma_f32_16x16x32_bf16 v[92:95], a[176:179], v[56:59], v[92:95]
ds_read_b128 v[56:59], v14 offset:32768
v_mfma_f32_16x16x32_bf16 v[96:99], a[48:51], v[60:63], v[96:99]
v_mfma_f32_16x16x32_bf16 v[100:103], a[176:179], v[60:63], v[100:103]
ds_read_b128 v[60:63], v14 offset:49152
s_waitcnt lgkmcnt(6)
v_mfma_f32_16x16x32_bf16 v[88:91], a[52:55], v[64:67], v[88:91]
v_mfma_f32_16x16x32_bf16 v[92:95], a[180:183], v[64:67], v[92:95]
ds_read_b128 v[64:67], v14 offset:33792
v_mfma_f32_16x16x32_bf16 v[96:99], a[52:55], v[68:71], v[96:99]
v_mfma_f32_16x16x32_bf16 v[100:103], a[180:183], v[68:71], v[100:103]
ds_read_b128 v[68:71], v14 offset:50176
s_waitcnt lgkmcnt(6)
v_mfma_f32_16x16x32_bf16 v[88:91], a[56:59], v[72:75], v[88:91]
buffer_load_dwordx4 v2, s[4:7], s29 offen offset:1024 lds
v_mfma_f32_16x16x32_bf16 v[92:95], a[184:187], v[72:75], v[92:95]
ds_read_b128 v[72:75], v14 offset:34816
v_mfma_f32_16x16x32_bf16 v[96:99], a[56:59], v[76:79], v[96:99]
v_mfma_f32_16x16x32_bf16 v[100:103], a[184:187], v[76:79], v[100:103]
ds_read_b128 v[76:79], v14 offset:51200
s_waitcnt lgkmcnt(6)
v_mfma_f32_16x16x32_bf16 v[88:91], a[60:63], v[80:83], v[88:91]
v_mfma_f32_16x16x32_bf16 v[92:95], a[188:191], v[80:83], v[92:95]
ds_read_b128 v[80:83], v14 offset:35840
v_mfma_f32_16x16x32_bf16 v[96:99], a[60:63], v[84:87], v[96:99]
v_mfma_f32_16x16x32_bf16 v[100:103], a[188:191], v[84:87], v[100:103]
ds_read_b128 v[84:87], v14 offset:52224
s_waitcnt vmcnt(12)
s_waitcnt lgkmcnt(6)
v_mfma_f32_16x16x32_bf16 v[88:91], a[64:67], v[56:59], v[88:91]
buffer_load_dwordx4 v2, s[4:7], s29 offen offset:2048 lds
v_mfma_f32_16x16x32_bf16 v[92:95], a[192:195], v[56:59], v[92:95]
v_lshlrev_b32 v196, 16, v144
ds_read_b128 v[56:59], v14 offset:36864
v_mfma_f32_16x16x32_bf16 v[96:99], a[64:67], v[60:63], v[96:99]
v_and_b32 v197, 0xffff0000, v144
v_lshlrev_b32 v192, 16, v148
v_mfma_f32_16x16x32_bf16 v[100:103], a[192:195], v[60:63], v[100:103]
ds_read_b128 v[60:63], v14 offset:53248
s_waitcnt lgkmcnt(6)
v_mfma_f32_16x16x32_bf16 v[88:91], a[68:71], v[64:67], v[88:91]
v_and_b32 v193, 0xffff0000, v148
v_pk_add_f32 v[196:197], v[196:197], v[192:193]
v_mfma_f32_16x16x32_bf16 v[92:95], a[196:199], v[64:67], v[92:95]
v_lshlrev_b32 v192, 16, v152
ds_read_b128 v[64:67], v14 offset:37888
v_mfma_f32_16x16x32_bf16 v[96:99], a[68:71], v[68:71], v[96:99]
v_and_b32 v193, 0xffff0000, v152
v_pk_add_f32 v[196:197], v[196:197], v[192:193]
v_mfma_f32_16x16x32_bf16 v[100:103], a[196:199], v[68:71], v[100:103]
ds_read_b128 v[68:71], v14 offset:54272
s_waitcnt lgkmcnt(6)
v_mfma_f32_16x16x32_bf16 v[88:91], a[72:75], v[72:75], v[88:91]
buffer_load_dwordx4 v2, s[4:7], s29 offen offset:3072 lds
v_mfma_f32_16x16x32_bf16 v[92:95], a[200:203], v[72:75], v[92:95]
v_lshlrev_b32 v192, 16, v156
ds_read_b128 v[72:75], v14 offset:38912
v_mfma_f32_16x16x32_bf16 v[96:99], a[72:75], v[76:79], v[96:99]
v_and_b32 v193, 0xffff0000, v156
v_pk_add_f32 v[196:197], v[196:197], v[192:193]
v_mfma_f32_16x16x32_bf16 v[100:103], a[200:203], v[76:79], v[100:103]
ds_read_b128 v[76:79], v14 offset:55296
s_waitcnt lgkmcnt(6)
v_mfma_f32_16x16x32_bf16 v[88:91], a[76:79], v[80:83], v[88:91]
v_cvt_pk_bf16_f32 v204, v196, v197
v_lshlrev_b32 v198, 16, v145
v_mfma_f32_16x16x32_bf16 v[92:95], a[204:207], v[80:83], v[92:95]
v_and_b32 v199, 0xffff0000, v145
ds_read_b128 v[80:83], v14 offset:39936
v_mfma_f32_16x16x32_bf16 v[96:99], a[76:79], v[84:87], v[96:99]
v_lshlrev_b32 v192, 16, v149
v_and_b32 v193, 0xffff0000, v149
v_mfma_f32_16x16x32_bf16 v[100:103], a[204:207], v[84:87], v[100:103]
ds_read_b128 v[84:87], v14 offset:56320
s_waitcnt lgkmcnt(6)
s_add_u32 m0, s44, 102400
s_add_u32 s29, s53, 36864
v_mfma_f32_16x16x32_bf16 v[88:91], a[80:83], v[56:59], v[88:91]
buffer_load_dwordx4 v2, s[4:7], s29 offen offset:0 lds
v_mfma_f32_16x16x32_bf16 v[92:95], a[208:211], v[56:59], v[92:95]
v_pk_add_f32 v[198:199], v[198:199], v[192:193]
ds_read_b128 v[56:59], v14 offset:40960
v_mfma_f32_16x16x32_bf16 v[96:99], a[80:83], v[60:63], v[96:99]
v_lshlrev_b32 v192, 16, v153
v_and_b32 v193, 0xffff0000, v153
v_mfma_f32_16x16x32_bf16 v[100:103], a[208:211], v[60:63], v[100:103]
ds_read_b128 v[60:63], v14 offset:57344
s_waitcnt lgkmcnt(6)
v_mfma_f32_16x16x32_bf16 v[88:91], a[84:87], v[64:67], v[88:91]
v_pk_add_f32 v[198:199], v[198:199], v[192:193]
v_lshlrev_b32 v192, 16, v157
v_mfma_f32_16x16x32_bf16 v[92:95], a[212:215], v[64:67], v[92:95]
v_and_b32 v193, 0xffff0000, v157
ds_read_b128 v[64:67], v14 offset:41984
v_mfma_f32_16x16x32_bf16 v[96:99], a[84:87], v[68:71], v[96:99]
v_pk_add_f32 v[198:199], v[198:199], v[192:193]
v_cvt_pk_bf16_f32 v205, v198, v199
v_mfma_f32_16x16x32_bf16 v[100:103], a[212:215], v[68:71], v[100:103]
ds_read_b128 v[68:71], v14 offset:58368
s_waitcnt lgkmcnt(6)
v_mfma_f32_16x16x32_bf16 v[88:91], a[88:91], v[72:75], v[88:91]
buffer_load_dwordx4 v2, s[4:7], s29 offen offset:1024 lds
v_mfma_f32_16x16x32_bf16 v[92:95], a[216:219], v[72:75], v[92:95]
v_lshlrev_b32 v200, 16, v146
ds_read_b128 v[72:75], v14 offset:43008
v_mfma_f32_16x16x32_bf16 v[96:99], a[88:91], v[76:79], v[96:99]
v_and_b32 v201, 0xffff0000, v146
v_lshlrev_b32 v192, 16, v150
v_mfma_f32_16x16x32_bf16 v[100:103], a[216:219], v[76:79], v[100:103]
ds_read_b128 v[76:79], v14 offset:59392
s_waitcnt lgkmcnt(6)
v_mfma_f32_16x16x32_bf16 v[88:91], a[92:95], v[80:83], v[88:91]
v_and_b32 v193, 0xffff0000, v150
v_pk_add_f32 v[200:201], v[200:201], v[192:193]
v_mfma_f32_16x16x32_bf16 v[92:95], a[220:223], v[80:83], v[92:95]
v_lshlrev_b32 v192, 16, v154
ds_read_b128 v[80:83], v14 offset:44032
v_mfma_f32_16x16x32_bf16 v[96:99], a[92:95], v[84:87], v[96:99]
v_and_b32 v193, 0xffff0000, v154
v_pk_add_f32 v[200:201], v[200:201], v[192:193]
v_mfma_f32_16x16x32_bf16 v[100:103], a[220:223], v[84:87], v[100:103]
ds_read_b128 v[84:87], v14 offset:60416
s_waitcnt lgkmcnt(6)
v_mfma_f32_16x16x32_bf16 v[88:91], a[96:99], v[56:59], v[88:91]
buffer_load_dwordx4 v2, s[4:7], s29 offen offset:2048 lds
v_mfma_f32_16x16x32_bf16 v[92:95], a[224:227], v[56:59], v[92:95]
v_lshlrev_b32 v192, 16, v158
ds_read_b128 v[56:59], v14 offset:45056
v_mfma_f32_16x16x32_bf16 v[96:99], a[96:99], v[60:63], v[96:99]
v_and_b32 v193, 0xffff0000, v158
v_pk_add_f32 v[200:201], v[200:201], v[192:193]
v_mfma_f32_16x16x32_bf16 v[100:103], a[224:227], v[60:63], v[100:103]
ds_read_b128 v[60:63], v14 offset:61440
s_waitcnt lgkmcnt(6)
v_mfma_f32_16x16x32_bf16 v[88:91], a[100:103], v[64:67], v[88:91]
v_cvt_pk_bf16_f32 v206, v200, v201
v_lshlrev_b32 v202, 16, v147
v_mfma_f32_16x16x32_bf16 v[92:95], a[228:231], v[64:67], v[92:95]
v_and_b32 v203, 0xffff0000, v147
ds_read_b128 v[64:67], v14 offset:46080
v_mfma_f32_16x16x32_bf16 v[96:99], a[100:103], v[68:71], v[96:99]
v_lshlrev_b32 v192, 16, v151
v_and_b32 v193, 0xffff0000, v151
v_mfma_f32_16x16x32_bf16 v[100:103], a[228:231], v[68:71], v[100:103]
ds_read_b128 v[68:71], v14 offset:62464
s_waitcnt lgkmcnt(6)
v_mfma_f32_16x16x32_bf16 v[88:91], a[104:107], v[72:75], v[88:91]
buffer_load_dwordx4 v2, s[4:7], s29 offen offset:3072 lds
v_mfma_f32_16x16x32_bf16 v[92:95], a[232:235], v[72:75], v[92:95]
v_pk_add_f32 v[202:203], v[202:203], v[192:193]
ds_read_b128 v[72:75], v14 offset:47104
v_mfma_f32_16x16x32_bf16 v[96:99], a[104:107], v[76:79], v[96:99]
v_lshlrev_b32 v192, 16, v155
v_and_b32 v193, 0xffff0000, v155
v_mfma_f32_16x16x32_bf16 v[100:103], a[232:235], v[76:79], v[100:103]
ds_read_b128 v[76:79], v14 offset:63488
s_waitcnt vmcnt(9)
v_cmp_gt_i32 vcc, v10, v12
s_waitcnt lgkmcnt(6)
v_mfma_f32_16x16x32_bf16 v[88:91], a[108:111], v[80:83], v[88:91]
v_pk_add_f32 v[202:203], v[202:203], v[192:193]
v_lshlrev_b32 v192, 16, v159
v_mfma_f32_16x16x32_bf16 v[92:95], a[236:239], v[80:83], v[92:95]
v_and_b32 v193, 0xffff0000, v159
ds_read_b128 v[80:83], v14 offset:48128
v_mfma_f32_16x16x32_bf16 v[96:99], a[108:111], v[84:87], v[96:99]
v_pk_add_f32 v[202:203], v[202:203], v[192:193]
v_cvt_pk_bf16_f32 v207, v202, v203
v_mfma_f32_16x16x32_bf16 v[100:103], a[236:239], v[84:87], v[100:103]
ds_read_b128 v[84:87], v14 offset:64512
s_cbranch_vccnz L_fgs1
L_fgb1:
s_waitcnt vmcnt(8)
s_barrier
s_waitcnt lgkmcnt(6)
s_add_u32 m0, s44, 0
s_add_u32 s29, s54, 0
v_mfma_f32_16x16x32_bf16 v[88:91], a[112:115], v[56:59], v[88:91]
buffer_load_dwordx4 v2, s[4:7], s29 offen offset:0 lds
v_mfma_f32_16x16x32_bf16 v[92:95], a[240:243], v[56:59], v[92:95]
buffer_store_dwordx4 v[204:207], v212, s[16:19], s39 offen sc1
ds_read_b128 v[56:59], v18 offset:0
v_mfma_f32_16x16x32_bf16 v[96:99], a[112:115], v[60:63], v[96:99]
v_mov_b32 v24, s38
buffer_store_dword v24, v23, s[4:7], 0 offen sc1
v_mfma_f32_16x16x32_bf16 v[100:103], a[240:243], v[60:63], v[100:103]
ds_read_b128 v[60:63], v18 offset:16384
s_waitcnt lgkmcnt(6)
v_mfma_f32_16x16x32_bf16 v[88:91], a[116:119], v[64:67], v[88:91]
s_add_u32 s38, s38, 1
v_mfma_f32_16x16x32_bf16 v[92:95], a[244:247], v[64:67], v[92:95]
ds_read_b128 v[64:67], v18 offset:1024
v_mfma_f32_16x16x32_bf16 v[96:99], a[116:119], v[68:71], v[96:99]
v_mfma_f32_16x16x32_bf16 v[100:103], a[244:247], v[68:71], v[100:103]
ds_read_b128 v[68:71], v18 offset:17408
s_waitcnt lgkmcnt(6)
v_mfma_f32_16x16x32_bf16 v[88:91], a[120:123], v[72:75], v[88:91]
buffer_load_dwordx4 v2, s[4:7], s29 offen offset:1024 lds
v_mfma_f32_16x16x32_bf16 v[92:95], a[248:251], v[72:75], v[92:95]
ds_read_b128 v[72:75], v18 offset:2048
v_mfma_f32_16x16x32_bf16 v[96:99], a[120:123], v[76:79], v[96:99]
v_mfma_f32_16x16x32_bf16 v[100:103], a[248:251], v[76:79], v[100:103]
ds_read_b128 v[76:79], v18 offset:18432
s_waitcnt lgkmcnt(6)
v_mfma_f32_16x16x32_bf16 v[88:91], a[124:127], v[80:83], v[88:91]
v_mfma_f32_16x16x32_bf16 v[92:95], a[252:255], v[80:83], v[92:95]
ds_read_b128 v[80:83], v18 offset:3072
v_mfma_f32_16x16x32_bf16 v[96:99], a[124:127], v[84:87], v[96:99]
v_mfma_f32_16x16x32_bf16 v[100:103], a[252:255], v[84:87], v[100:103]
ds_read_b128 v[84:87], v18 offset:19456
s_cmp_eq_u32 s38, s51
s_cbranch_scc1 L_fgx0
s_waitcnt lgkmcnt(6)
v_mfma_f32_16x16x32_bf16 v[104:107], a[0:3], v[56:59], 0
buffer_load_dwordx4 v2, s[4:7], s29 offen offset:2048 lds
v_mfma_f32_16x16x32_bf16 v[108:111], a[128:131], v[56:59], 0
ds_read_b128 v[56:59], v18 offset:4096
v_mfma_f32_16x16x32_bf16 v[112:115], a[0:3], v[60:63], 0
v_mfma_f32_16x16x32_bf16 v[116:119], a[128:131], v[60:63], 0
ds_read_b128 v[60:63], v18 offset:20480
s_waitcnt lgkmcnt(6)
v_mfma_f32_16x16x32_bf16 v[104:107], a[4:7], v[64:67], v[104:107]
v_cvt_pk_bf16_f32 v120, v88, v89
v_cvt_pk_bf16_f32 v121, v90, v91
v_mfma_f32_16x16x32_bf16 v[108:111], a[132:135], v[64:67], v[108:111]
v_cvt_pk_bf16_f32 v122, v92, v93
ds_read_b128 v[64:67], v18 offset:5120
v_mfma_f32_16x16x32_bf16 v[112:115], a[4:7], v[68:71], v[112:115]
v_cvt_pk_bf16_f32 v123, v94, v95
buffer_store_dwordx4 v[120:123], v8, s[8:11], s59 offen sc1
v_mfma_f32_16x16x32_bf16 v[116:119], a[132:135], v[68:71], v[116:119]
ds_read_b128 v[68:71], v18 offset:21504
s_waitcnt lgkmcnt(6)
v_mfma_f32_16x16x32_bf16 v[104:107], a[8:11], v[72:75], v[104:107]
buffer_load_dwordx4 v2, s[4:7], s29 offen offset:3072 lds
v_mfma_f32_16x16x32_bf16 v[108:111], a[136:139], v[72:75], v[108:111]
v_cvt_pk_bf16_f32 v124, v96, v97
ds_read_b128 v[72:75], v18 offset:6144
v_mfma_f32_16x16x32_bf16 v[112:115], a[8:11], v[76:79], v[112:115]
v_cvt_pk_bf16_f32 v125, v98, v99
v_cvt_pk_bf16_f32 v126, v100, v101
v_mfma_f32_16x16x32_bf16 v[116:119], a[136:139], v[76:79], v[116:119]
ds_read_b128 v[76:79], v18 offset:22528
s_waitcnt lgkmcnt(6)
v_mfma_f32_16x16x32_bf16 v[104:107], a[12:15], v[80:83], v[104:107]
v_cvt_pk_bf16_f32 v127, v102, v103
buffer_store_dwordx4 v[124:127], v9, s[8:11], s59 offen sc1
v_mfma_f32_16x16x32_bf16 v[108:111], a[140:143], v[80:83], v[108:111]
s_lshr_b32 s59, s60, 8
ds_read_b128 v[80:83], v18 offset:7168
v_mfma_f32_16x16x32_bf16 v[112:115], a[12:15], v[84:87], v[112:115]
s_xor_b32 s59, s59, s30
s_and_b32 s59, s59, s23
v_mfma_f32_16x16x32_bf16 v[116:119], a[140:143], v[84:87], v[116:119]
ds_read_b128 v[84:87], v18 offset:23552
s_waitcnt lgkmcnt(6)
s_add_u32 m0, s44, 4096
s_add_u32 s29, s54, 4096
v_mfma_f32_16x16x32_bf16 v[104:107], a[16:19], v[56:59], v[104:107]
buffer_load_dwordx4 v2, s[4:7], s29 offen offset:0 lds
v_mfma_f32_16x16x32_bf16 v[108:111], a[144:147], v[56:59], v[108:111]
s_or_b32 s59, s59, s60
ds_read_b128 v[56:59], v18 offset:8192
v_mfma_f32_16x16x32_bf16 v[112:115], a[16:19], v[60:63], v[112:115]
s_add_u32 s60, s60, s45
v_mfma_f32_16x16x32_bf16 v[116:119], a[144:147], v[60:63], v[116:119]
ds_read_b128 v[60:63], v18 offset:24576
s_waitcnt lgkmcnt(6)
v_mfma_f32_16x16x32_bf16 v[104:107], a[20:23], v[64:67], v[104:107]
v_mfma_f32_16x16x32_bf16 v[108:111], a[148:151], v[64:67], v[108:111]
ds_read_b128 v[64:67], v18 offset:9216
v_mfma_f32_16x16x32_bf16 v[112:115], a[20:23], v[68:71], v[112:115]
v_mfma_f32_16x16x32_bf16 v[116:119], a[148:151], v[68:71], v[116:119]
ds_read_b128 v[68:71], v18 offset:25600
s_waitcnt lgkmcnt(6)
v_mfma_f32_16x16x32_bf16 v[104:107], a[24:27], v[72:75], v[104:107]
buffer_load_dwordx4 v2, s[4:7], s29 offen offset:1024 lds
v_mfma_f32_16x16x32_bf16 v[108:111], a[152:155], v[72:75], v[108:111]
ds_read_b128 v[72:75], v18 offset:10240
v_mfma_f32_16x16x32_bf16 v[112:115], a[24:27], v[76:79], v[112:115]
v_mfma_f32_16x16x32_bf16 v[116:119], a[152:155], v[76:79], v[116:119]
ds_read_b128 v[76:79], v18 offset:26624
s_waitcnt lgkmcnt(6)
v_mfma_f32_16x16x32_bf16 v[104:107], a[28:31], v[80:83], v[104:107]
v_mfma_f32_16x16x32_bf16 v[108:111], a[156:159], v[80:83], v[108:111]
ds_read_b128 v[80:83], v18 offset:11264
v_mfma_f32_16x16x32_bf16 v[112:115], a[28:31], v[84:87], v[112:115]
v_mfma_f32_16x16x32_bf16 v[116:119], a[156:159], v[84:87], v[116:119]
ds_read_b128 v[84:87], v18 offset:27648
s_waitcnt lgkmcnt(6)
v_mfma_f32_16x16x32_bf16 v[104:107], a[32:35], v[56:59], v[104:107]
buffer_load_dwordx4 v2, s[4:7], s29 offen offset:2048 lds
v_mfma_f32_16x16x32_bf16 v[108:111], a[160:163], v[56:59], v[108:111]
ds_read_b128 v[56:59], v18 offset:12288
v_mfma_f32_16x16x32_bf16 v[112:115], a[32:35], v[60:63], v[112:115]
v_mfma_f32_16x16x32_bf16 v[116:119], a[160:163], v[60:63], v[116:119]
ds_read_b128 v[60:63], v18 offset:28672
s_waitcnt lgkmcnt(6)
v_mfma_f32_16x16x32_bf16 v[104:107], a[36:39], v[64:67], v[104:107]
v_add_u32 v10, v10, v11
v_min_i32 v10, s46, v10
v_mfma_f32_16x16x32_bf16 v[108:111], a[164:167], v[64:67], v[108:111]
buffer_load_dword v12, v27, s[4:7], 0 offen sc1
ds_read_b128 v[64:67], v18 offset:13312
v_mfma_f32_16x16x32_bf16 v[112:115], a[36:39], v[68:71], v[112:115]
v_mfma_f32_16x16x32_bf16 v[116:119], a[164:167], v[68:71], v[116:119]
ds_read_b128 v[68:71], v18 offset:29696
s_waitcnt lgkmcnt(6)
v_mfma_f32_16x16x32_bf16 v[104:107], a[40:43], v[72:75], v[104:107]
buffer_load_dwordx4 v2, s[4:7], s29 offen offset:3072 lds
v_mfma_f32_16x16x32_bf16 v[108:111], a[168:171], v[72:75], v[108:111]
ds_read_b128 v[72:75], v18 offset:14336
v_mfma_f32_16x16x32_bf16 v[112:115], a[40:43], v[76:79], v[112:115]
v_mfma_f32_16x16x32_bf16 v[116:119], a[168:171], v[76:79], v[116:119]
ds_read_b128 v[76:79], v18 offset:30720
s_waitcnt lgkmcnt(6)
v_mfma_f32_16x16x32_bf16 v[104:107], a[44:47], v[80:83], v[104:107]
v_mfma_f32_16x16x32_bf16 v[108:111], a[172:175], v[80:83], v[108:111]
ds_read_b128 v[80:83], v18 offset:15360
v_mfma_f32_16x16x32_bf16 v[112:115], a[44:47], v[84:87], v[112:115]
v_mfma_f32_16x16x32_bf16 v[116:119], a[172:175], v[84:87], v[116:119]
ds_read_b128 v[84:87], v18 offset:31744
s_waitcnt vmcnt(13)
s_barrier
s_waitcnt lgkmcnt(6)
s_add_u32 m0, s44, 32768
s_add_u32 s29, s54, 32768
v_mfma_f32_16x16x32_bf16 v[104:107], a[48:51], v[56:59], v[104:107]
buffer_load_dwordx4 v2, s[4:7], s29 offen offset:0 lds
v_mfma_f32_16x16x32_bf16 v[108:111], a[176:179], v[56:59], v[108:111]
ds_read_b128 v[56:59], v18 offset:32768
v_mfma_f32_16x16x32_bf16 v[112:115], a[48:51], v[60:63], v[112:115]
v_mfma_f32_16x16x32_bf16 v[116:119], a[176:179], v[60:63], v[116:119]
ds_read_b128 v[60:63], v18 offset:49152
s_waitcnt lgkmcnt(6)
v_mfma_f32_16x16x32_bf16 v[104:107], a[52:55], v[64:67], v[104:107]
v_mfma_f32_16x16x32_bf16 v[108:111], a[180:183], v[64:67], v[108:111]
ds_read_b128 v[64:67], v18 offset:33792
v_mfma_f32_16x16x32_bf16 v[112:115], a[52:55], v[68:71], v[112:115]
v_mfma_f32_16x16x32_bf16 v[116:119], a[180:183], v[68:71], v[116:119]
ds_read_b128 v[68:71], v18 offset:50176
s_waitcnt lgkmcnt(6)
v_mfma_f32_16x16x32_bf16 v[104:107], a[56:59], v[72:75], v[104:107]
buffer_load_dwordx4 v2, s[4:7], s29 offen offset:1024 lds
v_mfma_f32_16x16x32_bf16 v[108:111], a[184:187], v[72:75], v[108:111]
ds_read_b128 v[72:75], v18 offset:34816
v_mfma_f32_16x16x32_bf16 v[112:115], a[56:59], v[76:79], v[112:115]
v_mfma_f32_16x16x32_bf16 v[116:119], a[184:187], v[76:79], v[116:119]
ds_read_b128 v[76:79], v18 offset:51200
s_waitcnt lgkmcnt(6)
v_mfma_f32_16x16x32_bf16 v[104:107], a[60:63], v[80:83], v[104:107]
v_mfma_f32_16x16x32_bf16 v[108:111], a[188:191], v[80:83], v[108:111]
ds_read_b128 v[80:83], v18 offset:35840
v_mfma_f32_16x16x32_bf16 v[112:115], a[60:63], v[84:87], v[112:115]
v_mfma_f32_16x16x32_bf16 v[116:119], a[188:191], v[84:87], v[116:119]
ds_read_b128 v[84:87], v18 offset:52224
s_waitcnt lgkmcnt(6)
v_mfma_f32_16x16x32_bf16 v[104:107], a[64:67], v[56:59], v[104:107]
buffer_load_dwordx4 v2, s[4:7], s29 offen offset:2048 lds
v_mfma_f32_16x16x32_bf16 v[108:111], a[192:195], v[56:59], v[108:111]
ds_read_b128 v[56:59], v18 offset:36864
v_mfma_f32_16x16x32_bf16 v[112:115], a[64:67], v[60:63], v[112:115]
v_mfma_f32_16x16x32_bf16 v[116:119], a[192:195], v[60:63], v[116:119]
ds_read_b128 v[60:63], v18 offset:53248
s_waitcnt lgkmcnt(6)
v_mfma_f32_16x16x32_bf16 v[104:107], a[68:71], v[64:67], v[104:107]
v_mfma_f32_16x16x32_bf16 v[108:111], a[196:199], v[64:67], v[108:111]
ds_read_b128 v[64:67], v18 offset:37888
v_mfma_f32_16x16x32_bf16 v[112:115], a[68:71], v[68:71], v[112:115]
v_mfma_f32_16x16x32_bf16 v[116:119], a[196:199], v[68:71], v[116:119]
ds_read_b128 v[68:71], v18 offset:54272
s_waitcnt lgkmcnt(6)
v_mfma_f32_16x16x32_bf16 v[104:107], a[72:75], v[72:75], v[104:107]
buffer_load_dwordx4 v2, s[4:7], s29 offen offset:3072 lds
v_mfma_f32_16x16x32_bf16 v[108:111], a[200:203], v[72:75], v[108:111]
s_add_u32 s52, s54, s56
ds_read_b128 v[72:75], v18 offset:38912
v_mfma_f32_16x16x32_bf16 v[112:115], a[72:75], v[76:79], v[112:115]
s_xor_b32 s52, s52, s23
s_add_u32 s43, s55, s56
v_mfma_f32_16x16x32_bf16 v[116:119], a[200:203], v[76:79], v[116:119]
ds_read_b128 v[76:79], v18 offset:55296
s_waitcnt lgkmcnt(6)
v_mfma_f32_16x16x32_bf16 v[104:107], a[76:79], v[80:83], v[104:107]
s_xor_b32 s43, s43, s23
s_add_u32 s24, s38, 3
v_mfma_f32_16x16x32_bf16 v[108:111], a[204:207], v[80:83], v[108:111]
s_cmp_ge_u32 s24, s51
s_cselect_b32 s52, 2147483648, s52
ds_read_b128 v[80:83], v18 offset:39936
v_mfma_f32_16x16x32_bf16 v[112:115], a[76:79], v[84:87], v[112:115]
s_add_u32 s24, s38, 4
s_cmp_ge_u32 s24, s51
s_cselect_b32 s43, 2147483648, s43
v_mfma_f32_16x16x32_bf16 v[116:119], a[204:207], v[84:87], v[116:119]
ds_read_b128 v[84:87], v18 offset:56320
s_waitcnt lgkmcnt(6)
s_add_u32 m0, s44, 36864
s_add_u32 s29, s54, 36864
v_mfma_f32_16x16x32_bf16 v[104:107], a[80:83], v[56:59], v[104:107]
buffer_load_dwordx4 v2, s[4:7], s29 offen offset:0 lds
v_mfma_f32_16x16x32_bf16 v[108:111], a[208:211], v[56:59], v[108:111]
ds_read_b128 v[56:59], v18 offset:40960
v_mfma_f32_16x16x32_bf16 v[112:115], a[80:83], v[60:63], v[112:115]
v_mfma_f32_16x16x32_bf16 v[116:119], a[208:211], v[60:63], v[116:119]
ds_read_b128 v[60:63], v18 offset:57344
s_waitcnt lgkmcnt(6)
v_mfma_f32_16x16x32_bf16 v[104:107], a[84:87], v[64:67], v[104:107]
v_mfma_f32_16x16x32_bf16 v[108:111], a[212:215], v[64:67], v[108:111]
ds_read_b128 v[64:67], v18 offset:41984
v_mfma_f32_16x16x32_bf16 v[112:115], a[84:87], v[68:71], v[112:115]
v_mfma_f32_16x16x32_bf16 v[116:119], a[212:215], v[68:71], v[116:119]
ds_read_b128 v[68:71], v18 offset:58368
s_waitcnt lgkmcnt(6)
v_mfma_f32_16x16x32_bf16 v[104:107], a[88:91], v[72:75], v[104:107]
buffer_load_dwordx4 v2, s[4:7], s29 offen offset:1024 lds
v_mfma_f32_16x16x32_bf16 v[108:111], a[216:219], v[72:75], v[108:111]
ds_read_b128 v[72:75], v18 offset:43008
v_mfma_f32_16x16x32_bf16 v[112:115], a[88:91], v[76:79], v[112:115]
v_mfma_f32_16x16x32_bf16 v[116:119], a[216:219], v[76:79], v[116:119]
ds_read_b128 v[76:79], v18 offset:59392
s_waitcnt lgkmcnt(6)
v_mfma_f32_16x16x32_bf16 v[104:107], a[92:95], v[80:83], v[104:107]
v_mfma_f32_16x16x32_bf16 v[108:111], a[220:223], v[80:83], v[108:111]
ds_read_b128 v[80:83], v18 offset:44032
v_mfma_f32_16x16x32_bf16 v[112:115], a[92:95], v[84:87], v[112:115]
v_mfma_f32_16x16x32_bf16 v[116:119], a[220:223], v[84:87], v[116:119]
ds_read_b128 v[84:87], v18 offset:60416
s_waitcnt lgkmcnt(6)
v_mfma_f32_16x16x32_bf16 v[104:107], a[96:99], v[56:59], v[104:107]
buffer_load_dwordx4 v2, s[4:7], s29 offen offset:2048 lds
v_mfma_f32_16x16x32_bf16 v[108:111], a[224:227], v[56:59], v[108:111]
ds_read_b128 v[56:59], v18 offset:45056
v_mfma_f32_16x16x32_bf16 v[112:115], a[96:99], v[60:63], v[112:115]
v_mfma_f32_16x16x32_bf16 v[116:119], a[224:227], v[60:63], v[116:119]
ds_read_b128 v[60:63], v18 offset:61440
s_waitcnt lgkmcnt(6)
v_mfma_f32_16x16x32_bf16 v[104:107], a[100:103], v[64:67], v[104:107]
v_mfma_f32_16x16x32_bf16 v[108:111], a[228:231], v[64:67], v[108:111]
ds_read_b128 v[64:67], v18 offset:46080
v_mfma_f32_16x16x32_bf16 v[112:115], a[100:103], v[68:71], v[112:115]
v_mfma_f32_16x16x32_bf16 v[116:119], a[228:231], v[68:71], v[116:119]
ds_read_b128 v[68:71], v18 offset:62464
s_waitcnt lgkmcnt(6)
v_mfma_f32_16x16x32_bf16 v[104:107], a[104:107], v[72:75], v[104:107]
buffer_load_dwordx4 v2, s[4:7], s29 offen offset:3072 lds
v_mfma_f32_16x16x32_bf16 v[108:111], a[232:235], v[72:75], v[108:111]
ds_read_b128 v[72:75], v18 offset:47104
v_mfma_f32_16x16x32_bf16 v[112:115], a[104:107], v[76:79], v[112:115]
v_mfma_f32_16x16x32_bf16 v[116:119], a[232:235], v[76:79], v[116:119]
ds_read_b128 v[76:79], v18 offset:63488
s_waitcnt vmcnt(9)
v_cmp_gt_i32 vcc, v10, v12
s_waitcnt lgkmcnt(6)
v_mfma_f32_16x16x32_bf16 v[104:107], a[108:111], v[80:83], v[104:107]
v_mfma_f32_16x16x32_bf16 v[108:111], a[236:239], v[80:83], v[108:111]
ds_read_b128 v[80:83], v18 offset:48128
v_mfma_f32_16x16x32_bf16 v[112:115], a[108:111], v[84:87], v[112:115]
v_mfma_f32_16x16x32_bf16 v[116:119], a[236:239], v[84:87], v[116:119]
ds_read_b128 v[84:87], v18 offset:64512
s_cbranch_vccnz L_fgs3
L_fgb3:
s_waitcnt vmcnt(8)
s_barrier
s_waitcnt lgkmcnt(6)
s_add_u32 m0, s44, 65536
s_add_u32 s29, s55, 0
v_mfma_f32_16x16x32_bf16 v[104:107], a[112:115], v[56:59], v[104:107]
buffer_load_dwordx4 v2, s[4:7], s29 offen offset:0 lds
v_mfma_f32_16x16x32_bf16 v[108:111], a[240:243], v[56:59], v[108:111]
v_mov_b32 v24, s38
ds_read_b128 v[56:59], v14 offset:0
v_mfma_f32_16x16x32_bf16 v[112:115], a[112:115], v[60:63], v[112:115]
buffer_store_dword v24, v23, s[4:7], 0 offen sc1
s_add_u32 s38, s38, 1
v_mfma_f32_16x16x32_bf16 v[116:119], a[240:243], v[60:63], v[116:119]
ds_read_b128 v[60:63], v14 offset:16384
s_waitcnt lgkmcnt(6)
v_mfma_f32_16x16x32_bf16 v[104:107], a[116:119], v[64:67], v[104:107]
buffer_load_dwordx4 v[144:147], v208, s[4:7], s35 offen
buffer_load_dwordx4 v[148:151], v209, s[4:7], s35 offen
v_mfma_f32_16x16x32_bf16 v[108:111], a[244:247], v[64:67], v[108:111]
buffer_load_dwordx4 v[152:155], v210, s[4:7], s35 offen
ds_read_b128 v[64:67], v14 offset:1024
v_mfma_f32_16x16x32_bf16 v[112:115], a[116:119], v[68:71], v[112:115]
buffer_load_dwordx4 v[156:159], v211, s[4:7], s35 offen
s_mov_b32 s39, s36
v_mfma_f32_16x16x32_bf16 v[116:119], a[244:247], v[68:71], v[116:119]
ds_read_b128 v[68:71], v14 offset:17408
s_waitcnt lgkmcnt(6)
v_mfma_f32_16x16x32_bf16 v[104:107], a[120:123], v[72:75], v[104:107]
buffer_load_dwordx4 v2, s[4:7], s29 offen offset:1024 lds
v_mfma_f32_16x16x32_bf16 v[108:111], a[248:251], v[72:75], v[108:111]
s_mov_b32 s35, s57
ds_read_b128 v[72:75], v14 offset:2048
v_mfma_f32_16x16x32_bf16 v[112:115], a[120:123], v[76:79], v[112:115]
s_mov_b32 s36, s58
s_add_u32 s57, s57, 2097152
v_mfma_f32_16x16x32_bf16 v[116:119], a[248:251], v[76:79], v[116:119]
ds_read_b128 v[76:79], v14 offset:18432
s_waitcnt lgkmcnt(6)
v_mfma_f32_16x16x32_bf16 v[104:107], a[124:127], v[80:83], v[104:107]
s_xor_b32 s57, s57, s23
s_add_u32 s58, s58, 524288
v_mfma_f32_16x16x32_bf16 v[108:111], a[252:255], v[80:83], v[108:111]
ds_read_b128 v[80:83], v14 offset:3072
v_mfma_f32_16x16x32_bf16 v[112:115], a[124:127], v[84:87], v[112:115]
v_mfma_f32_16x16x32_bf16 v[116:119], a[252:255], v[84:87], v[116:119]
ds_read_b128 v[84:87], v14 offset:19456
s_mov_b32 s53, s55
s_mov_b32 s54, s52
s_mov_b32 s55, s43
s_cmp_lg_u32 s38, s51
s_cbranch_scc1 L_fgl0
s_branch L_fgx
.p2align 6
L_fgl1:
s_waitcnt lgkmcnt(6)
v_mfma_f32_16x16x32_bf16 v[88:91], a[0:3], v[56:59], 0
v_mfma_f32_16x16x32_bf16 v[92:95], a[128:131], v[56:59], 0
ds_read_b128 v[56:59], v14 offset:4096
v_mfma_f32_16x16x32_bf16 v[96:99], a[0:3], v[60:63], 0
buffer_load_dwordx4 v2, s[4:7], s29 offen offset:2048 lds
v_mfma_f32_16x16x32_bf16 v[100:103], a[128:131], v[60:63], 0
ds_read_b128 v[60:63], v14 offset:20480
s_waitcnt lgkmcnt(6)
v_mfma_f32_16x16x32_bf16 v[88:91], a[4:7], v[64:67], v[88:91]
v_mfma_f32_16x16x32_bf16 v[92:95], a[132:135], v[64:67], v[92:95]
ds_read_b128 v[64:67], v14 offset:5120
v_mfma_f32_16x16x32_bf16 v[96:99], a[4:7], v[68:71], v[96:99]
v_mfma_f32_16x16x32_bf16 v[100:103], a[132:135], v[68:71], v[100:103]
ds_read_b128 v[68:71], v14 offset:21504
s_waitcnt lgkmcnt(6)
v_mfma_f32_16x16x32_bf16 v[88:91], a[8:11], v[72:75], v[88:91]
v_cvt_pk_bf16_f32 v120, v104, v105
v_cvt_pk_bf16_f32 v121, v106, v107
v_mfma_f32_16x16x32_bf16 v[92:95], a[136:139], v[72:75], v[92:95]
v_cvt_pk_bf16_f32 v122, v108, v109
ds_read_b128 v[72:75], v14 offset:6144
v_mfma_f32_16x16x32_bf16 v[96:99], a[8:11], v[76:79], v[96:99]
buffer_load_dwordx4 v2, s[4:7], s29 offen offset:3072 lds
v_mfma_f32_16x16x32_bf16 v[100:103], a[136:139], v[76:79], v[100:103]
ds_read_b128 v[76:79], v14 offset:22528
s_waitcnt lgkmcnt(6)
v_mfma_f32_16x16x32_bf16 v[88:91], a[12:15], v[80:83], v[88:91]
v_cvt_pk_bf16_f32 v123, v110, v111
buffer_store_dwordx4 v[120:123], v8, s[8:11], s59 offen sc1
v_mfma_f32_16x16x32_bf16 v[92:95], a[140:143], v[80:83], v[92:95]
v_cvt_pk_bf16_f32 v124, v112, v113
ds_read_b128 v[80:83], v14 offset:7168
v_mfma_f32_16x16x32_bf16 v[96:99], a[12:15], v[84:87], v[96:99]
v_cvt_pk_bf16_f32 v125, v114, v115
v_cvt_pk_bf16_f32 v126, v116, v117
v_mfma_f32_16x16x32_bf16 v[100:103], a[140:143], v[84:87], v[100:103]
ds_read_b128 v[84:87], v14 offset:23552
s_waitcnt lgkmcnt(6)
v_mfma_f32_16x16x32_bf16 v[88:91], a[16:19], v[56:59], v[88:91]
v_cvt_pk_bf16_f32 v127, v118, v119
buffer_store_dwordx4 v[124:127], v9, s[8:11], s59 offen sc1
v_mfma_f32_16x16x32_bf16 v[92:95], a[144:147], v[56:59], v[92:95]
s_lshr_b32 s59, s60, 8
ds_read_b128 v[56:59], v14 offset:8192
s_add_u32 m0, s44, 69632
s_add_u32 s29, s53, 4096
v_mfma_f32_16x16x32_bf16 v[96:99], a[16:19], v[60:63], v[96:99]
buffer_load_dwordx4 v2, s[4:7], s29 offen offset:0 lds
v_mfma_f32_16x16x32_bf16 v[100:103], a[144:147], v[60:63], v[100:103]
ds_read_b128 v[60:63], v14 offset:24576
s_waitcnt lgkmcnt(6)
v_mfma_f32_16x16x32_bf16 v[88:91], a[20:23], v[64:67], v[88:91]
s_xor_b32 s59, s59, s30
s_and_b32 s59, s59, s23
v_mfma_f32_16x16x32_bf16 v[92:95], a[148:151], v[64:67], v[92:95]
s_or_b32 s59, s59, s60
ds_read_b128 v[64:67], v14 offset:9216
v_mfma_f32_16x16x32_bf16 v[96:99], a[20:23], v[68:71], v[96:99]
s_add_u32 s60, s60, s45
v_mfma_f32_16x16x32_bf16 v[100:103], a[148:151], v[68:71], v[100:103]
ds_read_b128 v[68:71], v14 offset:25600
s_waitcnt lgkmcnt(6)
v_mfma_f32_16x16x32_bf16 v[88:91], a[24:27], v[72:75], v[88:91]
v_mfma_f32_16x16x32_bf16 v[92:95], a[152:155], v[72:75], v[92:95]
ds_read_b128 v[72:75], v14 offset:10240
v_mfma_f32_16x16x32_bf16 v[96:99], a[24:27], v[76:79], v[96:99]
buffer_load_dwordx4 v2, s[4:7], s29 offen offset:1024 lds
v_mfma_f32_16x16x32_bf16 v[100:103], a[152:155], v[76:79], v[100:103]
ds_read_b128 v[76:79], v14 offset:26624
s_waitcnt lgkmcnt(6)
v_mfma_f32_16x16x32_bf16 v[88:91], a[28:31], v[80:83], v[88:91]
v_mfma_f32_16x16x32_bf16 v[92:95], a[156:159], v[80:83], v[92:95]
ds_read_b128 v[80:83], v14 offset:11264
v_mfma_f32_16x16x32_bf16 v[96:99], a[28:31], v[84:87], v[96:99]
v_mfma_f32_16x16x32_bf16 v[100:103], a[156:159], v[84:87], v[100:103]
ds_read_b128 v[84:87], v14 offset:27648
s_waitcnt lgkmcnt(6)
v_mfma_f32_16x16x32_bf16 v[88:91], a[32:35], v[56:59], v[88:91]
v_mfma_f32_16x16x32_bf16 v[92:95], a[160:163], v[56:59], v[92:95]
ds_read_b128 v[56:59], v14 offset:12288
v_mfma_f32_16x16x32_bf16 v[96:99], a[32:35], v[60:63], v[96:99]
buffer_load_dwordx4 v2, s[4:7], s29 offen offset:2048 lds
v_mfma_f32_16x16x32_bf16 v[100:103], a[160:163], v[60:63], v[100:103]
ds_read_b128 v[60:63], v14 offset:28672
s_waitcnt lgkmcnt(6)
v_mfma_f32_16x16x32_bf16 v[88:91], a[36:39], v[64:67], v[88:91]
v_mfma_f32_16x16x32_bf16 v[92:95], a[164:167], v[64:67], v[92:95]
ds_read_b128 v[64:67], v14 offset:13312
v_mfma_f32_16x16x32_bf16 v[96:99], a[36:39], v[68:71], v[96:99]
v_mfma_f32_16x16x32_bf16 v[100:103], a[164:167], v[68:71], v[100:103]
ds_read_b128 v[68:71], v14 offset:29696
s_waitcnt lgkmcnt(6)
v_mfma_f32_16x16x32_bf16 v[88:91], a[40:43], v[72:75], v[88:91]
v_mfma_f32_16x16x32_bf16 v[92:95], a[168:171], v[72:75], v[92:95]
ds_read_b128 v[72:75], v14 offset:14336
v_mfma_f32_16x16x32_bf16 v[96:99], a[40:43], v[76:79], v[96:99]
buffer_load_dwordx4 v2, s[4:7], s29 offen offset:3072 lds
v_mfma_f32_16x16x32_bf16 v[100:103], a[168:171], v[76:79], v[100:103]
ds_read_b128 v[76:79], v14 offset:30720
s_waitcnt lgkmcnt(6)
v_mfma_f32_16x16x32_bf16 v[88:91], a[44:47], v[80:83], v[88:91]
v_mfma_f32_16x16x32_bf16 v[92:95], a[172:175], v[80:83], v[92:95]
ds_read_b128 v[80:83], v14 offset:15360
v_mfma_f32_16x16x32_bf16 v[96:99], a[44:47], v[84:87], v[96:99]
v_mfma_f32_16x16x32_bf16 v[100:103], a[172:175], v[84:87], v[100:103]
ds_read_b128 v[84:87], v14 offset:31744
s_waitcnt vmcnt(14)
s_barrier
s_waitcnt lgkmcnt(6)
v_mfma_f32_16x16x32_bf16 v[88:91], a[48:51], v[56:59], v[88:91]
v_mfma_f32_16x16x32_bf16 v[92:95], a[176:179], v[56:59], v[92:95]
ds_read_b128 v[56:59], v14 offset:32768
s_add_u32 m0, s44, 98304
s_add_u32 s29, s53, 32768
v_mfma_f32_16x16x32_bf16 v[96:99], a[48:51], v[60:63], v[96:99]
buffer_load_dwordx4 v2, s[4:7], s29 offen offset:0 lds
v_mfma_f32_16x16x32_bf16 v[100:103], a[176:179], v[60:63], v[100:103]
ds_read_b128 v[60:63], v14 offset:49152
s_waitcnt lgkmcnt(6)
v_mfma_f32_16x16x32_bf16 v[88:91], a[52:55], v[64:67], v[88:91]
v_mfma_f32_16x16x32_bf16 v[92:95], a[180:183], v[64:67], v[92:95]
ds_read_b128 v[64:67], v14 offset:33792
v_mfma_f32_16x16x32_bf16 v[96:99], a[52:55], v[68:71], v[96:99]
v_mfma_f32_16x16x32_bf16 v[100:103], a[180:183], v[68:71], v[100:103]
ds_read_b128 v[68:71], v14 offset:50176
s_waitcnt lgkmcnt(6)
v_mfma_f32_16x16x32_bf16 v[88:91], a[56:59], v[72:75], v[88:91]
v_mfma_f32_16x16x32_bf16 v[92:95], a[184:187], v[72:75], v[92:95]
ds_read_b128 v[72:75], v14 offset:34816
v_mfma_f32_16x16x32_bf16 v[96:99], a[56:59], v[76:79], v[96:99]
buffer_load_dwordx4 v2, s[4:7], s29 offen offset:1024 lds
v_mfma_f32_16x16x32_bf16 v[100:103], a[184:187], v[76:79], v[100:103]
ds_read_b128 v[76:79], v14 offset:51200
s_waitcnt lgkmcnt(6)
v_mfma_f32_16x16x32_bf16 v[88:91], a[60:63], v[80:83], v[88:91]
v_mfma_f32_16x16x32_bf16 v[92:95], a[188:191], v[80:83], v[92:95]
ds_read_b128 v[80:83], v14 offset:35840
v_mfma_f32_16x16x32_bf16 v[96:99], a[60:63], v[84:87], v[96:99]
v_mfma_f32_16x16x32_bf16 v[100:103], a[188:191], v[84:87], v[100:103]
ds_read_b128 v[84:87], v14 offset:52224
s_waitcnt vmcnt(11)
s_waitcnt lgkmcnt(6)
v_mfma_f32_16x16x32_bf16 v[88:91], a[64:67], v[56:59], v[88:91]
v_lshlrev_b32 v196, 16, v144
v_and_b32 v197, 0xffff0000, v144
v_mfma_f32_16x16x32_bf16 v[92:95], a[192:195], v[56:59], v[92:95]
v_lshlrev_b32 v192, 16, v148
ds_read_b128 v[56:59], v14 offset:36864
v_mfma_f32_16x16x32_bf16 v[96:99], a[64:67], v[60:63], v[96:99]
buffer_load_dwordx4 v2, s[4:7], s29 offen offset:2048 lds
v_mfma_f32_16x16x32_bf16 v[100:103], a[192:195], v[60:63], v[100:103]
ds_read_b128 v[60:63], v14 offset:53248
s_waitcnt lgkmcnt(6)
v_mfma_f32_16x16x32_bf16 v[88:91], a[68:71], v[64:67], v[88:91]
v_and_b32 v193, 0xffff0000, v148
v_pk_add_f32 v[196:197], v[196:197], v[192:193]
v_mfma_f32_16x16x32_bf16 v[92:95], a[196:199], v[64:67], v[92:95]
v_lshlrev_b32 v192, 16, v152
ds_read_b128 v[64:67], v14 offset:37888
v_mfma_f32_16x16x32_bf16 v[96:99], a[68:71], v[68:71], v[96:99]
v_and_b32 v193, 0xffff0000, v152
v_pk_add_f32 v[196:197], v[196:197], v[192:193]
v_mfma_f32_16x16x32_bf16 v[100:103], a[196:199], v[68:71], v[100:103]
ds_read_b128 v[68:71], v14 offset:54272
s_waitcnt lgkmcnt(6)
v_mfma_f32_16x16x32_bf16 v[88:91], a[72:75], v[72:75], v[88:91]
v_lshlrev_b32 v192, 16, v156
v_and_b32 v193, 0xffff0000, v156
v_mfma_f32_16x16x32_bf16 v[92:95], a[200:203], v[72:75], v[92:95]
v_pk_add_f32 v[196:197], v[196:197], v[192:193]
ds_read_b128 v[72:75], v14 offset:38912
v_mfma_f32_16x16x32_bf16 v[96:99], a[72:75], v[76:79], v[96:99]
buffer_load_dwordx4 v2, s[4:7], s29 offen offset:3072 lds
v_mfma_f32_16x16x32_bf16 v[100:103], a[200:203], v[76:79], v[100:103]
ds_read_b128 v[76:79], v14 offset:55296
s_waitcnt lgkmcnt(6)
v_mfma_f32_16x16x32_bf16 v[88:91], a[76:79], v[80:83], v[88:91]
v_cvt_pk_bf16_f32 v204, v196, v197
v_lshlrev_b32 v198, 16, v145
v_mfma_f32_16x16x32_bf16 v[92:95], a[204:207], v[80:83], v[92:95]
v_and_b32 v199, 0xffff0000, v145
ds_read_b128 v[80:83], v14 offset:39936
v_mfma_f32_16x16x32_bf16 v[96:99], a[76:79], v[84:87], v[96:99]
v_lshlrev_b32 v192, 16, v149
v_and_b32 v193, 0xffff0000, v149
v_mfma_f32_16x16x32_bf16 v[100:103], a[204:207], v[84:87], v[100:103]
ds_read_b128 v[84:87], v14 offset:56320
s_waitcnt lgkmcnt(6)
v_mfma_f32_16x16x32_bf16 v[88:91], a[80:83], v[56:59], v[88:91]
v_pk_add_f32 v[198:199], v[198:199], v[192:193]
v_lshlrev_b32 v192, 16, v153
v_mfma_f32_16x16x32_bf16 v[92:95], a[208:211], v[56:59], v[92:95]
v_and_b32 v193, 0xffff0000, v153
ds_read_b128 v[56:59], v14 offset:40960
s_add_u32 m0, s44, 102400
s_add_u32 s29, s53, 36864
v_mfma_f32_16x16x32_bf16 v[96:99], a[80:83], v[60:63], v[96:99]
buffer_load_dwordx4 v2, s[4:7], s29 offen offset:0 lds
v_mfma_f32_16x16x32_bf16 v[100:103], a[208:211], v[60:63], v[100:103]
ds_read_b128 v[60:63], v14 offset:57344
s_waitcnt lgkmcnt(6)
v_mfma_f32_16x16x32_bf16 v[88:91], a[84:87], v[64:67], v[88:91]
v_pk_add_f32 v[198:199], v[198:199], v[192:193]
v_lshlrev_b32 v192, 16, v157
v_mfma_f32_16x16x32_bf16 v[92:95], a[212:215], v[64:67], v[92:95]
v_and_b32 v193, 0xffff0000, v157
ds_read_b128 v[64:67], v14 offset:41984
v_mfma_f32_16x16x32_bf16 v[96:99], a[84:87], v[68:71], v[96:99]
v_pk_add_f32 v[198:199], v[198:199], v[192:193]
v_cvt_pk_bf16_f32 v205, v198, v199
v_mfma_f32_16x16x32_bf16 v[100:103], a[212:215], v[68:71], v[100:103]
ds_read_b128 v[68:71], v14 offset:58368
s_waitcnt lgkmcnt(6)
v_mfma_f32_16x16x32_bf16 v[88:91], a[88:91], v[72:75], v[88:91]
v_lshlrev_b32 v200, 16, v146
v_and_b32 v201, 0xffff0000, v146
v_mfma_f32_16x16x32_bf16 v[92:95], a[216:219], v[72:75], v[92:95]
v_lshlrev_b32 v192, 16, v150
ds_read_b128 v[72:75], v14 offset:43008
v_mfma_f32_16x16x32_bf16 v[96:99], a[88:91], v[76:79], v[96:99]
buffer_load_dwordx4 v2, s[4:7], s29 offen offset:1024 lds
v_mfma_f32_16x16x32_bf16 v[100:103], a[216:219], v[76:79], v[100:103]
ds_read_b128 v[76:79], v14 offset:59392
s_waitcnt lgkmcnt(6)
v_mfma_f32_16x16x32_bf16 v[88:91], a[92:95], v[80:83], v[88:91]
v_and_b32 v193, 0xffff0000, v150
v_pk_add_f32 v[200:201], v[200:201], v[192:193]
v_mfma_f32_16x16x32_bf16 v[92:95], a[220:223], v[80:83], v[92:95]
v_lshlrev_b32 v192, 16, v154
ds_read_b128 v[80:83], v14 offset:44032
v_mfma_f32_16x16x32_bf16 v[96:99], a[92:95], v[84:87], v[96:99]
v_and_b32 v193, 0xffff0000, v154
v_pk_add_f32 v[200:201], v[200:201], v[192:193]
v_mfma_f32_16x16x32_bf16 v[100:103], a[220:223], v[84:87], v[100:103]
ds_read_b128 v[84:87], v14 offset:60416
s_waitcnt lgkmcnt(6)
v_mfma_f32_16x16x32_bf16 v[88:91], a[96:99], v[56:59], v[88:91]
v_lshlrev_b32 v192, 16, v158
v_and_b32 v193, 0xffff0000, v158
v_mfma_f32_16x16x32_bf16 v[92:95], a[224:227], v[56:59], v[92:95]
v_pk_add_f32 v[200:201], v[200:201], v[192:193]
ds_read_b128 v[56:59], v14 offset:45056
v_mfma_f32_16x16x32_bf16 v[96:99], a[96:99], v[60:63], v[96:99]
buffer_load_dwordx4 v2, s[4:7], s29 offen offset:2048 lds
v_mfma_f32_16x16x32_bf16 v[100:103], a[224:227], v[60:63], v[100:103]
ds_read_b128 v[60:63], v14 offset:61440
s_waitcnt lgkmcnt(6)
v_mfma_f32_16x16x32_bf16 v[88:91], a[100:103], v[64:67], v[88:91]
v_cvt_pk_bf16_f32 v206, v200, v201
v_lshlrev_b32 v202, 16, v147
v_mfma_f32_16x16x32_bf16 v[92:95], a[228:231], v[64:67], v[92:95]
v_and_b32 v203, 0xffff0000, v147
ds_read_b128 v[64:67], v14 offset:46080
v_mfma_f32_16x16x32_bf16 v[96:99], a[100:103], v[68:71], v[96:99]
v_lshlrev_b32 v192, 16, v151
v_and_b32 v193, 0xffff0000, v151
v_mfma_f32_16x16x32_bf16 v[100:103], a[228:231], v[68:71], v[100:103]
ds_read_b128 v[68:71], v14 offset:62464
s_waitcnt lgkmcnt(6)
v_mfma_f32_16x16x32_bf16 v[88:91], a[104:107], v[72:75], v[88:91]
v_pk_add_f32 v[202:203], v[202:203], v[192:193]
v_lshlrev_b32 v192, 16, v155
v_mfma_f32_16x16x32_bf16 v[92:95], a[232:235], v[72:75], v[92:95]
v_and_b32 v193, 0xffff0000, v155
ds_read_b128 v[72:75], v14 offset:47104
v_mfma_f32_16x16x32_bf16 v[96:99], a[104:107], v[76:79], v[96:99]
buffer_load_dwordx4 v2, s[4:7], s29 offen offset:3072 lds
v_mfma_f32_16x16x32_bf16 v[100:103], a[232:235], v[76:79], v[100:103]
ds_read_b128 v[76:79], v14 offset:63488
s_waitcnt lgkmcnt(6)
v_mfma_f32_16x16x32_bf16 v[88:91], a[108:111], v[80:83], v[88:91]
v_pk_add_f32 v[202:203], v[202:203], v[192:193]
v_lshlrev_b32 v192, 16, v159
v_mfma_f32_16x16x32_bf16 v[92:95], a[236:239], v[80:83], v[92:95]
v_and_b32 v193, 0xffff0000, v159
ds_read_b128 v[80:83], v14 offset:48128
v_mfma_f32_16x16x32_bf16 v[96:99], a[108:111], v[84:87], v[96:99]
v_pk_add_f32 v[202:203], v[202:203], v[192:193]
v_cvt_pk_bf16_f32 v207, v202, v203
v_mfma_f32_16x16x32_bf16 v[100:103], a[236:239], v[84:87], v[100:103]
ds_read_b128 v[84:87], v14 offset:64512
s_waitcnt vmcnt(8)
s_barrier
s_waitcnt lgkmcnt(6)
v_mfma_f32_16x16x32_bf16 v[88:91], a[112:115], v[56:59], v[88:91]
buffer_store_dwordx4 v[204:207], v212, s[16:19], s39 offen sc1
s_add_u32 s38, s38, 1
v_mfma_f32_16x16x32_bf16 v[92:95], a[240:243], v[56:59], v[92:95]
ds_read_b128 v[56:59], v18 offset:0
s_add_u32 m0, s44, 0
s_add_u32 s29, s54, 0
v_mfma_f32_16x16x32_bf16 v[96:99], a[112:115], v[60:63], v[96:99]
buffer_load_dwordx4 v2, s[4:7], s29 offen offset:0 lds
v_mfma_f32_16x16x32_bf16 v[100:103], a[240:243], v[60:63], v[100:103]
ds_read_b128 v[60:63], v18 offset:16384
s_waitcnt lgkmcnt(6)
v_mfma_f32_16x16x32_bf16 v[88:91], a[116:119], v[64:67], v[88:91]
v_mfma_f32_16x16x32_bf16 v[92:95], a[244:247], v[64:67], v[92:95]
ds_read_b128 v[64:67], v18 offset:1024
v_mfma_f32_16x16x32_bf16 v[96:99], a[116:119], v[68:71], v[96:99]
v_mfma_f32_16x16x32_bf16 v[100:103], a[244:247], v[68:71], v[100:103]
ds_read_b128 v[68:71], v18 offset:17408
s_waitcnt lgkmcnt(6)
v_mfma_f32_16x16x32_bf16 v[88:91], a[120:123], v[72:75], v[88:91]
v_mfma_f32_16x16x32_bf16 v[92:95], a[248:251], v[72:75], v[92:95]
ds_read_b128 v[72:75], v18 offset:2048
v_mfma_f32_16x16x32_bf16 v[96:99], a[120:123], v[76:79], v[96:99]
buffer_load_dwordx4 v2, s[4:7], s29 offen offset:1024 lds
v_mfma_f32_16x16x32_bf16 v[100:103], a[248:251], v[76:79], v[100:103]
ds_read_b128 v[76:79], v18 offset:18432
s_waitcnt lgkmcnt(6)
v_mfma_f32_16x16x32_bf16 v[88:91], a[124:127], v[80:83], v[88:91]
v_mfma_f32_16x16x32_bf16 v[92:95], a[252:255], v[80:83], v[92:95]
ds_read_b128 v[80:83], v18 offset:3072
v_mfma_f32_16x16x32_bf16 v[96:99], a[124:127], v[84:87], v[96:99]
v_mfma_f32_16x16x32_bf16 v[100:103], a[252:255], v[84:87], v[100:103]
ds_read_b128 v[84:87], v18 offset:19456
s_cmp_eq_u32 s38, s51
s_cbranch_scc1 L_fgx0
s_waitcnt lgkmcnt(6)
v_mfma_f32_16x16x32_bf16 v[104:107], a[0:3], v[56:59], 0
v_mfma_f32_16x16x32_bf16 v[108:111], a[128:131], v[56:59], 0
ds_read_b128 v[56:59], v18 offset:4096
v_mfma_f32_16x16x32_bf16 v[112:115], a[0:3], v[60:63], 0
buffer_load_dwordx4 v2, s[4:7], s29 offen offset:2048 lds
v_mfma_f32_16x16x32_bf16 v[116:119], a[128:131], v[60:63], 0
ds_read_b128 v[60:63], v18 offset:20480
s_waitcnt lgkmcnt(6)
v_mfma_f32_16x16x32_bf16 v[104:107], a[4:7], v[64:67], v[104:107]
v_mfma_f32_16x16x32_bf16 v[108:111], a[132:135], v[64:67], v[108:111]
ds_read_b128 v[64:67], v18 offset:5120
v_mfma_f32_16x16x32_bf16 v[112:115], a[4:7], v[68:71], v[112:115]
v_mfma_f32_16x16x32_bf16 v[116:119], a[132:135], v[68:71], v[116:119]
ds_read_b128 v[68:71], v18 offset:21504
s_waitcnt lgkmcnt(6)
v_mfma_f32_16x16x32_bf16 v[104:107], a[8:11], v[72:75], v[104:107]
v_cvt_pk_bf16_f32 v120, v88, v89
v_cvt_pk_bf16_f32 v121, v90, v91
v_mfma_f32_16x16x32_bf16 v[108:111], a[136:139], v[72:75], v[108:111]
v_cvt_pk_bf16_f32 v122, v92, v93
ds_read_b128 v[72:75], v18 offset:6144
v_mfma_f32_16x16x32_bf16 v[112:115], a[8:11], v[76:79], v[112:115]
buffer_load_dwordx4 v2, s[4:7], s29 offen offset:3072 lds
v_mfma_f32_16x16x32_bf16 v[116:119], a[136:139], v[76:79], v[116:119]
ds_read_b128 v[76:79], v18 offset:22528
s_waitcnt lgkmcnt(6)
v_mfma_f32_16x16x32_bf16 v[104:107], a[12:15], v[80:83], v[104:107]
v_cvt_pk_bf16_f32 v123, v94, v95
buffer_store_dwordx4 v[120:123], v8, s[8:11], s59 offen sc1
v_mfma_f32_16x16x32_bf16 v[108:111], a[140:143], v[80:83], v[108:111]
v_cvt_pk_bf16_f32 v124, v96, v97
ds_read_b128 v[80:83], v18 offset:7168
v_mfma_f32_16x16x32_bf16 v[112:115], a[12:15], v[84:87], v[112:115]
v_cvt_pk_bf16_f32 v125, v98, v99
v_cvt_pk_bf16_f32 v126, v100, v101
v_mfma_f32_16x16x32_bf16 v[116:119], a[140:143], v[84:87], v[116:119]
ds_read_b128 v[84:87], v18 offset:23552
s_waitcnt lgkmcnt(6)
v_mfma_f32_16x16x32_bf16 v[104:107], a[16:19], v[56:59], v[104:107]
v_cvt_pk_bf16_f32 v127, v102, v103
buffer_store_dwordx4 v[124:127], v9, s[8:11], s59 offen sc1
v_mfma_f32_16x16x32_bf16 v[108:111], a[144:147], v[56:59], v[108:111]
s_lshr_b32 s59, s60, 8
ds_read_b128 v[56:59], v18 offset:8192
s_add_u32 m0, s44, 4096
s_add_u32 s29, s54, 4096
v_mfma_f32_16x16x32_bf16 v[112:115], a[16:19], v[60:63], v[112:115]
buffer_load_dwordx4 v2, s[4:7], s29 offen offset:0 lds
v_mfma_f32_16x16x32_bf16 v[116:119], a[144:147], v[60:63], v[116:119]
ds_read_b128 v[60:63], v18 offset:24576
s_waitcnt lgkmcnt(6)
v_mfma_f32_16x16x32_bf16 v[104:107], a[20:23], v[64:67], v[104:107]
s_xor_b32 s59, s59, s30
s_and_b32 s59, s59, s23
v_mfma_f32_16x16x32_bf16 v[108:111], a[148:151], v[64:67], v[108:111]
s_or_b32 s59, s59, s60
ds_read_b128 v[64:67], v18 offset:9216
v_mfma_f32_16x16x32_bf16 v[112:115], a[20:23], v[68:71], v[112:115]
s_add_u32 s60, s60, s45
v_mfma_f32_16x16x32_bf16 v[116:119], a[148:151], v[68:71], v[116:119]
ds_read_b128 v[68:71], v18 offset:25600
s_waitcnt lgkmcnt(6)
v_mfma_f32_16x16x32_bf16 v[104:107], a[24:27], v[72:75], v[104:107]
v_mfma_f32_16x16x32_bf16 v[108:111], a[152:155], v[72:75], v[108:111]
ds_read_b128 v[72:75], v18 offset:10240
v_mfma_f32_16x16x32_bf16 v[112:115], a[24:27], v[76:79], v[112:115]
buffer_load_dwordx4 v2, s[4:7], s29 offen offset:1024 lds
v_mfma_f32_16x16x32_bf16 v[116:119], a[152:155], v[76:79], v[116:119]
ds_read_b128 v[76:79], v18 offset:26624
s_waitcnt lgkmcnt(6)
v_mfma_f32_16x16x32_bf16 v[104:107], a[28:31], v[80:83], v[104:107]
v_mfma_f32_16x16x32_bf16 v[108:111], a[156:159], v[80:83], v[108:111]
ds_read_b128 v[80:83], v18 offset:11264
v_mfma_f32_16x16x32_bf16 v[112:115], a[28:31], v[84:87], v[112:115]
v_mfma_f32_16x16x32_bf16 v[116:119], a[156:159], v[84:87], v[116:119]
ds_read_b128 v[84:87], v18 offset:27648
s_waitcnt lgkmcnt(6)
v_mfma_f32_16x16x32_bf16 v[104:107], a[32:35], v[56:59], v[104:107]
v_mfma_f32_16x16x32_bf16 v[108:111], a[160:163], v[56:59], v[108:111]
ds_read_b128 v[56:59], v18 offset:12288
v_mfma_f32_16x16x32_bf16 v[112:115], a[32:35], v[60:63], v[112:115]
buffer_load_dwordx4 v2, s[4:7], s29 offen offset:2048 lds
v_mfma_f32_16x16x32_bf16 v[116:119], a[160:163], v[60:63], v[116:119]
ds_read_b128 v[60:63], v18 offset:28672
s_waitcnt lgkmcnt(6)
v_mfma_f32_16x16x32_bf16 v[104:107], a[36:39], v[64:67], v[104:107]
v_mfma_f32_16x16x32_bf16 v[108:111], a[164:167], v[64:67], v[108:111]
ds_read_b128 v[64:67], v18 offset:13312
v_mfma_f32_16x16x32_bf16 v[112:115], a[36:39], v[68:71], v[112:115]
v_mfma_f32_16x16x32_bf16 v[116:119], a[164:167], v[68:71], v[116:119]
ds_read_b128 v[68:71], v18 offset:29696
s_waitcnt lgkmcnt(6)
v_mfma_f32_16x16x32_bf16 v[104:107], a[40:43], v[72:75], v[104:107]
v_mfma_f32_16x16x32_bf16 v[108:111], a[168:171], v[72:75], v[108:111]
ds_read_b128 v[72:75], v18 offset:14336
v_mfma_f32_16x16x32_bf16 v[112:115], a[40:43], v[76:79], v[112:115]
buffer_load_dwordx4 v2, s[4:7], s29 offen offset:3072 lds
v_mfma_f32_16x16x32_bf16 v[116:119], a[168:171], v[76:79], v[116:119]
ds_read_b128 v[76:79], v18 offset:30720
s_waitcnt lgkmcnt(6)
v_mfma_f32_16x16x32_bf16 v[104:107], a[44:47], v[80:83], v[104:107]
v_mfma_f32_16x16x32_bf16 v[108:111], a[172:175], v[80:83], v[108:111]
ds_read_b128 v[80:83], v18 offset:15360
v_mfma_f32_16x16x32_bf16 v[112:115], a[44:47], v[84:87], v[112:115]
v_mfma_f32_16x16x32_bf16 v[116:119], a[172:175], v[84:87], v[116:119]
ds_read_b128 v[84:87], v18 offset:31744
s_waitcnt vmcnt(11)
s_barrier
s_waitcnt lgkmcnt(6)
v_mfma_f32_16x16x32_bf16 v[104:107], a[48:51], v[56:59], v[104:107]
v_mfma_f32_16x16x32_bf16 v[108:111], a[176:179], v[56:59], v[108:111]
ds_read_b128 v[56:59], v18 offset:32768
s_add_u32 m0, s44, 32768
s_add_u32 s29, s54, 32768
v_mfma_f32_16x16x32_bf16 v[112:115], a[48:51], v[60:63], v[112:115]
buffer_load_dwordx4 v2, s[4:7], s29 offen offset:0 lds
v_mfma_f32_16x16x32_bf16 v[116:119], a[176:179], v[60:63], v[116:119]
ds_read_b128 v[60:63], v18 offset:49152
s_waitcnt lgkmcnt(6)
v_mfma_f32_16x16x32_bf16 v[104:107], a[52:55], v[64:67], v[104:107]
v_mfma_f32_16x16x32_bf16 v[108:111], a[180:183], v[64:67], v[108:111]
ds_read_b128 v[64:67], v18 offset:33792
v_mfma_f32_16x16x32_bf16 v[112:115], a[52:55], v[68:71], v[112:115]
v_mfma_f32_16x16x32_bf16 v[116:119], a[180:183], v[68:71], v[116:119]
ds_read_b128 v[68:71], v18 offset:50176
s_waitcnt lgkmcnt(6)
v_mfma_f32_16x16x32_bf16 v[104:107], a[56:59], v[72:75], v[104:107]
v_mfma_f32_16x16x32_bf16 v[108:111], a[184:187], v[72:75], v[108:111]
ds_read_b128 v[72:75], v18 offset:34816
v_mfma_f32_16x16x32_bf16 v[112:115], a[56:59], v[76:79], v[112:115]
buffer_load_dwordx4 v2, s[4:7], s29 offen offset:1024 lds
v_mfma_f32_16x16x32_bf16 v[116:119], a[184:187], v[76:79], v[116:119]
ds_read_b128 v[76:79], v18 offset:51200
s_waitcnt lgkmcnt(6)
v_mfma_f32_16x16x32_bf16 v[104:107], a[60:63], v[80:83], v[104:107]
v_mfma_f32_16x16x32_bf16 v[108:111], a[188:191], v[80:83], v[108:111]
ds_read_b128 v[80:83], v18 offset:35840
v_mfma_f32_16x16x32_bf16 v[112:115], a[60:63], v[84:87], v[112:115]
v_mfma_f32_16x16x32_bf16 v[116:119], a[188:191], v[84:87], v[116:119]
ds_read_b128 v[84:87], v18 offset:52224
s_waitcnt lgkmcnt(6)
v_mfma_f32_16x16x32_bf16 v[104:107], a[64:67], v[56:59], v[104:107]
v_mfma_f32_16x16x32_bf16 v[108:111], a[192:195], v[56:59], v[108:111]
ds_read_b128 v[56:59], v18 offset:36864
v_mfma_f32_16x16x32_bf16 v[112:115], a[64:67], v[60:63], v[112:115]
buffer_load_dwordx4 v2, s[4:7], s29 offen offset:2048 lds
v_mfma_f32_16x16x32_bf16 v[116:119], a[192:195], v[60:63], v[116:119]
ds_read_b128 v[60:63], v18 offset:53248
s_waitcnt lgkmcnt(6)
v_mfma_f32_16x16x32_bf16 v[104:107], a[68:71], v[64:67], v[104:107]
v_mfma_f32_16x16x32_bf16 v[108:111], a[196:199], v[64:67], v[108:111]
ds_read_b128 v[64:67], v18 offset:37888
v_mfma_f32_16x16x32_bf16 v[112:115], a[68:71], v[68:71], v[112:115]
v_mfma_f32_16x16x32_bf16 v[116:119], a[196:199], v[68:71], v[116:119]
ds_read_b128 v[68:71], v18 offset:54272
s_waitcnt lgkmcnt(6)
v_mfma_f32_16x16x32_bf16 v[104:107], a[72:75], v[72:75], v[104:107]
s_add_u32 s52, s54, s56
s_xor_b32 s52, s52, s23
v_mfma_f32_16x16x32_bf16 v[108:111], a[200:203], v[72:75], v[108:111]
s_add_u32 s43, s55, s56
ds_read_b128 v[72:75], v18 offset:38912
v_mfma_f32_16x16x32_bf16 v[112:115], a[72:75], v[76:79], v[112:115]
buffer_load_dwordx4 v2, s[4:7], s29 offen offset:3072 lds
v_mfma_f32_16x16x32_bf16 v[116:119], a[200:203], v[76:79], v[116:119]
ds_read_b128 v[76:79], v18 offset:55296
s_waitcnt lgkmcnt(6)
v_mfma_f32_16x16x32_bf16 v[104:107], a[76:79], v[80:83], v[104:107]
s_xor_b32 s43, s43, s23
s_add_u32 s24, s38, 3
v_mfma_f32_16x16x32_bf16 v[108:111], a[204:207], v[80:83], v[108:111]
s_cmp_ge_u32 s24, s51
s_cselect_b32 s52, 2147483648, s52
ds_read_b128 v[80:83], v18 offset:39936
v_mfma_f32_16x16x32_bf16 v[112:115], a[76:79], v[84:87], v[112:115]
s_add_u32 s24, s38, 4
s_cmp_ge_u32 s24, s51
s_cselect_b32 s43, 2147483648, s43
v_mfma_f32_16x16x32_bf16 v[116:119], a[204:207], v[84:87], v[116:119]
ds_read_b128 v[84:87], v18 offset:56320
s_waitcnt lgkmcnt(6)
v_mfma_f32_16x16x32_bf16 v[104:107], a[80:83], v[56:59], v[104:107]
v_mfma_f32_16x16x32_bf16 v[108:111], a[208:211], v[56:59], v[108:111]
ds_read_b128 v[56:59], v18 offset:40960
s_add_u32 m0, s44, 36864
s_add_u32 s29, s54, 36864
v_mfma_f32_16x16x32_bf16 v[112:115], a[80:83], v[60:63], v[112:115]
buffer_load_dwordx4 v2, s[4:7], s29 offen offset:0 lds
v_mfma_f32_16x16x32_bf16 v[116:119], a[208:211], v[60:63], v[116:119]
ds_read_b128 v[60:63], v18 offset:57344
s_waitcnt lgkmcnt(6)
v_mfma_f32_16x16x32_bf16 v[104:107], a[84:87], v[64:67], v[104:107]
v_mfma_f32_16x16x32_bf16 v[108:111], a[212:215], v[64:67], v[108:111]
ds_read_b128 v[64:67], v18 offset:41984
v_mfma_f32_16x16x32_bf16 v[112:115], a[84:87], v[68:71], v[112:115]
v_mfma_f32_16x16x32_bf16 v[116:119], a[212:215], v[68:71], v[116:119]
ds_read_b128 v[68:71], v18 offset:58368
s_waitcnt lgkmcnt(6)
v_mfma_f32_16x16x32_bf16 v[104:107], a[88:91], v[72:75], v[104:107]
v_mfma_f32_16x16x32_bf16 v[108:111], a[216:219], v[72:75], v[108:111]
ds_read_b128 v[72:75], v18 offset:43008
v_mfma_f32_16x16x32_bf16 v[112:115], a[88:91], v[76:79], v[112:115]
buffer_load_dwordx4 v2, s[4:7], s29 offen offset:1024 lds
v_mfma_f32_16x16x32_bf16 v[116:119], a[216:219], v[76:79], v[116:119]
ds_read_b128 v[76:79], v18 offset:59392
s_waitcnt lgkmcnt(6)
v_mfma_f32_16x16x32_bf16 v[104:107], a[92:95], v[80:83], v[104:107]
v_mfma_f32_16x16x32_bf16 v[108:111], a[220:223], v[80:83], v[108:111]
ds_read_b128 v[80:83], v18 offset:44032
v_mfma_f32_16x16x32_bf16 v[112:115], a[92:95], v[84:87], v[112:115]
v_mfma_f32_16x16x32_bf16 v[116:119], a[220:223], v[84:87], v[116:119]
ds_read_b128 v[84:87], v18 offset:60416
s_waitcnt lgkmcnt(6)
v_mfma_f32_16x16x32_bf16 v[104:107], a[96:99], v[56:59], v[104:107]
v_mfma_f32_16x16x32_bf16 v[108:111], a[224:227], v[56:59], v[108:111]
ds_read_b128 v[56:59], v18 offset:45056
v_mfma_f32_16x16x32_bf16 v[112:115], a[96:99], v[60:63], v[112:115]
buffer_load_dwordx4 v2, s[4:7], s29 offen offset:2048 lds
v_mfma_f32_16x16x32_bf16 v[116:119], a[224:227], v[60:63], v[116:119]
ds_read_b128 v[60:63], v18 offset:61440
s_waitcnt lgkmcnt(6)
v_mfma_f32_16x16x32_bf16 v[104:107], a[100:103], v[64:67], v[104:107]
v_mfma_f32_16x16x32_bf16 v[108:111], a[228:231], v[64:67], v[108:111]
ds_read_b128 v[64:67], v18 offset:46080
v_mfma_f32_16x16x32_bf16 v[112:115], a[100:103], v[68:71], v[112:115]
v_mfma_f32_16x16x32_bf16 v[116:119], a[228:231], v[68:71], v[116:119]
ds_read_b128 v[68:71], v18 offset:62464
s_waitcnt lgkmcnt(6)
v_mfma_f32_16x16x32_bf16 v[104:107], a[104:107], v[72:75], v[104:107]
v_mfma_f32_16x16x32_bf16 v[108:111], a[232:235], v[72:75], v[108:111]
ds_read_b128 v[72:75], v18 offset:47104
v_mfma_f32_16x16x32_bf16 v[112:115], a[104:107], v[76:79], v[112:115]
buffer_load_dwordx4 v2, s[4:7], s29 offen offset:3072 lds
v_mfma_f32_16x16x32_bf16 v[116:119], a[232:235], v[76:79], v[116:119]
ds_read_b128 v[76:79], v18 offset:63488
s_waitcnt lgkmcnt(6)
v_mfma_f32_16x16x32_bf16 v[104:107], a[108:111], v[80:83], v[104:107]
v_mfma_f32_16x16x32_bf16 v[108:111], a[236:239], v[80:83], v[108:111]
ds_read_b128 v[80:83], v18 offset:48128
v_mfma_f32_16x16x32_bf16 v[112:115], a[108:111], v[84:87], v[112:115]
v_mfma_f32_16x16x32_bf16 v[116:119], a[236:239], v[84:87], v[116:119]
ds_read_b128 v[84:87], v18 offset:64512
s_waitcnt vmcnt(8)
s_barrier
s_waitcnt lgkmcnt(6)
v_mfma_f32_16x16x32_bf16 v[104:107], a[112:115], v[56:59], v[104:107]
s_add_u32 s38, s38, 1
v_mfma_f32_16x16x32_bf16 v[108:111], a[240:243], v[56:59], v[108:111]
ds_read_b128 v[56:59], v14 offset:0
s_add_u32 m0, s44, 65536
s_add_u32 s29, s55, 0
v_mfma_f32_16x16x32_bf16 v[112:115], a[112:115], v[60:63], v[112:115]
buffer_load_dwordx4 v2, s[4:7], s29 offen offset:0 lds
v_mfma_f32_16x16x32_bf16 v[116:119], a[240:243], v[60:63], v[116:119]
ds_read_b128 v[60:63], v14 offset:16384
s_waitcnt lgkmcnt(6)
v_mfma_f32_16x16x32_bf16 v[104:107], a[116:119], v[64:67], v[104:107]
buffer_load_dwordx4 v[144:147], v208, s[4:7], s35 offen
buffer_load_dwordx4 v[148:151], v209, s[4:7], s35 offen
v_mfma_f32_16x16x32_bf16 v[108:111], a[244:247], v[64:67], v[108:111]
buffer_load_dwordx4 v[152:155], v210, s[4:7], s35 offen
ds_read_b128 v[64:67], v14 offset:1024
v_mfma_f32_16x16x32_bf16 v[112:115], a[116:119], v[68:71], v[112:115]
buffer_load_dwordx4 v[156:159], v211, s[4:7], s35 offen
s_mov_b32 s39, s36
v_mfma_f32_16x16x32_bf16 v[116:119], a[244:247], v[68:71], v[116:119]
ds_read_b128 v[68:71], v14 offset:17408
s_waitcnt lgkmcnt(6)
v_mfma_f32_16x16x32_bf16 v[104:107], a[120:123], v[72:75], v[104:107]
s_mov_b32 s35, s57
s_mov_b32 s36, s58
v_mfma_f32_16x16x32_bf16 v[108:111], a[248:251], v[72:75], v[108:111]
s_add_u32 s57, s57, 2097152
ds_read_b128 v[72:75], v14 offset:2048
v_mfma_f32_16x16x32_bf16 v[112:115], a[120:123], v[76:79], v[112:115]
buffer_load_dwordx4 v2, s[4:7], s29 offen offset:1024 lds
v_mfma_f32_16x16x32_bf16 v[116:119], a[248:251], v[76:79], v[116:119]
ds_read_b128 v[76:79], v14 offset:18432
s_waitcnt lgkmcnt(6)
v_mfma_f32_16x16x32_bf16 v[104:107], a[124:127], v[80:83], v[104:107]
s_xor_b32 s57, s57, s23
s_add_u32 s58, s58, 524288
v_mfma_f32_16x16x32_bf16 v[108:111], a[252:255], v[80:83], v[108:111]
ds_read_b128 v[80:83], v14 offset:3072
v_mfma_f32_16x16x32_bf16 v[112:115], a[124:127], v[84:87], v[112:115]
v_mfma_f32_16x16x32_bf16 v[116:119], a[252:255], v[84:87], v[116:119]
ds_read_b128 v[84:87], v14 offset:19456
s_mov_b32 s53, s55
s_mov_b32 s54, s52
s_mov_b32 s55, s43
s_cmp_lg_u32 s38, s51
s_cbranch_scc1 L_fgl1
s_branch L_fgx
.p2align 6
L_fgl2:
s_waitcnt lgkmcnt(6)
v_mfma_f32_16x16x32_bf16 v[88:91], a[0:3], v[56:59], 0
v_mfma_f32_16x16x32_bf16 v[92:95], a[128:131], v[56:59], 0
ds_read_b128 v[56:59], v14 offset:4096
v_mfma_f32_16x16x32_bf16 v[96:99], a[0:3], v[60:63], 0
v_mfma_f32_16x16x32_bf16 v[100:103], a[128:131], v[60:63], 0
ds_read_b128 v[60:63], v14 offset:20480
s_waitcnt lgkmcnt(6)
v_mfma_f32_16x16x32_bf16 v[88:91], a[4:7], v[64:67], v[88:91]
buffer_load_dwordx4 v2, s[4:7], s29 offen offset:2048 lds
v_mfma_f32_16x16x32_bf16 v[92:95], a[132:135], v[64:67], v[92:95]
ds_read_b128 v[64:67], v14 offset:5120
v_mfma_f32_16x16x32_bf16 v[96:99], a[4:7], v[68:71], v[96:99]
v_mfma_f32_16x16x32_bf16 v[100:103], a[132:135], v[68:71], v[100:103]
ds_read_b128 v[68:71], v14 offset:21504
s_waitcnt lgkmcnt(6)
v_mfma_f32_16x16x32_bf16 v[88:91], a[8:11], v[72:75], v[88:91]
v_mfma_f32_16x16x32_bf16 v[92:95], a[136:139], v[72:75], v[92:95]
ds_read_b128 v[72:75], v14 offset:6144
v_mfma_f32_16x16x32_bf16 v[96:99], a[8:11], v[76:79], v[96:99]
v_mfma_f32_16x16x32_bf16 v[100:103], a[136:139], v[76:79], v[100:103]
ds_read_b128 v[76:79], v14 offset:22528
s_waitcnt lgkmcnt(6)
v_mfma_f32_16x16x32_bf16 v[88:91], a[12:15], v[80:83], v[88:91]
buffer_load_dwordx4 v2, s[4:7], s29 offen offset:3072 lds
v_mfma_f32_16x16x32_bf16 v[92:95], a[140:143], v[80:83], v[92:95]
v_cvt_pk_bf16_f32 v120, v104, v105
ds_read_b128 v[80:83], v14 offset:7168
v_mfma_f32_16x16x32_bf16 v[96:99], a[12:15], v[84:87], v[96:99]
v_cvt_pk_bf16_f32 v121, v106, v107
v_cvt_pk_bf16_f32 v122, v108, v109
v_mfma_f32_16x16x32_bf16 v[100:103], a[140:143], v[84:87], v[100:103]
ds_read_b128 v[84:87], v14 offset:23552
s_waitcnt lgkmcnt(6)
v_mfma_f32_16x16x32_bf16 v[88:91], a[16:19], v[56:59], v[88:91]
v_cvt_pk_bf16_f32 v123, v110, v111
buffer_store_dwordx4 v[120:123], v8, s[8:11], s59 offen sc1
v_mfma_f32_16x16x32_bf16 v[92:95], a[144:147], v[56:59], v[92:95]
v_cvt_pk_bf16_f32 v124, v112, v113
ds_read_b128 v[56:59], v14 offset:8192
v_mfma_f32_16x16x32_bf16 v[96:99], a[16:19], v[60:63], v[96:99]
v_cvt_pk_bf16_f32 v125, v114, v115
v_cvt_pk_bf16_f32 v126, v116, v117
v_mfma_f32_16x16x32_bf16 v[100:103], a[144:147], v[60:63], v[100:103]
ds_read_b128 v[60:63], v14 offset:24576
s_waitcnt lgkmcnt(6)
s_add_u32 m0, s44, 69632
s_add_u32 s29, s53, 4096
v_mfma_f32_16x16x32_bf16 v[88:91], a[20:23], v[64:67], v[88:91]
buffer_load_dwordx4 v2, s[4:7], s29 offen offset:0 lds
v_mfma_f32_16x16x32_bf16 v[92:95], a[148:151], v[64:67], v[92:95]
v_cvt_pk_bf16_f32 v127, v118, v119
ds_read_b128 v[64:67], v14 offset:9216
v_mfma_f32_16x16x32_bf16 v[96:99], a[20:23], v[68:71], v[96:99]
buffer_store_dwordx4 v[124:127], v9, s[8:11], s59 offen sc1
s_lshr_b32 s59, s60, 8
v_mfma_f32_16x16x32_bf16 v[100:103], a[148:151], v[68:71], v[100:103]
ds_read_b128 v[68:71], v14 offset:25600
s_waitcnt lgkmcnt(6)
v_mfma_f32_16x16x32_bf16 v[88:91], a[24:27], v[72:75], v[88:91]
s_xor_b32 s59, s59, s30
s_and_b32 s59, s59, s23
v_mfma_f32_16x16x32_bf16 v[92:95], a[152:155], v[72:75], v[92:95]
s_or_b32 s59, s59, s60
ds_read_b128 v[72:75], v14 offset:10240
v_mfma_f32_16x16x32_bf16 v[96:99], a[24:27], v[76:79], v[96:99]
s_add_u32 s60, s60, s45
v_mfma_f32_16x16x32_bf16 v[100:103], a[152:155], v[76:79], v[100:103]
ds_read_b128 v[76:79], v14 offset:26624
s_waitcnt lgkmcnt(6)
v_mfma_f32_16x16x32_bf16 v[88:91], a[28:31], v[80:83], v[88:91]
buffer_load_dwordx4 v2, s[4:7], s29 offen offset:1024 lds
v_mfma_f32_16x16x32_bf16 v[92:95], a[156:159], v[80:83], v[92:95]
ds_read_b128 v[80:83], v14 offset:11264
v_mfma_f32_16x16x32_bf16 v[96:99], a[28:31], v[84:87], v[96:99]
v_mfma_f32_16x16x32_bf16 v[100:103], a[156:159], v[84:87], v[100:103]
ds_read_b128 v[84:87], v14 offset:27648
s_waitcnt lgkmcnt(6)
v_mfma_f32_16x16x32_bf16 v[88:91], a[32:35], v[56:59], v[88:91]
v_mfma_f32_16x16x32_bf16 v[92:95], a[160:163], v[56:59], v[92:95]
ds_read_b128 v[56:59], v14 offset:12288
v_mfma_f32_16x16x32_bf16 v[96:99], a[32:35], v[60:63], v[96:99]
v_mfma_f32_16x16x32_bf16 v[100:103], a[160:163], v[60:63], v[100:103]
ds_read_b128 v[60:63], v14 offset:28672
s_waitcnt lgkmcnt(6)
v_mfma_f32_16x16x32_bf16 v[88:91], a[36:39], v[64:67], v[88:91]
buffer_load_dwordx4 v2, s[4:7], s29 offen offset:2048 lds
v_mfma_f32_16x16x32_bf16 v[92:95], a[164:167], v[64:67], v[92:95]
ds_read_b128 v[64:67], v14 offset:13312
v_mfma_f32_16x16x32_bf16 v[96:99], a[36:39], v[68:71], v[96:99]
v_mfma_f32_16x16x32_bf16 v[100:103], a[164:167], v[68:71], v[100:103]
ds_read_b128 v[68:71], v14 offset:29696
s_waitcnt lgkmcnt(6)
v_mfma_f32_16x16x32_bf16 v[88:91], a[40:43], v[72:75], v[88:91]
v_mfma_f32_16x16x32_bf16 v[92:95], a[168:171], v[72:75], v[92:95]
ds_read_b128 v[72:75], v14 offset:14336
v_mfma_f32_16x16x32_bf16 v[96:99], a[40:43], v[76:79], v[96:99]
v_mfma_f32_16x16x32_bf16 v[100:103], a[168:171], v[76:79], v[100:103]
ds_read_b128 v[76:79], v14 offset:30720
s_waitcnt lgkmcnt(6)
v_mfma_f32_16x16x32_bf16 v[88:91], a[44:47], v[80:83], v[88:91]
buffer_load_dwordx4 v2, s[4:7], s29 offen offset:3072 lds
v_mfma_f32_16x16x32_bf16 v[92:95], a[172:175], v[80:83], v[92:95]
ds_read_b128 v[80:83], v14 offset:15360
v_mfma_f32_16x16x32_bf16 v[96:99], a[44:47], v[84:87], v[96:99]
v_mfma_f32_16x16x32_bf16 v[100:103], a[172:175], v[84:87], v[100:103]
ds_read_b128 v[84:87], v14 offset:31744
s_waitcnt vmcnt(14)
s_barrier
s_waitcnt lgkmcnt(6)
v_mfma_f32_16x16x32_bf16 v[88:91], a[48:51], v[56:59], v[88:91]
v_mfma_f32_16x16x32_bf16 v[92:95], a[176:179], v[56:59], v[92:95]
ds_read_b128 v[56:59], v14 offset:32768
v_mfma_f32_16x16x32_bf16 v[96:99], a[48:51], v[60:63], v[96:99]
v_mfma_f32_16x16x32_bf16 v[100:103], a[176:179], v[60:63], v[100:103]
ds_read_b128 v[60:63], v14 offset:49152
s_waitcnt lgkmcnt(6)
s_add_u32 m0, s44, 98304
s_add_u32 s29, s53, 32768
v_mfma_f32_16x16x32_bf16 v[88:91], a[52:55], v[64:67], v[88:91]
buffer_load_dwordx4 v2, s[4:7], s29 offen offset:0 lds
v_mfma_f32_16x16x32_bf16 v[92:95], a[180:183], v[64:67], v[92:95]
ds_read_b128 v[64:67], v14 offset:33792
v_mfma_f32_16x16x32_bf16 v[96:99], a[52:55], v[68:71], v[96:99]
v_mfma_f32_16x16x32_bf16 v[100:103], a[180:183], v[68:71], v[100:103]
ds_read_b128 v[68:71], v14 offset:50176
s_waitcnt lgkmcnt(6)
v_mfma_f32_16x16x32_bf16 v[88:91], a[56:59], v[72:75], v[88:91]
v_mfma_f32_16x16x32_bf16 v[92:95], a[184:187], v[72:75], v[92:95]
ds_read_b128 v[72:75], v14 offset:34816
v_mfma_f32_16x16x32_bf16 v[96:99], a[56:59], v[76:79], v[96:99]
v_mfma_f32_16x16x32_bf16 v[100:103], a[184:187], v[76:79], v[100:103]
ds_read_b128 v[76:79], v14 offset:51200
s_waitcnt lgkmcnt(6)
v_mfma_f32_16x16x32_bf16 v[88:91], a[60:63], v[80:83], v[88:91]
buffer_load_dwordx4 v2, s[4:7], s29 offen offset:1024 lds
v_mfma_f32_16x16x32_bf16 v[92:95], a[188:191], v[80:83], v[92:95]
ds_read_b128 v[80:83], v14 offset:35840
v_mfma_f32_16x16x32_bf16 v[96:99], a[60:63], v[84:87], v[96:99]
v_mfma_f32_16x16x32_bf16 v[100:103], a[188:191], v[84:87], v[100:103]
ds_read_b128 v[84:87], v14 offset:52224
s_waitcnt vmcnt(11)
s_waitcnt lgkmcnt(6)
v_mfma_f32_16x16x32_bf16 v[88:91], a[64:67], v[56:59], v[88:91]
v_lshlrev_b32 v196, 16, v144
v_and_b32 v197, 0xffff0000, v144
v_mfma_f32_16x16x32_bf16 v[92:95], a[192:195], v[56:59], v[92:95]
v_lshlrev_b32 v192, 16, v148
ds_read_b128 v[56:59], v14 offset:36864
v_mfma_f32_16x16x32_bf16 v[96:99], a[64:67], v[60:63], v[96:99]
v_and_b32 v193, 0xffff0000, v148
v_pk_add_f32 v[196:197], v[196:197], v[192:193]
v_mfma_f32_16x16x32_bf16 v[100:103], a[192:195], v[60:63], v[100:103]
ds_read_b128 v[60:63], v14 offset:53248
s_waitcnt lgkmcnt(6)
v_mfma_f32_16x16x32_bf16 v[88:91], a[68:71], v[64:67], v[88:91]
buffer_load_dwordx4 v2, s[4:7], s29 offen offset:2048 lds
v_mfma_f32_16x16x32_bf16 v[92:95], a[196:199], v[64:67], v[92:95]
v_lshlrev_b32 v192, 16, v152
ds_read_b128 v[64:67], v14 offset:37888
v_mfma_f32_16x16x32_bf16 v[96:99], a[68:71], v[68:71], v[96:99]
v_and_b32 v193, 0xffff0000, v152
v_pk_add_f32 v[196:197], v[196:197], v[192:193]
v_mfma_f32_16x16x32_bf16 v[100:103], a[196:199], v[68:71], v[100:103]
ds_read_b128 v[68:71], v14 offset:54272
s_waitcnt lgkmcnt(6)
v_mfma_f32_16x16x32_bf16 v[88:91], a[72:75], v[72:75], v[88:91]
v_lshlrev_b32 v192, 16, v156
v_and_b32 v193, 0xffff0000, v156
v_mfma_f32_16x16x32_bf16 v[92:95], a[200:203], v[72:75], v[92:95]
v_pk_add_f32 v[196:197], v[196:197], v[192:193]
ds_read_b128 v[72:75], v14 offset:38912
v_mfma_f32_16x16x32_bf16 v[96:99], a[72:75], v[76:79], v[96:99]
v_cvt_pk_bf16_f32 v204, v196, v197
v_lshlrev_b32 v198, 16, v145
v_mfma_f32_16x16x32_bf16 v[100:103], a[200:203], v[76:79], v[100:103]
ds_read_b128 v[76:79], v14 offset:55296
s_waitcnt lgkmcnt(6)
v_mfma_f32_16x16x32_bf16 v[88:91], a[76:79], v[80:83], v[88:91]
buffer_load_dwordx4 v2, s[4:7], s29 offen offset:3072 lds
v_mfma_f32_16x16x32_bf16 v[92:95], a[204:207], v[80:83], v[92:95]
v_and_b32 v199, 0xffff0000, v145
ds_read_b128 v[80:83], v14 offset:39936
v_mfma_f32_16x16x32_bf16 v[96:99], a[76:79], v[84:87], v[96:99]
v_lshlrev_b32 v192, 16, v149
v_and_b32 v193, 0xffff0000, v149
v_mfma_f32_16x16x32_bf16 v[100:103], a[204:207], v[84:87], v[100:103]
ds_read_b128 v[84:87], v14 offset:56320
s_waitcnt lgkmcnt(6)
v_mfma_f32_16x16x32_bf16 v[88:91], a[80:83], v[56:59], v[88:91]
v_pk_add_f32 v[198:199], v[198:199], v[192:193]
v_lshlrev_b32 v192, 16, v153
v_mfma_f32_16x16x32_bf16 v[92:95], a[208:211], v[56:59], v[92:95]
v_and_b32 v193, 0xffff0000, v153
ds_read_b128 v[56:59], v14 offset:40960
v_mfma_f32_16x16x32_bf16 v[96:99], a[80:83], v[60:63], v[96:99]
v_pk_add_f32 v[198:199], v[198:199], v[192:193]
v_lshlrev_b32 v192, 16, v157
v_mfma_f32_16x16x32_bf16 v[100:103], a[208:211], v[60:63], v[100:103]
ds_read_b128 v[60:63], v14 offset:57344
s_waitcnt lgkmcnt(6)
s_add_u32 m0, s44, 102400
s_add_u32 s29, s53, 36864
v_mfma_f32_16x16x32_bf16 v[88:91], a[84:87], v[64:67], v[88:91]
buffer_load_dwordx4 v2, s[4:7], s29 offen offset:0 lds
v_mfma_f32_16x16x32_bf16 v[92:95], a[212:215], v[64:67], v[92:95]
v_and_b32 v193, 0xffff0000, v157
ds_read_b128 v[64:67], v14 offset:41984
v_mfma_f32_16x16x32_bf16 v[96:99], a[84:87], v[68:71], v[96:99]
v_pk_add_f32 v[198:199], v[198:199], v[192:193]
v_cvt_pk_bf16_f32 v205, v198, v199
v_mfma_f32_16x16x32_bf16 v[100:103], a[212:215], v[68:71], v[100:103]
ds_read_b128 v[68:71], v14 offset:58368
s_waitcnt lgkmcnt(6)
v_mfma_f32_16x16x32_bf16 v[88:91], a[88:91], v[72:75], v[88:91]
v_lshlrev_b32 v200, 16, v146
v_and_b32 v201, 0xffff0000, v146
v_mfma_f32_16x16x32_bf16 v[92:95], a[216:219], v[72:75], v[92:95]
v_lshlrev_b32 v192, 16, v150
ds_read_b128 v[72:75], v14 offset:43008
v_mfma_f32_16x16x32_bf16 v[96:99], a[88:91], v[76:79], v[96:99]
v_and_b32 v193, 0xffff0000, v150
v_pk_add_f32 v[200:201], v[200:201], v[192:193]
v_mfma_f32_16x16x32_bf16 v[100:103], a[216:219], v[76:79], v[100:103]
ds_read_b128 v[76:79], v14 offset:59392
s_waitcnt lgkmcnt(6)
v_mfma_f32_16x16x32_bf16 v[88:91], a[92:95], v[80:83], v[88:91]
buffer_load_dwordx4 v2, s[4:7], s29 offen offset:1024 lds
v_mfma_f32_16x16x32_bf16 v[92:95], a[220:223], v[80:83], v[92:95]
v_lshlrev_b32 v192, 16, v154
ds_read_b128 v[80:83], v14 offset:44032
v_mfma_f32_16x16x32_bf16 v[96:99], a[92:95], v[84:87], v[96:99]
v_and_b32 v193, 0xffff0000, v154
v_pk_add_f32 v[200:201], v[200:201], v[192:193]
v_mfma_f32_16x16x32_bf16 v[100:103], a[220:223], v[84:87], v[100:103]
ds_read_b128 v[84:87], v14 offset:60416
s_waitcnt lgkmcnt(6)
v_mfma_f32_16x16x32_bf16 v[88:91], a[96:99], v[56:59], v[88:91]
v_lshlrev_b32 v192, 16, v158
v_and_b32 v193, 0xffff0000, v158
v_mfma_f32_16x16x32_bf16 v[92:95], a[224:227], v[56:59], v[92:95]
v_pk_add_f32 v[200:201], v[200:201], v[192:193]
ds_read_b128 v[56:59], v14 offset:45056
v_mfma_f32_16x16x32_bf16 v[96:99], a[96:99], v[60:63], v[96:99]
v_cvt_pk_bf16_f32 v206, v200, v201
v_lshlrev_b32 v202, 16, v147
v_mfma_f32_16x16x32_bf16 v[100:103], a[224:227], v[60:63], v[100:103]
ds_read_b128 v[60:63], v14 offset:61440
s_waitcnt lgkmcnt(6)
v_mfma_f32_16x16x32_bf16 v[88:91], a[100:103], v[64:67], v[88:91]
buffer_load_dwordx4 v2, s[4:7], s29 offen offset:2048 lds
v_mfma_f32_16x16x32_bf16 v[92:95], a[228:231], v[64:67], v[92:95]
v_and_b32 v203, 0xffff0000, v147
ds_read_b128 v[64:67], v14 offset:46080
v_mfma_f32_16x16x32_bf16 v[96:99], a[100:103], v[68:71], v[96:99]
v_lshlrev_b32 v192, 16, v151
v_and_b32 v193, 0xffff0000, v151
v_mfma_f32_16x16x32_bf16 v[100:103], a[228:231], v[68:71], v[100:103]
ds_read_b128 v[68:71], v14 offset:62464
s_waitcnt lgkmcnt(6)
v_mfma_f32_16x16x32_bf16 v[88:91], a[104:107], v[72:75], v[88:91]
v_pk_add_f32 v[202:203], v[202:203], v[192:193]
v_lshlrev_b32 v192, 16, v155
v_mfma_f32_16x16x32_bf16 v[92:95], a[232:235], v[72:75], v[92:95]
v_and_b32 v193, 0xffff0000, v155
ds_read_b128 v[72:75], v14 offset:47104
v_mfma_f32_16x16x32_bf16 v[96:99], a[104:107], v[76:79], v[96:99]
v_pk_add_f32 v[202:203], v[202:203], v[192:193]
v_lshlrev_b32 v192, 16, v159
v_mfma_f32_16x16x32_bf16 v[100:103], a[232:235], v[76:79], v[100:103]
ds_read_b128 v[76:79], v14 offset:63488
s_waitcnt lgkmcnt(6)
v_mfma_f32_16x16x32_bf16 v[88:91], a[108:111], v[80:83], v[88:91]
buffer_load_dwordx4 v2, s[4:7], s29 offen offset:3072 lds
v_mfma_f32_16x16x32_bf16 v[92:95], a[236:239], v[80:83], v[92:95]
v_and_b32 v193, 0xffff0000, v159
ds_read_b128 v[80:83], v14 offset:48128
v_mfma_f32_16x16x32_bf16 v[96:99], a[108:111], v[84:87], v[96:99]
v_pk_add_f32 v[202:203], v[202:203], v[192:193]
v_cvt_pk_bf16_f32 v207, v202, v203
v_mfma_f32_16x16x32_bf16 v[100:103], a[236:239], v[84:87], v[100:103]
ds_read_b128 v[84:87], v14 offset:64512
s_waitcnt vmcnt(8)
s_barrier
s_waitcnt lgkmcnt(6)
v_mfma_f32_16x16x32_bf16 v[88:91], a[112:115], v[56:59], v[88:91]
buffer_store_dwordx4 v[204:207], v212, s[16:19], s39 offen sc1
s_add_u32 s38, s38, 1
v_mfma_f32_16x16x32_bf16 v[92:95], a[240:243], v[56:59], v[92:95]
ds_read_b128 v[56:59], v18 offset:0
v_mfma_f32_16x16x32_bf16 v[96:99], a[112:115], v[60:63], v[96:99]
v_mfma_f32_16x16x32_bf16 v[100:103], a[240:243], v[60:63], v[100:103]
ds_read_b128 v[60:63], v18 offset:16384
s_waitcnt lgkmcnt(6)
s_add_u32 m0, s44, 0
s_add_u32 s29, s54, 0
v_mfma_f32_16x16x32_bf16 v[88:91], a[116:119], v[64:67], v[88:91]
buffer_load_dwordx4 v2, s[4:7], s29 offen offset:0 lds
v_mfma_f32_16x16x32_bf16 v[92:95], a[244:247], v[64:67], v[92:95]
ds_read_b128 v[64:67], v18 offset:1024
v_mfma_f32_16x16x32_bf16 v[96:99], a[116:119], v[68:71], v[96:99]
v_mfma_f32_16x16x32_bf16 v[100:103], a[244:247], v[68:71], v[100:103]
ds_read_b128 v[68:71], v18 offset:17408
s_waitcnt lgkmcnt(6)
v_mfma_f32_16x16x32_bf16 v[88:91], a[120:123], v[72:75], v[88:91]
v_mfma_f32_16x16x32_bf16 v[92:95], a[248:251], v[72:75], v[92:95]
ds_read_b128 v[72:75], v18 offset:2048
v_mfma_f32_16x16x32_bf16 v[96:99], a[120:123], v[76:79], v[96:99]
v_mfma_f32_16x16x32_bf16 v[100:103], a[248:251], v[76:79], v[100:103]
ds_read_b128 v[76:79], v18 offset:18432
s_waitcnt lgkmcnt(6)
v_mfma_f32_16x16x32_bf16 v[88:91], a[124:127], v[80:83], v[88:91]
buffer_load_dwordx4 v2, s[4:7], s29 offen offset:1024 lds
v_mfma_f32_16x16x32_bf16 v[92:95], a[252:255], v[80:83], v[92:95]
ds_read_b128 v[80:83], v18 offset:3072
v_mfma_f32_16x16x32_bf16 v[96:99], a[124:127], v[84:87], v[96:99]
v_mfma_f32_16x16x32_bf16 v[100:103], a[252:255], v[84:87], v[100:103]
ds_read_b128 v[84:87], v18 offset:19456
s_cmp_eq_u32 s38, s51
s_cbranch_scc1 L_fgx0
s_waitcnt lgkmcnt(6)
v_mfma_f32_16x16x32_bf16 v[104:107], a[0:3], v[56:59], 0
v_mfma_f32_16x16x32_bf16 v[108:111], a[128:131], v[56:59], 0
ds_read_b128 v[56:59], v18 offset:4096
v_mfma_f32_16x16x32_bf16 v[112:115], a[0:3], v[60:63], 0
v_mfma_f32_16x16x32_bf16 v[116:119], a[128:131], v[60:63], 0
ds_read_b128 v[60:63], v18 offset:20480
s_waitcnt lgkmcnt(6)
v_mfma_f32_16x16x32_bf16 v[104:107], a[4:7], v[64:67], v[104:107]
buffer_load_dwordx4 v2, s[4:7], s29 offen offset:2048 lds
v_mfma_f32_16x16x32_bf16 v[108:111], a[132:135], v[64:67], v[108:111]
ds_read_b128 v[64:67], v18 offset:5120
v_mfma_f32_16x16x32_bf16 v[112:115], a[4:7], v[68:71], v[112:115]
v_mfma_f32_16x16x32_bf16 v[116:119], a[132:135], v[68:71], v[116:119]
ds_read_b128 v[68:71], v18 offset:21504
s_waitcnt lgkmcnt(6)
v_mfma_f32_16x16x32_bf16 v[104:107], a[8:11], v[72:75], v[104:107]
v_mfma_f32_16x16x32_bf16 v[108:111], a[136:139], v[72:75], v[108:111]
ds_read_b128 v[72:75], v18 offset:6144
v_mfma_f32_16x16x32_bf16 v[112:115], a[8:11], v[76:79], v[112:115]
v_mfma_f32_16x16x32_bf16 v[116:119], a[136:139], v[76:79], v[116:119]
ds_read_b128 v[76:79], v18 offset:22528
s_waitcnt lgkmcnt(6)
v_mfma_f32_16x16x32_bf16 v[104:107], a[12:15], v[80:83], v[104:107]
buffer_load_dwordx4 v2, s[4:7], s29 offen offset:3072 lds
v_mfma_f32_16x16x32_bf16 v[108:111], a[140:143], v[80:83], v[108:111]
v_cvt_pk_bf16_f32 v120, v88, v89
ds_read_b128 v[80:83], v18 offset:7168
v_mfma_f32_16x16x32_bf16 v[112:115], a[12:15], v[84:87], v[112:115]
v_cvt_pk_bf16_f32 v121, v90, v91
v_cvt_pk_bf16_f32 v122, v92, v93
v_mfma_f32_16x16x32_bf16 v[116:119], a[140:143], v[84:87], v[116:119]
ds_read_b128 v[84:87], v18 offset:23552
s_waitcnt lgkmcnt(6)
v_mfma_f32_16x16x32_bf16 v[104:107], a[16:19], v[56:59], v[104:107]
v_cvt_pk_bf16_f32 v123, v94, v95
buffer_store_dwordx4 v[120:123], v8, s[8:11], s59 offen sc1
v_mfma_f32_16x16x32_bf16 v[108:111], a[144:147], v[56:59], v[108:111]
v_cvt_pk_bf16_f32 v124, v96, v97
ds_read_b128 v[56:59], v18 offset:8192
v_mfma_f32_16x16x32_bf16 v[112:115], a[16:19], v[60:63], v[112:115]
v_cvt_pk_bf16_f32 v125, v98, v99
v_cvt_pk_bf16_f32 v126, v100, v101
v_mfma_f32_16x16x32_bf16 v[116:119], a[144:147], v[60:63], v[116:119]
ds_read_b128 v[60:63], v18 offset:24576
s_waitcnt lgkmcnt(6)
s_add_u32 m0, s44, 4096
s_add_u32 s29, s54, 4096
v_mfma_f32_16x16x32_bf16 v[104:107], a[20:23], v[64:67], v[104:107]
buffer_load_dwordx4 v2, s[4:7], s29 offen offset:0 lds
v_mfma_f32_16x16x32_bf16 v[108:111], a[148:151], v[64:67], v[108:111]
v_cvt_pk_bf16_f32 v127, v102, v103
ds_read_b128 v[64:67], v18 offset:9216
v_mfma_f32_16x16x32_bf16 v[112:115], a[20:23], v[68:71], v[112:115]
buffer_store_dwordx4 v[124:127], v9, s[8:11], s59 offen sc1
s_lshr_b32 s59, s60, 8
v_mfma_f32_16x16x32_bf16 v[116:119], a[148:151], v[68:71], v[116:119]
ds_read_b128 v[68:71], v18 offset:25600
s_waitcnt lgkmcnt(6)
v_mfma_f32_16x16x32_bf16 v[104:107], a[24:27], v[72:75], v[104:107]
s_xor_b32 s59, s59, s30
s_and_b32 s59, s59, s23
v_mfma_f32_16x16x32_bf16 v[108:111], a[152:155], v[72:75], v[108:111]
s_or_b32 s59, s59, s60
ds_read_b128 v[72:75], v18 offset:10240
v_mfma_f32_16x16x32_bf16 v[112:115], a[24:27], v[76:79], v[112:115]
s_add_u32 s60, s60, s45
v_mfma_f32_16x16x32_bf16 v[116:119], a[152:155], v[76:79], v[116:119]
ds_read_b128 v[76:79], v18 offset:26624
s_waitcnt lgkmcnt(6)
v_mfma_f32_16x16x32_bf16 v[104:107], a[28:31], v[80:83], v[104:107]
buffer_load_dwordx4 v2, s[4:7], s29 offen offset:1024 lds
v_mfma_f32_16x16x32_bf16 v[108:111], a[156:159], v[80:83], v[108:111]
ds_read_b128 v[80:83], v18 offset:11264
v_mfma_f32_16x16x32_bf16 v[112:115], a[28:31], v[84:87], v[112:115]
v_mfma_f32_16x16x32_bf16 v[116:119], a[156:159], v[84:87], v[116:119]
ds_read_b128 v[84:87], v18 offset:27648
s_waitcnt lgkmcnt(6)
v_mfma_f32_16x16x32_bf16 v[104:107], a[32:35], v[56:59], v[104:107]
v_mfma_f32_16x16x32_bf16 v[108:111], a[160:163], v[56:59], v[108:111]
ds_read_b128 v[56:59], v18 offset:12288
v_mfma_f32_16x16x32_bf16 v[112:115], a[32:35], v[60:63], v[112:115]
v_mfma_f32_16x16x32_bf16 v[116:119], a[160:163], v[60:63], v[116:119]
ds_read_b128 v[60:63], v18 offset:28672
s_waitcnt lgkmcnt(6)
v_mfma_f32_16x16x32_bf16 v[104:107], a[36:39], v[64:67], v[104:107]
buffer_load_dwordx4 v2, s[4:7], s29 offen offset:2048 lds
v_mfma_f32_16x16x32_bf16 v[108:111], a[164:167], v[64:67], v[108:111]
ds_read_b128 v[64:67], v18 offset:13312
v_mfma_f32_16x16x32_bf16 v[112:115], a[36:39], v[68:71], v[112:115]
v_mfma_f32_16x16x32_bf16 v[116:119], a[164:167], v[68:71], v[116:119]
ds_read_b128 v[68:71], v18 offset:29696
s_waitcnt lgkmcnt(6)
v_mfma_f32_16x16x32_bf16 v[104:107], a[40:43], v[72:75], v[104:107]
v_mfma_f32_16x16x32_bf16 v[108:111], a[168:171], v[72:75], v[108:111]
ds_read_b128 v[72:75], v18 offset:14336
v_mfma_f32_16x16x32_bf16 v[112:115], a[40:43], v[76:79], v[112:115]
v_mfma_f32_16x16x32_bf16 v[116:119], a[168:171], v[76:79], v[116:119]
ds_read_b128 v[76:79], v18 offset:30720
s_waitcnt lgkmcnt(6)
v_mfma_f32_16x16x32_bf16 v[104:107], a[44:47], v[80:83], v[104:107]
buffer_load_dwordx4 v2, s[4:7], s29 offen offset:3072 lds
v_mfma_f32_16x16x32_bf16 v[108:111], a[172:175], v[80:83], v[108:111]
ds_read_b128 v[80:83], v18 offset:15360
v_mfma_f32_16x16x32_bf16 v[112:115], a[44:47], v[84:87], v[112:115]
v_mfma_f32_16x16x32_bf16 v[116:119], a[172:175], v[84:87], v[116:119]
ds_read_b128 v[84:87], v18 offset:31744
s_waitcnt vmcnt(11)
s_barrier
s_waitcnt lgkmcnt(6)
v_mfma_f32_16x16x32_bf16 v[104:107], a[48:51], v[56:59], v[104:107]
v_mfma_f32_16x16x32_bf16 v[108:111], a[176:179], v[56:59], v[108:111]
ds_read_b128 v[56:59], v18 offset:32768
v_mfma_f32_16x16x32_bf16 v[112:115], a[48:51], v[60:63], v[112:115]
v_mfma_f32_16x16x32_bf16 v[116:119], a[176:179], v[60:63], v[116:119]
ds_read_b128 v[60:63], v18 offset:49152
s_waitcnt lgkmcnt(6)
s_add_u32 m0, s44, 32768
s_add_u32 s29, s54, 32768
v_mfma_f32_16x16x32_bf16 v[104:107], a[52:55], v[64:67], v[104:107]
buffer_load_dwordx4 v2, s[4:7], s29 offen offset:0 lds
v_mfma_f32_16x16x32_bf16 v[108:111], a[180:183], v[64:67], v[108:111]
ds_read_b128 v[64:67], v18 offset:33792
v_mfma_f32_16x16x32_bf16 v[112:115], a[52:55], v[68:71], v[112:115]
v_mfma_f32_16x16x32_bf16 v[116:119], a[180:183], v[68:71], v[116:119]
ds_read_b128 v[68:71], v18 offset:50176
s_waitcnt lgkmcnt(6)
v_mfma_f32_16x16x32_bf16 v[104:107], a[56:59], v[72:75], v[104:107]
v_mfma_f32_16x16x32_bf16 v[108:111], a[184:187], v[72:75], v[108:111]
ds_read_b128 v[72:75], v18 offset:34816
v_mfma_f32_16x16x32_bf16 v[112:115], a[56:59], v[76:79], v[112:115]
v_mfma_f32_16x16x32_bf16 v[116:119], a[184:187], v[76:79], v[116:119]
ds_read_b128 v[76:79], v18 offset:51200
s_waitcnt lgkmcnt(6)
v_mfma_f32_16x16x32_bf16 v[104:107], a[60:63], v[80:83], v[104:107]
buffer_load_dwordx4 v2, s[4:7], s29 offen offset:1024 lds
v_mfma_f32_16x16x32_bf16 v[108:111], a[188:191], v[80:83], v[108:111]
ds_read_b128 v[80:83], v18 offset:35840
v_mfma_f32_16x16x32_bf16 v[112:115], a[60:63], v[84:87], v[112:115]
v_mfma_f32_16x16x32_bf16 v[116:119], a[188:191], v[84:87], v[116:119]
ds_read_b128 v[84:87], v18 offset:52224
s_waitcnt lgkmcnt(6)
v_mfma_f32_16x16x32_bf16 v[104:107], a[64:67], v[56:59], v[104:107]
v_mfma_f32_16x16x32_bf16 v[108:111], a[192:195], v[56:59], v[108:111]
ds_read_b128 v[56:59], v18 offset:36864
v_mfma_f32_16x16x32_bf16 v[112:115], a[64:67], v[60:63], v[112:115]
v_mfma_f32_16x16x32_bf16 v[116:119], a[192:195], v[60:63], v[116:119]
ds_read_b128 v[60:63], v18 offset:53248
s_waitcnt lgkmcnt(6)
v_mfma_f32_16x16x32_bf16 v[104:107], a[68:71], v[64:67], v[104:107]
buffer_load_dwordx4 v2, s[4:7], s29 offen offset:2048 lds
v_mfma_f32_16x16x32_bf16 v[108:111], a[196:199], v[64:67], v[108:111]
ds_read_b128 v[64:67], v18 offset:37888
v_mfma_f32_16x16x32_bf16 v[112:115], a[68:71], v[68:71], v[112:115]
v_mfma_f32_16x16x32_bf16 v[116:119], a[196:199], v[68:71], v[116:119]
ds_read_b128 v[68:71], v18 offset:54272
s_waitcnt lgkmcnt(6)
v_mfma_f32_16x16x32_bf16 v[104:107], a[72:75], v[72:75], v[104:107]
s_add_u32 s52, s54, s56
s_xor_b32 s52, s52, s23
v_mfma_f32_16x16x32_bf16 v[108:111], a[200:203], v[72:75], v[108:111]
s_add_u32 s43, s55, s56
ds_read_b128 v[72:75], v18 offset:38912
v_mfma_f32_16x16x32_bf16 v[112:115], a[72:75], v[76:79], v[112:115]
s_xor_b32 s43, s43, s23
s_add_u32 s24, s38, 3
v_mfma_f32_16x16x32_bf16 v[116:119], a[200:203], v[76:79], v[116:119]
ds_read_b128 v[76:79], v18 offset:55296
s_waitcnt lgkmcnt(6)
v_mfma_f32_16x16x32_bf16 v[104:107], a[76:79], v[80:83], v[104:107]
buffer_load_dwordx4 v2, s[4:7], s29 offen offset:3072 lds
v_mfma_f32_16x16x32_bf16 v[108:111], a[204:207], v[80:83], v[108:111]
s_cmp_ge_u32 s24, s51
s_cselect_b32 s52, 2147483648, s52
ds_read_b128 v[80:83], v18 offset:39936
v_mfma_f32_16x16x32_bf16 v[112:115], a[76:79], v[84:87], v[112:115]
s_add_u32 s24, s38, 4
s_cmp_ge_u32 s24, s51
s_cselect_b32 s43, 2147483648, s43
v_mfma_f32_16x16x32_bf16 v[116:119], a[204:207], v[84:87], v[116:119]
ds_read_b128 v[84:87], v18 offset:56320
s_waitcnt lgkmcnt(6)
v_mfma_f32_16x16x32_bf16 v[104:107], a[80:83], v[56:59], v[104:107]
v_mfma_f32_16x16x32_bf16 v[108:111], a[208:211], v[56:59], v[108:111]
ds_read_b128 v[56:59], v18 offset:40960
v_mfma_f32_16x16x32_bf16 v[112:115], a[80:83], v[60:63], v[112:115]
v_mfma_f32_16x16x32_bf16 v[116:119], a[208:211], v[60:63], v[116:119]
ds_read_b128 v[60:63], v18 offset:57344
s_waitcnt lgkmcnt(6)
s_add_u32 m0, s44, 36864
s_add_u32 s29, s54, 36864
v_mfma_f32_16x16x32_bf16 v[104:107], a[84:87], v[64:67], v[104:107]
buffer_load_dwordx4 v2, s[4:7], s29 offen offset:0 lds
v_mfma_f32_16x16x32_bf16 v[108:111], a[212:215], v[64:67], v[108:111]
ds_read_b128 v[64:67], v18 offset:41984
v_mfma_f32_16x16x32_bf16 v[112:115], a[84:87], v[68:71], v[112:115]
v_mfma_f32_16x16x32_bf16 v[116:119], a[212:215], v[68:71], v[116:119]
ds_read_b128 v[68:71], v18 offset:58368
s_waitcnt lgkmcnt(6)
v_mfma_f32_16x16x32_bf16 v[104:107], a[88:91], v[72:75], v[104:107]
v_mfma_f32_16x16x32_bf16 v[108:111], a[216:219], v[72:75], v[108:111]
ds_read_b128 v[72:75], v18 offset:43008
v_mfma_f32_16x16x32_bf16 v[112:115], a[88:91], v[76:79], v[112:115]
v_mfma_f32_16x16x32_bf16 v[116:119], a[216:219], v[76:79], v[116:119]
ds_read_b128 v[76:79], v18 offset:59392
s_waitcnt lgkmcnt(6)
v_mfma_f32_16x16x32_bf16 v[104:107], a[92:95], v[80:83], v[104:107]
buffer_load_dwordx4 v2, s[4:7], s29 offen offset:1024 lds
v_mfma_f32_16x16x32_bf16 v[108:111], a[220:223], v[80:83], v[108:111]
ds_read_b128 v[80:83], v18 offset:44032
v_mfma_f32_16x16x32_bf16 v[112:115], a[92:95], v[84:87], v[112:115]
v_mfma_f32_16x16x32_bf16 v[116:119], a[220:223], v[84:87], v[116:119]
ds_read_b128 v[84:87], v18 offset:60416
s_waitcnt lgkmcnt(6)
v_mfma_f32_16x16x32_bf16 v[104:107], a[96:99], v[56:59], v[104:107]
v_mfma_f32_16x16x32_bf16 v[108:111], a[224:227], v[56:59], v[108:111]
ds_read_b128 v[56:59], v18 offset:45056
v_mfma_f32_16x16x32_bf16 v[112:115], a[96:99], v[60:63], v[112:115]
v_mfma_f32_16x16x32_bf16 v[116:119], a[224:227], v[60:63], v[116:119]
ds_read_b128 v[60:63], v18 offset:61440
s_waitcnt lgkmcnt(6)
v_mfma_f32_16x16x32_bf16 v[104:107], a[100:103], v[64:67], v[104:107]
buffer_load_dwordx4 v2, s[4:7], s29 offen offset:2048 lds
v_mfma_f32_16x16x32_bf16 v[108:111], a[228:231], v[64:67], v[108:111]
ds_read_b128 v[64:67], v18 offset:46080
v_mfma_f32_16x16x32_bf16 v[112:115], a[100:103], v[68:71], v[112:115]
v_mfma_f32_16x16x32_bf16 v[116:119], a[228:231], v[68:71], v[116:119]
ds_read_b128 v[68:71], v18 offset:62464
s_waitcnt lgkmcnt(6)
v_mfma_f32_16x16x32_bf16 v[104:107], a[104:107], v[72:75], v[104:107]
v_mfma_f32_16x16x32_bf16 v[108:111], a[232:235], v[72:75], v[108:111]
ds_read_b128 v[72:75], v18 offset:47104
v_mfma_f32_16x16x32_bf16 v[112:115], a[104:107], v[76:79], v[112:115]
v_mfma_f32_16x16x32_bf16 v[116:119], a[232:235], v[76:79], v[116:119]
ds_read_b128 v[76:79], v18 offset:63488
s_waitcnt lgkmcnt(6)
v_mfma_f32_16x16x32_bf16 v[104:107], a[108:111], v[80:83], v[104:107]
buffer_load_dwordx4 v2, s[4:7], s29 offen offset:3072 lds
v_mfma_f32_16x16x32_bf16 v[108:111], a[236:239], v[80:83], v[108:111]
ds_read_b128 v[80:83], v18 offset:48128
v_mfma_f32_16x16x32_bf16 v[112:115], a[108:111], v[84:87], v[112:115]
v_mfma_f32_16x16x32_bf16 v[116:119], a[236:239], v[84:87], v[116:119]
ds_read_b128 v[84:87], v18 offset:64512
s_waitcnt vmcnt(8)
s_barrier
s_waitcnt lgkmcnt(6)
v_mfma_f32_16x16x32_bf16 v[104:107], a[112:115], v[56:59], v[104:107]
s_add_u32 s38, s38, 1
v_mfma_f32_16x16x32_bf16 v[108:111], a[240:243], v[56:59], v[108:111]
ds_read_b128 v[56:59], v14 offset:0
v_mfma_f32_16x16x32_bf16 v[112:115], a[112:115], v[60:63], v[112:115]
v_mfma_f32_16x16x32_bf16 v[116:119], a[240:243], v[60:63], v[116:119]
ds_read_b128 v[60:63], v14 offset:16384
s_waitcnt lgkmcnt(6)
s_add_u32 m0, s44, 65536
s_add_u32 s29, s55, 0
v_mfma_f32_16x16x32_bf16 v[104:107], a[116:119], v[64:67], v[104:107]
buffer_load_dwordx4 v2, s[4:7], s29 offen offset:0 lds
v_mfma_f32_16x16x32_bf16 v[108:111], a[244:247], v[64:67], v[108:111]
buffer_load_dwordx4 v[144:147], v208, s[4:7], s35 offen
ds_read_b128 v[64:67], v14 offset:1024
v_mfma_f32_16x16x32_bf16 v[112:115], a[116:119], v[68:71], v[112:115]
buffer_load_dwordx4 v[148:151], v209, s[4:7], s35 offen
buffer_load_dwordx4 v[152:155], v210, s[4:7], s35 offen
v_mfma_f32_16x16x32_bf16 v[116:119], a[244:247], v[68:71], v[116:119]
ds_read_b128 v[68:71], v14 offset:17408
s_waitcnt lgkmcnt(6)
v_mfma_f32_16x16x32_bf16 v[104:107], a[120:123], v[72:75], v[104:107]
buffer_load_dwordx4 v[156:159], v211, s[4:7], s35 offen
s_mov_b32 s39, s36
v_mfma_f32_16x16x32_bf16 v[108:111], a[248:251], v[72:75], v[108:111]
s_mov_b32 s35, s57
ds_read_b128 v[72:75], v14 offset:2048
v_mfma_f32_16x16x32_bf16 v[112:115], a[120:123], v[76:79], v[112:115]
s_mov_b32 s36, s58
s_add_u32 s57, s57, 2097152
v_mfma_f32_16x16x32_bf16 v[116:119], a[248:251], v[76:79], v[116:119]
ds_read_b128 v[76:79], v14 offset:18432
s_waitcnt lgkmcnt(6)
v_mfma_f32_16x16x32_bf16 v[104:107], a[124:127], v[80:83], v[104:107]
buffer_load_dwordx4 v2, s[4:7], s29 offen offset:1024 lds
v_mfma_f32_16x16x32_bf16 v[108:111], a[252:255], v[80:83], v[108:111]
s_xor_b32 s57, s57, s23
ds_read_b128 v[80:83], v14 offset:3072
v_mfma_f32_16x16x32_bf16 v[112:115], a[124:127], v[84:87], v[112:115]
s_add_u32 s58, s58, 524288
v_mfma_f32_16x16x32_bf16 v[116:119], a[252:255], v[84:87], v[116:119]
ds_read_b128 v[84:87], v14 offset:19456
s_mov_b32 s53, s55
s_mov_b32 s54, s52
s_mov_b32 s55, s43
s_cmp_lg_u32 s38, s51
s_cbranch_scc1 L_fgl2
s_branch L_fgx
.p2align 6
L_fgl3:
s_waitcnt lgkmcnt(6)
v_mfma_f32_16x16x32_bf16 v[88:91], a[0:3], v[56:59], 0
v_mfma_f32_16x16x32_bf16 v[92:95], a[128:131], v[56:59], 0
ds_read_b128 v[56:59], v14 offset:4096
v_mfma_f32_16x16x32_bf16 v[96:99], a[0:3], v[60:63], 0
v_mfma_f32_16x16x32_bf16 v[100:103], a[128:131], v[60:63], 0
ds_read_b128 v[60:63], v14 offset:20480
s_waitcnt lgkmcnt(6)
v_mfma_f32_16x16x32_bf16 v[88:91], a[4:7], v[64:67], v[88:91]
v_mfma_f32_16x16x32_bf16 v[92:95], a[132:135], v[64:67], v[92:95]
ds_read_b128 v[64:67], v14 offset:5120
v_mfma_f32_16x16x32_bf16 v[96:99], a[4:7], v[68:71], v[96:99]
buffer_load_dwordx4 v2, s[4:7], s29 offen offset:2048 lds
v_mfma_f32_16x16x32_bf16 v[100:103], a[132:135], v[68:71], v[100:103]
ds_read_b128 v[68:71], v14 offset:21504
s_waitcnt lgkmcnt(6)
v_mfma_f32_16x16x32_bf16 v[88:91], a[8:11], v[72:75], v[88:91]
v_mfma_f32_16x16x32_bf16 v[92:95], a[136:139], v[72:75], v[92:95]
ds_read_b128 v[72:75], v14 offset:6144
v_mfma_f32_16x16x32_bf16 v[96:99], a[8:11], v[76:79], v[96:99]
v_mfma_f32_16x16x32_bf16 v[100:103], a[136:139], v[76:79], v[100:103]
ds_read_b128 v[76:79], v14 offset:22528
s_waitcnt lgkmcnt(6)
v_mfma_f32_16x16x32_bf16 v[88:91], a[12:15], v[80:83], v[88:91]
v_mfma_f32_16x16x32_bf16 v[92:95], a[140:143], v[80:83], v[92:95]
ds_read_b128 v[80:83], v14 offset:7168
v_mfma_f32_16x16x32_bf16 v[96:99], a[12:15], v[84:87], v[96:99]
buffer_load_dwordx4 v2, s[4:7], s29 offen offset:3072 lds
v_mfma_f32_16x16x32_bf16 v[100:103], a[140:143], v[84:87], v[100:103]
ds_read_b128 v[84:87], v14 offset:23552
s_waitcnt lgkmcnt(6)
v_mfma_f32_16x16x32_bf16 v[88:91], a[16:19], v[56:59], v[88:91]
v_cvt_pk_bf16_f32 v120, v104, v105
v_cvt_pk_bf16_f32 v121, v106, v107
v_mfma_f32_16x16x32_bf16 v[92:95], a[144:147], v[56:59], v[92:95]
v_cvt_pk_bf16_f32 v122, v108, v109
ds_read_b128 v[56:59], v14 offset:8192
v_mfma_f32_16x16x32_bf16 v[96:99], a[16:19], v[60:63], v[96:99]
v_cvt_pk_bf16_f32 v123, v110, v111
buffer_store_dwordx4 v[120:123], v8, s[8:11], s59 offen sc1
v_mfma_f32_16x16x32_bf16 v[100:103], a[144:147], v[60:63], v[100:103]
ds_read_b128 v[60:63], v14 offset:24576
s_waitcnt lgkmcnt(6)
v_mfma_f32_16x16x32_bf16 v[88:91], a[20:23], v[64:67], v[88:91]
v_cvt_pk_bf16_f32 v124, v112, v113
v_cvt_pk_bf16_f32 v125, v114, v115
v_mfma_f32_16x16x32_bf16 v[92:95], a[148:151], v[64:67], v[92:95]
v_cvt_pk_bf16_f32 v126, v116, v117
ds_read_b128 v[64:67], v14 offset:9216
s_add_u32 m0, s44, 69632
s_add_u32 s29, s53, 4096
v_mfma_f32_16x16x32_bf16 v[96:99], a[20:23], v[68:71], v[96:99]
buffer_load_dwordx4 v2, s[4:7], s29 offen offset:0 lds
v_mfma_f32_16x16x32_bf16 v[100:103], a[148:151], v[68:71], v[100:103]
ds_read_b128 v[68:71], v14 offset:25600
s_waitcnt lgkmcnt(6)
v_mfma_f32_16x16x32_bf16 v[88:91], a[24:27], v[72:75], v[88:91]
v_cvt_pk_bf16_f32 v127, v118, v119
buffer_store_dwordx4 v[124:127], v9, s[8:11], s59 offen sc1
v_mfma_f32_16x16x32_bf16 v[92:95], a[152:155], v[72:75], v[92:95]
s_lshr_b32 s59, s60, 8
ds_read_b128 v[72:75], v14 offset:10240
v_mfma_f32_16x16x32_bf16 v[96:99], a[24:27], v[76:79], v[96:99]
s_xor_b32 s59, s59, s30
s_and_b32 s59, s59, s23
v_mfma_f32_16x16x32_bf16 v[100:103], a[152:155], v[76:79], v[100:103]
ds_read_b128 v[76:79], v14 offset:26624
s_waitcnt lgkmcnt(6)
v_mfma_f32_16x16x32_bf16 v[88:91], a[28:31], v[80:83], v[88:91]
s_or_b32 s59, s59, s60
s_add_u32 s60, s60, s45
v_mfma_f32_16x16x32_bf16 v[92:95], a[156:159], v[80:83], v[92:95]
ds_read_b128 v[80:83], v14 offset:11264
v_mfma_f32_16x16x32_bf16 v[96:99], a[28:31], v[84:87], v[96:99]
buffer_load_dwordx4 v2, s[4:7], s29 offen offset:1024 lds
v_mfma_f32_16x16x32_bf16 v[100:103], a[156:159], v[84:87], v[100:103]
ds_read_b128 v[84:87], v14 offset:27648
s_waitcnt lgkmcnt(6)
v_mfma_f32_16x16x32_bf16 v[88:91], a[32:35], v[56:59], v[88:91]
v_mfma_f32_16x16x32_bf16 v[92:95], a[160:163], v[56:59], v[92:95]
ds_read_b128 v[56:59], v14 offset:12288
v_mfma_f32_16x16x32_bf16 v[96:99], a[32:35], v[60:63], v[96:99]
v_mfma_f32_16x16x32_bf16 v[100:103], a[160:163], v[60:63], v[100:103]
ds_read_b128 v[60:63], v14 offset:28672
s_waitcnt lgkmcnt(6)
v_mfma_f32_16x16x32_bf16 v[88:91], a[36:39], v[64:67], v[88:91]
v_mfma_f32_16x16x32_bf16 v[92:95], a[164:167], v[64:67], v[92:95]
ds_read_b128 v[64:67], v14 offset:13312
v_mfma_f32_16x16x32_bf16 v[96:99], a[36:39], v[68:71], v[96:99]
buffer_load_dwordx4 v2, s[4:7], s29 offen offset:2048 lds
v_mfma_f32_16x16x32_bf16 v[100:103], a[164:167], v[68:71], v[100:103]
ds_read_b128 v[68:71], v14 offset:29696
s_waitcnt lgkmcnt(6)
v_mfma_f32_16x16x32_bf16 v[88:91], a[40:43], v[72:75], v[88:91]
v_mfma_f32_16x16x32_bf16 v[92:95], a[168:171], v[72:75], v[92:95]
ds_read_b128 v[72:75], v14 offset:14336
v_mfma_f32_16x16x32_bf16 v[96:99], a[40:43], v[76:79], v[96:99]
v_mfma_f32_16x16x32_bf16 v[100:103], a[168:171], v[76:79], v[100:103]
ds_read_b128 v[76:79], v14 offset:30720
s_waitcnt lgkmcnt(6)
v_mfma_f32_16x16x32_bf16 v[88:91], a[44:47], v[80:83], v[88:91]
v_mfma_f32_16x16x32_bf16 v[92:95], a[172:175], v[80:83], v[92:95]
ds_read_b128 v[80:83], v14 offset:15360
v_mfma_f32_16x16x32_bf16 v[96:99], a[44:47], v[84:87], v[96:99]
buffer_load_dwordx4 v2, s[4:7], s29 offen offset:3072 lds
v_mfma_f32_16x16x32_bf16 v[100:103], a[172:175], v[84:87], v[100:103]
ds_read_b128 v[84:87], v14 offset:31744
s_waitcnt vmcnt(14)
s_barrier
s_waitcnt lgkmcnt(6)
v_mfma_f32_16x16x32_bf16 v[88:91], a[48:51], v[56:59], v[88:91]
v_mfma_f32_16x16x32_bf16 v[92:95], a[176:179], v[56:59], v[92:95]
ds_read_b128 v[56:59], v14 offset:32768
v_mfma_f32_16x16x32_bf16 v[96:99], a[48:51], v[60:63], v[96:99]
v_mfma_f32_16x16x32_bf16 v[100:103], a[176:179], v[60:63], v[100:103]
ds_read_b128 v[60:63], v14 offset:49152
s_waitcnt lgkmcnt(6)
v_mfma_f32_16x16x32_bf16 v[88:91], a[52:55], v[64:67], v[88:91]
v_mfma_f32_16x16x32_bf16 v[92:95], a[180:183], v[64:67], v[92:95]
ds_read_b128 v[64:67], v14 offset:33792
s_add_u32 m0, s44, 98304
s_add_u32 s29, s53, 32768
v_mfma_f32_16x16x32_bf16 v[96:99], a[52:55], v[68:71], v[96:99]
buffer_load_dwordx4 v2, s[4:7], s29 offen offset:0 lds
v_mfma_f32_16x16x32_bf16 v[100:103], a[180:183], v[68:71], v[100:103]
ds_read_b128 v[68:71], v14 offset:50176
s_waitcnt lgkmcnt(6)
v_mfma_f32_16x16x32_bf16 v[88:91], a[56:59], v[72:75], v[88:91]
v_mfma_f32_16x16x32_bf16 v[92:95], a[184:187], v[72:75], v[92:95]
ds_read_b128 v[72:75], v14 offset:34816
v_mfma_f32_16x16x32_bf16 v[96:99], a[56:59], v[76:79], v[96:99]
v_mfma_f32_16x16x32_bf16 v[100:103], a[184:187], v[76:79], v[100:103]
ds_read_b128 v[76:79], v14 offset:51200
s_waitcnt lgkmcnt(6)
v_mfma_f32_16x16x32_bf16 v[88:91], a[60:63], v[80:83], v[88:91]
v_mfma_f32_16x16x32_bf16 v[92:95], a[188:191], v[80:83], v[92:95]
ds_read_b128 v[80:83], v14 offset:35840
v_mfma_f32_16x16x32_bf16 v[96:99], a[60:63], v[84:87], v[96:99]
buffer_load_dwordx4 v2, s[4:7], s29 offen offset:1024 lds
v_mfma_f32_16x16x32_bf16 v[100:103], a[188:191], v[84:87], v[100:103]
ds_read_b128 v[84:87], v14 offset:52224
s_waitcnt vmcnt(11)
s_waitcnt lgkmcnt(6)
v_mfma_f32_16x16x32_bf16 v[88:91], a[64:67], v[56:59], v[88:91]
v_lshlrev_b32 v196, 16, v144
v_and_b32 v197, 0xffff0000, v144
v_mfma_f32_16x16x32_bf16 v[92:95], a[192:195], v[56:59], v[92:95]
v_lshlrev_b32 v192, 16, v148
ds_read_b128 v[56:59], v14 offset:36864
v_mfma_f32_16x16x32_bf16 v[96:99], a[64:67], v[60:63], v[96:99]
v_and_b32 v193, 0xffff0000, v148
v_pk_add_f32 v[196:197], v[196:197], v[192:193]
v_mfma_f32_16x16x32_bf16 v[100:103], a[192:195], v[60:63], v[100:103]
ds_read_b128 v[60:63], v14 offset:53248
s_waitcnt lgkmcnt(6)
v_mfma_f32_16x16x32_bf16 v[88:91], a[68:71], v[64:67], v[88:91]
v_lshlrev_b32 v192, 16, v152
v_and_b32 v193, 0xffff0000, v152
v_mfma_f32_16x16x32_bf16 v[92:95], a[196:199], v[64:67], v[92:95]
v_pk_add_f32 v[196:197], v[196:197], v[192:193]
ds_read_b128 v[64:67], v14 offset:37888
v_mfma_f32_16x16x32_bf16 v[96:99], a[68:71], v[68:71], v[96:99]
buffer_load_dwordx4 v2, s[4:7], s29 offen offset:2048 lds
v_mfma_f32_16x16x32_bf16 v[100:103], a[196:199], v[68:71], v[100:103]
ds_read_b128 v[68:71], v14 offset:54272
s_waitcnt lgkmcnt(6)
v_mfma_f32_16x16x32_bf16 v[88:91], a[72:75], v[72:75], v[88:91]
v_lshlrev_b32 v192, 16, v156
v_and_b32 v193, 0xffff0000, v156
v_mfma_f32_16x16x32_bf16 v[92:95], a[200:203], v[72:75], v[92:95]
v_pk_add_f32 v[196:197], v[196:197], v[192:193]
ds_read_b128 v[72:75], v14 offset:38912
v_mfma_f32_16x16x32_bf16 v[96:99], a[72:75], v[76:79], v[96:99]
v_cvt_pk_bf16_f32 v204, v196, v197
v_lshlrev_b32 v198, 16, v145
v_mfma_f32_16x16x32_bf16 v[100:103], a[200:203], v[76:79], v[100:103]
ds_read_b128 v[76:79], v14 offset:55296
s_waitcnt lgkmcnt(6)
v_mfma_f32_16x16x32_bf16 v[88:91], a[76:79], v[80:83], v[88:91]
v_and_b32 v199, 0xffff0000, v145
v_lshlrev_b32 v192, 16, v149
v_mfma_f32_16x16x32_bf16 v[92:95], a[204:207], v[80:83], v[92:95]
v_and_b32 v193, 0xffff0000, v149
ds_read_b128 v[80:83], v14 offset:39936
v_mfma_f32_16x16x32_bf16 v[96:99], a[76:79], v[84:87], v[96:99]
buffer_load_dwordx4 v2, s[4:7], s29 offen offset:3072 lds
v_mfma_f32_16x16x32_bf16 v[100:103], a[204:207], v[84:87], v[100:103]
ds_read_b128 v[84:87], v14 offset:56320
s_waitcnt lgkmcnt(6)
v_mfma_f32_16x16x32_bf16 v[88:91], a[80:83], v[56:59], v[88:91]
v_pk_add_f32 v[198:199], v[198:199], v[192:193]
v_lshlrev_b32 v192, 16, v153
v_mfma_f32_16x16x32_bf16 v[92:95], a[208:211], v[56:59], v[92:95]
v_and_b32 v193, 0xffff0000, v153
ds_read_b128 v[56:59], v14 offset:40960
v_mfma_f32_16x16x32_bf16 v[96:99], a[80:83], v[60:63], v[96:99]
v_pk_add_f32 v[198:199], v[198:199], v[192:193]
v_lshlrev_b32 v192, 16, v157
v_mfma_f32_16x16x32_bf16 v[100:103], a[208:211], v[60:63], v[100:103]
ds_read_b128 v[60:63], v14 offset:57344
s_waitcnt lgkmcnt(6)
v_mfma_f32_16x16x32_bf16 v[88:91], a[84:87], v[64:67], v[88:91]
v_and_b32 v193, 0xffff0000, v157
v_pk_add_f32 v[198:199], v[198:199], v[192:193]
v_mfma_f32_16x16x32_bf16 v[92:95], a[212:215], v[64:67], v[92:95]
v_cvt_pk_bf16_f32 v205, v198, v199
ds_read_b128 v[64:67], v14 offset:41984
s_add_u32 m0, s44, 102400
s_add_u32 s29, s53, 36864
v_mfma_f32_16x16x32_bf16 v[96:99], a[84:87], v[68:71], v[96:99]
buffer_load_dwordx4 v2, s[4:7], s29 offen offset:0 lds
v_mfma_f32_16x16x32_bf16 v[100:103], a[212:215], v[68:71], v[100:103]
ds_read_b128 v[68:71], v14 offset:58368
s_waitcnt lgkmcnt(6)
v_mfma_f32_16x16x32_bf16 v[88:91], a[88:91], v[72:75], v[88:91]
v_lshlrev_b32 v200, 16, v146
v_and_b32 v201, 0xffff0000, v146
v_mfma_f32_16x16x32_bf16 v[92:95], a[216:219], v[72:75], v[92:95]
v_lshlrev_b32 v192, 16, v150
ds_read_b128 v[72:75], v14 offset:43008
v_mfma_f32_16x16x32_bf16 v[96:99], a[88:91], v[76:79], v[96:99]
v_and_b32 v193, 0xffff0000, v150
v_pk_add_f32 v[200:201], v[200:201], v[192:193]
v_mfma_f32_16x16x32_bf16 v[100:103], a[216:219], v[76:79], v[100:103]
ds_read_b128 v[76:79], v14 offset:59392
s_waitcnt lgkmcnt(6)
v_mfma_f32_16x16x32_bf16 v[88:91], a[92:95], v[80:83], v[88:91]
v_lshlrev_b32 v192, 16, v154
v_and_b32 v193, 0xffff0000, v154
v_mfma_f32_16x16x32_bf16 v[92:95], a[220:223], v[80:83], v[92:95]
v_pk_add_f32 v[200:201], v[200:201], v[192:193]
ds_read_b128 v[80:83], v14 offset:44032
v_mfma_f32_16x16x32_bf16 v[96:99], a[92:95], v[84:87], v[96:99]
buffer_load_dwordx4 v2, s[4:7], s29 offen offset:1024 lds
v_mfma_f32_16x16x32_bf16 v[100:103], a[220:223], v[84:87], v[100:103]
ds_read_b128 v[84:87], v14 offset:60416
s_waitcnt lgkmcnt(6)
v_mfma_f32_16x16x32_bf16 v[88:91], a[96:99], v[56:59], v[88:91]
v_lshlrev_b32 v192, 16, v158
v_and_b32 v193, 0xffff0000, v158
v_mfma_f32_16x16x32_bf16 v[92:95], a[224:227], v[56:59], v[92:95]
v_pk_add_f32 v[200:201], v[200:201], v[192:193]
ds_read_b128 v[56:59], v14 offset:45056
v_mfma_f32_16x16x32_bf16 v[96:99], a[96:99], v[60:63], v[96:99]
v_cvt_pk_bf16_f32 v206, v200, v201
v_lshlrev_b32 v202, 16, v147
v_mfma_f32_16x16x32_bf16 v[100:103], a[224:227], v[60:63], v[100:103]
ds_read_b128 v[60:63], v14 offset:61440
s_waitcnt lgkmcnt(6)
v_mfma_f32_16x16x32_bf16 v[88:91], a[100:103], v[64:67], v[88:91]
v_and_b32 v203, 0xffff0000, v147
v_lshlrev_b32 v192, 16, v151
v_mfma_f32_16x16x32_bf16 v[92:95], a[228:231], v[64:67], v[92:95]
v_and_b32 v193, 0xffff0000, v151
ds_read_b128 v[64:67], v14 offset:46080
v_mfma_f32_16x16x32_bf16 v[96:99], a[100:103], v[68:71], v[96:99]
buffer_load_dwordx4 v2, s[4:7], s29 offen offset:2048 lds
v_mfma_f32_16x16x32_bf16 v[100:103], a[228:231], v[68:71], v[100:103]
ds_read_b128 v[68:71], v14 offset:62464
s_waitcnt lgkmcnt(6)
v_mfma_f32_16x16x32_bf16 v[88:91], a[104:107], v[72:75], v[88:91]
v_pk_add_f32 v[202:203], v[202:203], v[192:193]
v_lshlrev_b32 v192, 16, v155
v_mfma_f32_16x16x32_bf16 v[92:95], a[232:235], v[72:75], v[92:95]
v_and_b32 v193, 0xffff0000, v155
ds_read_b128 v[72:75], v14 offset:47104
v_mfma_f32_16x16x32_bf16 v[96:99], a[104:107], v[76:79], v[96:99]
v_pk_add_f32 v[202:203], v[202:203], v[192:193]
v_lshlrev_b32 v192, 16, v159
v_mfma_f32_16x16x32_bf16 v[100:103], a[232:235], v[76:79], v[100:103]
ds_read_b128 v[76:79], v14 offset:63488
s_waitcnt lgkmcnt(6)
v_mfma_f32_16x16x32_bf16 v[88:91], a[108:111], v[80:83], v[88:91]
v_and_b32 v193, 0xffff0000, v159
v_pk_add_f32 v[202:203], v[202:203], v[192:193]
v_mfma_f32_16x16x32_bf16 v[92:95], a[236:239], v[80:83], v[92:95]
v_cvt_pk_bf16_f32 v207, v202, v203
ds_read_b128 v[80:83], v14 offset:48128
v_mfma_f32_16x16x32_bf16 v[96:99], a[108:111], v[84:87], v[96:99]
buffer_load_dwordx4 v2, s[4:7], s29 offen offset:3072 lds
v_mfma_f32_16x16x32_bf16 v[100:103], a[236:239], v[84:87], v[100:103]
ds_read_b128 v[84:87], v14 offset:64512
s_waitcnt vmcnt(8)
s_barrier
s_waitcnt lgkmcnt(6)
v_mfma_f32_16x16x32_bf16 v[88:91], a[112:115], v[56:59], v[88:91]
buffer_store_dwordx4 v[204:207], v212, s[16:19], s39 offen sc1
s_add_u32 s38, s38, 1
v_mfma_f32_16x16x32_bf16 v[92:95], a[240:243], v[56:59], v[92:95]
ds_read_b128 v[56:59], v18 offset:0
v_mfma_f32_16x16x32_bf16 v[96:99], a[112:115], v[60:63], v[96:99]
v_mfma_f32_16x16x32_bf16 v[100:103], a[240:243], v[60:63], v[100:103]
ds_read_b128 v[60:63], v18 offset:16384
s_waitcnt lgkmcnt(6)
v_mfma_f32_16x16x32_bf16 v[88:91], a[116:119], v[64:67], v[88:91]
v_mfma_f32_16x16x32_bf16 v[92:95], a[244:247], v[64:67], v[92:95]
ds_read_b128 v[64:67], v18 offset:1024
s_add_u32 m0, s44, 0
s_add_u32 s29, s54, 0
v_mfma_f32_16x16x32_bf16 v[96:99], a[116:119], v[68:71], v[96:99]
buffer_load_dwordx4 v2, s[4:7], s29 offen offset:0 lds
v_mfma_f32_16x16x32_bf16 v[100:103], a[244:247], v[68:71], v[100:103]
ds_read_b128 v[68:71], v18 offset:17408
s_waitcnt lgkmcnt(6)
v_mfma_f32_16x16x32_bf16 v[88:91], a[120:123], v[72:75], v[88:91]
v_mfma_f32_16x16x32_bf16 v[92:95], a[248:251], v[72:75], v[92:95]
ds_read_b128 v[72:75], v18 offset:2048
v_mfma_f32_16x16x32_bf16 v[96:99], a[120:123], v[76:79], v[96:99]
v_mfma_f32_16x16x32_bf16 v[100:103], a[248:251], v[76:79], v[100:103]
ds_read_b128 v[76:79], v18 offset:18432
s_waitcnt lgkmcnt(6)
v_mfma_f32_16x16x32_bf16 v[88:91], a[124:127], v[80:83], v[88:91]
v_mfma_f32_16x16x32_bf16 v[92:95], a[252:255], v[80:83], v[92:95]
ds_read_b128 v[80:83], v18 offset:3072
v_mfma_f32_16x16x32_bf16 v[96:99], a[124:127], v[84:87], v[96:99]
buffer_load_dwordx4 v2, s[4:7], s29 offen offset:1024 lds
v_mfma_f32_16x16x32_bf16 v[100:103], a[252:255], v[84:87], v[100:103]
ds_read_b128 v[84:87], v18 offset:19456
s_cmp_eq_u32 s38, s51
s_cbranch_scc1 L_fgx0
s_waitcnt lgkmcnt(6)
v_mfma_f32_16x16x32_bf16 v[104:107], a[0:3], v[56:59], 0
v_mfma_f32_16x16x32_bf16 v[108:111], a[128:131], v[56:59], 0
ds_read_b128 v[56:59], v18 offset:4096
v_mfma_f32_16x16x32_bf16 v[112:115], a[0:3], v[60:63], 0
v_mfma_f32_16x16x32_bf16 v[116:119], a[128:131], v[60:63], 0
ds_read_b128 v[60:63], v18 offset:20480
s_waitcnt lgkmcnt(6)
v_mfma_f32_16x16x32_bf16 v[104:107], a[4:7], v[64:67], v[104:107]
v_mfma_f32_16x16x32_bf16 v[108:111], a[132:135], v[64:67], v[108:111]
ds_read_b128 v[64:67], v18 offset:5120
v_mfma_f32_16x16x32_bf16 v[112:115], a[4:7], v[68:71], v[112:115]
buffer_load_dwordx4 v2, s[4:7], s29 offen offset:2048 lds
v_mfma_f32_16x16x32_bf16 v[116:119], a[132:135], v[68:71], v[116:119]
ds_read_b128 v[68:71], v18 offset:21504
s_waitcnt lgkmcnt(6)
v_mfma_f32_16x16x32_bf16 v[104:107], a[8:11], v[72:75], v[104:107]
v_mfma_f32_16x16x32_bf16 v[108:111], a[136:139], v[72:75], v[108:111]
ds_read_b128 v[72:75], v18 offset:6144
v_mfma_f32_16x16x32_bf16 v[112:115], a[8:11], v[76:79], v[112:115]
v_mfma_f32_16x16x32_bf16 v[116:119], a[136:139], v[76:79], v[116:119]
ds_read_b128 v[76:79], v18 offset:22528
s_waitcnt lgkmcnt(6)
v_mfma_f32_16x16x32_bf16 v[104:107], a[12:15], v[80:83], v[104:107]
v_mfma_f32_16x16x32_bf16 v[108:111], a[140:143], v[80:83], v[108:111]
ds_read_b128 v[80:83], v18 offset:7168
v_mfma_f32_16x16x32_bf16 v[112:115], a[12:15], v[84:87], v[112:115]
buffer_load_dwordx4 v2, s[4:7], s29 offen offset:3072 lds
v_mfma_f32_16x16x32_bf16 v[116:119], a[140:143], v[84:87], v[116:119]
ds_read_b128 v[84:87], v18 offset:23552
s_waitcnt lgkmcnt(6)
v_mfma_f32_16x16x32_bf16 v[104:107], a[16:19], v[56:59], v[104:107]
v_cvt_pk_bf16_f32 v120, v88, v89
v_cvt_pk_bf16_f32 v121, v90, v91
v_mfma_f32_16x16x32_bf16 v[108:111], a[144:147], v[56:59], v[108:111]
v_cvt_pk_bf16_f32 v122, v92, v93
ds_read_b128 v[56:59], v18 offset:8192
v_mfma_f32_16x16x32_bf16 v[112:115], a[16:19], v[60:63], v[112:115]
v_cvt_pk_bf16_f32 v123, v94, v95
buffer_store_dwordx4 v[120:123], v8, s[8:11], s59 offen sc1
v_mfma_f32_16x16x32_bf16 v[116:119], a[144:147], v[60:63], v[116:119]
ds_read_b128 v[60:63], v18 offset:24576
s_waitcnt lgkmcnt(6)
v_mfma_f32_16x16x32_bf16 v[104:107], a[20:23], v[64:67], v[104:107]
v_cvt_pk_bf16_f32 v124, v96, v97
v_cvt_pk_bf16_f32 v125, v98, v99
v_mfma_f32_16x16x32_bf16 v[108:111], a[148:151], v[64:67], v[108:111]
v_cvt_pk_bf16_f32 v126, v100, v101
ds_read_b128 v[64:67], v18 offset:9216
s_add_u32 m0, s44, 4096
s_add_u32 s29, s54, 4096
v_mfma_f32_16x16x32_bf16 v[112:115], a[20:23], v[68:71], v[112:115]
buffer_load_dwordx4 v2, s[4:7], s29 offen offset:0 lds
v_mfma_f32_16x16x32_bf16 v[116:119], a[148:151], v[68:71], v[116:119]
ds_read_b128 v[68:71], v18 offset:25600
s_waitcnt lgkmcnt(6)
v_mfma_f32_16x16x32_bf16 v[104:107], a[24:27], v[72:75], v[104:107]
v_cvt_pk_bf16_f32 v127, v102, v103
buffer_store_dwordx4 v[124:127], v9, s[8:11], s59 offen sc1
v_mfma_f32_16x16x32_bf16 v[108:111], a[152:155], v[72:75], v[108:111]
s_lshr_b32 s59, s60, 8
ds_read_b128 v[72:75], v18 offset:10240
v_mfma_f32_16x16x32_bf16 v[112:115], a[24:27], v[76:79], v[112:115]
s_xor_b32 s59, s59, s30
s_and_b32 s59, s59, s23
v_mfma_f32_16x16x32_bf16 v[116:119], a[152:155], v[76:79], v[116:119]
ds_read_b128 v[76:79], v18 offset:26624
s_waitcnt lgkmcnt(6)
v_mfma_f32_16x16x32_bf16 v[104:107], a[28:31], v[80:83], v[104:107]
s_or_b32 s59, s59, s60
s_add_u32 s60, s60, s45
v_mfma_f32_16x16x32_bf16 v[108:111], a[156:159], v[80:83], v[108:111]
ds_read_b128 v[80:83], v18 offset:11264
v_mfma_f32_16x16x32_bf16 v[112:115], a[28:31], v[84:87], v[112:115]
buffer_load_dwordx4 v2, s[4:7], s29 offen offset:1024 lds
v_mfma_f32_16x16x32_bf16 v[116:119], a[156:159], v[84:87], v[116:119]
ds_read_b128 v[84:87], v18 offset:27648
s_waitcnt lgkmcnt(6)
v_mfma_f32_16x16x32_bf16 v[104:107], a[32:35], v[56:59], v[104:107]
v_mfma_f32_16x16x32_bf16 v[108:111], a[160:163], v[56:59], v[108:111]
ds_read_b128 v[56:59], v18 offset:12288
v_mfma_f32_16x16x32_bf16 v[112:115], a[32:35], v[60:63], v[112:115]
v_mfma_f32_16x16x32_bf16 v[116:119], a[160:163], v[60:63], v[116:119]
ds_read_b128 v[60:63], v18 offset:28672
s_waitcnt lgkmcnt(6)
v_mfma_f32_16x16x32_bf16 v[104:107], a[36:39], v[64:67], v[104:107]
v_mfma_f32_16x16x32_bf16 v[108:111], a[164:167], v[64:67], v[108:111]
ds_read_b128 v[64:67], v18 offset:13312
v_mfma_f32_16x16x32_bf16 v[112:115], a[36:39], v[68:71], v[112:115]
buffer_load_dwordx4 v2, s[4:7], s29 offen offset:2048 lds
v_mfma_f32_16x16x32_bf16 v[116:119], a[164:167], v[68:71], v[116:119]
ds_read_b128 v[68:71], v18 offset:29696
s_waitcnt lgkmcnt(6)
v_mfma_f32_16x16x32_bf16 v[104:107], a[40:43], v[72:75], v[104:107]
v_mfma_f32_16x16x32_bf16 v[108:111], a[168:171], v[72:75], v[108:111]
ds_read_b128 v[72:75], v18 offset:14336
v_mfma_f32_16x16x32_bf16 v[112:115], a[40:43], v[76:79], v[112:115]
v_mfma_f32_16x16x32_bf16 v[116:119], a[168:171], v[76:79], v[116:119]
ds_read_b128 v[76:79], v18 offset:30720
s_waitcnt lgkmcnt(6)
v_mfma_f32_16x16x32_bf16 v[104:107], a[44:47], v[80:83], v[104:107]
v_mfma_f32_16x16x32_bf16 v[108:111], a[172:175], v[80:83], v[108:111]
ds_read_b128 v[80:83], v18 offset:15360
v_mfma_f32_16x16x32_bf16 v[112:115], a[44:47], v[84:87], v[112:115]
buffer_load_dwordx4 v2, s[4:7], s29 offen offset:3072 lds
v_mfma_f32_16x16x32_bf16 v[116:119], a[172:175], v[84:87], v[116:119]
ds_read_b128 v[84:87], v18 offset:31744
s_waitcnt vmcnt(11)
s_barrier
s_waitcnt lgkmcnt(6)
v_mfma_f32_16x16x32_bf16 v[104:107], a[48:51], v[56:59], v[104:107]
v_mfma_f32_16x16x32_bf16 v[108:111], a[176:179], v[56:59], v[108:111]
ds_read_b128 v[56:59], v18 offset:32768
v_mfma_f32_16x16x32_bf16 v[112:115], a[48:51], v[60:63], v[112:115]
v_mfma_f32_16x16x32_bf16 v[116:119], a[176:179], v[60:63], v[116:119]
ds_read_b128 v[60:63], v18 offset:49152
s_waitcnt lgkmcnt(6)
v_mfma_f32_16x16x32_bf16 v[104:107], a[52:55], v[64:67], v[104:107]
v_mfma_f32_16x16x32_bf16 v[108:111], a[180:183], v[64:67], v[108:111]
ds_read_b128 v[64:67], v18 offset:33792
s_add_u32 m0, s44, 32768
s_add_u32 s29, s54, 32768
v_mfma_f32_16x16x32_bf16 v[112:115], a[52:55], v[68:71], v[112:115]
buffer_load_dwordx4 v2, s[4:7], s29 offen offset:0 lds
v_mfma_f32_16x16x32_bf16 v[116:119], a[180:183], v[68:71], v[116:119]
ds_read_b128 v[68:71], v18 offset:50176
s_waitcnt lgkmcnt(6)
v_mfma_f32_16x16x32_bf16 v[104:107], a[56:59], v[72:75], v[104:107]
v_mfma_f32_16x16x32_bf16 v[108:111], a[184:187], v[72:75], v[108:111]
ds_read_b128 v[72:75], v18 offset:34816
v_mfma_f32_16x16x32_bf16 v[112:115], a[56:59], v[76:79], v[112:115]
v_mfma_f32_16x16x32_bf16 v[116:119], a[184:187], v[76:79], v[116:119]
ds_read_b128 v[76:79], v18 offset:51200
s_waitcnt lgkmcnt(6)
v_mfma_f32_16x16x32_bf16 v[104:107], a[60:63], v[80:83], v[104:107]
v_mfma_f32_16x16x32_bf16 v[108:111], a[188:191], v[80:83], v[108:111]
ds_read_b128 v[80:83], v18 offset:35840
v_mfma_f32_16x16x32_bf16 v[112:115], a[60:63], v[84:87], v[112:115]
buffer_load_dwordx4 v2, s[4:7], s29 offen offset:1024 lds
v_mfma_f32_16x16x32_bf16 v[116:119], a[188:191], v[84:87], v[116:119]
ds_read_b128 v[84:87], v18 offset:52224
s_waitcnt lgkmcnt(6)
v_mfma_f32_16x16x32_bf16 v[104:107], a[64:67], v[56:59], v[104:107]
v_mfma_f32_16x16x32_bf16 v[108:111], a[192:195], v[56:59], v[108:111]
ds_read_b128 v[56:59], v18 offset:36864
v_mfma_f32_16x16x32_bf16 v[112:115], a[64:67], v[60:63], v[112:115]
v_mfma_f32_16x16x32_bf16 v[116:119], a[192:195], v[60:63], v[116:119]
ds_read_b128 v[60:63], v18 offset:53248
s_waitcnt lgkmcnt(6)
v_mfma_f32_16x16x32_bf16 v[104:107], a[68:71], v[64:67], v[104:107]
v_mfma_f32_16x16x32_bf16 v[108:111], a[196:199], v[64:67], v[108:111]
ds_read_b128 v[64:67], v18 offset:37888
v_mfma_f32_16x16x32_bf16 v[112:115], a[68:71], v[68:71], v[112:115]
buffer_load_dwordx4 v2, s[4:7], s29 offen offset:2048 lds
v_mfma_f32_16x16x32_bf16 v[116:119], a[196:199], v[68:71], v[116:119]
ds_read_b128 v[68:71], v18 offset:54272
s_waitcnt lgkmcnt(6)
v_mfma_f32_16x16x32_bf16 v[104:107], a[72:75], v[72:75], v[104:107]
s_add_u32 s52, s54, s56
s_xor_b32 s52, s52, s23
v_mfma_f32_16x16x32_bf16 v[108:111], a[200:203], v[72:75], v[108:111]
s_add_u32 s43, s55, s56
ds_read_b128 v[72:75], v18 offset:38912
v_mfma_f32_16x16x32_bf16 v[112:115], a[72:75], v[76:79], v[112:115]
s_xor_b32 s43, s43, s23
s_add_u32 s24, s38, 3
v_mfma_f32_16x16x32_bf16 v[116:119], a[200:203], v[76:79], v[116:119]
ds_read_b128 v[76:79], v18 offset:55296
s_waitcnt lgkmcnt(6)
v_mfma_f32_16x16x32_bf16 v[104:107], a[76:79], v[80:83], v[104:107]
s_cmp_ge_u32 s24, s51
s_cselect_b32 s52, 2147483648, s52
s_add_u32 s24, s38, 4
v_mfma_f32_16x16x32_bf16 v[108:111], a[204:207], v[80:83], v[108:111]
s_cmp_ge_u32 s24, s51
s_cselect_b32 s43, 2147483648, s43
ds_read_b128 v[80:83], v18 offset:39936
v_mfma_f32_16x16x32_bf16 v[112:115], a[76:79], v[84:87], v[112:115]
buffer_load_dwordx4 v2, s[4:7], s29 offen offset:3072 lds
v_mfma_f32_16x16x32_bf16 v[116:119], a[204:207], v[84:87], v[116:119]
ds_read_b128 v[84:87], v18 offset:56320
s_waitcnt lgkmcnt(6)
v_mfma_f32_16x16x32_bf16 v[104:107], a[80:83], v[56:59], v[104:107]
v_mfma_f32_16x16x32_bf16 v[108:111], a[208:211], v[56:59], v[108:111]
ds_read_b128 v[56:59], v18 offset:40960
v_mfma_f32_16x16x32_bf16 v[112:115], a[80:83], v[60:63], v[112:115]
v_mfma_f32_16x16x32_bf16 v[116:119], a[208:211], v[60:63], v[116:119]
ds_read_b128 v[60:63], v18 offset:57344
s_waitcnt lgkmcnt(6)
v_mfma_f32_16x16x32_bf16 v[104:107], a[84:87], v[64:67], v[104:107]
v_mfma_f32_16x16x32_bf16 v[108:111], a[212:215], v[64:67], v[108:111]
ds_read_b128 v[64:67], v18 offset:41984
s_add_u32 m0, s44, 36864
s_add_u32 s29, s54, 36864
v_mfma_f32_16x16x32_bf16 v[112:115], a[84:87], v[68:71], v[112:115]
buffer_load_dwordx4 v2, s[4:7], s29 offen offset:0 lds
v_mfma_f32_16x16x32_bf16 v[116:119], a[212:215], v[68:71], v[116:119]
ds_read_b128 v[68:71], v18 offset:58368
s_waitcnt lgkmcnt(6)
v_mfma_f32_16x16x32_bf16 v[104:107], a[88:91], v[72:75], v[104:107]
v_mfma_f32_16x16x32_bf16 v[108:111], a[216:219], v[72:75], v[108:111]
ds_read_b128 v[72:75], v18 offset:43008
v_mfma_f32_16x16x32_bf16 v[112:115], a[88:91], v[76:79], v[112:115]
v_mfma_f32_16x16x32_bf16 v[116:119], a[216:219], v[76:79], v[116:119]
ds_read_b128 v[76:79], v18 offset:59392
s_waitcnt lgkmcnt(6)
v_mfma_f32_16x16x32_bf16 v[104:107], a[92:95], v[80:83], v[104:107]
v_mfma_f32_16x16x32_bf16 v[108:111], a[220:223], v[80:83], v[108:111]
ds_read_b128 v[80:83], v18 offset:44032
v_mfma_f32_16x16x32_bf16 v[112:115], a[92:95], v[84:87], v[112:115]
buffer_load_dwordx4 v2, s[4:7], s29 offen offset:1024 lds
v_mfma_f32_16x16x32_bf16 v[116:119], a[220:223], v[84:87], v[116:119]
ds_read_b128 v[84:87], v18 offset:60416
s_waitcnt lgkmcnt(6)
v_mfma_f32_16x16x32_bf16 v[104:107], a[96:99], v[56:59], v[104:107]
v_mfma_f32_16x16x32_bf16 v[108:111], a[224:227], v[56:59], v[108:111]
ds_read_b128 v[56:59], v18 offset:45056
v_mfma_f32_16x16x32_bf16 v[112:115], a[96:99], v[60:63], v[112:115]
v_mfma_f32_16x16x32_bf16 v[116:119], a[224:227], v[60:63], v[116:119]
ds_read_b128 v[60:63], v18 offset:61440
s_waitcnt lgkmcnt(6)
v_mfma_f32_16x16x32_bf16 v[104:107], a[100:103], v[64:67], v[104:107]
v_mfma_f32_16x16x32_bf16 v[108:111], a[228:231], v[64:67], v[108:111]
ds_read_b128 v[64:67], v18 offset:46080
v_mfma_f32_16x16x32_bf16 v[112:115], a[100:103], v[68:71], v[112:115]
buffer_load_dwordx4 v2, s[4:7], s29 offen offset:2048 lds
v_mfma_f32_16x16x32_bf16 v[116:119], a[228:231], v[68:71], v[116:119]
ds_read_b128 v[68:71], v18 offset:62464
s_waitcnt lgkmcnt(6)
v_mfma_f32_16x16x32_bf16 v[104:107], a[104:107], v[72:75], v[104:107]
v_mfma_f32_16x16x32_bf16 v[108:111], a[232:235], v[72:75], v[108:111]
ds_read_b128 v[72:75], v18 offset:47104
v_mfma_f32_16x16x32_bf16 v[112:115], a[104:107], v[76:79], v[112:115]
v_mfma_f32_16x16x32_bf16 v[116:119], a[232:235], v[76:79], v[116:119]
ds_read_b128 v[76:79], v18 offset:63488
s_waitcnt lgkmcnt(6)
v_mfma_f32_16x16x32_bf16 v[104:107], a[108:111], v[80:83], v[104:107]
v_mfma_f32_16x16x32_bf16 v[108:111], a[236:239], v[80:83], v[108:111]
ds_read_b128 v[80:83], v18 offset:48128
v_mfma_f32_16x16x32_bf16 v[112:115], a[108:111], v[84:87], v[112:115]
buffer_load_dwordx4 v2, s[4:7], s29 offen offset:3072 lds
v_mfma_f32_16x16x32_bf16 v[116:119], a[236:239], v[84:87], v[116:119]
ds_read_b128 v[84:87], v18 offset:64512
s_waitcnt vmcnt(8)
s_barrier
s_waitcnt lgkmcnt(6)
v_mfma_f32_16x16x32_bf16 v[104:107], a[112:115], v[56:59], v[104:107]
s_add_u32 s38, s38, 1
v_mfma_f32_16x16x32_bf16 v[108:111], a[240:243], v[56:59], v[108:111]
ds_read_b128 v[56:59], v14 offset:0
v_mfma_f32_16x16x32_bf16 v[112:115], a[112:115], v[60:63], v[112:115]
v_mfma_f32_16x16x32_bf16 v[116:119], a[240:243], v[60:63], v[116:119]
ds_read_b128 v[60:63], v14 offset:16384
s_waitcnt lgkmcnt(6)
v_mfma_f32_16x16x32_bf16 v[104:107], a[116:119], v[64:67], v[104:107]
buffer_load_dwordx4 v[144:147], v208, s[4:7], s35 offen
buffer_load_dwordx4 v[148:151], v209, s[4:7], s35 offen
v_mfma_f32_16x16x32_bf16 v[108:111], a[244:247], v[64:67], v[108:111]
buffer_load_dwordx4 v[152:155], v210, s[4:7], s35 offen
ds_read_b128 v[64:67], v14 offset:1024
s_add_u32 m0, s44, 65536
s_add_u32 s29, s55, 0
v_mfma_f32_16x16x32_bf16 v[112:115], a[116:119], v[68:71], v[112:115]
buffer_load_dwordx4 v2, s[4:7], s29 offen offset:0 lds
v_mfma_f32_16x16x32_bf16 v[116:119], a[244:247], v[68:71], v[116:119]
ds_read_b128 v[68:71], v14 offset:17408
s_waitcnt lgkmcnt(6)
v_mfma_f32_16x16x32_bf16 v[104:107], a[120:123], v[72:75], v[104:107]
buffer_load_dwordx4 v[156:159], v211, s[4:7], s35 offen
s_mov_b32 s39, s36
v_mfma_f32_16x16x32_bf16 v[108:111], a[248:251], v[72:75], v[108:111]
s_mov_b32 s35, s57
ds_read_b128 v[72:75], v14 offset:2048
v_mfma_f32_16x16x32_bf16 v[112:115], a[120:123], v[76:79], v[112:115]
s_mov_b32 s36, s58
s_add_u32 s57, s57, 2097152
v_mfma_f32_16x16x32_bf16 v[116:119], a[248:251], v[76:79], v[116:119]
ds_read_b128 v[76:79], v14 offset:18432
s_waitcnt lgkmcnt(6)
v_mfma_f32_16x16x32_bf16 v[104:107], a[124:127], v[80:83], v[104:107]
s_xor_b32 s57, s57, s23
s_add_u32 s58, s58, 524288
v_mfma_f32_16x16x32_bf16 v[108:111], a[252:255], v[80:83], v[108:111]
ds_read_b128 v[80:83], v14 offset:3072
v_mfma_f32_16x16x32_bf16 v[112:115], a[124:127], v[84:87], v[112:115]
buffer_load_dwordx4 v2, s[4:7], s29 offen offset:1024 lds
v_mfma_f32_16x16x32_bf16 v[116:119], a[252:255], v[84:87], v[116:119]
ds_read_b128 v[84:87], v14 offset:19456
s_mov_b32 s53, s55
s_mov_b32 s54, s52
s_mov_b32 s55, s43
s_cmp_lg_u32 s38, s51
s_cbranch_scc1 L_fgl3
L_fgx:
s_waitcnt lgkmcnt(0)
s_nop 7
v_cvt_pk_bf16_f32 v120, v104, v105
v_cvt_pk_bf16_f32 v121, v106, v107
v_cvt_pk_bf16_f32 v122, v108, v109
v_cvt_pk_bf16_f32 v123, v110, v111
buffer_store_dwordx4 v[120:123], v8, s[8:11], s59 offen sc1
v_cvt_pk_bf16_f32 v124, v112, v113
v_cvt_pk_bf16_f32 v125, v114, v115
v_cvt_pk_bf16_f32 v126, v116, v117
v_cvt_pk_bf16_f32 v127, v118, v119
buffer_store_dwordx4 v[124:127], v9, s[8:11], s59 offen sc1
s_lshr_b32 s59, s60, 8
s_xor_b32 s59, s59, s30
s_and_b32 s59, s59, s23
s_or_b32 s59, s59, s60
s_add_u32 s60, s60, s45
s_waitcnt vmcnt(2)
v_lshlrev_b32 v196, 16, v144
v_and_b32 v197, 0xffff0000, v144
v_lshlrev_b32 v192, 16, v148
v_and_b32 v193, 0xffff0000, v148
v_pk_add_f32 v[196:197], v[196:197], v[192:193]
v_lshlrev_b32 v192, 16, v152
v_and_b32 v193, 0xffff0000, v152
v_pk_add_f32 v[196:197], v[196:197], v[192:193]
v_lshlrev_b32 v192, 16, v156
v_and_b32 v193, 0xffff0000, v156
v_pk_add_f32 v[196:197], v[196:197], v[192:193]
v_cvt_pk_bf16_f32 v204, v196, v197
v_lshlrev_b32 v198, 16, v145
v_and_b32 v199, 0xffff0000, v145
v_lshlrev_b32 v192, 16, v149
v_and_b32 v193, 0xffff0000, v149
v_pk_add_f32 v[198:199], v[198:199], v[192:193]
v_lshlrev_b32 v192, 16, v153
v_and_b32 v193, 0xffff0000, v153
v_pk_add_f32 v[198:199], v[198:199], v[192:193]
v_lshlrev_b32 v192, 16, v157
v_and_b32 v193, 0xffff0000, v157
v_pk_add_f32 v[198:199], v[198:199], v[192:193]
v_cvt_pk_bf16_f32 v205, v198, v199
v_lshlrev_b32 v200, 16, v146
v_and_b32 v201, 0xffff0000, v146
v_lshlrev_b32 v192, 16, v150
v_and_b32 v193, 0xffff0000, v150
v_pk_add_f32 v[200:201], v[200:201], v[192:193]
v_lshlrev_b32 v192, 16, v154
v_and_b32 v193, 0xffff0000, v154
v_pk_add_f32 v[200:201], v[200:201], v[192:193]
v_lshlrev_b32 v192, 16, v158
v_and_b32 v193, 0xffff0000, v158
v_pk_add_f32 v[200:201], v[200:201], v[192:193]
v_cvt_pk_bf16_f32 v206, v200, v201
v_lshlrev_b32 v202, 16, v147
v_and_b32 v203, 0xffff0000, v147
v_lshlrev_b32 v192, 16, v151
v_and_b32 v193, 0xffff0000, v151
v_pk_add_f32 v[202:203], v[202:203], v[192:193]
v_lshlrev_b32 v192, 16, v155
v_and_b32 v193, 0xffff0000, v155
v_pk_add_f32 v[202:203], v[202:203], v[192:193]
v_lshlrev_b32 v192, 16, v159
v_and_b32 v193, 0xffff0000, v159
v_pk_add_f32 v[202:203], v[202:203], v[192:193]
v_cvt_pk_bf16_f32 v207, v202, v203
buffer_store_dwordx4 v[204:207], v212, s[16:19], s39 offen sc1
s_waitcnt vmcnt(1)
s_branch L_fgx1
L_fgx0:
s_waitcnt lgkmcnt(0)
s_nop 7
v_cvt_pk_bf16_f32 v120, v88, v89
v_cvt_pk_bf16_f32 v121, v90, v91
v_cvt_pk_bf16_f32 v122, v92, v93
v_cvt_pk_bf16_f32 v123, v94, v95
buffer_store_dwordx4 v[120:123], v8, s[8:11], s59 offen sc1
v_cvt_pk_bf16_f32 v124, v96, v97
v_cvt_pk_bf16_f32 v125, v98, v99
v_cvt_pk_bf16_f32 v126, v100, v101
v_cvt_pk_bf16_f32 v127, v102, v103
buffer_store_dwordx4 v[124:127], v9, s[8:11], s59 offen sc1
s_lshr_b32 s59, s60, 8
s_xor_b32 s59, s59, s30
s_and_b32 s59, s59, s23
s_or_b32 s59, s59, s60
s_add_u32 s60, s60, s45
s_waitcnt vmcnt(0)
L_fgx1:
s_barrier
v_mov_b32 v24, s38
buffer_store_dword v24, v23, s[4:7], 0 offen sc1
s_cmp_eq_u32 s49, 4
s_cbranch_scc1 L_fgdone
v_mov_b32 v5, s51
v_mov_b32 v6, -2
v_lshrrev_b32 v7, 5, v0
v_cmp_eq_u32 vcc, 1, v7
s_nop 1
v_cndmask_b32 v10, v6, v5, vcc
s_cmp_ge_u32 s49, 2
s_cselect_b32 s57, 2147483648, s57
s_cselect_b32 s58, 2147483648, s58
s_branch L_fgw1_go
L_fgw1:
s_sleep 2
L_fgw1_go:
buffer_load_dword v12, v27, s[4:7], 0 offen sc1
s_sub_u32 s28, s28, 1
s_cbranch_scc1 L_end
s_waitcnt vmcnt(0)
v_cmp_gt_i32 vcc, v10, v12
s_cbranch_vccnz L_fgw1
s_barrier
buffer_load_dwordx4 v[160:163], v208, s[4:7], s35 offen
buffer_load_dwordx4 v[164:167], v209, s[4:7], s35 offen
buffer_load_dwordx4 v[168:171], v210, s[4:7], s35 offen
buffer_load_dwordx4 v[172:175], v211, s[4:7], s35 offen
s_mov_b32 s40, s36
s_mov_b32 s35, s57
s_mov_b32 s36, s58
s_add_u32 s57, s57, 2097152
s_xor_b32 s57, s57, s23
s_add_u32 s58, s58, 524288
buffer_load_dwordx4 v[176:179], v208, s[4:7], s35 offen
buffer_load_dwordx4 v[180:183], v209, s[4:7], s35 offen
buffer_load_dwordx4 v[184:187], v210, s[4:7], s35 offen
buffer_load_dwordx4 v[188:191], v211, s[4:7], s35 offen
s_mov_b32 s47, s36
s_mov_b32 s35, s57
s_mov_b32 s36, s58
s_add_u32 s57, s57, 2097152
s_xor_b32 s57, s57, s23
s_add_u32 s58, s58, 524288
s_waitcnt vmcnt(4)
v_lshlrev_b32 v196, 16, v160
v_and_b32 v197, 0xffff0000, v160
v_lshlrev_b32 v192, 16, v164
v_and_b32 v193, 0xffff0000, v164
v_pk_add_f32 v[196:197], v[196:197], v[192:193]
v_lshlrev_b32 v192, 16, v168
v_and_b32 v193, 0xffff0000, v168
v_pk_add_f32 v[196:197], v[196:197], v[192:193]
v_lshlrev_b32 v192, 16, v172
v_and_b32 v193, 0xffff0000, v172
v_pk_add_f32 v[196:197], v[196:197], v[192:193]
v_cvt_pk_bf16_f32 v204, v196, v197
v_lshlrev_b32 v198, 16, v161
v_and_b32 v199, 0xffff0000, v161
v_lshlrev_b32 v192, 16, v165
v_and_b32 v193, 0xffff0000, v165
v_pk_add_f32 v[198:199], v[198:199], v[192:193]
v_lshlrev_b32 v192, 16, v169
v_and_b32 v193, 0xffff0000, v169
v_pk_add_f32 v[198:199], v[198:199], v[192:193]
v_lshlrev_b32 v192, 16, v173
v_and_b32 v193, 0xffff0000, v173
v_pk_add_f32 v[198:199], v[198:199], v[192:193]
v_cvt_pk_bf16_f32 v205, v198, v199
v_lshlrev_b32 v200, 16, v162
v_and_b32 v201, 0xffff0000, v162
v_lshlrev_b32 v192, 16, v166
v_and_b32 v193, 0xffff0000, v166
v_pk_add_f32 v[200:201], v[200:201], v[192:193]
v_lshlrev_b32 v192, 16, v170
v_and_b32 v193, 0xffff0000, v170
v_pk_add_f32 v[200:201], v[200:201], v[192:193]
v_lshlrev_b32 v192, 16, v174
v_and_b32 v193, 0xffff0000, v174
v_pk_add_f32 v[200:201], v[200:201], v[192:193]
v_cvt_pk_bf16_f32 v206, v200, v201
v_lshlrev_b32 v202, 16, v163
v_and_b32 v203, 0xffff0000, v163
v_lshlrev_b32 v192, 16, v167
v_and_b32 v193, 0xffff0000, v167
v_pk_add_f32 v[202:203], v[202:203], v[192:193]
v_lshlrev_b32 v192, 16, v171
v_and_b32 v193, 0xffff0000, v171
v_pk_add_f32 v[202:203], v[202:203], v[192:193]
v_lshlrev_b32 v192, 16, v175
v_and_b32 v193, 0xffff0000, v175
v_pk_add_f32 v[202:203], v[202:203], v[192:193]
v_cvt_pk_bf16_f32 v207, v202, v203
buffer_store_dwordx4 v[204:207], v212, s[16:19], s40 offen sc1
s_waitcnt vmcnt(1)
v_lshlrev_b32 v196, 16, v176
v_and_b32 v197, 0xffff0000, v176
v_lshlrev_b32 v192, 16, v180
v_and_b32 v193, 0xffff0000, v180
v_pk_add_f32 v[196:197], v[196:197], v[192:193]
v_lshlrev_b32 v192, 16, v184
v_and_b32 v193, 0xffff0000, v184
v_pk_add_f32 v[196:197], v[196:197], v[192:193]
v_lshlrev_b32 v192, 16, v188
v_and_b32 v193, 0xffff0000, v188
v_pk_add_f32 v[196:197], v[196:197], v[192:193]
v_cvt_pk_bf16_f32 v204, v196, v197
v_lshlrev_b32 v198, 16, v177
v_and_b32 v199, 0xffff0000, v177
v_lshlrev_b32 v192, 16, v181
v_and_b32 v193, 0xffff0000, v181
v_pk_add_f32 v[198:199], v[198:199], v[192:193]
v_lshlrev_b32 v192, 16, v185
v_and_b32 v193, 0xffff0000, v185
v_pk_add_f32 v[198:199], v[198:199], v[192:193]
v_lshlrev_b32 v192, 16, v189
v_and_b32 v193, 0xffff0000, v189
v_pk_add_f32 v[198:199], v[198:199], v[192:193]
v_cvt_pk_bf16_f32 v205, v198, v199
v_lshlrev_b32 v200, 16, v178
v_and_b32 v201, 0xffff0000, v178
v_lshlrev_b32 v192, 16, v182
v_and_b32 v193, 0xffff0000, v182
v_pk_add_f32 v[200:201], v[200:201], v[192:193]
v_lshlrev_b32 v192, 16, v186
v_and_b32 v193, 0xffff0000, v186
v_pk_add_f32 v[200:201], v[200:201], v[192:193]
v_lshlrev_b32 v192, 16, v190
v_and_b32 v193, 0xffff0000, v190
v_pk_add_f32 v[200:201], v[200:201], v[192:193]
v_cvt_pk_bf16_f32 v206, v200, v201
v_lshlrev_b32 v202, 16, v179
v_and_b32 v203, 0xffff0000, v179
v_lshlrev_b32 v192, 16, v183
v_and_b32 v193, 0xffff0000, v183
v_pk_add_f32 v[202:203], v[202:203], v[192:193]
v_lshlrev_b32 v192, 16, v187
v_and_b32 v193, 0xffff0000, v187
v_pk_add_f32 v[202:203], v[202:203], v[192:193]
v_lshlrev_b32 v192, 16, v191
v_and_b32 v193, 0xffff0000, v191
v_pk_add_f32 v[202:203], v[202:203], v[192:193]
v_cvt_pk_bf16_f32 v207, v202, v203
buffer_store_dwordx4 v[204:207], v212, s[16:19], s47 offen sc1
L_fgdone:
s_branch L_end
L_fgs1:
s_sleep 16
L_fgs1_go:
buffer_load_dword v12, v27, s[4:7], 0 offen sc1
s_sub_u32 s28, s28, 1
s_cbranch_scc1 L_end
s_waitcnt vmcnt(0)
v_cmp_gt_i32 vcc, v10, v12
s_cbranch_vccnz L_fgs1
s_branch L_fgb1
L_fgs3:
s_sleep 16
L_fgs3_go:
buffer_load_dword v12, v27, s[4:7], 0 offen sc1
s_sub_u32 s28, s28, 1
s_cbranch_scc1 L_end
s_waitcnt vmcnt(0)
v_cmp_gt_i32 vcc, v10, v12
s_cbranch_vccnz L_fgs3
s_branch L_fgb3
L_b2role:
s_and_b32 s48, s32, 7
s_lshl_b32 s48, s48, 2
s_add_u32 s48, s48, s20
s_and_b32 s49, s48, 7
s_lshl_b32 s49, s49, 21
s_lshr_b32 s50, s48, 3
s_mul_i32 s50, s50, 328704
s_add_u32 s49, s49, s50
s_add_u32 s49, s49, 142606336
s_and_b32 s55, s48, 1
s_mov_b32 s50, -1
s_mov_b32 s51, -1
s_mov_b32 s52, 0
v_mov_b32 v5, 0
v_mov_b32 v6, -1
s_mov_b64 exec, 1
s_mov_b32 s46, -1
s_mov_b32 s47, -1
L_cal:
s_add_u32 s53, s49, 0
s_memtime s[60:61]
s_waitcnt lgkmcnt(0)
buffer_store_dword v6, v5, s[4:7], s53 offen sc1
s_waitcnt vmcnt(0)
s_memtime s[56:57]
s_waitcnt lgkmcnt(0)
buffer_load_dword v7, v5, s[4:7], s53 offen sc1
s_waitcnt vmcnt(0)
s_memtime s[58:59]
s_waitcnt lgkmcnt(0)
s_sub_u32 s58, s58, s56
s_min_u32 s50, s50, s58
s_sub_u32 s56, s56, s60
s_min_u32 s46, s46, s56
s_add_u32 s53, s49, 8192
s_memtime s[60:61]
s_waitcnt lgkmcnt(0)
buffer_store_dword v6, v5, s[4:7], s53 offen sc1
s_waitcnt vmcnt(0)
s_memtime s[56:57]
s_waitcnt lgkmcnt(0)
buffer_load_dword v7, v5, s[4:7], s53 offen sc1
s_waitcnt vmcnt(0)
s_memtime s[58:59]
s_waitcnt lgkmcnt(0)
s_sub_u32 s58, s58, s56
s_min_u32 s51, s51, s58
s_sub_u32 s56, s56, s60
s_min_u32 s47, s47, s56
s_add_u32 s49, s49, 49280
s_add_u32 s52, s52, 1
s_cmp_lt_u32 s52, 4
s_cbranch_scc1 L_cal
s_add_u32 s50, s50, s46
s_add_u32 s51, s51, s47
s_mov_b64 exec, -1
s_cmp_lt_u32 s51, s50
s_cselect_b32 s50, 1, 0
s_lshr_b32 s51, s3, 2
s_xor_b32 s50, s50, s51
s_xor_b32 s50, s50, s55
s_cmp_lg_u32 s22, 0
s_cbranch_scc1 L_conf_ok_t
v_lshlrev_b32 v5, 2, v1
s_branch L_conf_go_t
L_conf_poll_t:
s_sleep 8
L_conf_go_t:
buffer_load_dword v6, v5, s[8:11], 0 offen sc1
s_sub_u32 s28, s28, 1
s_cbranch_scc1 L_end
s_waitcnt vmcnt(0) lgkmcnt(0)
L_conf_ev_t:
v_bcnt_u32_b32 v7, v6, 0
v_cmp_ne_u32 vcc, 4, v7
s_cbranch_vccnz L_conf_poll_t
v_lshrrev_b32 v7, 16, v6
v_or_b32 v7, v7, v6
v_lshrrev_b32 v5, 8, v7
v_or_b32 v7, v7, v5
v_and_b32 v7, 0xff, v7
s_nop 1
v_or_b32_dpp v7, v7, v7 quad_perm:[1,0,3,2] row_mask:0xf bank_mask:0xf
s_mov_b32 s22, 1
v_cmp_ne_u32 vcc, 0xff, v7
s_cbranch_vccnz L_respec
L_conf_ok_t:
s_lshl_b32 s49, s48, 2
s_add_u32 s49, s49, 49664
v_mov_b32 v5, 0
v_mov_b32 v6, s50
s_mov_b64 exec, 1
buffer_store_dword v6, v5, s[4:7], s49 offen sc1
s_mov_b64 exec, -1
L_b2go:
v_lshrrev_b32 v5, 2, v4
v_sub_u32 v5, v5, v3
v_lshlrev_b32 v5, 3, v5
v_and_b32 v6, 3, v4
v_add_u32 v44, v5, v6
v_add_u32 v45, 4, v44
v_mov_b32 v46, 0xf149f2ca
v_mov_b32 v52, 0x3f803f80
v_mov_b32 v53, 0x3f803f80
v_mov_b32 v54, 0x3f803f80
v_mov_b32 v55, 0x3f803f80
v_cmp_le_i32 s[64:65], 0, v44
v_cmp_le_i32 s[66:67], 1, v44
v_cmp_le_i32 s[68:69], 2, v44
v_cmp_le_i32 s[70:71], 3, v44
v_cmp_le_i32 s[72:73], 4, v44
v_cmp_le_i32 s[74:75], 5, v44
v_cmp_le_i32 s[76:77], 6, v44
v_cmp_le_i32 s[78:79], 7, v44
v_cmp_le_i32 s[80:81], 0, v45
v_cmp_le_i32 s[82:83], 1, v45
v_cmp_le_i32 s[84:85], 2, v45
v_cmp_le_i32 s[86:87], 3, v45
v_cmp_le_i32 s[88:89], 4, v45
v_cmp_le_i32 s[90:91], 5, v45
v_cmp_le_i32 s[92:93], 6, v45
v_cmp_le_i32 s[94:95], 7, v45
s_and_b32 s48, s32, 7
s_lshl_b32 s48, s48, 2
s_add_u32 s48, s48, s20
s_mov_b32 s27, 0x3e8293ee
s_lshl_b32 s24, s48, 11
s_add_u32 s24, s24, 159383552
v_add_u32 v22, s24, v2
s_lshr_b32 s24, s48, 3
s_lshl_b32 s24, s24, 14
s_and_b32 s25, s48, 7
s_lshl_b32 s25, s25, 10
s_add_u32 s24, s24, s25
s_add_u32 s24, s24, 171966464
v_add_u32 v23, s24, v2
v_min_u32 v5, 2, v1
v_lshlrev_b32 v5, 11, v5
s_add_u32 s24, s48, 384
s_lshl_b32 s24, s24, 6
v_add_u32 v27, s24, v5
s_sub_u32 s24, s32, 96
s_lshr_b32 s24, s24, 3
s_mul_i32 s24, s24, 7
s_add_u32 s49, s24, 42
s_add_u32 s53, s49, 7
s_cmp_ge_u32 s32, 120
s_cselect_b32 s49, -1, s49
s_cselect_b32 s53, 42, s53
s_cselect_b32 s50, 6, 0
s_mov_b32 s51, 0
s_add_u32 s52, s49, 1
s_lshl_b32 s52, s52, 16
v_mov_b32 v5, 0xffff
v_mov_b32 v6, 0xffff0000
v_cndmask_b32 v10, 0, v5, s[64:65]
v_cndmask_b32 v7, 0, v6, s[66:67]
v_or_b32 v10, v10, v7
v_cndmask_b32 v11, 0, v5, s[68:69]
v_cndmask_b32 v7, 0, v6, s[70:71]
v_or_b32 v11, v11, v7
v_cndmask_b32 v12, 0, v5, s[72:73]
v_cndmask_b32 v7, 0, v6, s[74:75]
v_or_b32 v12, v12, v7
v_cndmask_b32 v13, 0, v5, s[76:77]
v_cndmask_b32 v7, 0, v6, s[78:79]
v_or_b32 v13, v13, v7
v_cndmask_b32 v14, 0, v5, s[80:81]
v_cndmask_b32 v7, 0, v6, s[82:83]
v_or_b32 v14, v14, v7
v_cndmask_b32 v15, 0, v5, s[84:85]
v_cndmask_b32 v7, 0, v6, s[86:87]
v_or_b32 v15, v15, v7
v_cndmask_b32 v16, 0, v5, s[88:89]
v_cndmask_b32 v7, 0, v6, s[90:91]
v_or_b32 v16, v16, v7
v_cndmask_b32 v17, 0, v5, s[92:93]
v_cndmask_b32 v7, 0, v6, s[94:95]
v_or_b32 v17, v17, v7
v_accvgpr_write_b32 a0, 0
v_accvgpr_write_b32 a1, 0
v_accvgpr_write_b32 a2, 0
v_accvgpr_write_b32 a3, 0
v_accvgpr_write_b32 a4, 0
v_accvgpr_write_b32 a5, 0
v_accvgpr_write_b32 a6, 0
v_accvgpr_write_b32 a7, 0
v_accvgpr_write_b32 a8, 0
v_accvgpr_write_b32 a9, 0
v_accvgpr_write_b32 a10, 0
v_accvgpr_write_b32 a11, 0
v_accvgpr_write_b32 a12, 0
v_accvgpr_write_b32 a13, 0
v_accvgpr_write_b32 a14, 0
v_accvgpr_write_b32 a15, 0
v_accvgpr_write_b32 a16, 0
v_accvgpr_write_b32 a17, 0
v_accvgpr_write_b32 a18, 0
v_accvgpr_write_b32 a19, 0
v_accvgpr_write_b32 a20, 0
v_accvgpr_write_b32 a21, 0
v_accvgpr_write_b32 a22, 0
v_accvgpr_write_b32 a23, 0
v_accvgpr_write_b32 a24, 0
v_accvgpr_write_b32 a25, 0
v_accvgpr_write_b32 a26, 0
v_accvgpr_write_b32 a27, 0
v_accvgpr_write_b32 a28, 0
v_accvgpr_write_b32 a29, 0
v_accvgpr_write_b32 a30, 0
v_accvgpr_write_b32 a31, 0
v_accvgpr_write_b32 a32, 0
v_accvgpr_write_b32 a33, 0
v_accvgpr_write_b32 a34, 0
v_accvgpr_write_b32 a35, 0
v_accvgpr_write_b32 a36, 0
v_accvgpr_write_b32 a37, 0
v_accvgpr_write_b32 a38, 0
v_accvgpr_write_b32 a39, 0
v_accvgpr_write_b32 a40, 0
v_accvgpr_write_b32 a41, 0
v_accvgpr_write_b32 a42, 0
v_accvgpr_write_b32 a43, 0
v_accvgpr_write_b32 a44, 0
v_accvgpr_write_b32 a45, 0
v_accvgpr_write_b32 a46, 0
v_accvgpr_write_b32 a47, 0
v_accvgpr_write_b32 a48, 0
v_accvgpr_write_b32 a49, 0
v_accvgpr_write_b32 a50, 0
v_accvgpr_write_b32 a51, 0
v_accvgpr_write_b32 a52, 0
v_accvgpr_write_b32 a53, 0
v_accvgpr_write_b32 a54, 0
v_accvgpr_write_b32 a55, 0
v_accvgpr_write_b32 a56, 0
v_accvgpr_write_b32 a57, 0
v_accvgpr_write_b32 a58, 0
v_accvgpr_write_b32 a59, 0
v_accvgpr_write_b32 a60, 0
v_accvgpr_write_b32 a61, 0
v_accvgpr_write_b32 a62, 0
v_accvgpr_write_b32 a63, 0
v_accvgpr_write_b32 a64, 0
v_accvgpr_write_b32 a65, 0
v_accvgpr_write_b32 a66, 0
v_accvgpr_write_b32 a67, 0
v_accvgpr_write_b32 a68, 0
v_accvgpr_write_b32 a69, 0
v_accvgpr_write_b32 a70, 0
v_accvgpr_write_b32 a71, 0
v_accvgpr_write_b32 a72, 0
v_accvgpr_write_b32 a73, 0
v_accvgpr_write_b32 a74, 0
v_accvgpr_write_b32 a75, 0
v_accvgpr_write_b32 a76, 0
v_accvgpr_write_b32 a77, 0
v_accvgpr_write_b32 a78, 0
v_accvgpr_write_b32 a79, 0
v_accvgpr_write_b32 a80, 0
v_accvgpr_write_b32 a81, 0
v_accvgpr_write_b32 a82, 0
v_accvgpr_write_b32 a83, 0
v_accvgpr_write_b32 a84, 0
v_accvgpr_write_b32 a85, 0
v_accvgpr_write_b32 a86, 0
v_accvgpr_write_b32 a87, 0
v_accvgpr_write_b32 a88, 0
v_accvgpr_write_b32 a89, 0
v_accvgpr_write_b32 a90, 0
v_accvgpr_write_b32 a91, 0
v_accvgpr_write_b32 a92, 0
v_accvgpr_write_b32 a93, 0
v_accvgpr_write_b32 a94, 0
v_accvgpr_write_b32 a95, 0
v_accvgpr_write_b32 a96, 0
v_accvgpr_write_b32 a97, 0
v_accvgpr_write_b32 a98, 0
v_accvgpr_write_b32 a99, 0
v_accvgpr_write_b32 a100, 0
v_accvgpr_write_b32 a101, 0
v_accvgpr_write_b32 a102, 0
v_accvgpr_write_b32 a103, 0
v_accvgpr_write_b32 a104, 0
v_accvgpr_write_b32 a105, 0
v_accvgpr_write_b32 a106, 0
v_accvgpr_write_b32 a107, 0
v_accvgpr_write_b32 a108, 0
v_accvgpr_write_b32 a109, 0
v_accvgpr_write_b32 a110, 0
v_accvgpr_write_b32 a111, 0
v_accvgpr_write_b32 a112, 0
v_accvgpr_write_b32 a113, 0
v_accvgpr_write_b32 a114, 0
v_accvgpr_write_b32 a115, 0
v_accvgpr_write_b32 a116, 0
v_accvgpr_write_b32 a117, 0
v_accvgpr_write_b32 a118, 0
v_accvgpr_write_b32 a119, 0
v_accvgpr_write_b32 a120, 0
v_accvgpr_write_b32 a121, 0
v_accvgpr_write_b32 a122, 0
v_accvgpr_write_b32 a123, 0
v_accvgpr_write_b32 a124, 0
v_accvgpr_write_b32 a125, 0
v_accvgpr_write_b32 a126, 0
v_accvgpr_write_b32 a127, 0
v_accvgpr_write_b32 a128, 0
v_accvgpr_write_b32 a129, 0
v_accvgpr_write_b32 a130, 0
v_accvgpr_write_b32 a131, 0
v_accvgpr_write_b32 a132, 0
v_accvgpr_write_b32 a133, 0
v_accvgpr_write_b32 a134, 0
v_accvgpr_write_b32 a135, 0
v_accvgpr_write_b32 a136, 0
v_accvgpr_write_b32 a137, 0
v_accvgpr_write_b32 a138, 0
v_accvgpr_write_b32 a139, 0
v_accvgpr_write_b32 a140, 0
v_accvgpr_write_b32 a141, 0
v_accvgpr_write_b32 a142, 0
v_accvgpr_write_b32 a143, 0
v_accvgpr_write_b32 a144, 0
v_accvgpr_write_b32 a145, 0
v_accvgpr_write_b32 a146, 0
v_accvgpr_write_b32 a147, 0
v_accvgpr_write_b32 a148, 0
v_accvgpr_write_b32 a149, 0
v_accvgpr_write_b32 a150, 0
v_accvgpr_write_b32 a151, 0
v_accvgpr_write_b32 a152, 0
v_accvgpr_write_b32 a153, 0
v_accvgpr_write_b32 a154, 0
v_accvgpr_write_b32 a155, 0
v_accvgpr_write_b32 a156, 0
v_accvgpr_write_b32 a157, 0
v_accvgpr_write_b32 a158, 0
v_accvgpr_write_b32 a159, 0
s_add_u32 s26, s49, 2
s_min_i32 s26, s26, 64
s_cmp_ge_i32 s51, s26
s_cbranch_scc1 L_bf_okp
s_branch L_bf_gop
L_bfp:
s_sleep 16
L_bf_gop:
buffer_load_dword v40, v27, s[4:7], 0 offen sc1
s_sub_u32 s28, s28, 1
s_cbranch_scc1 L_end
s_waitcnt vmcnt(0)
v_readlane_b32 s24, v40, 0
v_readlane_b32 s25, v40, 1
v_readlane_b32 s51, v40, 2
s_nop 0
s_min_i32 s51, s51, s24
s_min_i32 s51, s51, s25
s_cmp_ge_i32 s51, s26
s_cbranch_scc0 L_bfp
L_bf_okp:
s_sub_u32 s26, s26, 1
s_lshl_b32 s26, s26, 16
s_add_u32 s24, s26, 4194304
s_add_u32 s25, s26, 8388608
buffer_load_dwordx4 v[64:67], v22, s[4:7], s26 offen offset:0
buffer_load_dwordx4 v[68:71], v22, s[4:7], s26 offen offset:1024
buffer_load_dwordx4 a[144:147], v22, s[4:7], s24 offen offset:0
buffer_load_dwordx4 a[148:151], v22, s[4:7], s24 offen offset:1024
buffer_load_dwordx4 a[152:155], v22, s[4:7], s25 offen offset:0
buffer_load_dwordx4 a[156:159], v22, s[4:7], s25 offen offset:1024
s_cmp_ge_u32 s32, 120
s_cbranch_scc1 L_b2w
s_add_u32 s24, s52, 3670016
s_add_u32 s25, s24, 4194304
buffer_load_dwordx4 a[0:3], v22, s[4:7], s24 offen offset:0
buffer_load_dwordx4 a[4:7], v22, s[4:7], s24 offen offset:1024
buffer_load_dwordx4 a[8:11], v22, s[4:7], s25 offen offset:0
buffer_load_dwordx4 a[12:15], v22, s[4:7], s25 offen offset:1024
s_add_u32 s24, s52, 3735552
s_add_u32 s25, s24, 4194304
buffer_load_dwordx4 a[16:19], v22, s[4:7], s24 offen offset:0
buffer_load_dwordx4 a[20:23], v22, s[4:7], s24 offen offset:1024
buffer_load_dwordx4 a[24:27], v22, s[4:7], s25 offen offset:0
buffer_load_dwordx4 a[28:31], v22, s[4:7], s25 offen offset:1024
s_add_u32 s24, s52, 3801088
s_add_u32 s25, s24, 4194304
buffer_load_dwordx4 a[32:35], v22, s[4:7], s24 offen offset:0
buffer_load_dwordx4 a[36:39], v22, s[4:7], s24 offen offset:1024
buffer_load_dwordx4 a[40:43], v22, s[4:7], s25 offen offset:0
buffer_load_dwordx4 a[44:47], v22, s[4:7], s25 offen offset:1024
s_add_u32 s24, s52, 3866624
s_add_u32 s25, s24, 4194304
buffer_load_dwordx4 a[48:51], v22, s[4:7], s24 offen offset:0
buffer_load_dwordx4 a[52:55], v22, s[4:7], s24 offen offset:1024
buffer_load_dwordx4 a[56:59], v22, s[4:7], s25 offen offset:0
buffer_load_dwordx4 a[60:63], v22, s[4:7], s25 offen offset:1024
s_add_u32 s24, s52, 3932160
s_add_u32 s25, s24, 4194304
buffer_load_dwordx4 a[64:67], v22, s[4:7], s24 offen offset:0
buffer_load_dwordx4 a[68:71], v22, s[4:7], s24 offen offset:1024
buffer_load_dwordx4 a[72:75], v22, s[4:7], s25 offen offset:0
buffer_load_dwordx4 a[76:79], v22, s[4:7], s25 offen offset:1024
s_add_u32 s24, s52, 3997696
s_add_u32 s25, s24, 4194304
buffer_load_dwordx4 a[80:83], v22, s[4:7], s24 offen offset:0
buffer_load_dwordx4 a[84:87], v22, s[4:7], s24 offen offset:1024
buffer_load_dwordx4 a[88:91], v22, s[4:7], s25 offen offset:0
buffer_load_dwordx4 a[92:95], v22, s[4:7], s25 offen offset:1024
s_add_u32 s24, s52, 4063232
s_add_u32 s25, s24, 4194304
buffer_load_dwordx4 a[96:99], v22, s[4:7], s24 offen offset:0
buffer_load_dwordx4 a[100:103], v22, s[4:7], s24 offen offset:1024
buffer_load_dwordx4 a[104:107], v22, s[4:7], s25 offen offset:0
buffer_load_dwordx4 a[108:111], v22, s[4:7], s25 offen offset:1024
s_add_u32 s24, s52, 4128768
s_add_u32 s25, s24, 4194304
buffer_load_dwordx4 a[128:131], v22, s[4:7], s24 offen offset:0
buffer_load_dwordx4 a[132:135], v22, s[4:7], s24 offen offset:1024
buffer_load_dwordx4 a[136:139], v22, s[4:7], s25 offen offset:0
buffer_load_dwordx4 a[140:143], v22, s[4:7], s25 offen offset:1024
L_b2w:
s_waitcnt vmcnt(0)
.p2align 6
L_b2l:
s_waitcnt vmcnt(2)
s_add_u32 s49, s49, 1
s_cmp_eq_u32 s50, 0
s_cbranch_scc1 L_rot0
s_cmp_eq_u32 s50, 1
s_cbranch_scc1 L_rot1
s_cmp_eq_u32 s50, 2
s_cbranch_scc1 L_rot2
s_cmp_eq_u32 s50, 3
s_cbranch_scc1 L_rot3
s_cmp_eq_u32 s50, 4
s_cbranch_scc1 L_rot4
s_cmp_eq_u32 s50, 5
s_cbranch_scc1 L_rot5
s_cmp_eq_u32 s50, 6
s_cbranch_scc1 L_rot6
L_rot0:
v_accvgpr_mov_b32 a112, a0
v_accvgpr_mov_b32 a113, a1
v_accvgpr_mov_b32 a114, a2
v_accvgpr_mov_b32 a115, a3
v_accvgpr_mov_b32 a116, a4
v_accvgpr_mov_b32 a117, a5
v_accvgpr_mov_b32 a118, a6
v_accvgpr_mov_b32 a119, a7
v_accvgpr_mov_b32 a120, a8
v_accvgpr_mov_b32 a121, a9
v_accvgpr_mov_b32 a122, a10
v_accvgpr_mov_b32 a123, a11
v_accvgpr_mov_b32 a124, a12
v_accvgpr_mov_b32 a125, a13
v_accvgpr_mov_b32 a126, a14
v_accvgpr_mov_b32 a127, a15
v_accvgpr_mov_b32 a0, a128
v_accvgpr_mov_b32 a1, a129
v_accvgpr_mov_b32 a2, a130
v_accvgpr_mov_b32 a3, a131
v_accvgpr_mov_b32 a4, a132
v_accvgpr_mov_b32 a5, a133
v_accvgpr_mov_b32 a6, a134
v_accvgpr_mov_b32 a7, a135
v_accvgpr_mov_b32 a8, a136
v_accvgpr_mov_b32 a9, a137
v_accvgpr_mov_b32 a10, a138
v_accvgpr_mov_b32 a11, a139
v_accvgpr_mov_b32 a12, a140
v_accvgpr_mov_b32 a13, a141
v_accvgpr_mov_b32 a14, a142
v_accvgpr_mov_b32 a15, a143
s_branch L_rotd
L_rot1:
v_accvgpr_mov_b32 a112, a16
v_accvgpr_mov_b32 a113, a17
v_accvgpr_mov_b32 a114, a18
v_accvgpr_mov_b32 a115, a19
v_accvgpr_mov_b32 a116, a20
v_accvgpr_mov_b32 a117, a21
v_accvgpr_mov_b32 a118, a22
v_accvgpr_mov_b32 a119, a23
v_accvgpr_mov_b32 a120, a24
v_accvgpr_mov_b32 a121, a25
v_accvgpr_mov_b32 a122, a26
v_accvgpr_mov_b32 a123, a27
v_accvgpr_mov_b32 a124, a28
v_accvgpr_mov_b32 a125, a29
v_accvgpr_mov_b32 a126, a30
v_accvgpr_mov_b32 a127, a31
v_accvgpr_mov_b32 a16, a128
v_accvgpr_mov_b32 a17, a129
v_accvgpr_mov_b32 a18, a130
v_accvgpr_mov_b32 a19, a131
v_accvgpr_mov_b32 a20, a132
v_accvgpr_mov_b32 a21, a133
v_accvgpr_mov_b32 a22, a134
v_accvgpr_mov_b32 a23, a135
v_accvgpr_mov_b32 a24, a136
v_accvgpr_mov_b32 a25, a137
v_accvgpr_mov_b32 a26, a138
v_accvgpr_mov_b32 a27, a139
v_accvgpr_mov_b32 a28, a140
v_accvgpr_mov_b32 a29, a141
v_accvgpr_mov_b32 a30, a142
v_accvgpr_mov_b32 a31, a143
s_branch L_rotd
L_rot2:
v_accvgpr_mov_b32 a112, a32
v_accvgpr_mov_b32 a113, a33
v_accvgpr_mov_b32 a114, a34
v_accvgpr_mov_b32 a115, a35
v_accvgpr_mov_b32 a116, a36
v_accvgpr_mov_b32 a117, a37
v_accvgpr_mov_b32 a118, a38
v_accvgpr_mov_b32 a119, a39
v_accvgpr_mov_b32 a120, a40
v_accvgpr_mov_b32 a121, a41
v_accvgpr_mov_b32 a122, a42
v_accvgpr_mov_b32 a123, a43
v_accvgpr_mov_b32 a124, a44
v_accvgpr_mov_b32 a125, a45
v_accvgpr_mov_b32 a126, a46
v_accvgpr_mov_b32 a127, a47
v_accvgpr_mov_b32 a32, a128
v_accvgpr_mov_b32 a33, a129
v_accvgpr_mov_b32 a34, a130
v_accvgpr_mov_b32 a35, a131
v_accvgpr_mov_b32 a36, a132
v_accvgpr_mov_b32 a37, a133
v_accvgpr_mov_b32 a38, a134
v_accvgpr_mov_b32 a39, a135
v_accvgpr_mov_b32 a40, a136
v_accvgpr_mov_b32 a41, a137
v_accvgpr_mov_b32 a42, a138
v_accvgpr_mov_b32 a43, a139
v_accvgpr_mov_b32 a44, a140
v_accvgpr_mov_b32 a45, a141
v_accvgpr_mov_b32 a46, a142
v_accvgpr_mov_b32 a47, a143
s_branch L_rotd
L_rot3:
v_accvgpr_mov_b32 a112, a48
v_accvgpr_mov_b32 a113, a49
v_accvgpr_mov_b32 a114, a50
v_accvgpr_mov_b32 a115, a51
v_accvgpr_mov_b32 a116, a52
v_accvgpr_mov_b32 a117, a53
v_accvgpr_mov_b32 a118, a54
v_accvgpr_mov_b32 a119, a55
v_accvgpr_mov_b32 a120, a56
v_accvgpr_mov_b32 a121, a57
v_accvgpr_mov_b32 a122, a58
v_accvgpr_mov_b32 a123, a59
v_accvgpr_mov_b32 a124, a60
v_accvgpr_mov_b32 a125, a61
v_accvgpr_mov_b32 a126, a62
v_accvgpr_mov_b32 a127, a63
v_accvgpr_mov_b32 a48, a128
v_accvgpr_mov_b32 a49, a129
v_accvgpr_mov_b32 a50, a130
v_accvgpr_mov_b32 a51, a131
v_accvgpr_mov_b32 a52, a132
v_accvgpr_mov_b32 a53, a133
v_accvgpr_mov_b32 a54, a134
v_accvgpr_mov_b32 a55, a135
v_accvgpr_mov_b32 a56, a136
v_accvgpr_mov_b32 a57, a137
v_accvgpr_mov_b32 a58, a138
v_accvgpr_mov_b32 a59, a139
v_accvgpr_mov_b32 a60, a140
v_accvgpr_mov_b32 a61, a141
v_accvgpr_mov_b32 a62, a142
v_accvgpr_mov_b32 a63, a143
s_branch L_rotd
L_rot4:
v_accvgpr_mov_b32 a112, a64
v_accvgpr_mov_b32 a113, a65
v_accvgpr_mov_b32 a114, a66
v_accvgpr_mov_b32 a115, a67
v_accvgpr_mov_b32 a116, a68
v_accvgpr_mov_b32 a117, a69
v_accvgpr_mov_b32 a118, a70
v_accvgpr_mov_b32 a119, a71
v_accvgpr_mov_b32 a120, a72
v_accvgpr_mov_b32 a121, a73
v_accvgpr_mov_b32 a122, a74
v_accvgpr_mov_b32 a123, a75
v_accvgpr_mov_b32 a124, a76
v_accvgpr_mov_b32 a125, a77
v_accvgpr_mov_b32 a126, a78
v_accvgpr_mov_b32 a127, a79
v_accvgpr_mov_b32 a64, a128
v_accvgpr_mov_b32 a65, a129
v_accvgpr_mov_b32 a66, a130
v_accvgpr_mov_b32 a67, a131
v_accvgpr_mov_b32 a68, a132
v_accvgpr_mov_b32 a69, a133
v_accvgpr_mov_b32 a70, a134
v_accvgpr_mov_b32 a71, a135
v_accvgpr_mov_b32 a72, a136
v_accvgpr_mov_b32 a73, a137
v_accvgpr_mov_b32 a74, a138
v_accvgpr_mov_b32 a75, a139
v_accvgpr_mov_b32 a76, a140
v_accvgpr_mov_b32 a77, a141
v_accvgpr_mov_b32 a78, a142
v_accvgpr_mov_b32 a79, a143
s_branch L_rotd
L_rot5:
v_accvgpr_mov_b32 a112, a80
v_accvgpr_mov_b32 a113, a81
v_accvgpr_mov_b32 a114, a82
v_accvgpr_mov_b32 a115, a83
v_accvgpr_mov_b32 a116, a84
v_accvgpr_mov_b32 a117, a85
v_accvgpr_mov_b32 a118, a86
v_accvgpr_mov_b32 a119, a87
v_accvgpr_mov_b32 a120, a88
v_accvgpr_mov_b32 a121, a89
v_accvgpr_mov_b32 a122, a90
v_accvgpr_mov_b32 a123, a91
v_accvgpr_mov_b32 a124, a92
v_accvgpr_mov_b32 a125, a93
v_accvgpr_mov_b32 a126, a94
v_accvgpr_mov_b32 a127, a95
v_accvgpr_mov_b32 a80, a128
v_accvgpr_mov_b32 a81, a129
v_accvgpr_mov_b32 a82, a130
v_accvgpr_mov_b32 a83, a131
v_accvgpr_mov_b32 a84, a132
v_accvgpr_mov_b32 a85, a133
v_accvgpr_mov_b32 a86, a134
v_accvgpr_mov_b32 a87, a135
v_accvgpr_mov_b32 a88, a136
v_accvgpr_mov_b32 a89, a137
v_accvgpr_mov_b32 a90, a138
v_accvgpr_mov_b32 a91, a139
v_accvgpr_mov_b32 a92, a140
v_accvgpr_mov_b32 a93, a141
v_accvgpr_mov_b32 a94, a142
v_accvgpr_mov_b32 a95, a143
s_branch L_rotd
L_rot6:
v_accvgpr_mov_b32 a112, a96
v_accvgpr_mov_b32 a113, a97
v_accvgpr_mov_b32 a114, a98
v_accvgpr_mov_b32 a115, a99
v_accvgpr_mov_b32 a116, a100
v_accvgpr_mov_b32 a117, a101
v_accvgpr_mov_b32 a118, a102
v_accvgpr_mov_b32 a119, a103
v_accvgpr_mov_b32 a120, a104
v_accvgpr_mov_b32 a121, a105
v_accvgpr_mov_b32 a122, a106
v_accvgpr_mov_b32 a123, a107
v_accvgpr_mov_b32 a124, a108
v_accvgpr_mov_b32 a125, a109
v_accvgpr_mov_b32 a126, a110
v_accvgpr_mov_b32 a127, a111
v_accvgpr_mov_b32 a96, a128
v_accvgpr_mov_b32 a97, a129
v_accvgpr_mov_b32 a98, a130
v_accvgpr_mov_b32 a99, a131
v_accvgpr_mov_b32 a100, a132
v_accvgpr_mov_b32 a101, a133
v_accvgpr_mov_b32 a102, a134
v_accvgpr_mov_b32 a103, a135
v_accvgpr_mov_b32 a104, a136
v_accvgpr_mov_b32 a105, a137
v_accvgpr_mov_b32 a106, a138
v_accvgpr_mov_b32 a107, a139
v_accvgpr_mov_b32 a108, a140
v_accvgpr_mov_b32 a109, a141
v_accvgpr_mov_b32 a110, a142
v_accvgpr_mov_b32 a111, a143
s_branch L_rotd
L_rotd:
v_accvgpr_mov_b32 a128, a144
v_accvgpr_mov_b32 a129, a145
v_accvgpr_mov_b32 a130, a146
v_accvgpr_mov_b32 a131, a147
v_accvgpr_mov_b32 a132, a148
v_accvgpr_mov_b32 a133, a149
v_accvgpr_mov_b32 a134, a150
v_accvgpr_mov_b32 a135, a151
v_accvgpr_mov_b32 a136, a152
v_accvgpr_mov_b32 a137, a153
v_accvgpr_mov_b32 a138, a154
v_accvgpr_mov_b32 a139, a155
v_accvgpr_mov_b32 a140, a156
v_accvgpr_mov_b32 a141, a157
v_accvgpr_mov_b32 a142, a158
v_accvgpr_mov_b32 a143, a159
v_mov_b32 v56, v64
v_mov_b32 v57, v65
v_mov_b32 v58, v66
v_mov_b32 v59, v67
v_mov_b32 v60, v68
v_mov_b32 v61, v69
v_mov_b32 v62, v70
v_mov_b32 v63, v71
s_add_u32 s50, s50, 1
s_cmp_eq_u32 s50, 7
s_cselect_b32 s50, 0, s50
s_add_u32 s26, s49, 2
s_min_i32 s26, s26, 64
s_cmp_ge_i32 s51, s26
s_cbranch_scc1 L_bf_okl
s_branch L_bf_gol
L_bfl:
s_sleep 16
L_bf_gol:
buffer_load_dword v40, v27, s[4:7], 0 offen sc1
s_sub_u32 s28, s28, 1
s_cbranch_scc1 L_end
s_waitcnt vmcnt(0)
v_readlane_b32 s24, v40, 0
v_readlane_b32 s25, v40, 1
v_readlane_b32 s51, v40, 2
s_nop 0
s_min_i32 s51, s51, s24
s_min_i32 s51, s51, s25
s_cmp_ge_i32 s51, s26
s_cbranch_scc0 L_bfl
L_bf_okl:
s_sub_u32 s26, s26, 1
s_lshl_b32 s26, s26, 16
s_add_u32 s24, s26, 4194304
s_add_u32 s25, s26, 8388608
buffer_load_dwordx4 v[64:67], v22, s[4:7], s26 offen offset:0
buffer_load_dwordx4 v[68:71], v22, s[4:7], s26 offen offset:1024
buffer_load_dwordx4 a[144:147], v22, s[4:7], s24 offen offset:0
buffer_load_dwordx4 a[148:151], v22, s[4:7], s24 offen offset:1024
buffer_load_dwordx4 a[152:155], v22, s[4:7], s25 offen offset:0
buffer_load_dwordx4 a[156:159], v22, s[4:7], s25 offen offset:1024
v_mfma_f32_16x16x32_bf16 v[184:187], a[112:115], v[56:59], 0
v_mfma_f32_16x16x32_bf16 v[188:191], a[116:119], v[56:59], 0
v_mfma_f32_16x16x32_bf16 v[192:195], a[112:115], v[60:63], 0
v_mfma_f32_16x16x32_bf16 v[196:199], a[116:119], v[60:63], 0
v_mfma_f32_16x16x32_bf16 v[200:203], a[128:131], v[56:59], 0
v_mfma_f32_16x16x32_bf16 v[204:207], a[132:135], v[56:59], 0
v_mfma_f32_16x16x32_bf16 v[208:211], a[128:131], v[60:63], 0
v_mfma_f32_16x16x32_bf16 v[212:215], a[132:135], v[60:63], 0
v_mfma_f32_16x16x32_bf16 v[72:75], a[0:3], v[56:59], 0
v_mfma_f32_16x16x32_bf16 v[76:79], a[4:7], v[56:59], 0
v_mfma_f32_16x16x32_bf16 v[80:83], a[0:3], v[60:63], 0
v_mfma_f32_16x16x32_bf16 v[84:87], a[4:7], v[60:63], 0
s_cmp_le_u32 s49, 7
s_cbranch_scc1 L_bi7
L_bv7:
v_mfma_f32_16x16x32_bf16 v[88:91], a[16:19], v[56:59], 0
v_cndmask_b32 v200, v184, v200, s[64:65]
v_cndmask_b32 v201, v185, v201, s[66:67]
v_cndmask_b32 v202, v186, v202, s[68:69]
v_mfma_f32_16x16x32_bf16 v[92:95], a[20:23], v[56:59], 0
v_cndmask_b32 v203, v187, v203, s[70:71]
v_cndmask_b32 v204, v188, v204, s[72:73]
v_cndmask_b32 v205, v189, v205, s[74:75]
v_mfma_f32_16x16x32_bf16 v[96:99], a[16:19], v[60:63], 0
v_cndmask_b32 v206, v190, v206, s[76:77]
v_cndmask_b32 v207, v191, v207, s[78:79]
v_max_f32 v47, v200, v201
v_mfma_f32_16x16x32_bf16 v[100:103], a[20:23], v[60:63], 0
v_max3_f32 v47, v47, v202, v203
v_max3_f32 v47, v47, v204, v205
v_max3_f32 v47, v47, v206, v207
v_mfma_f32_16x16x32_bf16 v[104:107], a[32:35], v[56:59], 0
v_cndmask_b32 v208, v192, v208, s[80:81]
v_cndmask_b32 v209, v193, v209, s[82:83]
v_cndmask_b32 v210, v194, v210, s[84:85]
v_mfma_f32_16x16x32_bf16 v[108:111], a[36:39], v[56:59], 0
v_cndmask_b32 v211, v195, v211, s[86:87]
v_cndmask_b32 v212, v196, v212, s[88:89]
v_cndmask_b32 v213, v197, v213, s[90:91]
v_mfma_f32_16x16x32_bf16 v[112:115], a[32:35], v[60:63], 0
v_cndmask_b32 v214, v198, v214, s[92:93]
v_cndmask_b32 v215, v199, v215, s[94:95]
v_max_f32 v48, v208, v209
v_mfma_f32_16x16x32_bf16 v[116:119], a[36:39], v[60:63], 0
v_max3_f32 v48, v48, v210, v211
v_max3_f32 v48, v48, v212, v213
v_max3_f32 v48, v48, v214, v215
s_cmp_le_u32 s49, 0
s_cbranch_scc1 L_bi0
L_bv0:
v_mfma_f32_16x16x32_bf16 v[120:123], a[48:51], v[56:59], 0
v_max3_f32 v47, v47, v72, v73
v_max3_f32 v47, v47, v74, v75
v_mfma_f32_16x16x32_bf16 v[124:127], a[52:55], v[56:59], 0
v_max3_f32 v47, v47, v76, v77
v_max3_f32 v47, v47, v78, v79
v_mfma_f32_16x16x32_bf16 v[128:131], a[48:51], v[60:63], 0
v_max3_f32 v48, v48, v80, v81
v_max3_f32 v48, v48, v82, v83
v_mfma_f32_16x16x32_bf16 v[132:135], a[52:55], v[60:63], 0
v_max3_f32 v48, v48, v84, v85
v_max3_f32 v48, v48, v86, v87
s_cmp_le_u32 s49, 1
s_cbranch_scc1 L_bi1
L_bv1:
v_mfma_f32_16x16x32_bf16 v[136:139], a[64:67], v[56:59], 0
v_max3_f32 v47, v47, v88, v89
v_max3_f32 v47, v47, v90, v91
v_mfma_f32_16x16x32_bf16 v[140:143], a[68:71], v[56:59], 0
v_max3_f32 v47, v47, v92, v93
v_max3_f32 v47, v47, v94, v95
v_mfma_f32_16x16x32_bf16 v[144:147], a[64:67], v[60:63], 0
v_max3_f32 v48, v48, v96, v97
v_max3_f32 v48, v48, v98, v99
v_mfma_f32_16x16x32_bf16 v[148:151], a[68:71], v[60:63], 0
v_max3_f32 v48, v48, v100, v101
v_max3_f32 v48, v48, v102, v103
s_cmp_le_u32 s49, 2
s_cbranch_scc1 L_bi2
L_bv2:
v_mfma_f32_16x16x32_bf16 v[152:155], a[80:83], v[56:59], 0
v_max3_f32 v47, v47, v104, v105
v_max3_f32 v47, v47, v106, v107
v_mfma_f32_16x16x32_bf16 v[156:159], a[84:87], v[56:59], 0
v_max3_f32 v47, v47, v108, v109
v_max3_f32 v47, v47, v110, v111
v_mfma_f32_16x16x32_bf16 v[160:163], a[80:83], v[60:63], 0
v_max3_f32 v48, v48, v112, v113
v_max3_f32 v48, v48, v114, v115
v_mfma_f32_16x16x32_bf16 v[164:167], a[84:87], v[60:63], 0
v_max3_f32 v48, v48, v116, v117
v_max3_f32 v48, v48, v118, v119
s_cmp_le_u32 s49, 3
s_cbranch_scc1 L_bi3
L_bv3:
v_mfma_f32_16x16x32_bf16 v[168:171], a[96:99], v[56:59], 0
v_max3_f32 v47, v47, v120, v121
v_max3_f32 v47, v47, v122, v123
v_mfma_f32_16x16x32_bf16 v[172:175], a[100:103], v[56:59], 0
v_max3_f32 v47, v47, v124, v125
v_max3_f32 v47, v47, v126, v127
v_mfma_f32_16x16x32_bf16 v[176:179], a[96:99], v[60:63], 0
v_max3_f32 v48, v48, v128, v129
v_max3_f32 v48, v48, v130, v131
v_mfma_f32_16x16x32_bf16 v[180:183], a[100:103], v[60:63], 0
v_max3_f32 v48, v48, v132, v133
v_max3_f32 v48, v48, v134, v135
s_cmp_le_u32 s49, 4
s_cbranch_scc1 L_bi4
L_bv4:
v_max3_f32 v47, v47, v136, v137
v_max3_f32 v47, v47, v138, v139
v_max3_f32 v47, v47, v140, v141
v_max3_f32 v47, v47, v142, v143
v_max3_f32 v48, v48, v144, v145
v_max3_f32 v48, v48, v146, v147
v_max3_f32 v48, v48, v148, v149
v_max3_f32 v48, v48, v150, v151
s_cmp_le_u32 s49, 5
s_cbranch_scc1 L_bi5
L_bv5:
v_max3_f32 v47, v47, v152, v153
v_max3_f32 v47, v47, v154, v155
v_max3_f32 v47, v47, v156, v157
v_max3_f32 v47, v47, v158, v159
v_max3_f32 v48, v48, v160, v161
v_max3_f32 v48, v48, v162, v163
v_max3_f32 v48, v48, v164, v165
v_max3_f32 v48, v48, v166, v167
s_cmp_le_u32 s49, 6
s_cbranch_scc1 L_bi6
L_bv6:
v_max3_f32 v47, v47, v168, v169
v_max3_f32 v47, v47, v170, v171
v_max3_f32 v47, v47, v172, v173
v_max3_f32 v47, v47, v174, v175
v_max3_f32 v48, v48, v176, v177
v_max3_f32 v48, v48, v178, v179
v_max3_f32 v48, v48, v180, v181
v_max3_f32 v48, v48, v182, v183
v_mov_b32 v49, v47
s_nop 1
v_permlane16_swap_b32 v47, v49
v_max_f32 v47, v47, v49
v_mov_b32 v49, v47
s_nop 1
v_permlane32_swap_b32 v47, v49
v_max_f32 v47, v47, v49
v_mul_f32 v47, s27, v47
v_mov_b32 v49, v48
s_nop 1
v_permlane16_swap_b32 v48, v49
v_max_f32 v48, v48, v49
v_mov_b32 v49, v48
s_nop 1
v_permlane32_swap_b32 v48, v49
v_max_f32 v48, v48, v49
v_mul_f32 v48, s27, v48
v_fma_f32 v200, v200, s27, -v47
v_fma_f32 v201, v201, s27, -v47
v_fma_f32 v202, v202, s27, -v47
v_fma_f32 v203, v203, s27, -v47
v_fma_f32 v204, v204, s27, -v47
v_fma_f32 v205, v205, s27, -v47
v_fma_f32 v206, v206, s27, -v47
v_fma_f32 v207, v207, s27, -v47
v_exp_f32 v200, v200
v_exp_f32 v201, v201
v_exp_f32 v202, v202
v_exp_f32 v203, v203
v_exp_f32 v204, v204
v_exp_f32 v205, v205
v_exp_f32 v206, v206
v_exp_f32 v207, v207
v_cvt_pk_bf16_f32 v200, v200, v201
v_cvt_pk_bf16_f32 v201, v202, v203
v_cvt_pk_bf16_f32 v202, v204, v205
v_cvt_pk_bf16_f32 v203, v206, v207
v_and_b32 v188, v10, v200
v_xor_b32 v184, v188, v200
v_and_b32 v189, v11, v201
v_xor_b32 v185, v189, v201
v_and_b32 v190, v12, v202
v_xor_b32 v186, v190, v202
v_and_b32 v191, v13, v203
v_xor_b32 v187, v191, v203
v_fma_f32 v208, v208, s27, -v48
v_fma_f32 v209, v209, s27, -v48
v_mfma_f32_16x16x32_bf16 v[232:235], v[52:55], v[200:203], 0
v_fma_f32 v210, v210, s27, -v48
v_fma_f32 v211, v211, s27, -v48
v_fma_f32 v212, v212, s27, -v48
v_fma_f32 v213, v213, s27, -v48
v_fma_f32 v214, v214, s27, -v48
v_mfma_f32_16x16x32_bf16 v[216:219], a[136:139], v[188:191], 0
v_fma_f32 v215, v215, s27, -v48
v_exp_f32 v208, v208
v_exp_f32 v209, v209
v_exp_f32 v210, v210
v_exp_f32 v211, v211
v_mfma_f32_16x16x32_bf16 v[220:223], a[140:143], v[188:191], 0
v_exp_f32 v212, v212
v_exp_f32 v213, v213
v_exp_f32 v214, v214
v_exp_f32 v215, v215
v_cvt_pk_bf16_f32 v208, v208, v209
v_mfma_f32_16x16x32_bf16 v[216:219], a[120:123], v[184:187], v[216:219]
v_cvt_pk_bf16_f32 v209, v210, v211
v_cvt_pk_bf16_f32 v210, v212, v213
v_cvt_pk_bf16_f32 v211, v214, v215
v_and_b32 v196, v14, v208
v_xor_b32 v192, v196, v208
v_mfma_f32_16x16x32_bf16 v[220:223], a[124:127], v[184:187], v[220:223]
v_and_b32 v197, v15, v209
v_xor_b32 v193, v197, v209
v_and_b32 v198, v16, v210
v_xor_b32 v194, v198, v210
v_and_b32 v199, v17, v211
v_xor_b32 v195, v199, v211
v_fma_f32 v72, v72, s27, -v47
v_fma_f32 v73, v73, s27, -v47
v_mfma_f32_16x16x32_bf16 v[236:239], v[52:55], v[208:211], 0
v_fma_f32 v74, v74, s27, -v47
v_fma_f32 v75, v75, s27, -v47
v_fma_f32 v76, v76, s27, -v47
v_mfma_f32_16x16x32_bf16 v[224:227], a[136:139], v[196:199], 0
v_fma_f32 v77, v77, s27, -v47
v_fma_f32 v78, v78, s27, -v47
v_fma_f32 v79, v79, s27, -v47
v_mfma_f32_16x16x32_bf16 v[228:231], a[140:143], v[196:199], 0
v_exp_f32 v72, v72
v_exp_f32 v73, v73
v_exp_f32 v74, v74
v_mfma_f32_16x16x32_bf16 v[224:227], a[120:123], v[192:195], v[224:227]
v_exp_f32 v75, v75
v_exp_f32 v76, v76
v_exp_f32 v77, v77
v_mfma_f32_16x16x32_bf16 v[228:231], a[124:127], v[192:195], v[228:231]
v_exp_f32 v78, v78
v_exp_f32 v79, v79
v_cvt_pk_bf16_f32 v72, v72, v73
v_cvt_pk_bf16_f32 v73, v74, v75
v_cvt_pk_bf16_f32 v74, v76, v77
v_cvt_pk_bf16_f32 v75, v78, v79
v_fma_f32 v80, v80, s27, -v48
v_fma_f32 v81, v81, s27, -v48
v_mfma_f32_16x16x32_bf16 v[232:235], v[52:55], v[72:75], v[232:235]
v_fma_f32 v82, v82, s27, -v48
v_fma_f32 v83, v83, s27, -v48
v_fma_f32 v84, v84, s27, -v48
v_fma_f32 v85, v85, s27, -v48
v_fma_f32 v86, v86, s27, -v48
v_fma_f32 v87, v87, s27, -v48
v_mfma_f32_16x16x32_bf16 v[216:219], a[8:11], v[72:75], v[216:219]
v_exp_f32 v80, v80
v_exp_f32 v81, v81
v_exp_f32 v82, v82
v_exp_f32 v83, v83
v_exp_f32 v84, v84
v_exp_f32 v85, v85
v_mfma_f32_16x16x32_bf16 v[220:223], a[12:15], v[72:75], v[220:223]
v_exp_f32 v86, v86
v_exp_f32 v87, v87
v_cvt_pk_bf16_f32 v80, v80, v81
v_cvt_pk_bf16_f32 v81, v82, v83
v_cvt_pk_bf16_f32 v82, v84, v85
v_cvt_pk_bf16_f32 v83, v86, v87
v_fma_f32 v88, v88, s27, -v47
v_fma_f32 v89, v89, s27, -v47
v_mfma_f32_16x16x32_bf16 v[236:239], v[52:55], v[80:83], v[236:239]
v_fma_f32 v90, v90, s27, -v47
v_fma_f32 v91, v91, s27, -v47
v_fma_f32 v92, v92, s27, -v47
v_fma_f32 v93, v93, s27, -v47
v_fma_f32 v94, v94, s27, -v47
v_fma_f32 v95, v95, s27, -v47
v_mfma_f32_16x16x32_bf16 v[224:227], a[8:11], v[80:83], v[224:227]
v_exp_f32 v88, v88
v_exp_f32 v89, v89
v_exp_f32 v90, v90
v_exp_f32 v91, v91
v_exp_f32 v92, v92
v_exp_f32 v93, v93
v_mfma_f32_16x16x32_bf16 v[228:231], a[12:15], v[80:83], v[228:231]
v_exp_f32 v94, v94
v_exp_f32 v95, v95
v_cvt_pk_bf16_f32 v88, v88, v89
v_cvt_pk_bf16_f32 v89, v90, v91
v_cvt_pk_bf16_f32 v90, v92, v93
v_cvt_pk_bf16_f32 v91, v94, v95
v_fma_f32 v96, v96, s27, -v48
v_fma_f32 v97, v97, s27, -v48
v_mfma_f32_16x16x32_bf16 v[232:235], v[52:55], v[88:91], v[232:235]
v_fma_f32 v98, v98, s27, -v48
v_fma_f32 v99, v99, s27, -v48
v_fma_f32 v100, v100, s27, -v48
v_fma_f32 v101, v101, s27, -v48
v_fma_f32 v102, v102, s27, -v48
v_fma_f32 v103, v103, s27, -v48
v_mfma_f32_16x16x32_bf16 v[216:219], a[24:27], v[88:91], v[216:219]
v_exp_f32 v96, v96
v_exp_f32 v97, v97
v_exp_f32 v98, v98
v_exp_f32 v99, v99
v_exp_f32 v100, v100
v_exp_f32 v101, v101
v_mfma_f32_16x16x32_bf16 v[220:223], a[28:31], v[88:91], v[220:223]
v_exp_f32 v102, v102
v_exp_f32 v103, v103
v_cvt_pk_bf16_f32 v96, v96, v97
v_cvt_pk_bf16_f32 v97, v98, v99
v_cvt_pk_bf16_f32 v98, v100, v101
v_cvt_pk_bf16_f32 v99, v102, v103
v_fma_f32 v104, v104, s27, -v47
v_fma_f32 v105, v105, s27, -v47
v_mfma_f32_16x16x32_bf16 v[236:239], v[52:55], v[96:99], v[236:239]
v_fma_f32 v106, v106, s27, -v47
v_fma_f32 v107, v107, s27, -v47
v_fma_f32 v108, v108, s27, -v47
v_fma_f32 v109, v109, s27, -v47
v_fma_f32 v110, v110, s27, -v47
v_fma_f32 v111, v111, s27, -v47
v_mfma_f32_16x16x32_bf16 v[224:227], a[24:27], v[96:99], v[224:227]
v_exp_f32 v104, v104
v_exp_f32 v105, v105
v_exp_f32 v106, v106
v_exp_f32 v107, v107
v_exp_f32 v108, v108
v_exp_f32 v109, v109
v_mfma_f32_16x16x32_bf16 v[228:231], a[28:31], v[96:99], v[228:231]
v_exp_f32 v110, v110
v_exp_f32 v111, v111
v_cvt_pk_bf16_f32 v104, v104, v105
v_cvt_pk_bf16_f32 v105, v106, v107
v_cvt_pk_bf16_f32 v106, v108, v109
v_cvt_pk_bf16_f32 v107, v110, v111
v_fma_f32 v112, v112, s27, -v48
v_fma_f32 v113, v113, s27, -v48
v_mfma_f32_16x16x32_bf16 v[232:235], v[52:55], v[104:107], v[232:235]
v_fma_f32 v114, v114, s27, -v48
v_fma_f32 v115, v115, s27, -v48
v_fma_f32 v116, v116, s27, -v48
v_fma_f32 v117, v117, s27, -v48
v_fma_f32 v118, v118, s27, -v48
v_fma_f32 v119, v119, s27, -v48
v_mfma_f32_16x16x32_bf16 v[216:219], a[40:43], v[104:107], v[216:219]
v_exp_f32 v112, v112
v_exp_f32 v113, v113
v_exp_f32 v114, v114
v_exp_f32 v115, v115
v_exp_f32 v116, v116
v_exp_f32 v117, v117
v_mfma_f32_16x16x32_bf16 v[220:223], a[44:47], v[104:107], v[220:223]
v_exp_f32 v118, v118
v_exp_f32 v119, v119
v_cvt_pk_bf16_f32 v112, v112, v113
v_cvt_pk_bf16_f32 v113, v114, v115
v_cvt_pk_bf16_f32 v114, v116, v117
v_cvt_pk_bf16_f32 v115, v118, v119
v_fma_f32 v120, v120, s27, -v47
v_fma_f32 v121, v121, s27, -v47
v_mfma_f32_16x16x32_bf16 v[236:239], v[52:55], v[112:115], v[236:239]
v_fma_f32 v122, v122, s27, -v47
v_fma_f32 v123, v123, s27, -v47
v_fma_f32 v124, v124, s27, -v47
v_fma_f32 v125, v125, s27, -v47
v_fma_f32 v126, v126, s27, -v47
v_fma_f32 v127, v127, s27, -v47
v_mfma_f32_16x16x32_bf16 v[224:227], a[40:43], v[112:115], v[224:227]
v_exp_f32 v120, v120
v_exp_f32 v121, v121
v_exp_f32 v122, v122
v_exp_f32 v123, v123
v_exp_f32 v124, v124
v_exp_f32 v125, v125
v_mfma_f32_16x16x32_bf16 v[228:231], a[44:47], v[112:115], v[228:231]
v_exp_f32 v126, v126
v_exp_f32 v127, v127
v_cvt_pk_bf16_f32 v120, v120, v121
v_cvt_pk_bf16_f32 v121, v122, v123
v_cvt_pk_bf16_f32 v122, v124, v125
v_cvt_pk_bf16_f32 v123, v126, v127
v_fma_f32 v128, v128, s27, -v48
v_fma_f32 v129, v129, s27, -v48
v_mfma_f32_16x16x32_bf16 v[232:235], v[52:55], v[120:123], v[232:235]
v_fma_f32 v130, v130, s27, -v48
v_fma_f32 v131, v131, s27, -v48
v_fma_f32 v132, v132, s27, -v48
v_fma_f32 v133, v133, s27, -v48
v_fma_f32 v134, v134, s27, -v48
v_fma_f32 v135, v135, s27, -v48
v_mfma_f32_16x16x32_bf16 v[216:219], a[56:59], v[120:123], v[216:219]
v_exp_f32 v128, v128
v_exp_f32 v129, v129
v_exp_f32 v130, v130
v_exp_f32 v131, v131
v_exp_f32 v132, v132
v_exp_f32 v133, v133
v_mfma_f32_16x16x32_bf16 v[220:223], a[60:63], v[120:123], v[220:223]
v_exp_f32 v134, v134
v_exp_f32 v135, v135
v_cvt_pk_bf16_f32 v128, v128, v129
v_cvt_pk_bf16_f32 v129, v130, v131
v_cvt_pk_bf16_f32 v130, v132, v133
v_cvt_pk_bf16_f32 v131, v134, v135
v_fma_f32 v136, v136, s27, -v47
v_fma_f32 v137, v137, s27, -v47
v_mfma_f32_16x16x32_bf16 v[236:239], v[52:55], v[128:131], v[236:239]
v_fma_f32 v138, v138, s27, -v47
v_fma_f32 v139, v139, s27, -v47
v_fma_f32 v140, v140, s27, -v47
v_fma_f32 v141, v141, s27, -v47
v_fma_f32 v142, v142, s27, -v47
v_fma_f32 v143, v143, s27, -v47
v_mfma_f32_16x16x32_bf16 v[224:227], a[56:59], v[128:131], v[224:227]
v_exp_f32 v136, v136
v_exp_f32 v137, v137
v_exp_f32 v138, v138
v_exp_f32 v139, v139
v_exp_f32 v140, v140
v_exp_f32 v141, v141
v_mfma_f32_16x16x32_bf16 v[228:231], a[60:63], v[128:131], v[228:231]
v_exp_f32 v142, v142
v_exp_f32 v143, v143
v_cvt_pk_bf16_f32 v136, v136, v137
v_cvt_pk_bf16_f32 v137, v138, v139
v_cvt_pk_bf16_f32 v138, v140, v141
v_cvt_pk_bf16_f32 v139, v142, v143
v_fma_f32 v144, v144, s27, -v48
v_fma_f32 v145, v145, s27, -v48
v_mfma_f32_16x16x32_bf16 v[232:235], v[52:55], v[136:139], v[232:235]
v_fma_f32 v146, v146, s27, -v48
v_fma_f32 v147, v147, s27, -v48
v_fma_f32 v148, v148, s27, -v48
v_fma_f32 v149, v149, s27, -v48
v_fma_f32 v150, v150, s27, -v48
v_fma_f32 v151, v151, s27, -v48
v_mfma_f32_16x16x32_bf16 v[216:219], a[72:75], v[136:139], v[216:219]
v_exp_f32 v144, v144
v_exp_f32 v145, v145
v_exp_f32 v146, v146
v_exp_f32 v147, v147
v_exp_f32 v148, v148
v_exp_f32 v149, v149
v_mfma_f32_16x16x32_bf16 v[220:223], a[76:79], v[136:139], v[220:223]
v_exp_f32 v150, v150
v_exp_f32 v151, v151
v_cvt_pk_bf16_f32 v144, v144, v145
v_cvt_pk_bf16_f32 v145, v146, v147
v_cvt_pk_bf16_f32 v146, v148, v149
v_cvt_pk_bf16_f32 v147, v150, v151
v_fma_f32 v152, v152, s27, -v47
v_fma_f32 v153, v153, s27, -v47
v_mfma_f32_16x16x32_bf16 v[236:239], v[52:55], v[144:147], v[236:239]
v_fma_f32 v154, v154, s27, -v47
v_fma_f32 v155, v155, s27, -v47
v_fma_f32 v156, v156, s27, -v47
v_fma_f32 v157, v157, s27, -v47
v_fma_f32 v158, v158, s27, -v47
v_fma_f32 v159, v159, s27, -v47
v_mfma_f32_16x16x32_bf16 v[224:227], a[72:75], v[144:147], v[224:227]
v_exp_f32 v152, v152
v_exp_f32 v153, v153
v_exp_f32 v154, v154
v_exp_f32 v155, v155
v_exp_f32 v156, v156
v_exp_f32 v157, v157
v_mfma_f32_16x16x32_bf16 v[228:231], a[76:79], v[144:147], v[228:231]
v_exp_f32 v158, v158
v_exp_f32 v159, v159
v_cvt_pk_bf16_f32 v152, v152, v153
v_cvt_pk_bf16_f32 v153, v154, v155
v_cvt_pk_bf16_f32 v154, v156, v157
v_cvt_pk_bf16_f32 v155, v158, v159
v_fma_f32 v160, v160, s27, -v48
v_fma_f32 v161, v161, s27, -v48
v_mfma_f32_16x16x32_bf16 v[232:235], v[52:55], v[152:155], v[232:235]
v_fma_f32 v162, v162, s27, -v48
v_fma_f32 v163, v163, s27, -v48
v_fma_f32 v164, v164, s27, -v48
v_fma_f32 v165, v165, s27, -v48
v_fma_f32 v166, v166, s27, -v48
v_fma_f32 v167, v167, s27, -v48
v_mfma_f32_16x16x32_bf16 v[216:219], a[88:91], v[152:155], v[216:219]
v_exp_f32 v160, v160
v_exp_f32 v161, v161
v_exp_f32 v162, v162
v_exp_f32 v163, v163
v_exp_f32 v164, v164
v_exp_f32 v165, v165
v_mfma_f32_16x16x32_bf16 v[220:223], a[92:95], v[152:155], v[220:223]
v_exp_f32 v166, v166
v_exp_f32 v167, v167
v_cvt_pk_bf16_f32 v160, v160, v161
v_cvt_pk_bf16_f32 v161, v162, v163
v_cvt_pk_bf16_f32 v162, v164, v165
v_cvt_pk_bf16_f32 v163, v166, v167
v_fma_f32 v168, v168, s27, -v47
v_fma_f32 v169, v169, s27, -v47
v_mfma_f32_16x16x32_bf16 v[236:239], v[52:55], v[160:163], v[236:239]
v_fma_f32 v170, v170, s27, -v47
v_fma_f32 v171, v171, s27, -v47
v_fma_f32 v172, v172, s27, -v47
v_fma_f32 v173, v173, s27, -v47
v_fma_f32 v174, v174, s27, -v47
v_fma_f32 v175, v175, s27, -v47
v_mfma_f32_16x16x32_bf16 v[224:227], a[88:91], v[160:163], v[224:227]
v_exp_f32 v168, v168
v_exp_f32 v169, v169
v_exp_f32 v170, v170
v_exp_f32 v171, v171
v_exp_f32 v172, v172
v_exp_f32 v173, v173
v_mfma_f32_16x16x32_bf16 v[228:231], a[92:95], v[160:163], v[228:231]
v_exp_f32 v174, v174
v_exp_f32 v175, v175
v_cvt_pk_bf16_f32 v168, v168, v169
v_cvt_pk_bf16_f32 v169, v170, v171
v_cvt_pk_bf16_f32 v170, v172, v173
v_cvt_pk_bf16_f32 v171, v174, v175
v_fma_f32 v176, v176, s27, -v48
v_fma_f32 v177, v177, s27, -v48
v_mfma_f32_16x16x32_bf16 v[232:235], v[52:55], v[168:171], v[232:235]
v_fma_f32 v178, v178, s27, -v48
v_fma_f32 v179, v179, s27, -v48
v_fma_f32 v180, v180, s27, -v48
v_fma_f32 v181, v181, s27, -v48
v_fma_f32 v182, v182, s27, -v48
v_fma_f32 v183, v183, s27, -v48
v_mfma_f32_16x16x32_bf16 v[216:219], a[104:107], v[168:171], v[216:219]
v_exp_f32 v176, v176
v_exp_f32 v177, v177
v_exp_f32 v178, v178
v_exp_f32 v179, v179
v_exp_f32 v180, v180
v_exp_f32 v181, v181
v_mfma_f32_16x16x32_bf16 v[220:223], a[108:111], v[168:171], v[220:223]
v_exp_f32 v182, v182
v_exp_f32 v183, v183
v_cvt_pk_bf16_f32 v176, v176, v177
v_cvt_pk_bf16_f32 v177, v178, v179
v_cvt_pk_bf16_f32 v178, v180, v181
v_cvt_pk_bf16_f32 v179, v182, v183
s_nop 1
v_mfma_f32_16x16x32_bf16 v[236:239], v[52:55], v[176:179], v[236:239]
v_mfma_f32_16x16x32_bf16 v[224:227], a[104:107], v[176:179], v[224:227]
v_mfma_f32_16x16x32_bf16 v[228:231], a[108:111], v[176:179], v[228:231]
s_lshl_b32 s25, s52, 1
s_add_u32 s26, s25, 65536
v_rcp_f32 v47, v232
s_nop 0
v_mul_f32 v216, v216, v47
v_mul_f32 v217, v217, v47
v_mul_f32 v218, v218, v47
v_mul_f32 v219, v219, v47
v_cvt_pk_bf16_f32 v92, v216, v217
v_cvt_pk_bf16_f32 v93, v218, v219
v_mul_f32 v220, v220, v47
v_mul_f32 v221, v221, v47
v_mul_f32 v222, v222, v47
v_mul_f32 v223, v223, v47
v_cvt_pk_bf16_f32 v94, v220, v221
v_cvt_pk_bf16_f32 v95, v222, v223
buffer_store_dwordx4 v[92:95], v23, s[4:7], s25 offen sc1
v_rcp_f32 v48, v236
s_nop 0
v_mul_f32 v224, v224, v48
v_mul_f32 v225, v225, v48
v_mul_f32 v226, v226, v48
v_mul_f32 v227, v227, v48
v_cvt_pk_bf16_f32 v100, v224, v225
v_cvt_pk_bf16_f32 v101, v226, v227
v_mul_f32 v228, v228, v48
v_mul_f32 v229, v229, v48
v_mul_f32 v230, v230, v48
v_mul_f32 v231, v231, v48
v_cvt_pk_bf16_f32 v102, v228, v229
v_cvt_pk_bf16_f32 v103, v230, v231
buffer_store_dwordx4 v[100:103], v23, s[4:7], s26 offen sc1
s_cmp_lg_u32 s49, 31
s_cbranch_scc1 L_b2n0
v_mov_b32 v5, 49408
v_mov_b32 v6, 1
s_waitcnt vmcnt(0)
s_mov_b64 exec, 1
buffer_atomic_add v6, v5, s[4:7], 0 offen sc1
s_mov_b64 exec, -1
L_b2n0:
s_add_u32 s52, s52, 65536
s_cmp_lt_i32 s49, s53
s_cbranch_scc1 L_b2l
v_mov_b32 v5, 49152
v_mov_b32 v6, 1
s_waitcnt vmcnt(0)
s_mov_b64 exec, 1
buffer_atomic_add v6, v5, s[4:7], 0 offen sc1
s_mov_b64 exec, -1
s_branch L_fg
L_bi7:
s_nop 7
v_mov_b32 v184, v46
v_mov_b32 v185, v46
v_mov_b32 v186, v46
v_mov_b32 v187, v46
v_mov_b32 v188, v46
v_mov_b32 v189, v46
v_mov_b32 v190, v46
v_mov_b32 v191, v46
v_mov_b32 v192, v46
v_mov_b32 v193, v46
v_mov_b32 v194, v46
v_mov_b32 v195, v46
v_mov_b32 v196, v46
v_mov_b32 v197, v46
v_mov_b32 v198, v46
v_mov_b32 v199, v46
s_branch L_bv7
L_bi0:
s_nop 7
v_mov_b32 v72, v46
v_mov_b32 v73, v46
v_mov_b32 v74, v46
v_mov_b32 v75, v46
v_mov_b32 v76, v46
v_mov_b32 v77, v46
v_mov_b32 v78, v46
v_mov_b32 v79, v46
v_mov_b32 v80, v46
v_mov_b32 v81, v46
v_mov_b32 v82, v46
v_mov_b32 v83, v46
v_mov_b32 v84, v46
v_mov_b32 v85, v46
v_mov_b32 v86, v46
v_mov_b32 v87, v46
s_branch L_bv0
L_bi1:
s_nop 7
v_mov_b32 v88, v46
v_mov_b32 v89, v46
v_mov_b32 v90, v46
v_mov_b32 v91, v46
v_mov_b32 v92, v46
v_mov_b32 v93, v46
v_mov_b32 v94, v46
v_mov_b32 v95, v46
v_mov_b32 v96, v46
v_mov_b32 v97, v46
v_mov_b32 v98, v46
v_mov_b32 v99, v46
v_mov_b32 v100, v46
v_mov_b32 v101, v46
v_mov_b32 v102, v46
v_mov_b32 v103, v46
s_branch L_bv1
L_bi2:
s_nop 7
v_mov_b32 v104, v46
v_mov_b32 v105, v46
v_mov_b32 v106, v46
v_mov_b32 v107, v46
v_mov_b32 v108, v46
v_mov_b32 v109, v46
v_mov_b32 v110, v46
v_mov_b32 v111, v46
v_mov_b32 v112, v46
v_mov_b32 v113, v46
v_mov_b32 v114, v46
v_mov_b32 v115, v46
v_mov_b32 v116, v46
v_mov_b32 v117, v46
v_mov_b32 v118, v46
v_mov_b32 v119, v46
s_branch L_bv2
L_bi3:
s_nop 7
v_mov_b32 v120, v46
v_mov_b32 v121, v46
v_mov_b32 v122, v46
v_mov_b32 v123, v46
v_mov_b32 v124, v46
v_mov_b32 v125, v46
v_mov_b32 v126, v46
v_mov_b32 v127, v46
v_mov_b32 v128, v46
v_mov_b32 v129, v46
v_mov_b32 v130, v46
v_mov_b32 v131, v46
v_mov_b32 v132, v46
v_mov_b32 v133, v46
v_mov_b32 v134, v46
v_mov_b32 v135, v46
s_branch L_bv3
L_bi4:
s_nop 7
v_mov_b32 v136, v46
v_mov_b32 v137, v46
v_mov_b32 v138, v46
v_mov_b32 v139, v46
v_mov_b32 v140, v46
v_mov_b32 v141, v46
v_mov_b32 v142, v46
v_mov_b32 v143, v46
v_mov_b32 v144, v46
v_mov_b32 v145, v46
v_mov_b32 v146, v46
v_mov_b32 v147, v46
v_mov_b32 v148, v46
v_mov_b32 v149, v46
v_mov_b32 v150, v46
v_mov_b32 v151, v46
s_branch L_bv4
L_bi5:
s_nop 7
v_mov_b32 v152, v46
v_mov_b32 v153, v46
v_mov_b32 v154, v46
v_mov_b32 v155, v46
v_mov_b32 v156, v46
v_mov_b32 v157, v46
v_mov_b32 v158, v46
v_mov_b32 v159, v46
v_mov_b32 v160, v46
v_mov_b32 v161, v46
v_mov_b32 v162, v46
v_mov_b32 v163, v46
v_mov_b32 v164, v46
v_mov_b32 v165, v46
v_mov_b32 v166, v46
v_mov_b32 v167, v46
s_branch L_bv5
L_bi6:
s_nop 7
v_mov_b32 v168, v46
v_mov_b32 v169, v46
v_mov_b32 v170, v46
v_mov_b32 v171, v46
v_mov_b32 v172, v46
v_mov_b32 v173, v46
v_mov_b32 v174, v46
v_mov_b32 v175, v46
v_mov_b32 v176, v46
v_mov_b32 v177, v46
v_mov_b32 v178, v46
v_mov_b32 v179, v46
v_mov_b32 v180, v46
v_mov_b32 v181, v46
v_mov_b32 v182, v46
v_mov_b32 v183, v46
s_branch L_bv6
s_endpgm
.section .rodata,"a"
.p2align 6
.amdhsa_kernel concat_heads__memory_aug_recurrent_mem_tr__sliding_block__prompt_kernel
  .amdhsa_next_free_vgpr 512
  .amdhsa_next_free_sgpr 102
  .amdhsa_accum_offset 256
  .amdhsa_group_segment_fixed_size 0
  .amdhsa_kernarg_size 104
  .amdhsa_user_sgpr_count 2
  .amdhsa_user_sgpr_kernarg_segment_ptr 1
  .amdhsa_system_sgpr_workgroup_id_x 1
.end_amdhsa_kernel
.text
```
